```python
import torch

def _softmax(x, axis=-1):
    return torch.softmax(x, dim=axis)
def _gelu(x):
    return torch.nn.functional.gelu(x, approximate="tanh")
def _silu(x):
    return torch.nn.functional.silu(x)
def _sigmoid(x):
    return torch.sigmoid(x)
def _layernorm(x, axis=-1, eps=1e-5):
    m = x.mean(dim=axis, keepdim=True)
    v = x.var(dim=axis, keepdim=True, unbiased=False)
    return (x - m) / torch.sqrt(v + eps)
def _scatter_add(tgt, idx, src, axis=0):
    return tgt.clone().index_add_(axis, idx, src)
def _segment_sum(src, seg, n):
    out = torch.zeros((n,) + src.shape[1:], dtype=src.dtype)
    return out.index_add_(0, seg, src)
def _pad(x, pw):
    flat = tuple(v for pair in reversed(pw) for v in pair)
    return torch.nn.functional.pad(x, flat)

kernel_name = 'interleave_layers__ssm_conv_h3__glu_gated_bilinear__prompt'

def setup_inputs():

    _w = (lambda a: (lambda t: t.to(torch.bfloat16) if t.is_floating_point() else t)(torch.as_tensor(a)))
    def _A_setup():
        B, S, D = 1, 2048, 1024
        ks = 4
        return {
            "q": _w((lambda *s: torch.randn(*s, dtype=torch.bfloat16) * 0.05)(B, S, D)),
            "k": _w((lambda *s: torch.randn(*s, dtype=torch.bfloat16) * 0.2)(B, S, D)),
            "v": _w((lambda *s: torch.randn(*s, dtype=torch.bfloat16) * 0.2)(B, S, D)),
            "shift_k": _w((lambda *s: torch.randn(*s, dtype=torch.bfloat16) * 0.2)(D, ks) * 0.5),
            "ssm_k": _w((lambda *s: torch.randn(*s, dtype=torch.bfloat16) * 0.4)(D, S) * (1.0 / S ** 0.5)),
            "ssm_D": _w((lambda *s: torch.randn(*s, dtype=torch.bfloat16) * 0.2)(D)),
        }
    _A_in = _A_setup()

    def _B_setup():
        B, S, D, F = 1, 2048, 1024, 3584
        return {
            "x": _w((lambda *s: torch.randn(*s, dtype=torch.bfloat16) * 0.05)(B, S, D)),
            "w_gate": _w((lambda *s: torch.randn(*s, dtype=torch.bfloat16) * 0.4)(D, F) * (D ** -0.5)),
            "w_up": _w((lambda *s: torch.randn(*s, dtype=torch.bfloat16) * 0.4)(D, F) * (D ** -0.5)),
            "w_down": _w((lambda *s: torch.randn(*s, dtype=torch.bfloat16) * 0.4)(F, D) * (F ** -0.5)),
        }
    _B_in = _B_setup()

    return {
        "A_q": _A_in["q"],
        "A_k": _A_in["k"],
        "A_v": _A_in["v"],
        "A_shift_k": _A_in["shift_k"],
        "A_ssm_k": _A_in["ssm_k"],
        "A_ssm_D": _A_in["ssm_D"],
        "B_x": _B_in["x"],
        "B_w_gate": _B_in["w_gate"],
        "B_w_up": _B_in["w_up"],
        "B_w_down": _B_in["w_down"],
    }

def reference(A_q, A_k, A_v, A_shift_k, A_ssm_k, A_ssm_D, B_x, B_w_gate, B_w_up, B_w_down):
    def _A_ref(q, k, v, shift_k, ssm_k, ssm_D):
        B, S, D = q.shape
        ks = shift_k.shape[-1]
        k_pad = _pad(k, ((0, 0), (ks - 1, 0), (0, 0)))
        k_shift = torch.zeros_like(k)
        for t in range(ks):
            k_shift = k_shift + k_pad[:, t:t + S, :] * shift_k[:, ks - 1 - t][None, None, :]
        kv = k_shift * v
        L = 2 * S
        kv_pad = _pad(kv, ((0, 0), (0, S), (0, 0)))
        kf_pad = _pad(ssm_k, ((0, 0), (0, S)))
        kv_f = (lambda x, axes=(-2,-1): torch.fft.rfft2(x.float(), dim=axes))(kv_pad[:, None, :, :], axes=(1, 2))
        kf_f = (lambda x, axes=(-2,-1): torch.fft.rfft2(x.float(), dim=axes))(kf_pad[:, None, :], axes=(1, 2))
        kf_f = (lambda x, *d: x.permute(*d))(kf_f, 1, 2, 0)
        y_f = kv_f * kf_f[None, :, :, :]
        y = (lambda x, s, axes=(-2,-1): torch.fft.irfft2(x, s=s, dim=axes).to(torch.bfloat16))(y_f, (1, L), axes=(1, 2))[:, 0, :S, :]
        y = y + kv * ssm_D[None, None, :]
        return q * y

    def _B_ref(x, w_gate, w_up, w_down):
        g = torch.einsum("bsd,df->bsf", x, w_gate)
        u = torch.einsum("bsd,df->bsf", x, w_up)
        h = g * u
        return torch.einsum("bsf,fd->bsd", h, w_down)

    x = A_q
    x = x + _A_ref(_layernorm(x, axis=-1), A_k, A_v, A_shift_k, A_ssm_k, A_ssm_D)
    x = x + _B_ref(_layernorm(x, axis=-1), B_w_gate, B_w_up, B_w_down)
    x = x + _A_ref(_layernorm(x, axis=-1), A_k, A_v, A_shift_k, A_ssm_k, A_ssm_D)
    x = x + _B_ref(_layernorm(x, axis=-1), B_w_gate, B_w_up, B_w_down)
    return x
```

```asm
; @launch grid=(256,1,1) block=(256,1,1) lds=160768
.amdgcn_target "amdgcn-amd-amdhsa--gfx950"

.text
.globl interleave_layers__ssm_conv_h3__glu_gated_bilinear__prompt_kernel
.p2align 8
.type interleave_layers__ssm_conv_h3__glu_gated_bilinear__prompt_kernel,@function
interleave_layers__ssm_conv_h3__glu_gated_bilinear__prompt_kernel:
    s_cmp_ge_u32 s2, 256
    s_cbranch_scc1 L_end
    s_load_dwordx2 s[52:53], s[0:1], 8
    s_load_dwordx2 s[8:9], s[0:1], 96
    s_load_dwordx2 s[56:57], s[0:1], 16
    s_load_dwordx2 s[60:61], s[0:1], 24
    s_load_dwordx2 s[48:49], s[0:1], 88
    s_load_dwordx2 s[36:37], s[0:1], 0
    s_load_dwordx2 s[32:33], s[0:1], 32
    v_lshrrev_b32 v2, 6, v0
    v_and_b32 v3, 63, v0
    v_readfirstlane_b32 s4, v2
    v_lshlrev_b32 v1, 4, v3
    s_mov_b32 s94, 0
    s_getpc_b64 s[28:29]
L_pc:
    s_lshr_b32 s5, s2, 3
    s_lshl_b32 s5, s5, 2
    s_add_u32 s5, s5, s4
    s_mul_i32 s5, s5, 10
    v_min_u32 v9, 9, v3
    v_add_u32 v9, s5, v9
    v_lshlrev_b32 v9, 6, v9
    v_min_u32 v9, L_end-L_pc, v9
    v_accvgpr_write_b32 a201, v9
    global_load_dword a200, v9, s[28:29]
    s_mov_b32 s10, 268435456
    s_mov_b32 s11, 0x20000
    s_mov_b32 s54, 4194304
    s_mov_b32 s55, 0x20000
    s_mov_b32 s58, 4194304
    s_mov_b32 s59, 0x20000
    s_mov_b32 s62, 8192
    s_mov_b32 s63, 0x20000
    s_lshr_b32 s7, s2, 3
    s_and_b32 s6, s7, 15
    s_add_u32 s5, s2, s7
    s_lshl_b32 s5, s5, 1
    s_lshr_b32 s7, s7, 4
    s_add_u32 s5, s5, s7
    s_and_b32 s5, s5, 15
    v_lshrrev_b32 v10, 4, v0
    v_and_b32 v11, 15, v0
    s_lshl_b32 s7, s5, 4
    v_add_u32 v12, s7, v10
    v_lshlrev_b32 v13, 14, v12
    s_lshl_b32 s7, s6, 7
    v_lshl_add_u32 v14, v11, 3, s7
    v_add_u32 v13, v13, v14
    v_subrev_u32 v15, 6144, v13
    v_cmp_eq_u32 vcc, 0, v12
    v_bfrev_b32 v16, 1
    v_lshlrev_b32 v17, 2, v14
    v_cndmask_b32 v15, v15, v16, vcc
    s_movk_i32 s64, 4096
    s_movk_i32 s65, 8192
    s_movk_i32 s66, 12288
    s_waitcnt lgkmcnt(0)
    s_lshl_b32 s3, s4, 8
    s_add_u32 s3, s3, s2
    s_cmp_ge_u32 s3, 4
    s_cbranch_scc1 L_noclr
    v_mov_b32 v24, 0
    v_mov_b32 v25, 0
    v_mov_b32 v26, 0
    v_mov_b32 v27, 0
    v_and_b32 v21, 63, v3
    v_lshlrev_b32 v21, 7, v21
    s_mul_i32 s3, s2, 8192
    s_add_u32 s3, s3, 20971520
    buffer_store_dwordx4 v[24:27], v21, s[8:11], s3 offen sc1
L_noclr:
    buffer_load_dwordx4 v[72:75], v17, s[60:63], 0 offen
    buffer_load_dwordx4 v[76:79], v17, s[60:63], 0 offen offset:16
    buffer_load_dwordx2 v[32:33], v15, s[52:55], 0 offen offset:0 nt
    buffer_load_dwordx2 v[34:35], v15, s[52:55], 0 offen offset:2048 nt
    buffer_load_dwordx2 v[36:37], v15, s[52:55], s64 offen offset:0 nt
    buffer_load_dwordx2 v[38:39], v13, s[52:55], 0 offen offset:0 nt
    buffer_load_dwordx2 v[54:55], v13, s[56:59], 0 offen offset:0 nt
    buffer_load_dwordx2 v[40:41], v13, s[52:55], 0 offen offset:2048 nt
    buffer_load_dwordx2 v[56:57], v13, s[56:59], 0 offen offset:2048 nt
    buffer_load_dwordx2 v[42:43], v13, s[52:55], s64 offen offset:0 nt
    buffer_load_dwordx2 v[58:59], v13, s[56:59], s64 offen offset:0 nt
    buffer_load_dwordx2 v[44:45], v13, s[52:55], s64 offen offset:2048 nt
    buffer_load_dwordx2 v[60:61], v13, s[56:59], s64 offen offset:2048 nt
    buffer_load_dwordx2 v[46:47], v13, s[52:55], s65 offen offset:0 nt
    buffer_load_dwordx2 v[62:63], v13, s[56:59], s65 offen offset:0 nt
    buffer_load_dwordx2 v[48:49], v13, s[52:55], s65 offen offset:2048 nt
    buffer_load_dwordx2 v[64:65], v13, s[56:59], s65 offen offset:2048 nt
    buffer_load_dwordx2 v[50:51], v13, s[52:55], s66 offen offset:0 nt
    buffer_load_dwordx2 v[66:67], v13, s[56:59], s66 offen offset:0 nt
    buffer_load_dwordx2 v[52:53], v13, s[52:55], s66 offen offset:2048 nt
    buffer_load_dwordx2 v[68:69], v13, s[56:59], s66 offen offset:2048 nt
    s_mov_b32 s42, 7340032
    s_mov_b32 s43, 0x20000
    s_mov_b32 s46, 7340032
    s_mov_b32 s47, 0x20000
    s_mov_b32 s50, 256
    s_mov_b32 s51, 0x20000
    s_mov_b32 s34, 4194304
    s_mov_b32 s35, 0x20000
    s_mov_b32 s38, 4194304
    s_mov_b32 s39, 0x20000
    s_and_b32 s5, s2, 7
    s_lshr_b32 s6, s2, 3
    s_lshl_b32 s84, s5, 5
    s_add_u32 s84, s84, s6
    s_mov_b32 s85, 0
    s_mov_b32 s86, 0
    s_lshl_b32 s101, s2, 7
    s_add_u32 s101, s101, 20971520
    s_mov_b64 s[74:75], s[28:29]
    s_cmp_ge_u32 s2, 4
    s_cbranch_scc1 L_nordy
    s_mul_i32 s3, s2, 64
    s_waitcnt vmcnt(21)
    s_cmp_lg_u32 s4, 0
    s_cbranch_scc1 L_nordy
    s_mov_b64 exec, 1
    v_mov_b32 v28, 0
    v_mov_b32 v29, 1
    buffer_store_dword v29, v28, s[48:51], s3 offen sc1
    s_mov_b64 exec, -1
L_nordy:
    s_load_dwordx2 s[88:89], s[0:1], 40
    s_load_dwordx4 s[76:79], s[0:1], 56
    s_load_dwordx2 s[44:45], s[0:1], 72
    s_waitcnt lgkmcnt(0)
    s_lshl_b32 s5, s2, 2
    s_add_u32 s5, s5, s4
    s_and_b32 s6, s5, -2
    s_lshl_b32 s6, s6, 1
    s_load_dword s87, s[88:89], s6
    s_mul_i32 s95, s5, 4096
    s_add_u32 s95, s95, 23068672
    s_lshl_b32 s15, s4, 14
    s_add_u32 s15, s15, 65536
    s_and_b32 s5, s2, 7
    s_lshr_b32 s6, s2, 3
    s_and_b32 s12, s6, 3
    s_lshr_b32 s13, s6, 2
    s_and_b32 s7, s5, 1
    s_lshl_b32 s7, s7, 2
    s_add_u32 s96, s12, s7
    s_lshr_b32 s7, s5, 1
    s_lshl_b32 s7, s7, 3
    s_add_u32 s97, s13, s7
    s_and_b32 s7, s5, 3
    s_lshl_b32 s7, s7, 2
    s_add_u32 s98, s12, s7
    s_mov_b32 s99, s13
    s_lshr_b32 s100, s5, 2
    s_mov_b32 s19, s96
    s_and_b32 s7, s5, 1
    s_xor_b32 s7, s7, 1
    s_lshl_b32 s7, s7, 1
    s_bfe_u32 s3, s5, 0x10001
    s_add_u32 s7, s7, s3
    s_lshl_b32 s98, s7, 2
    s_add_u32 s98, s98, s12
    s_lshl_b32 s7, s7, 1
    s_add_u32 s7, s7, s100
    s_lshl_b32 s84, s7, 5
    s_add_u32 s84, s84, s6
    s_lshr_b32 s18, s96, 1
    s_bfe_u32 s3, s18, 0x10001
    s_xor_b32 s3, s3, 1
    s_and_b32 s19, s18, 1
    s_lshl_b32 s19, s19, 1
    s_add_u32 s19, s19, s3
    s_and_b32 s7, s96, 1
    s_lshl_b32 s7, s7, 2
    s_add_u32 s19, s19, s7
    s_cmp_lt_u32 s4, 2
    s_cselect_b32 s40, s76, s78
    s_cselect_b32 s41, s77, s79
    s_mul_i32 s80, s97, 224
    s_and_b32 s7, s4, 1
    s_mul_i32 s7, s7, 229376
    s_add_u32 s80, s80, s7
    s_mul_i32 s82, s4, 7168
    s_lshl_b32 s81, s99, 8
    s_mul_i32 s7, s100, 3670016
    s_add_u32 s81, s81, s7
    s_mul_i32 s7, s4, 7
    s_add_u32 s12, s7, 3
    s_lshl_b32 s12, s12, 16
    s_add_u32 s73, s81, s12
    s_add_u32 s7, s7, 1
    s_lshr_b32 s7, s7, 1
    s_lshl_b32 s7, s7, 16
    s_add_u32 s81, s81, s7
    s_lshl_b32 s83, s4, 13
    v_and_b32 v4, 7, v3
    v_bfe_u32 v5, v3, 3, 1
    s_lshr_b32 s7, s2, 4
    s_lshl_b32 s7, s7, 3
    v_lshl_add_u32 v6, v5, 7, v4
    v_add_lshl_u32 v6, v6, s7, 7
    v_accvgpr_write_b32 a207, v6
    s_lshl_b32 s7, s4, 3
    v_or_b32 v6, s7, v4
    v_lshlrev_b32 v6, 3, v6
    v_add_lshl_u32 v6, v6, s19, 7
    s_lshr_b32 s7, s5, 1
    s_add_u32 s7, s7, 1
    s_lshl_b32 s7, s7, 15
    v_accvgpr_write_b32 a204, v6
    s_lshr_b32 s12, s98, 1
    s_and_b32 s13, s12, 3
    s_lshl_b32 s13, s13, 3
    s_lshr_b32 s12, s12, 2
    s_add_u32 s12, s12, s13
    s_lshl_b32 s13, s100, 2
    s_add_u32 s12, s12, s13
    v_lshlrev_b32 v6, 5, v4
    v_lshl_add_u32 v7, v5, 1, v6
    v_add_lshl_u32 v7, v7, s12, 7
    s_cmp_eq_u32 s4, 0
    s_cselect_b32 s12, 0, 0x80000000
    v_or_b32 v7, s12, v7
    v_accvgpr_write_b32 a205, v7
    s_lshr_b32 s12, s84, 4
    s_and_b32 s13, s12, 3
    s_lshl_b32 s13, s13, 3
    s_lshr_b32 s12, s12, 2
    s_and_b32 s12, s5, 3
    s_add_u32 s12, s12, s13
    v_lshl_add_u32 v7, v5, 2, v6
    v_add_lshl_u32 v7, v7, s12, 7
    s_bfe_u32 s13, s98, 0x10001
    s_lshl_b32 s13, s13, 2
    s_and_b32 s3, s5, 3
    s_add_u32 s13, s13, s3
    s_and_b32 s3, s98, 1
    s_lshl_b32 s3, s3, 7
    s_add_u32 s13, s13, s3
    v_and_b32 v8, 15, v3
    v_lshlrev_b32 v8, 3, v8
    v_add_lshl_u32 v8, v8, s13, 7
    v_accvgpr_read_b32 v6, a205
    v_cmp_gt_u32 vcc, 16, v3
    s_cmp_eq_u32 s4, 0
    s_cselect_b32 s13, 0, 0x80000000
    v_cndmask_b32 v8, v8, v6, vcc
    v_or_b32 v8, s13, v8
    v_accvgpr_write_b32 a203, v8
    s_and_b32 s13, s4, 1
    s_lshl_b32 s13, s13, 2
    s_add_u32 s12, s12, s13
    s_lshr_b32 s13, s4, 1
    s_lshl_b32 s13, s13, 5
    s_add_u32 s12, s12, s13
    v_and_b32 v7, 3, v3
    v_lshlrev_b32 v7, 6, v7
    v_add_lshl_u32 v7, v7, s12, 7
    v_accvgpr_write_b32 a206, v7
    s_and_b32 s7, s97, 1
    s_lshl_b32 s7, s7, 1
    s_and_b32 s7, s97, 1
    s_lshl_b32 s7, s7, 1
    v_add_u32 v4, 0, v3
    v_mul_u32_u24 v5, 4682, v4
    v_lshrrev_b32 v5, 16, v5
    v_mul_u32_u24 v6, 14, v5
    v_sub_u32 v6, v4, v6
    v_add_u32 v6, s7, v6
    v_subrev_u32 v7, 14, v6
    v_min_u32 v6, v6, v7
    v_bfe_u32 v7, v5, 2, 2
    v_lshlrev_b32 v7, 3, v7
    v_and_or_b32 v7, v5, 3, v7
    v_lshrrev_b32 v4, 4, v5
    v_lshl_add_u32 v4, v4, 2, v7
    v_mul_u32_u24 v4, 7168, v4
    v_lshl_add_u32 v4, v6, 4, v4
    v_subrev_u32 v4, 0, v4
    v_add_u32 v4, s80, v4
    v_accvgpr_write_b32 a208, v4
    v_add_u32 v4, 64, v3
    v_mul_u32_u24 v5, 4682, v4
    v_lshrrev_b32 v5, 16, v5
    v_mul_u32_u24 v6, 14, v5
    v_sub_u32 v6, v4, v6
    v_add_u32 v6, s7, v6
    v_subrev_u32 v7, 14, v6
    v_min_u32 v6, v6, v7
    v_bfe_u32 v7, v5, 2, 2
    v_lshlrev_b32 v7, 3, v7
    v_and_or_b32 v7, v5, 3, v7
    v_lshrrev_b32 v4, 4, v5
    v_lshl_add_u32 v4, v4, 2, v7
    v_mul_u32_u24 v4, 7168, v4
    v_lshl_add_u32 v4, v6, 4, v4
    v_subrev_u32 v4, 1024, v4
    v_add_u32 v4, s80, v4
    v_accvgpr_write_b32 a209, v4
    v_add_u32 v4, 128, v3
    v_mul_u32_u24 v5, 4682, v4
    v_lshrrev_b32 v5, 16, v5
    v_mul_u32_u24 v6, 14, v5
    v_sub_u32 v6, v4, v6
    v_add_u32 v6, s7, v6
    v_subrev_u32 v7, 14, v6
    v_min_u32 v6, v6, v7
    v_bfe_u32 v7, v5, 2, 2
    v_lshlrev_b32 v7, 3, v7
    v_and_or_b32 v7, v5, 3, v7
    v_lshrrev_b32 v4, 4, v5
    v_lshl_add_u32 v4, v4, 2, v7
    v_mul_u32_u24 v4, 7168, v4
    v_lshl_add_u32 v4, v6, 4, v4
    v_subrev_u32 v4, 2048, v4
    v_add_u32 v4, s80, v4
    v_accvgpr_write_b32 a210, v4
    v_add_u32 v4, 192, v3
    v_mul_u32_u24 v5, 4682, v4
    v_lshrrev_b32 v5, 16, v5
    v_mul_u32_u24 v6, 14, v5
    v_sub_u32 v6, v4, v6
    v_add_u32 v6, s7, v6
    v_subrev_u32 v7, 14, v6
    v_min_u32 v6, v6, v7
    v_bfe_u32 v7, v5, 2, 2
    v_lshlrev_b32 v7, 3, v7
    v_and_or_b32 v7, v5, 3, v7
    v_lshrrev_b32 v4, 4, v5
    v_lshl_add_u32 v4, v4, 2, v7
    v_mul_u32_u24 v4, 7168, v4
    v_lshl_add_u32 v4, v6, 4, v4
    v_subrev_u32 v4, 3072, v4
    v_add_u32 v4, s80, v4
    v_accvgpr_write_b32 a211, v4
    v_add_u32 v4, 256, v3
    v_mul_u32_u24 v5, 4682, v4
    v_lshrrev_b32 v5, 16, v5
    v_mul_u32_u24 v6, 14, v5
    v_sub_u32 v6, v4, v6
    v_add_u32 v6, s7, v6
    v_subrev_u32 v7, 14, v6
    v_min_u32 v6, v6, v7
    v_bfe_u32 v7, v5, 2, 2
    v_lshlrev_b32 v7, 3, v7
    v_and_or_b32 v7, v5, 3, v7
    v_lshrrev_b32 v4, 4, v5
    v_lshl_add_u32 v4, v4, 2, v7
    v_mul_u32_u24 v4, 7168, v4
    v_lshl_add_u32 v4, v6, 4, v4
    v_subrev_u32 v4, 0, v4
    v_add_u32 v4, s80, v4
    v_accvgpr_write_b32 a212, v4
    v_add_u32 v4, 320, v3
    v_mul_u32_u24 v5, 4682, v4
    v_lshrrev_b32 v5, 16, v5
    v_mul_u32_u24 v6, 14, v5
    v_sub_u32 v6, v4, v6
    v_add_u32 v6, s7, v6
    v_subrev_u32 v7, 14, v6
    v_min_u32 v6, v6, v7
    v_bfe_u32 v7, v5, 2, 2
    v_lshlrev_b32 v7, 3, v7
    v_and_or_b32 v7, v5, 3, v7
    v_lshrrev_b32 v4, 4, v5
    v_lshl_add_u32 v4, v4, 2, v7
    v_mul_u32_u24 v4, 7168, v4
    v_lshl_add_u32 v4, v6, 4, v4
    v_subrev_u32 v4, 1024, v4
    v_add_u32 v4, s80, v4
    v_accvgpr_write_b32 a213, v4
    v_add_u32 v4, 384, v3
    v_mul_u32_u24 v5, 4682, v4
    v_lshrrev_b32 v5, 16, v5
    v_mul_u32_u24 v6, 14, v5
    v_sub_u32 v6, v4, v6
    v_add_u32 v6, s7, v6
    v_subrev_u32 v7, 14, v6
    v_min_u32 v6, v6, v7
    v_bfe_u32 v7, v5, 2, 2
    v_lshlrev_b32 v7, 3, v7
    v_and_or_b32 v7, v5, 3, v7
    v_lshrrev_b32 v4, 4, v5
    v_lshl_add_u32 v4, v4, 2, v7
    v_mul_u32_u24 v4, 7168, v4
    v_lshl_add_u32 v4, v6, 4, v4
    v_subrev_u32 v4, 2048, v4
    v_add_u32 v4, s80, v4
    v_accvgpr_write_b32 a214, v4
    v_lshrrev_b32 v5, 4, v3
    v_and_b32 v7, 15, v3
    v_lshlrev_b32 v6, 1, v5
    v_xor_b32 v6, v6, v7
    v_lshlrev_b32 v5, 11, v5
    v_lshl_add_u32 v4, v6, 4, v5
    s_lshl_b32 s7, s100, 7
    v_xor_b32 v4, s7, v4
    v_xor_b32 v5, 0x80, v4
    v_add_u32 v4, s81, v4
    v_add_u32 v5, s81, v5
    s_sub_u32 s73, s73, s81
    v_add_u32 v6, 0, v4
    v_accvgpr_write_b32 a215, v6
    v_add_u32 v6, 15360, v5
    v_accvgpr_write_b32 a216, v6
    v_add_u32 v6, 30720, v4
    v_accvgpr_write_b32 a217, v6
    v_add_u32 v6, 46080, v5
    v_accvgpr_write_b32 a218, v6
    v_add_u32 v6, 8192, v4
    v_accvgpr_write_b32 a219, v6
    v_add_u32 v6, 23552, v5
    v_accvgpr_write_b32 a220, v6
    v_add_u32 v6, 38912, v4
    v_accvgpr_write_b32 a221, v6
    v_add_u32 v6, 54272, v5
    v_accvgpr_write_b32 a222, v6
    v_and_b32 v24, 15, v3
    v_lshrrev_b32 v25, 4, v3
    v_lshlrev_b32 v26, 1, v24
    v_lshlrev_b32 v27, 4, v25
    v_sub_u32 v26, v26, v27
    v_and_b32 v28, 1, v24
    v_cmp_eq_u32 vcc, 0, v28
    v_mov_b32 v29, 4162
    s_add_u32 s7, s15, 50
    v_cndmask_b32 v28, 0, v29, vcc
    v_add3_u32 v232, v26, v28, s7
    v_add_u32 v233, 1024, v232
    v_add_u32 v234, 2048, v232
    v_add_u32 v235, 3072, v232
    v_lshl_add_u32 v27, v24, 5, v27
    s_add_u32 s7, s15, 8480
    v_add_u32 v236, s7, v27
    v_add_u32 v237, s15, v1
    v_and_b32 v26, 1, v3
    v_lshlrev_b32 v26, 4, v26
    v_cmp_gt_u32 vcc, 34, v3
    v_add_u32 v27, 4160, v26
    v_add_u32 v28, 8448, v1
    v_cndmask_b32 v26, v27, v26, vcc
    v_cmp_gt_u32 vcc, 32, v3
    v_mov_b32 v240, 0
    v_mov_b32 v241, 0
    v_cndmask_b32 v26, v26, v28, vcc
    v_mov_b32 v242, 0
    v_mov_b32 v243, 0
    v_add_u32 v26, s15, v26
    ds_write_b128 v26, v[240:243]
    v_lshlrev_b32 v27, 3, v25
    v_sub_u32 v27, v27, v24
    v_subrev_u32 v27, 9, v27
    s_and_b32 s6, s4, 1
    s_lshl_b32 s6, s6, 4
    v_and_b32 v28, 1, v27
    v_lshlrev_b32 v28, 4, v28
    v_ashrrev_i32 v27, 1, v27
    s_waitcnt lgkmcnt(0)
    s_lshr_b32 s14, s87, s6
    s_and_b32 s14, s14, 0xffff
    v_lshlrev_b32 v28, v28, s14
    v_cmp_eq_u32 s[20:21], 0, v27
    v_cmp_eq_u32 s[22:23], 1, v27
    v_cmp_eq_u32 s[24:25], 2, v27
    v_cmp_eq_u32 s[26:27], 3, v27
    v_cndmask_b32 v240, 0, v28, s[20:21]
    v_cndmask_b32 v241, 0, v28, s[22:23]
    v_cndmask_b32 v242, 0, v28, s[24:25]
    v_cndmask_b32 v243, 0, v28, s[26:27]
    v_and_b32 v26, 1, v25
    v_lshrrev_b32 v27, 1, v25
    v_lshlrev_b32 v26, 9, v26
    v_lshl_add_u32 v26, v27, 4, v26
    v_lshl_add_u32 v26, v24, 5, v26
    s_mul_i32 s7, s4, 4224
    v_add_u32 v238, s7, v26
    v_bfe_u32 v26, v3, 2, 2
    v_and_b32 v27, 3, v3
    v_mul_u32_u24 v26, 4224, v26
    v_lshl_add_u32 v26, v27, 4, v26
    v_lshrrev_b32 v27, 4, v0
    v_lshl_add_u32 v26, v27, 6, v26
    v_add_u32 v239, 0, v26
    s_mov_b32 s87, 20971520
    v_subrev_u32 v24, 4, v1
    v_cmp_eq_u32 vcc, 0, v3
    v_bfrev_b32 v25, 1
    v_add_u32 v26, 1020, v1
    s_lshl_b32 s12, s2, 2
    s_add_u32 s12, s12, s4
    s_lshl_b32 s12, s12, 12
    v_cndmask_b32 v24, v24, v25, vcc
    v_mul_u32_u24 v18, 2048, v14
    v_lshl_add_u32 v18, v12, 4, v18
    s_mov_b32 s67, 23068672
    s_mov_b32 s68, 23072768
    s_mov_b32 s69, 23076864
    s_mov_b32 s70, 23080960
    s_waitcnt vmcnt(19)
    v_lshlrev_b32 v80, 16, v72
    v_and_b32 v84, 0xffff0000, v72
    v_lshlrev_b32 v88, 16, v73
    v_and_b32 v92, 0xffff0000, v73
    v_lshlrev_b32 v81, 16, v74
    v_and_b32 v85, 0xffff0000, v74
    v_lshlrev_b32 v89, 16, v75
    v_and_b32 v93, 0xffff0000, v75
    v_lshlrev_b32 v82, 16, v76
    v_and_b32 v86, 0xffff0000, v76
    v_lshlrev_b32 v90, 16, v77
    v_and_b32 v94, 0xffff0000, v77
    v_lshlrev_b32 v83, 16, v78
    v_and_b32 v87, 0xffff0000, v78
    v_lshlrev_b32 v91, 16, v79
    v_and_b32 v95, 0xffff0000, v79
    s_waitcnt vmcnt(18)
    v_lshlrev_b32 v96, 16, v32
    v_and_b32 v97, 0xffff0000, v32
    v_lshlrev_b32 v98, 16, v33
    v_and_b32 v99, 0xffff0000, v33
    s_waitcnt vmcnt(17)
    v_lshlrev_b32 v100, 16, v34
    v_and_b32 v101, 0xffff0000, v34
    v_lshlrev_b32 v102, 16, v35
    v_and_b32 v103, 0xffff0000, v35
    s_waitcnt vmcnt(16)
    v_lshlrev_b32 v104, 16, v36
    v_and_b32 v105, 0xffff0000, v36
    v_lshlrev_b32 v106, 16, v37
    v_and_b32 v107, 0xffff0000, v37
    s_waitcnt vmcnt(14)
    v_lshlrev_b32 v108, 16, v38
    v_and_b32 v109, 0xffff0000, v38
    v_lshlrev_b32 v110, 16, v39
    v_and_b32 v111, 0xffff0000, v39
    v_lshlrev_b32 v140, 16, v54
    v_and_b32 v141, 0xffff0000, v54
    v_lshlrev_b32 v142, 16, v55
    v_and_b32 v143, 0xffff0000, v55
    v_pk_mul_f32 v[20:21], v[96:97], v[92:93]
    v_pk_mul_f32 v[22:23], v[98:99], v[94:95]
    v_pk_fma_f32 v[20:21], v[100:101], v[88:89], v[20:21]
    v_pk_fma_f32 v[22:23], v[102:103], v[90:91], v[22:23]
    v_pk_fma_f32 v[20:21], v[104:105], v[84:85], v[20:21]
    v_pk_fma_f32 v[22:23], v[106:107], v[86:87], v[22:23]
    v_pk_fma_f32 v[20:21], v[108:109], v[80:81], v[20:21]
    v_pk_fma_f32 v[22:23], v[110:111], v[82:83], v[22:23]
    v_pk_mul_f32 v[140:141], v[20:21], v[140:141]
    v_pk_mul_f32 v[142:143], v[22:23], v[142:143]
    s_waitcnt vmcnt(12)
    v_lshlrev_b32 v112, 16, v40
    v_and_b32 v113, 0xffff0000, v40
    v_lshlrev_b32 v114, 16, v41
    v_and_b32 v115, 0xffff0000, v41
    v_lshlrev_b32 v144, 16, v56
    v_and_b32 v145, 0xffff0000, v56
    v_lshlrev_b32 v146, 16, v57
    v_and_b32 v147, 0xffff0000, v57
    v_pk_mul_f32 v[20:21], v[100:101], v[92:93]
    v_pk_mul_f32 v[22:23], v[102:103], v[94:95]
    v_pk_fma_f32 v[20:21], v[104:105], v[88:89], v[20:21]
    v_pk_fma_f32 v[22:23], v[106:107], v[90:91], v[22:23]
    v_pk_fma_f32 v[20:21], v[108:109], v[84:85], v[20:21]
    v_pk_fma_f32 v[22:23], v[110:111], v[86:87], v[22:23]
    v_pk_fma_f32 v[20:21], v[112:113], v[80:81], v[20:21]
    v_pk_fma_f32 v[22:23], v[114:115], v[82:83], v[22:23]
    v_pk_mul_f32 v[144:145], v[20:21], v[144:145]
    v_pk_mul_f32 v[146:147], v[22:23], v[146:147]
    s_waitcnt vmcnt(10)
    v_lshlrev_b32 v116, 16, v42
    v_and_b32 v117, 0xffff0000, v42
    v_lshlrev_b32 v118, 16, v43
    v_and_b32 v119, 0xffff0000, v43
    v_lshlrev_b32 v148, 16, v58
    v_and_b32 v149, 0xffff0000, v58
    v_lshlrev_b32 v150, 16, v59
    v_and_b32 v151, 0xffff0000, v59
    v_pk_mul_f32 v[20:21], v[104:105], v[92:93]
    v_pk_mul_f32 v[22:23], v[106:107], v[94:95]
    v_pk_fma_f32 v[20:21], v[108:109], v[88:89], v[20:21]
    v_pk_fma_f32 v[22:23], v[110:111], v[90:91], v[22:23]
    v_pk_fma_f32 v[20:21], v[112:113], v[84:85], v[20:21]
    v_pk_fma_f32 v[22:23], v[114:115], v[86:87], v[22:23]
    v_pk_fma_f32 v[20:21], v[116:117], v[80:81], v[20:21]
    v_pk_fma_f32 v[22:23], v[118:119], v[82:83], v[22:23]
    v_pk_mul_f32 v[148:149], v[20:21], v[148:149]
    v_pk_mul_f32 v[150:151], v[22:23], v[150:151]
    s_waitcnt vmcnt(8)
    v_lshlrev_b32 v120, 16, v44
    v_and_b32 v121, 0xffff0000, v44
    v_lshlrev_b32 v122, 16, v45
    v_and_b32 v123, 0xffff0000, v45
    v_lshlrev_b32 v152, 16, v60
    v_and_b32 v153, 0xffff0000, v60
    v_lshlrev_b32 v154, 16, v61
    v_and_b32 v155, 0xffff0000, v61
    v_pk_mul_f32 v[20:21], v[108:109], v[92:93]
    v_pk_mul_f32 v[22:23], v[110:111], v[94:95]
    v_pk_fma_f32 v[20:21], v[112:113], v[88:89], v[20:21]
    v_pk_fma_f32 v[22:23], v[114:115], v[90:91], v[22:23]
    v_pk_fma_f32 v[20:21], v[116:117], v[84:85], v[20:21]
    v_pk_fma_f32 v[22:23], v[118:119], v[86:87], v[22:23]
    v_pk_fma_f32 v[20:21], v[120:121], v[80:81], v[20:21]
    v_pk_fma_f32 v[22:23], v[122:123], v[82:83], v[22:23]
    v_pk_mul_f32 v[152:153], v[20:21], v[152:153]
    v_pk_mul_f32 v[154:155], v[22:23], v[154:155]
    s_waitcnt vmcnt(6)
    v_lshlrev_b32 v124, 16, v46
    v_and_b32 v125, 0xffff0000, v46
    v_lshlrev_b32 v126, 16, v47
    v_and_b32 v127, 0xffff0000, v47
    v_lshlrev_b32 v156, 16, v62
    v_and_b32 v157, 0xffff0000, v62
    v_lshlrev_b32 v158, 16, v63
    v_and_b32 v159, 0xffff0000, v63
    v_pk_mul_f32 v[20:21], v[112:113], v[92:93]
    v_pk_mul_f32 v[22:23], v[114:115], v[94:95]
    v_pk_fma_f32 v[20:21], v[116:117], v[88:89], v[20:21]
    v_pk_fma_f32 v[22:23], v[118:119], v[90:91], v[22:23]
    v_pk_fma_f32 v[20:21], v[120:121], v[84:85], v[20:21]
    v_pk_fma_f32 v[22:23], v[122:123], v[86:87], v[22:23]
    v_pk_fma_f32 v[20:21], v[124:125], v[80:81], v[20:21]
    v_pk_fma_f32 v[22:23], v[126:127], v[82:83], v[22:23]
    v_pk_mul_f32 v[156:157], v[20:21], v[156:157]
    v_pk_mul_f32 v[158:159], v[22:23], v[158:159]
    s_waitcnt vmcnt(4)
    v_lshlrev_b32 v128, 16, v48
    v_and_b32 v129, 0xffff0000, v48
    v_lshlrev_b32 v130, 16, v49
    v_and_b32 v131, 0xffff0000, v49
    v_lshlrev_b32 v160, 16, v64
    v_and_b32 v161, 0xffff0000, v64
    v_lshlrev_b32 v162, 16, v65
    v_and_b32 v163, 0xffff0000, v65
    v_pk_mul_f32 v[20:21], v[116:117], v[92:93]
    v_pk_mul_f32 v[22:23], v[118:119], v[94:95]
    v_pk_fma_f32 v[20:21], v[120:121], v[88:89], v[20:21]
    v_pk_fma_f32 v[22:23], v[122:123], v[90:91], v[22:23]
    v_pk_fma_f32 v[20:21], v[124:125], v[84:85], v[20:21]
    v_pk_fma_f32 v[22:23], v[126:127], v[86:87], v[22:23]
    v_pk_fma_f32 v[20:21], v[128:129], v[80:81], v[20:21]
    v_pk_fma_f32 v[22:23], v[130:131], v[82:83], v[22:23]
    v_pk_mul_f32 v[160:161], v[20:21], v[160:161]
    v_pk_mul_f32 v[162:163], v[22:23], v[162:163]
    s_waitcnt vmcnt(2)
    v_lshlrev_b32 v132, 16, v50
    v_and_b32 v133, 0xffff0000, v50
    v_lshlrev_b32 v134, 16, v51
    v_and_b32 v135, 0xffff0000, v51
    v_lshlrev_b32 v164, 16, v66
    v_and_b32 v165, 0xffff0000, v66
    v_lshlrev_b32 v166, 16, v67
    v_and_b32 v167, 0xffff0000, v67
    v_pk_mul_f32 v[20:21], v[120:121], v[92:93]
    v_pk_mul_f32 v[22:23], v[122:123], v[94:95]
    v_pk_fma_f32 v[20:21], v[124:125], v[88:89], v[20:21]
    v_pk_fma_f32 v[22:23], v[126:127], v[90:91], v[22:23]
    v_pk_fma_f32 v[20:21], v[128:129], v[84:85], v[20:21]
    v_pk_fma_f32 v[22:23], v[130:131], v[86:87], v[22:23]
    v_pk_fma_f32 v[20:21], v[132:133], v[80:81], v[20:21]
    v_pk_fma_f32 v[22:23], v[134:135], v[82:83], v[22:23]
    v_pk_mul_f32 v[164:165], v[20:21], v[164:165]
    v_pk_mul_f32 v[166:167], v[22:23], v[166:167]
    s_waitcnt vmcnt(0)
    v_lshlrev_b32 v136, 16, v52
    v_and_b32 v137, 0xffff0000, v52
    v_lshlrev_b32 v138, 16, v53
    v_and_b32 v139, 0xffff0000, v53
    v_lshlrev_b32 v168, 16, v68
    v_and_b32 v169, 0xffff0000, v68
    v_lshlrev_b32 v170, 16, v69
    v_and_b32 v171, 0xffff0000, v69
    v_pk_mul_f32 v[20:21], v[124:125], v[92:93]
    v_pk_mul_f32 v[22:23], v[126:127], v[94:95]
    v_pk_fma_f32 v[20:21], v[128:129], v[88:89], v[20:21]
    v_pk_fma_f32 v[22:23], v[130:131], v[90:91], v[22:23]
    v_pk_fma_f32 v[20:21], v[132:133], v[84:85], v[20:21]
    v_pk_fma_f32 v[22:23], v[134:135], v[86:87], v[22:23]
    v_pk_fma_f32 v[20:21], v[136:137], v[80:81], v[20:21]
    v_pk_fma_f32 v[22:23], v[138:139], v[82:83], v[22:23]
    v_pk_mul_f32 v[168:169], v[20:21], v[168:169]
    v_pk_mul_f32 v[170:171], v[22:23], v[170:171]
    v_cvt_pk_bf16_f32 v176, v168, v164
    v_cvt_pk_bf16_f32 v177, v160, v156
    v_cvt_pk_bf16_f32 v178, v152, v148
    v_cvt_pk_bf16_f32 v179, v144, v140
    buffer_store_dwordx4 v[176:179], v18, s[8:11], s67 offen sc1
    v_cvt_pk_bf16_f32 v180, v169, v165
    v_cvt_pk_bf16_f32 v181, v161, v157
    v_cvt_pk_bf16_f32 v182, v153, v149
    v_cvt_pk_bf16_f32 v183, v145, v141
    buffer_store_dwordx4 v[180:183], v18, s[8:11], s68 offen sc1
    v_cvt_pk_bf16_f32 v184, v170, v166
    v_cvt_pk_bf16_f32 v185, v162, v158
    v_cvt_pk_bf16_f32 v186, v154, v150
    v_cvt_pk_bf16_f32 v187, v146, v142
    buffer_store_dwordx4 v[184:187], v18, s[8:11], s69 offen sc1
    v_cvt_pk_bf16_f32 v188, v171, v167
    v_cvt_pk_bf16_f32 v189, v163, v159
    v_cvt_pk_bf16_f32 v190, v155, v151
    v_cvt_pk_bf16_f32 v191, v147, v143
    buffer_store_dwordx4 v[188:191], v18, s[8:11], s70 offen sc1
    v_mov_b32 v29, 1
    s_cmp_lg_u32 s4, 0
    s_cbranch_scc1 L_nord
    v_min_u32 v28, 3, v3
    v_mul_u32_u24 v28, 64, v28
    buffer_load_dword v29, v28, s[48:51], 0 offen sc1
L_nord:
    buffer_load_dwordx4 v[192:195], v1, s[32:35], s12 offen offset:0 nt
    buffer_load_dwordx4 v[196:199], v1, s[32:35], s12 offen offset:1024 nt
    buffer_load_dwordx4 v[200:203], v1, s[32:35], s12 offen offset:2048 nt
    buffer_load_dwordx4 v[204:207], v1, s[32:35], s12 offen offset:3072 nt
    s_lshr_b32 s5, s2, 3
    s_lshr_b32 s6, s5, 2
    s_add_u32 s5, s5, s6
    s_and_b32 s5, s5, 3
    s_and_b32 s6, s2, 1
    s_lshl_b32 s6, s6, 2
    s_add_u32 s5, s5, s6
    s_mov_b32 s64, 1750286864
    s_mov_b32 s65, 4275817111
    s_cmp_eq_u32 s5, 1
    s_cselect_b32 s64, 2521117185, s64
    s_cselect_b32 s65, 4274895495, s65
    s_cmp_eq_u32 s5, 2
    s_cselect_b32 s64, 1969500448, s64
    s_cselect_b32 s65, 4260149642, s65
    s_cmp_eq_u32 s5, 3
    s_cselect_b32 s64, 1733567248, s64
    s_cselect_b32 s65, 4024215992, s65
    s_cmp_eq_u32 s5, 4
    s_cselect_b32 s64, 2253595664, s64
    s_cselect_b32 s65, 4275809431, s65
    s_cmp_eq_u32 s5, 5
    s_cselect_b32 s64, 1984123393, s64
    s_cselect_b32 s65, 4274772617, s65
    s_cmp_eq_u32 s5, 6
    s_cselect_b32 s64, 1967534368, s64
    s_cselect_b32 s65, 4258183592, s65
    s_cmp_eq_u32 s5, 7
    s_cselect_b32 s64, 1702109968, s64
    s_cselect_b32 s65, 3992759192, s65
    s_lshr_b32 s5, s2, 3
    s_lshr_b32 s6, s5, 2
    s_add_u32 s5, s5, s6
    s_and_b32 s5, s5, 3
    s_mov_b32 s68, 706481664
    s_mov_b32 s69, 35458817
    s_mov_b32 s70, 740167723
    s_mov_b32 s71, 7168
    s_mov_b32 s66, 2253664784
    s_mov_b32 s67, 14465687
    s_cmp_eq_u32 s5, 1
    s_cselect_b32 s68, 706478094, s68
    s_cselect_b32 s69, 723321103, s69
    s_cselect_b32 s70, 740164112, s70
    s_cselect_b32 s71, 28, s71
    s_cmp_eq_u32 s5, 1
    s_cselect_b32 s66, 1984246273, s66
    s_cselect_b32 s67, 13482633, s67
    s_cmp_eq_u32 s5, 2
    s_cselect_b32 s68, 705567744, s68
    s_cselect_b32 s69, 722410753, s69
    s_cselect_b32 s70, 739253762, s70
    s_cselect_b32 s71, 7168, s71
    s_cmp_eq_u32 s5, 2
    s_cselect_b32 s66, 1969500448, s66
    s_cselect_b32 s67, 14465448, s67
    s_cmp_eq_u32 s5, 3
    s_cselect_b32 s68, 472518144, s68
    s_cselect_b32 s69, 489361153, s69
    s_cselect_b32 s70, 506204162, s70
    s_cselect_b32 s71, 7168, s71
    s_cmp_eq_u32 s5, 3
    s_cselect_b32 s66, 1733567248, s66
    s_cselect_b32 s67, 14461848, s67
    s_mul_i32 s5, s2, 28672
    v_and_b32 v4, 7, v0
    v_lshrrev_b32 v5, 3, v0
    v_lshlrev_b32 v7, 11, v4
    v_lshl_add_u32 v7, v5, 4, v7
    s_lshl_b32 s13, s84, 14
    v_accvgpr_write_b32 a180, -1
    v_accvgpr_write_b32 a181, -1
    v_accvgpr_write_b32 a182, -1
    v_accvgpr_write_b32 a183, -1
    v_accvgpr_write_b32 a184, -1
    v_accvgpr_write_b32 a185, -1
    v_accvgpr_write_b32 a186, -1
    v_accvgpr_write_b32 a187, -1
    v_accvgpr_write_b32 a188, -1
    v_accvgpr_write_b32 a189, -1
    v_accvgpr_write_b32 a190, -1
    v_accvgpr_write_b32 a191, -1
    v_accvgpr_write_b32 a192, -1
    v_accvgpr_write_b32 a193, -1
    v_accvgpr_write_b32 a194, -1
    v_accvgpr_write_b32 a195, -1
    s_lshl_b32 s56, s2, 2
    s_add_u32 s56, s56, s4
    s_lshl_b32 s56, s56, 12
    s_add_u32 s56, s56, 92274688
    s_add_u32 s57, s56, 1024
    s_add_u32 s58, s56, 2048
    s_add_u32 s59, s56, 3072
    v_lshrrev_b32 v11, 2, v5
    v_and_b32 v13, 3, v5
    v_lshlrev_b32 v11, 12, v11
    v_lshl_add_u32 v11, v13, 8, v11
    v_lshl_add_u32 v11, v4, 4, v11
    s_cmp_lt_u32 s4, 2
    s_cselect_b32 s6, 0, 0x80000000
    v_or_b32 v11, s6, v11
    s_lshr_b32 s6, s84, 3
    s_lshl_b32 s16, s6, 17
    s_bfe_u32 s6, s84, 0x20001
    s_lshl_b32 s6, s6, 10
    s_add_u32 s16, s16, s6
    s_and_b32 s6, s84, 1
    s_lshl_b32 s6, s6, 7
    s_add_u32 s16, s16, s6
    s_add_u32 s16, s16, 37748736
    s_add_u32 s17, s16, 33554432
    v_mov_b32 v16, -1
    v_mov_b32 v17, -1
    v_mov_b32 v18, -1
    v_mov_b32 v19, -1
    s_waitcnt vmcnt(4)
    v_cmp_le_u32 vcc, 1, v29
    s_cmp_eq_u64 vcc, -1
    s_cbranch_scc1 L_isrdy
    s_cmp_lg_u32 s4, 0
    s_cbranch_scc1 L_pdone_2
    s_mov_b32 s3, 0
L_poll_1:
    buffer_load_dword v29, v28, s[48:51], 0 offen sc1
    s_add_u32 s3, s3, 1
    s_waitcnt vmcnt(0)
    v_cmp_gt_u32 vcc, 1, v29
    s_and_b64 exec, exec, vcc
    s_cbranch_scc0 L_pexit_3
    s_cmp_lt_u32 s3, 400000
    s_cbranch_scc1 L_poll_1
L_pexit_3:
    s_mov_b64 exec, -1
L_pdone_2:
L_isrdy:
    s_add_u32 s86, s86, 1
    s_barrier
    s_cmp_lg_u32 s4, 0
    s_cbranch_scc1 L_sig_4
    s_mov_b64 exec, 1
    v_mov_b32 v28, 0
    v_mov_b32 v29, s86
    buffer_store_dword v29, v28, s[8:11], s101 offen sc1
    s_mov_b64 exec, -1
L_sig_4:
    s_cmp_lg_u32 s4, 0
    s_cbranch_scc1 L_pdone_6
    v_accvgpr_read_b32 v28, a207
    s_mov_b32 s3, 0
L_poll_5:
    buffer_load_dword v29, v28, s[8:11], s87 offen sc1
    s_add_u32 s3, s3, 1
    s_waitcnt vmcnt(0)
    v_cmp_gt_u32 vcc, s86, v29
    s_and_b64 exec, exec, vcc
    s_cbranch_scc0 L_pexit_7
    s_cmp_lt_u32 s3, 400000
    s_cbranch_scc1 L_poll_5
L_pexit_7:
    s_mov_b64 exec, -1
L_pdone_6:
    s_barrier
    s_add_u32 m0, s15, 8960
    s_nop 0
    buffer_load_dwordx4 v1, s[8:11], s95 offen offset:0 sc1 lds
    buffer_load_dwordx4 v1, s[8:11], s95 offen offset:1024 sc1 lds
    buffer_load_dwordx4 v1, s[8:11], s95 offen offset:2048 sc1 lds
    buffer_load_dwordx4 v1, s[8:11], s95 offen offset:3072 sc1 lds
    v_min_u32 v10, 6, v3
    s_mul_i32 s6, s4, 7
    v_add_lshl_u32 v10, v10, s6, 7
    s_waitcnt vmcnt(7)
    ds_write_b128 v237, v[192:195] offset:32
    v_mov_b32 v208, 0
    v_alignbit_b32 v213, v193, v192, 16
    v_alignbit_b32 v214, v194, v193, 16
    v_alignbit_b32 v215, v195, v194, 16
    v_mov_b32_dpp v208, v195 wave_shr:1 row_mask:0xf bank_mask:0xf
    v_alignbit_b32 v212, v192, v208, 16
    ds_write_b128 v237, v[212:215] offset:4192
    s_waitcnt vmcnt(6)
    ds_write_b128 v237, v[196:199] offset:1056
    v_mov_b32_dpp v209, v195 wave_ror:1 row_mask:0xf bank_mask:0xf
    v_alignbit_b32 v217, v197, v196, 16
    v_alignbit_b32 v218, v198, v197, 16
    v_alignbit_b32 v219, v199, v198, 16
    v_mov_b32_dpp v209, v199 wave_shr:1 row_mask:0xf bank_mask:0xf
    v_alignbit_b32 v216, v196, v209, 16
    ds_write_b128 v237, v[216:219] offset:5216
    s_waitcnt vmcnt(5)
    ds_write_b128 v237, v[200:203] offset:2080
    v_mov_b32_dpp v210, v199 wave_ror:1 row_mask:0xf bank_mask:0xf
    v_alignbit_b32 v221, v201, v200, 16
    v_alignbit_b32 v222, v202, v201, 16
    v_alignbit_b32 v223, v203, v202, 16
    v_mov_b32_dpp v210, v203 wave_shr:1 row_mask:0xf bank_mask:0xf
    v_alignbit_b32 v220, v200, v210, 16
    ds_write_b128 v237, v[220:223] offset:6240
    s_waitcnt vmcnt(4)
    ds_write_b128 v237, v[204:207] offset:3104
    v_mov_b32_dpp v211, v203 wave_ror:1 row_mask:0xf bank_mask:0xf
    v_alignbit_b32 v225, v205, v204, 16
    v_alignbit_b32 v226, v206, v205, 16
    v_alignbit_b32 v227, v207, v206, 16
    v_mov_b32_dpp v211, v207 wave_shr:1 row_mask:0xf bank_mask:0xf
    v_alignbit_b32 v224, v204, v211, 16
    ds_write_b128 v237, v[224:227] offset:7264
    s_waitcnt lgkmcnt(0)
    ds_read2_b32 v[64:65], v232 offset0:0 offset1:1
    ds_read2_b32 v[66:67], v232 offset0:2 offset1:3
    ds_read2_b32 v[68:69], v232 offset0:128 offset1:129
    ds_read2_b32 v[70:71], v232 offset0:130 offset1:131
    ds_read2_b32 v[72:73], v233 offset0:0 offset1:1
    ds_read2_b32 v[74:75], v233 offset0:2 offset1:3
    ds_read2_b32 v[76:77], v233 offset0:128 offset1:129
    ds_read2_b32 v[78:79], v233 offset0:130 offset1:131
    ds_read2_b32 v[80:81], v234 offset0:0 offset1:1
    ds_read2_b32 v[82:83], v234 offset0:2 offset1:3
    ds_read2_b32 v[84:85], v234 offset0:128 offset1:129
    ds_read2_b32 v[86:87], v234 offset0:130 offset1:131
    ds_read2_b32 v[88:89], v235 offset0:0 offset1:1
    ds_read2_b32 v[90:91], v235 offset0:2 offset1:3
    ds_read2_b32 v[92:93], v235 offset0:128 offset1:129
    ds_read2_b32 v[94:95], v235 offset0:130 offset1:131
    s_waitcnt vmcnt(0)
    s_waitcnt lgkmcnt(0)
    ds_read_b128 v[128:131], v236 offset:448
    ds_read_b128 v[132:135], v236 offset:960
    ds_read_b128 v[136:139], v236 offset:1472
    ds_read_b128 v[140:143], v236 offset:1984
    ds_read_b128 v[144:147], v236 offset:2496
    ds_read_b128 v[148:151], v236 offset:3008
    ds_read_b128 v[152:155], v236 offset:3520
    ds_read_b128 v[156:159], v236 offset:4032
    ds_read2_b32 v[96:97], v232 offset0:16 offset1:17
    ds_read2_b32 v[98:99], v232 offset0:18 offset1:19
    s_waitcnt lgkmcnt(9)
    v_mfma_f32_16x16x32_bf16 v[32:35], v[64:67], v[128:131], 0
    buffer_load_dwordx4 a[224:227], v7, s[36:39], s13 offen offset:0 nt
    v_mfma_f32_16x16x32_bf16 v[32:35], v[240:243], v[128:131], v[32:35]
    ds_read_b128 v[160:163], v236 offset:384
    s_waitcnt lgkmcnt(9)
    v_mfma_f32_16x16x32_bf16 v[36:39], v[64:67], v[132:135], 0
    ds_read_b128 v[164:167], v236 offset:896
    v_mfma_f32_16x16x32_bf16 v[36:39], v[240:243], v[132:135], v[36:39]
    v_mfma_f32_16x16x32_bf16 v[36:39], v[68:71], v[128:131], v[36:39]
    v_mfma_f32_16x16x32_bf16 v[40:43], v[68:71], v[132:135], 0
    s_waitcnt lgkmcnt(9)
    v_mfma_f32_16x16x32_bf16 v[40:43], v[64:67], v[136:139], v[40:43]
    buffer_load_dwordx4 a[228:231], v7, s[36:39], s13 offen offset:512 nt
    v_mfma_f32_16x16x32_bf16 v[40:43], v[240:243], v[136:139], v[40:43]
    ds_read2_b32 v[100:101], v232 offset0:144 offset1:145
    v_mfma_f32_16x16x32_bf16 v[40:43], v[72:75], v[128:131], v[40:43]
    v_mfma_f32_16x16x32_bf16 v[44:47], v[68:71], v[136:139], 0
    v_mfma_f32_16x16x32_bf16 v[44:47], v[72:75], v[132:135], v[44:47]
    s_waitcnt lgkmcnt(9)
    v_mfma_f32_16x16x32_bf16 v[44:47], v[64:67], v[140:143], v[44:47]
    ds_read2_b32 v[102:103], v232 offset0:146 offset1:147
    v_mfma_f32_16x16x32_bf16 v[44:47], v[240:243], v[140:143], v[44:47]
    buffer_load_dwordx4 a[232:235], v7, s[36:39], s13 offen offset:1024 nt
    v_mfma_f32_16x16x32_bf16 v[44:47], v[76:79], v[128:131], v[44:47]
    v_mfma_f32_16x16x32_bf16 v[48:51], v[68:71], v[140:143], 0
    v_mfma_f32_16x16x32_bf16 v[48:51], v[72:75], v[136:139], v[48:51]
    v_mfma_f32_16x16x32_bf16 v[48:51], v[76:79], v[132:135], v[48:51]
    s_waitcnt lgkmcnt(9)
    v_mfma_f32_16x16x32_bf16 v[48:51], v[64:67], v[144:147], v[48:51]
    ds_read_b128 v[168:171], v236 offset:1408
    v_mfma_f32_16x16x32_bf16 v[48:51], v[240:243], v[144:147], v[48:51]
    buffer_load_dwordx4 a[236:239], v7, s[36:39], s13 offen offset:1536 nt
    v_mfma_f32_16x16x32_bf16 v[48:51], v[80:83], v[128:131], v[48:51]
    v_mfma_f32_16x16x32_bf16 v[52:55], v[68:71], v[144:147], 0
    v_mfma_f32_16x16x32_bf16 v[52:55], v[72:75], v[140:143], v[52:55]
    v_mfma_f32_16x16x32_bf16 v[52:55], v[76:79], v[136:139], v[52:55]
    v_mfma_f32_16x16x32_bf16 v[52:55], v[80:83], v[132:135], v[52:55]
    s_waitcnt lgkmcnt(9)
    v_mfma_f32_16x16x32_bf16 v[52:55], v[64:67], v[148:151], v[52:55]
    ds_read2_b32 v[104:105], v233 offset0:16 offset1:17
    v_mfma_f32_16x16x32_bf16 v[52:55], v[240:243], v[148:151], v[52:55]
    v_mfma_f32_16x16x32_bf16 v[52:55], v[84:87], v[128:131], v[52:55]
    v_mfma_f32_16x16x32_bf16 v[56:59], v[68:71], v[148:151], 0
    v_mfma_f32_16x16x32_bf16 v[56:59], v[72:75], v[144:147], v[56:59]
    v_mfma_f32_16x16x32_bf16 v[56:59], v[76:79], v[140:143], v[56:59]
    v_mfma_f32_16x16x32_bf16 v[56:59], v[80:83], v[136:139], v[56:59]
    v_mfma_f32_16x16x32_bf16 v[56:59], v[84:87], v[132:135], v[56:59]
    s_waitcnt lgkmcnt(9)
    v_mfma_f32_16x16x32_bf16 v[56:59], v[64:67], v[152:155], v[56:59]
    ds_read2_b32 v[106:107], v233 offset0:18 offset1:19
    v_mfma_f32_16x16x32_bf16 v[56:59], v[240:243], v[152:155], v[56:59]
    v_mfma_f32_16x16x32_bf16 v[56:59], v[88:91], v[128:131], v[56:59]
    v_mfma_f32_16x16x32_bf16 v[60:63], v[68:71], v[152:155], 0
    v_mfma_f32_16x16x32_bf16 v[60:63], v[72:75], v[148:151], v[60:63]
    v_mfma_f32_16x16x32_bf16 v[60:63], v[76:79], v[144:147], v[60:63]
    v_mfma_f32_16x16x32_bf16 v[60:63], v[80:83], v[140:143], v[60:63]
    v_mfma_f32_16x16x32_bf16 v[60:63], v[84:87], v[136:139], v[60:63]
    v_mfma_f32_16x16x32_bf16 v[60:63], v[88:91], v[132:135], v[60:63]
    s_waitcnt lgkmcnt(9)
    v_mfma_f32_16x16x32_bf16 v[60:63], v[64:67], v[156:159], v[60:63]
    ds_read_b128 v[172:175], v236 offset:1920
    v_mfma_f32_16x16x32_bf16 v[60:63], v[240:243], v[156:159], v[60:63]
    v_mfma_f32_16x16x32_bf16 v[60:63], v[92:95], v[128:131], v[60:63]
    s_waitcnt lgkmcnt(7)
    v_mfma_f32_16x16x32_bf16 v[32:35], v[96:99], v[160:163], v[32:35]
    ds_read2_b32 v[108:109], v233 offset0:144 offset1:145
    s_waitcnt lgkmcnt(7)
    v_mfma_f32_16x16x32_bf16 v[36:39], v[96:99], v[164:167], v[36:39]
    ds_read2_b32 v[110:111], v233 offset0:146 offset1:147
    s_waitcnt lgkmcnt(6)
    v_mfma_f32_16x16x32_bf16 v[36:39], v[100:103], v[160:163], v[36:39]
    ds_read_b128 v[176:179], v236 offset:2432
    v_mfma_f32_16x16x32_bf16 v[40:43], v[100:103], v[164:167], v[40:43]
    ds_read2_b32 v[112:113], v234 offset0:16 offset1:17
    s_waitcnt lgkmcnt(7)
    v_mfma_f32_16x16x32_bf16 v[40:43], v[96:99], v[168:171], v[40:43]
    ds_read2_b32 v[114:115], v234 offset0:18 offset1:19
    s_waitcnt lgkmcnt(6)
    v_mfma_f32_16x16x32_bf16 v[40:43], v[104:107], v[160:163], v[40:43]
    ds_read_b128 v[180:183], v236 offset:2944
    v_mfma_f32_16x16x32_bf16 v[44:47], v[100:103], v[168:171], v[44:47]
    ds_read2_b32 v[116:117], v234 offset0:144 offset1:145
    v_mfma_f32_16x16x32_bf16 v[44:47], v[104:107], v[164:167], v[44:47]
    ds_read2_b32 v[118:119], v234 offset0:146 offset1:147
    s_waitcnt lgkmcnt(8)
    v_mfma_f32_16x16x32_bf16 v[44:47], v[96:99], v[172:175], v[44:47]
    ds_read_b128 v[184:187], v236 offset:3456
    s_waitcnt lgkmcnt(7)
    v_mfma_f32_16x16x32_bf16 v[44:47], v[108:111], v[160:163], v[44:47]
    ds_read2_b32 v[120:121], v235 offset0:16 offset1:17
    v_mfma_f32_16x16x32_bf16 v[48:51], v[100:103], v[172:175], v[48:51]
    ds_read2_b32 v[122:123], v235 offset0:18 offset1:19
    v_mfma_f32_16x16x32_bf16 v[48:51], v[104:107], v[168:171], v[48:51]
    ds_read_b128 v[188:191], v236 offset:3968
    v_mfma_f32_16x16x32_bf16 v[48:51], v[108:111], v[164:167], v[48:51]
    s_waitcnt lgkmcnt(9)
    v_mfma_f32_16x16x32_bf16 v[48:51], v[96:99], v[176:179], v[48:51]
    ds_read2_b32 v[124:125], v235 offset0:144 offset1:145
    s_waitcnt lgkmcnt(8)
    v_mfma_f32_16x16x32_bf16 v[48:51], v[112:115], v[160:163], v[48:51]
    ds_read2_b32 v[126:127], v235 offset0:146 offset1:147
    v_mfma_f32_16x16x32_bf16 v[52:55], v[100:103], v[176:179], v[52:55]
    ds_read2_b32 v[64:65], v232 offset0:32 offset1:33
    v_mfma_f32_16x16x32_bf16 v[52:55], v[104:107], v[172:175], v[52:55]
    buffer_load_dword a200, v10, s[44:47], s5 offen
    s_add_u32 s5, s5, 3584
    v_mfma_f32_16x16x32_bf16 v[52:55], v[108:111], v[168:171], v[52:55]
    v_mfma_f32_16x16x32_bf16 v[52:55], v[112:115], v[164:167], v[52:55]
    s_waitcnt lgkmcnt(9)
    v_mfma_f32_16x16x32_bf16 v[52:55], v[96:99], v[180:183], v[52:55]
    ds_read2_b32 v[66:67], v232 offset0:34 offset1:35
    s_waitcnt lgkmcnt(8)
    v_mfma_f32_16x16x32_bf16 v[52:55], v[116:119], v[160:163], v[52:55]
    ds_read_b128 v[128:131], v236 offset:320
    v_mfma_f32_16x16x32_bf16 v[56:59], v[100:103], v[180:183], v[56:59]
    ds_read_b128 v[132:135], v236 offset:832
    v_mfma_f32_16x16x32_bf16 v[56:59], v[104:107], v[176:179], v[56:59]
    v_mfma_f32_16x16x32_bf16 v[56:59], v[108:111], v[172:175], v[56:59]
    v_mfma_f32_16x16x32_bf16 v[56:59], v[112:115], v[168:171], v[56:59]
    v_mfma_f32_16x16x32_bf16 v[56:59], v[116:119], v[164:167], v[56:59]
    s_waitcnt lgkmcnt(9)
    v_mfma_f32_16x16x32_bf16 v[56:59], v[96:99], v[184:187], v[56:59]
    ds_read2_b32 v[68:69], v232 offset0:160 offset1:161
    s_waitcnt lgkmcnt(8)
    v_mfma_f32_16x16x32_bf16 v[56:59], v[120:123], v[160:163], v[56:59]
    ds_read2_b32 v[70:71], v232 offset0:162 offset1:163
    v_mfma_f32_16x16x32_bf16 v[60:63], v[100:103], v[184:187], v[60:63]
    ds_read_b128 v[136:139], v236 offset:1344
    v_mfma_f32_16x16x32_bf16 v[60:63], v[104:107], v[180:183], v[60:63]
    v_mfma_f32_16x16x32_bf16 v[60:63], v[108:111], v[176:179], v[60:63]
    v_mfma_f32_16x16x32_bf16 v[60:63], v[112:115], v[172:175], v[60:63]
    v_mfma_f32_16x16x32_bf16 v[60:63], v[116:119], v[168:171], v[60:63]
    v_mfma_f32_16x16x32_bf16 v[60:63], v[120:123], v[164:167], v[60:63]
    s_waitcnt lgkmcnt(9)
    v_mfma_f32_16x16x32_bf16 v[60:63], v[96:99], v[188:191], v[60:63]
    ds_read2_b32 v[72:73], v233 offset0:32 offset1:33
    s_waitcnt lgkmcnt(8)
    v_mfma_f32_16x16x32_bf16 v[60:63], v[124:127], v[160:163], v[60:63]
    ds_read2_b32 v[74:75], v233 offset0:34 offset1:35
    s_waitcnt lgkmcnt(6)
    v_mfma_f32_16x16x32_bf16 v[32:35], v[64:67], v[128:131], v[32:35]
    buffer_load_dword a200, v10, s[44:47], s5 offen
    s_add_u32 s5, s5, 3584
    s_waitcnt lgkmcnt(5)
    v_mfma_f32_16x16x32_bf16 v[36:39], v[64:67], v[132:135], v[36:39]
    ds_read_b128 v[140:143], v236 offset:1856
    s_waitcnt lgkmcnt(4)
    v_mfma_f32_16x16x32_bf16 v[36:39], v[68:71], v[128:131], v[36:39]
    ds_read2_b32 v[76:77], v233 offset0:160 offset1:161
    v_mfma_f32_16x16x32_bf16 v[40:43], v[68:71], v[132:135], v[40:43]
    ds_read2_b32 v[78:79], v233 offset0:162 offset1:163
    s_waitcnt lgkmcnt(5)
    v_mfma_f32_16x16x32_bf16 v[40:43], v[64:67], v[136:139], v[40:43]
    ds_read_b128 v[144:147], v236 offset:2368
    s_waitcnt lgkmcnt(4)
    v_mfma_f32_16x16x32_bf16 v[40:43], v[72:75], v[128:131], v[40:43]
    ds_read2_b32 v[80:81], v234 offset0:32 offset1:33
    v_mfma_f32_16x16x32_bf16 v[44:47], v[68:71], v[136:139], v[44:47]
    ds_read2_b32 v[82:83], v234 offset0:34 offset1:35
    v_mfma_f32_16x16x32_bf16 v[44:47], v[72:75], v[132:135], v[44:47]
    ds_read_b128 v[148:151], v236 offset:2880
    s_waitcnt lgkmcnt(6)
    v_mfma_f32_16x16x32_bf16 v[44:47], v[64:67], v[140:143], v[44:47]
    ds_read2_b32 v[84:85], v234 offset0:160 offset1:161
    s_waitcnt lgkmcnt(5)
    v_mfma_f32_16x16x32_bf16 v[44:47], v[76:79], v[128:131], v[44:47]
    ds_read2_b32 v[86:87], v234 offset0:162 offset1:163
    v_mfma_f32_16x16x32_bf16 v[48:51], v[68:71], v[140:143], v[48:51]
    ds_read_b128 v[152:155], v236 offset:3392
    v_mfma_f32_16x16x32_bf16 v[48:51], v[72:75], v[136:139], v[48:51]
    ds_read2_b32 v[88:89], v235 offset0:32 offset1:33
    v_mfma_f32_16x16x32_bf16 v[48:51], v[76:79], v[132:135], v[48:51]
    ds_read2_b32 v[90:91], v235 offset0:34 offset1:35
    s_waitcnt lgkmcnt(8)
    v_mfma_f32_16x16x32_bf16 v[48:51], v[64:67], v[144:147], v[48:51]
    ds_read_b128 v[156:159], v236 offset:3904
    s_waitcnt lgkmcnt(7)
    v_mfma_f32_16x16x32_bf16 v[48:51], v[80:83], v[128:131], v[48:51]
    ds_read2_b32 v[92:93], v235 offset0:160 offset1:161
    v_mfma_f32_16x16x32_bf16 v[52:55], v[68:71], v[144:147], v[52:55]
    ds_read2_b32 v[94:95], v235 offset0:162 offset1:163
    v_mfma_f32_16x16x32_bf16 v[52:55], v[72:75], v[140:143], v[52:55]
    ds_read2_b32 v[96:97], v232 offset0:48 offset1:49
    v_mfma_f32_16x16x32_bf16 v[52:55], v[76:79], v[136:139], v[52:55]
    v_mfma_f32_16x16x32_bf16 v[52:55], v[80:83], v[132:135], v[52:55]
    s_waitcnt lgkmcnt(9)
    v_mfma_f32_16x16x32_bf16 v[52:55], v[64:67], v[148:151], v[52:55]
    ds_read2_b32 v[98:99], v232 offset0:50 offset1:51
    s_waitcnt lgkmcnt(8)
    v_mfma_f32_16x16x32_bf16 v[52:55], v[84:87], v[128:131], v[52:55]
    buffer_load_dword a200, v10, s[44:47], s5 offen
    s_add_u32 s5, s5, 3584
    v_mfma_f32_16x16x32_bf16 v[56:59], v[68:71], v[148:151], v[56:59]
    ds_read_b128 v[160:163], v236 offset:256
    v_mfma_f32_16x16x32_bf16 v[56:59], v[72:75], v[144:147], v[56:59]
    ds_read_b128 v[164:167], v236 offset:768
    v_mfma_f32_16x16x32_bf16 v[56:59], v[76:79], v[140:143], v[56:59]
    v_mfma_f32_16x16x32_bf16 v[56:59], v[80:83], v[136:139], v[56:59]
    v_mfma_f32_16x16x32_bf16 v[56:59], v[84:87], v[132:135], v[56:59]
    s_waitcnt lgkmcnt(9)
    v_mfma_f32_16x16x32_bf16 v[56:59], v[64:67], v[152:155], v[56:59]
    ds_read2_b32 v[100:101], v232 offset0:176 offset1:177
    s_waitcnt lgkmcnt(8)
    v_mfma_f32_16x16x32_bf16 v[56:59], v[88:91], v[128:131], v[56:59]
    ds_read2_b32 v[102:103], v232 offset0:178 offset1:179
    v_mfma_f32_16x16x32_bf16 v[60:63], v[68:71], v[152:155], v[60:63]
    ds_read_b128 v[168:171], v236 offset:1280
    v_mfma_f32_16x16x32_bf16 v[60:63], v[72:75], v[148:151], v[60:63]
    v_mfma_f32_16x16x32_bf16 v[60:63], v[76:79], v[144:147], v[60:63]
    v_mfma_f32_16x16x32_bf16 v[60:63], v[80:83], v[140:143], v[60:63]
    v_mfma_f32_16x16x32_bf16 v[60:63], v[84:87], v[136:139], v[60:63]
    v_mfma_f32_16x16x32_bf16 v[60:63], v[88:91], v[132:135], v[60:63]
    s_waitcnt lgkmcnt(9)
    v_mfma_f32_16x16x32_bf16 v[60:63], v[64:67], v[156:159], v[60:63]
    ds_read2_b32 v[104:105], v233 offset0:48 offset1:49
    s_waitcnt lgkmcnt(8)
    v_mfma_f32_16x16x32_bf16 v[60:63], v[92:95], v[128:131], v[60:63]
    ds_read2_b32 v[106:107], v233 offset0:50 offset1:51
    s_waitcnt lgkmcnt(6)
    v_mfma_f32_16x16x32_bf16 v[32:35], v[96:99], v[160:163], v[32:35]
    ds_read_b128 v[172:175], v236 offset:1792
    s_waitcnt lgkmcnt(6)
    v_mfma_f32_16x16x32_bf16 v[36:39], v[96:99], v[164:167], v[36:39]
    ds_read2_b32 v[108:109], v233 offset0:176 offset1:177
    s_waitcnt lgkmcnt(5)
    v_mfma_f32_16x16x32_bf16 v[36:39], v[100:103], v[160:163], v[36:39]
    ds_read2_b32 v[110:111], v233 offset0:178 offset1:179
    v_mfma_f32_16x16x32_bf16 v[40:43], v[100:103], v[164:167], v[40:43]
    ds_read_b128 v[176:179], v236 offset:2304
    s_waitcnt lgkmcnt(6)
    v_mfma_f32_16x16x32_bf16 v[40:43], v[96:99], v[168:171], v[40:43]
    buffer_load_dword a200, v10, s[44:47], s5 offen
    s_add_u32 s5, s5, 3584
    s_waitcnt lgkmcnt(4)
    v_mfma_f32_16x16x32_bf16 v[40:43], v[104:107], v[160:163], v[40:43]
    ds_read2_b32 v[112:113], v234 offset0:48 offset1:49
    v_mfma_f32_16x16x32_bf16 v[44:47], v[100:103], v[168:171], v[44:47]
    ds_read2_b32 v[114:115], v234 offset0:50 offset1:51
    v_mfma_f32_16x16x32_bf16 v[44:47], v[104:107], v[164:167], v[44:47]
    ds_read_b128 v[180:183], v236 offset:2816
    s_waitcnt lgkmcnt(6)
    v_mfma_f32_16x16x32_bf16 v[44:47], v[96:99], v[172:175], v[44:47]
    ds_read2_b32 v[116:117], v234 offset0:176 offset1:177
    s_waitcnt lgkmcnt(5)
    v_mfma_f32_16x16x32_bf16 v[44:47], v[108:111], v[160:163], v[44:47]
    ds_read2_b32 v[118:119], v234 offset0:178 offset1:179
    v_mfma_f32_16x16x32_bf16 v[48:51], v[100:103], v[172:175], v[48:51]
    ds_read_b128 v[184:187], v236 offset:3328
    v_mfma_f32_16x16x32_bf16 v[48:51], v[104:107], v[168:171], v[48:51]
    ds_read2_b32 v[120:121], v235 offset0:48 offset1:49
    v_mfma_f32_16x16x32_bf16 v[48:51], v[108:111], v[164:167], v[48:51]
    ds_read2_b32 v[122:123], v235 offset0:50 offset1:51
    s_waitcnt lgkmcnt(8)
    v_mfma_f32_16x16x32_bf16 v[48:51], v[96:99], v[176:179], v[48:51]
    ds_read_b128 v[188:191], v236 offset:3840
    s_waitcnt lgkmcnt(7)
    v_mfma_f32_16x16x32_bf16 v[48:51], v[112:115], v[160:163], v[48:51]
    ds_read2_b32 v[124:125], v235 offset0:176 offset1:177
    v_mfma_f32_16x16x32_bf16 v[52:55], v[100:103], v[176:179], v[52:55]
    ds_read2_b32 v[126:127], v235 offset0:178 offset1:179
    v_mfma_f32_16x16x32_bf16 v[52:55], v[104:107], v[172:175], v[52:55]
    ds_read2_b32 v[64:65], v232 offset0:64 offset1:65
    v_mfma_f32_16x16x32_bf16 v[52:55], v[108:111], v[168:171], v[52:55]
    v_mfma_f32_16x16x32_bf16 v[52:55], v[112:115], v[164:167], v[52:55]
    s_waitcnt lgkmcnt(9)
    v_mfma_f32_16x16x32_bf16 v[52:55], v[96:99], v[180:183], v[52:55]
    ds_read2_b32 v[66:67], v232 offset0:66 offset1:67
    s_waitcnt lgkmcnt(8)
    v_mfma_f32_16x16x32_bf16 v[52:55], v[116:119], v[160:163], v[52:55]
    ds_read_b128 v[128:131], v236 offset:192
    v_mfma_f32_16x16x32_bf16 v[56:59], v[100:103], v[180:183], v[56:59]
    ds_read_b128 v[132:135], v236 offset:704
    v_mfma_f32_16x16x32_bf16 v[56:59], v[104:107], v[176:179], v[56:59]
    v_mfma_f32_16x16x32_bf16 v[56:59], v[108:111], v[172:175], v[56:59]
    v_mfma_f32_16x16x32_bf16 v[56:59], v[112:115], v[168:171], v[56:59]
    buffer_load_dword a200, v10, s[44:47], s5 offen
    s_add_u32 s5, s5, 3584
    v_mfma_f32_16x16x32_bf16 v[56:59], v[116:119], v[164:167], v[56:59]
    s_waitcnt lgkmcnt(9)
    v_mfma_f32_16x16x32_bf16 v[56:59], v[96:99], v[184:187], v[56:59]
    ds_read2_b32 v[68:69], v232 offset0:192 offset1:193
    s_waitcnt lgkmcnt(8)
    v_mfma_f32_16x16x32_bf16 v[56:59], v[120:123], v[160:163], v[56:59]
    ds_read2_b32 v[70:71], v232 offset0:194 offset1:195
    v_mfma_f32_16x16x32_bf16 v[60:63], v[100:103], v[184:187], v[60:63]
    ds_read_b128 v[136:139], v236 offset:1216
    v_mfma_f32_16x16x32_bf16 v[60:63], v[104:107], v[180:183], v[60:63]
    v_mfma_f32_16x16x32_bf16 v[60:63], v[108:111], v[176:179], v[60:63]
    v_mfma_f32_16x16x32_bf16 v[60:63], v[112:115], v[172:175], v[60:63]
    v_mfma_f32_16x16x32_bf16 v[60:63], v[116:119], v[168:171], v[60:63]
    v_mfma_f32_16x16x32_bf16 v[60:63], v[120:123], v[164:167], v[60:63]
    s_waitcnt lgkmcnt(9)
    v_mfma_f32_16x16x32_bf16 v[60:63], v[96:99], v[188:191], v[60:63]
    ds_read2_b32 v[72:73], v233 offset0:64 offset1:65
    s_waitcnt lgkmcnt(8)
    v_mfma_f32_16x16x32_bf16 v[60:63], v[124:127], v[160:163], v[60:63]
    ds_read2_b32 v[74:75], v233 offset0:66 offset1:67
    s_waitcnt lgkmcnt(6)
    v_mfma_f32_16x16x32_bf16 v[32:35], v[64:67], v[128:131], v[32:35]
    ds_read_b128 v[140:143], v236 offset:1728
    s_waitcnt lgkmcnt(6)
    v_mfma_f32_16x16x32_bf16 v[36:39], v[64:67], v[132:135], v[36:39]
    ds_read2_b32 v[76:77], v233 offset0:192 offset1:193
    s_waitcnt lgkmcnt(5)
    v_mfma_f32_16x16x32_bf16 v[36:39], v[68:71], v[128:131], v[36:39]
    ds_read2_b32 v[78:79], v233 offset0:194 offset1:195
    v_mfma_f32_16x16x32_bf16 v[40:43], v[68:71], v[132:135], v[40:43]
    ds_read_b128 v[144:147], v236 offset:2240
    s_waitcnt lgkmcnt(6)
    v_mfma_f32_16x16x32_bf16 v[40:43], v[64:67], v[136:139], v[40:43]
    ds_read2_b32 v[80:81], v234 offset0:64 offset1:65
    s_waitcnt lgkmcnt(5)
    v_mfma_f32_16x16x32_bf16 v[40:43], v[72:75], v[128:131], v[40:43]
    ds_read2_b32 v[82:83], v234 offset0:66 offset1:67
    v_mfma_f32_16x16x32_bf16 v[44:47], v[68:71], v[136:139], v[44:47]
    ds_read_b128 v[148:151], v236 offset:2752
    v_mfma_f32_16x16x32_bf16 v[44:47], v[72:75], v[132:135], v[44:47]
    ds_read2_b32 v[84:85], v234 offset0:192 offset1:193
    s_waitcnt lgkmcnt(7)
    v_mfma_f32_16x16x32_bf16 v[44:47], v[64:67], v[140:143], v[44:47]
    buffer_load_dword a200, v10, s[44:47], s5 offen
    s_add_u32 s5, s5, 3584
    s_waitcnt lgkmcnt(5)
    v_mfma_f32_16x16x32_bf16 v[44:47], v[76:79], v[128:131], v[44:47]
    ds_read2_b32 v[86:87], v234 offset0:194 offset1:195
    v_mfma_f32_16x16x32_bf16 v[48:51], v[68:71], v[140:143], v[48:51]
    ds_read_b128 v[152:155], v236 offset:3264
    v_mfma_f32_16x16x32_bf16 v[48:51], v[72:75], v[136:139], v[48:51]
    ds_read2_b32 v[88:89], v235 offset0:64 offset1:65
    v_mfma_f32_16x16x32_bf16 v[48:51], v[76:79], v[132:135], v[48:51]
    ds_read2_b32 v[90:91], v235 offset0:66 offset1:67
    s_waitcnt lgkmcnt(8)
    v_mfma_f32_16x16x32_bf16 v[48:51], v[64:67], v[144:147], v[48:51]
    ds_read_b128 v[156:159], v236 offset:3776
    s_waitcnt lgkmcnt(7)
    v_mfma_f32_16x16x32_bf16 v[48:51], v[80:83], v[128:131], v[48:51]
    ds_read2_b32 v[92:93], v235 offset0:192 offset1:193
    v_mfma_f32_16x16x32_bf16 v[52:55], v[68:71], v[144:147], v[52:55]
    ds_read2_b32 v[94:95], v235 offset0:194 offset1:195
    v_mfma_f32_16x16x32_bf16 v[52:55], v[72:75], v[140:143], v[52:55]
    ds_read2_b32 v[96:97], v232 offset0:80 offset1:81
    v_mfma_f32_16x16x32_bf16 v[52:55], v[76:79], v[136:139], v[52:55]
    v_mfma_f32_16x16x32_bf16 v[52:55], v[80:83], v[132:135], v[52:55]
    s_waitcnt lgkmcnt(9)
    v_mfma_f32_16x16x32_bf16 v[52:55], v[64:67], v[148:151], v[52:55]
    ds_read2_b32 v[98:99], v232 offset0:82 offset1:83
    s_waitcnt lgkmcnt(8)
    v_mfma_f32_16x16x32_bf16 v[52:55], v[84:87], v[128:131], v[52:55]
    ds_read_b128 v[160:163], v236 offset:128
    v_mfma_f32_16x16x32_bf16 v[56:59], v[68:71], v[148:151], v[56:59]
    ds_read_b128 v[164:167], v236 offset:640
    v_mfma_f32_16x16x32_bf16 v[56:59], v[72:75], v[144:147], v[56:59]
    v_mfma_f32_16x16x32_bf16 v[56:59], v[76:79], v[140:143], v[56:59]
    v_mfma_f32_16x16x32_bf16 v[56:59], v[80:83], v[136:139], v[56:59]
    v_mfma_f32_16x16x32_bf16 v[56:59], v[84:87], v[132:135], v[56:59]
    s_waitcnt lgkmcnt(9)
    v_mfma_f32_16x16x32_bf16 v[56:59], v[64:67], v[152:155], v[56:59]
    ds_read2_b32 v[100:101], v232 offset0:208 offset1:209
    s_waitcnt lgkmcnt(8)
    v_mfma_f32_16x16x32_bf16 v[56:59], v[88:91], v[128:131], v[56:59]
    ds_read2_b32 v[102:103], v232 offset0:210 offset1:211
    v_mfma_f32_16x16x32_bf16 v[60:63], v[68:71], v[152:155], v[60:63]
    buffer_load_dword a200, v10, s[44:47], s5 offen
    s_add_u32 s5, s5, 3584
    v_mfma_f32_16x16x32_bf16 v[60:63], v[72:75], v[148:151], v[60:63]
    ds_read_b128 v[168:171], v236 offset:1152
    v_mfma_f32_16x16x32_bf16 v[60:63], v[76:79], v[144:147], v[60:63]
    v_mfma_f32_16x16x32_bf16 v[60:63], v[80:83], v[140:143], v[60:63]
    v_mfma_f32_16x16x32_bf16 v[60:63], v[84:87], v[136:139], v[60:63]
    v_mfma_f32_16x16x32_bf16 v[60:63], v[88:91], v[132:135], v[60:63]
    s_waitcnt lgkmcnt(9)
    v_mfma_f32_16x16x32_bf16 v[60:63], v[64:67], v[156:159], v[60:63]
    ds_read2_b32 v[104:105], v233 offset0:80 offset1:81
    s_waitcnt lgkmcnt(8)
    v_mfma_f32_16x16x32_bf16 v[60:63], v[92:95], v[128:131], v[60:63]
    ds_read2_b32 v[106:107], v233 offset0:82 offset1:83
    s_waitcnt lgkmcnt(6)
    v_mfma_f32_16x16x32_bf16 v[32:35], v[96:99], v[160:163], v[32:35]
    ds_read_b128 v[172:175], v236 offset:1664
    s_waitcnt lgkmcnt(6)
    v_mfma_f32_16x16x32_bf16 v[36:39], v[96:99], v[164:167], v[36:39]
    ds_read2_b32 v[108:109], v233 offset0:208 offset1:209
    s_waitcnt lgkmcnt(5)
    v_mfma_f32_16x16x32_bf16 v[36:39], v[100:103], v[160:163], v[36:39]
    ds_read2_b32 v[110:111], v233 offset0:210 offset1:211
    v_mfma_f32_16x16x32_bf16 v[40:43], v[100:103], v[164:167], v[40:43]
    ds_read_b128 v[176:179], v236 offset:2176
    s_waitcnt lgkmcnt(6)
    v_mfma_f32_16x16x32_bf16 v[40:43], v[96:99], v[168:171], v[40:43]
    ds_read2_b32 v[112:113], v234 offset0:80 offset1:81
    s_waitcnt lgkmcnt(5)
    v_mfma_f32_16x16x32_bf16 v[40:43], v[104:107], v[160:163], v[40:43]
    ds_read2_b32 v[114:115], v234 offset0:82 offset1:83
    v_mfma_f32_16x16x32_bf16 v[44:47], v[100:103], v[168:171], v[44:47]
    ds_read_b128 v[180:183], v236 offset:2688
    v_mfma_f32_16x16x32_bf16 v[44:47], v[104:107], v[164:167], v[44:47]
    ds_read2_b32 v[116:117], v234 offset0:208 offset1:209
    s_waitcnt lgkmcnt(7)
    v_mfma_f32_16x16x32_bf16 v[44:47], v[96:99], v[172:175], v[44:47]
    ds_read2_b32 v[118:119], v234 offset0:210 offset1:211
    s_waitcnt lgkmcnt(6)
    v_mfma_f32_16x16x32_bf16 v[44:47], v[108:111], v[160:163], v[44:47]
    ds_read_b128 v[184:187], v236 offset:3200
    v_mfma_f32_16x16x32_bf16 v[48:51], v[100:103], v[172:175], v[48:51]
    ds_read2_b32 v[120:121], v235 offset0:80 offset1:81
    v_mfma_f32_16x16x32_bf16 v[48:51], v[104:107], v[168:171], v[48:51]
    ds_read2_b32 v[122:123], v235 offset0:82 offset1:83
    v_mfma_f32_16x16x32_bf16 v[48:51], v[108:111], v[164:167], v[48:51]
    buffer_load_dword a200, v10, s[44:47], s5 offen
    s_add_u32 s5, s5, 3584
    s_waitcnt lgkmcnt(8)
    v_mfma_f32_16x16x32_bf16 v[48:51], v[96:99], v[176:179], v[48:51]
    ds_read_b128 v[188:191], v236 offset:3712
    s_waitcnt lgkmcnt(7)
    v_mfma_f32_16x16x32_bf16 v[48:51], v[112:115], v[160:163], v[48:51]
    ds_read2_b32 v[124:125], v235 offset0:208 offset1:209
    v_mfma_f32_16x16x32_bf16 v[52:55], v[100:103], v[176:179], v[52:55]
    ds_read2_b32 v[126:127], v235 offset0:210 offset1:211
    v_mfma_f32_16x16x32_bf16 v[52:55], v[104:107], v[172:175], v[52:55]
    ds_read2_b32 v[64:65], v232 offset0:96 offset1:97
    v_mfma_f32_16x16x32_bf16 v[52:55], v[108:111], v[168:171], v[52:55]
    v_mfma_f32_16x16x32_bf16 v[52:55], v[112:115], v[164:167], v[52:55]
    s_waitcnt lgkmcnt(9)
    v_mfma_f32_16x16x32_bf16 v[52:55], v[96:99], v[180:183], v[52:55]
    ds_read2_b32 v[66:67], v232 offset0:98 offset1:99
    s_waitcnt lgkmcnt(8)
    v_mfma_f32_16x16x32_bf16 v[52:55], v[116:119], v[160:163], v[52:55]
    ds_read_b128 v[128:131], v236 offset:64
    v_mfma_f32_16x16x32_bf16 v[56:59], v[100:103], v[180:183], v[56:59]
    ds_read_b128 v[132:135], v236 offset:576
    v_mfma_f32_16x16x32_bf16 v[56:59], v[104:107], v[176:179], v[56:59]
    v_mfma_f32_16x16x32_bf16 v[56:59], v[108:111], v[172:175], v[56:59]
    v_mfma_f32_16x16x32_bf16 v[56:59], v[112:115], v[168:171], v[56:59]
    v_mfma_f32_16x16x32_bf16 v[56:59], v[116:119], v[164:167], v[56:59]
    s_waitcnt lgkmcnt(9)
    v_mfma_f32_16x16x32_bf16 v[56:59], v[96:99], v[184:187], v[56:59]
    ds_read2_b32 v[68:69], v232 offset0:224 offset1:225
    s_waitcnt lgkmcnt(8)
    v_mfma_f32_16x16x32_bf16 v[56:59], v[120:123], v[160:163], v[56:59]
    ds_read2_b32 v[70:71], v232 offset0:226 offset1:227
    v_mfma_f32_16x16x32_bf16 v[60:63], v[100:103], v[184:187], v[60:63]
    ds_read_b128 v[136:139], v236 offset:1088
    v_mfma_f32_16x16x32_bf16 v[60:63], v[104:107], v[180:183], v[60:63]
    v_mfma_f32_16x16x32_bf16 v[60:63], v[108:111], v[176:179], v[60:63]
    v_mfma_f32_16x16x32_bf16 v[60:63], v[112:115], v[172:175], v[60:63]
    v_mfma_f32_16x16x32_bf16 v[60:63], v[116:119], v[168:171], v[60:63]
    buffer_store_dwordx4 v[16:19], v11, s[8:11], s16 offen sc1
    v_mfma_f32_16x16x32_bf16 v[60:63], v[120:123], v[164:167], v[60:63]
    s_waitcnt lgkmcnt(9)
    v_mfma_f32_16x16x32_bf16 v[60:63], v[96:99], v[188:191], v[60:63]
    ds_read2_b32 v[72:73], v233 offset0:96 offset1:97
    s_waitcnt lgkmcnt(8)
    v_mfma_f32_16x16x32_bf16 v[60:63], v[124:127], v[160:163], v[60:63]
    ds_read2_b32 v[74:75], v233 offset0:98 offset1:99
    s_waitcnt lgkmcnt(6)
    v_mfma_f32_16x16x32_bf16 v[32:35], v[64:67], v[128:131], v[32:35]
    ds_read_b128 v[140:143], v236 offset:1600
    s_waitcnt lgkmcnt(6)
    v_mfma_f32_16x16x32_bf16 v[36:39], v[64:67], v[132:135], v[36:39]
    ds_read2_b32 v[76:77], v233 offset0:224 offset1:225
    s_waitcnt lgkmcnt(5)
    v_mfma_f32_16x16x32_bf16 v[36:39], v[68:71], v[128:131], v[36:39]
    ds_read2_b32 v[78:79], v233 offset0:226 offset1:227
    v_mfma_f32_16x16x32_bf16 v[40:43], v[68:71], v[132:135], v[40:43]
    ds_read_b128 v[144:147], v236 offset:2112
    s_waitcnt lgkmcnt(6)
    v_mfma_f32_16x16x32_bf16 v[40:43], v[64:67], v[136:139], v[40:43]
    ds_read2_b32 v[80:81], v234 offset0:96 offset1:97
    s_waitcnt lgkmcnt(5)
    v_mfma_f32_16x16x32_bf16 v[40:43], v[72:75], v[128:131], v[40:43]
    ds_read2_b32 v[82:83], v234 offset0:98 offset1:99
    v_mfma_f32_16x16x32_bf16 v[44:47], v[68:71], v[136:139], v[44:47]
    buffer_store_dwordx4 v[16:19], v11, s[8:11], s17 offen sc1
    v_mfma_f32_16x16x32_bf16 v[44:47], v[72:75], v[132:135], v[44:47]
    ds_read_b128 v[148:151], v236 offset:2624
    s_waitcnt lgkmcnt(6)
    v_mfma_f32_16x16x32_bf16 v[44:47], v[64:67], v[140:143], v[44:47]
    ds_read2_b32 v[84:85], v234 offset0:224 offset1:225
    s_waitcnt lgkmcnt(5)
    v_mfma_f32_16x16x32_bf16 v[44:47], v[76:79], v[128:131], v[44:47]
    ds_read2_b32 v[86:87], v234 offset0:226 offset1:227
    v_mfma_f32_16x16x32_bf16 v[48:51], v[68:71], v[140:143], v[48:51]
    ds_read_b128 v[152:155], v236 offset:3136
    v_mfma_f32_16x16x32_bf16 v[48:51], v[72:75], v[136:139], v[48:51]
    ds_read2_b32 v[88:89], v235 offset0:96 offset1:97
    v_mfma_f32_16x16x32_bf16 v[48:51], v[76:79], v[132:135], v[48:51]
    ds_read2_b32 v[90:91], v235 offset0:98 offset1:99
    s_waitcnt lgkmcnt(8)
    v_mfma_f32_16x16x32_bf16 v[48:51], v[64:67], v[144:147], v[48:51]
    ds_read_b128 v[156:159], v236 offset:3648
    s_waitcnt lgkmcnt(7)
    v_mfma_f32_16x16x32_bf16 v[48:51], v[80:83], v[128:131], v[48:51]
    ds_read2_b32 v[92:93], v235 offset0:224 offset1:225
    v_mfma_f32_16x16x32_bf16 v[52:55], v[68:71], v[144:147], v[52:55]
    ds_read2_b32 v[94:95], v235 offset0:226 offset1:227
    v_mfma_f32_16x16x32_bf16 v[52:55], v[72:75], v[140:143], v[52:55]
    ds_read2_b32 v[96:97], v232 offset0:112 offset1:113
    v_mfma_f32_16x16x32_bf16 v[52:55], v[76:79], v[136:139], v[52:55]
    v_mfma_f32_16x16x32_bf16 v[52:55], v[80:83], v[132:135], v[52:55]
    s_waitcnt lgkmcnt(9)
    v_mfma_f32_16x16x32_bf16 v[52:55], v[64:67], v[148:151], v[52:55]
    ds_read2_b32 v[98:99], v232 offset0:114 offset1:115
    s_waitcnt lgkmcnt(8)
    v_mfma_f32_16x16x32_bf16 v[52:55], v[84:87], v[128:131], v[52:55]
    ds_read_b128 v[160:163], v236 offset:0
    v_mfma_f32_16x16x32_bf16 v[56:59], v[68:71], v[148:151], v[56:59]
    ds_read_b128 v[164:167], v236 offset:512
    v_mfma_f32_16x16x32_bf16 v[56:59], v[72:75], v[144:147], v[56:59]
    v_mfma_f32_16x16x32_bf16 v[56:59], v[76:79], v[140:143], v[56:59]
    v_mfma_f32_16x16x32_bf16 v[56:59], v[80:83], v[136:139], v[56:59]
    v_mfma_f32_16x16x32_bf16 v[56:59], v[84:87], v[132:135], v[56:59]
    s_waitcnt lgkmcnt(9)
    v_mfma_f32_16x16x32_bf16 v[56:59], v[64:67], v[152:155], v[56:59]
    ds_read2_b32 v[100:101], v232 offset0:240 offset1:241
    s_waitcnt lgkmcnt(8)
    v_mfma_f32_16x16x32_bf16 v[56:59], v[88:91], v[128:131], v[56:59]
    ds_read2_b32 v[102:103], v232 offset0:242 offset1:243
    v_mfma_f32_16x16x32_bf16 v[60:63], v[68:71], v[152:155], v[60:63]
    ds_read_b128 v[168:171], v236 offset:1024
    v_mfma_f32_16x16x32_bf16 v[60:63], v[72:75], v[148:151], v[60:63]
    v_mfma_f32_16x16x32_bf16 v[60:63], v[76:79], v[144:147], v[60:63]
    v_mfma_f32_16x16x32_bf16 v[60:63], v[80:83], v[140:143], v[60:63]
    v_mfma_f32_16x16x32_bf16 v[60:63], v[84:87], v[136:139], v[60:63]
    v_lshlrev_b32 v12, 4, v0
    v_mfma_f32_16x16x32_bf16 v[60:63], v[88:91], v[132:135], v[60:63]
    s_lshl_b32 s12, s2, 14
    s_waitcnt lgkmcnt(9)
    v_mfma_f32_16x16x32_bf16 v[60:63], v[64:67], v[156:159], v[60:63]
    ds_read2_b32 v[104:105], v233 offset0:112 offset1:113
    s_add_u32 s12, s12, 29360128
    s_waitcnt lgkmcnt(8)
    v_mfma_f32_16x16x32_bf16 v[60:63], v[92:95], v[128:131], v[60:63]
    ds_read2_b32 v[106:107], v233 offset0:114 offset1:115
    s_waitcnt lgkmcnt(6)
    v_mfma_f32_16x16x32_bf16 v[32:35], v[96:99], v[160:163], v[32:35]
    ds_read_b128 v[172:175], v236 offset:1536
    s_waitcnt lgkmcnt(6)
    v_mfma_f32_16x16x32_bf16 v[36:39], v[96:99], v[164:167], v[36:39]
    ds_read2_b32 v[108:109], v233 offset0:240 offset1:241
    s_waitcnt lgkmcnt(5)
    v_mfma_f32_16x16x32_bf16 v[36:39], v[100:103], v[160:163], v[36:39]
    ds_read2_b32 v[110:111], v233 offset0:242 offset1:243
    v_mfma_f32_16x16x32_bf16 v[40:43], v[100:103], v[164:167], v[40:43]
    ds_read_b128 v[176:179], v236 offset:2048
    s_waitcnt lgkmcnt(6)
    v_mfma_f32_16x16x32_bf16 v[40:43], v[96:99], v[168:171], v[40:43]
    ds_read2_b32 v[112:113], v234 offset0:112 offset1:113
    s_waitcnt lgkmcnt(5)
    v_mfma_f32_16x16x32_bf16 v[40:43], v[104:107], v[160:163], v[40:43]
    ds_read2_b32 v[114:115], v234 offset0:114 offset1:115
    v_mfma_f32_16x16x32_bf16 v[44:47], v[100:103], v[168:171], v[44:47]
    ds_read_b128 v[180:183], v236 offset:2560
    v_mfma_f32_16x16x32_bf16 v[44:47], v[104:107], v[164:167], v[44:47]
    ds_read2_b32 v[116:117], v234 offset0:240 offset1:241
    s_waitcnt lgkmcnt(7)
    v_mfma_f32_16x16x32_bf16 v[44:47], v[96:99], v[172:175], v[44:47]
    ds_read2_b32 v[118:119], v234 offset0:242 offset1:243
    s_waitcnt lgkmcnt(6)
    v_mfma_f32_16x16x32_bf16 v[44:47], v[108:111], v[160:163], v[44:47]
    ds_read_b128 v[184:187], v236 offset:3072
    v_mfma_f32_16x16x32_bf16 v[48:51], v[100:103], v[172:175], v[48:51]
    ds_read2_b32 v[120:121], v235 offset0:112 offset1:113
    v_cvt_pk_bf16_f32 v64, v32, v33
    v_mfma_f32_16x16x32_bf16 v[48:51], v[104:107], v[168:171], v[48:51]
    ds_read2_b32 v[122:123], v235 offset0:114 offset1:115
    v_cvt_pk_bf16_f32 v66, v36, v37
    v_mfma_f32_16x16x32_bf16 v[48:51], v[108:111], v[164:167], v[48:51]
    ds_read_b128 v[188:191], v236 offset:3584
    v_cvt_pk_bf16_f32 v65, v34, v35
    s_waitcnt lgkmcnt(9)
    v_mfma_f32_16x16x32_bf16 v[48:51], v[96:99], v[176:179], v[48:51]
    ds_read2_b32 v[124:125], v235 offset0:240 offset1:241
    v_cvt_pk_bf16_f32 v67, v38, v39
    s_waitcnt lgkmcnt(8)
    v_mfma_f32_16x16x32_bf16 v[48:51], v[112:115], v[160:163], v[48:51]
    ds_read2_b32 v[126:127], v235 offset0:242 offset1:243
    v_permlane16_swap_b32 v64, v66
    v_mfma_f32_16x16x32_bf16 v[52:55], v[100:103], v[176:179], v[52:55]
    s_nop 0
    v_permlane16_swap_b32 v65, v67
    v_mfma_f32_16x16x32_bf16 v[52:55], v[104:107], v[172:175], v[52:55]
    ds_write_b128 v238, v[64:67] offset:0
    v_mfma_f32_16x16x32_bf16 v[52:55], v[108:111], v[168:171], v[52:55]
    v_cvt_pk_bf16_f32 v68, v40, v41
    v_mfma_f32_16x16x32_bf16 v[52:55], v[112:115], v[164:167], v[52:55]
    v_cvt_pk_bf16_f32 v70, v44, v45
    s_waitcnt lgkmcnt(9)
    v_mfma_f32_16x16x32_bf16 v[52:55], v[96:99], v[180:183], v[52:55]
    v_cvt_pk_bf16_f32 v69, v42, v43
    s_waitcnt lgkmcnt(7)
    v_mfma_f32_16x16x32_bf16 v[52:55], v[116:119], v[160:163], v[52:55]
    v_cvt_pk_bf16_f32 v71, v46, v47
    v_mfma_f32_16x16x32_bf16 v[56:59], v[100:103], v[180:183], v[56:59]
    v_permlane16_swap_b32 v68, v70
    v_mfma_f32_16x16x32_bf16 v[56:59], v[104:107], v[176:179], v[56:59]
    s_nop 0
    v_permlane16_swap_b32 v69, v71
    v_mfma_f32_16x16x32_bf16 v[56:59], v[108:111], v[172:175], v[56:59]
    ds_write_b128 v238, v[68:71] offset:1024
    v_mfma_f32_16x16x32_bf16 v[56:59], v[112:115], v[168:171], v[56:59]
    v_mfma_f32_16x16x32_bf16 v[56:59], v[116:119], v[164:167], v[56:59]
    s_waitcnt lgkmcnt(7)
    v_mfma_f32_16x16x32_bf16 v[56:59], v[96:99], v[184:187], v[56:59]
    s_waitcnt lgkmcnt(5)
    v_mfma_f32_16x16x32_bf16 v[56:59], v[120:123], v[160:163], v[56:59]
    v_mfma_f32_16x16x32_bf16 v[60:63], v[100:103], v[184:187], v[60:63]
    v_cvt_pk_bf16_f32 v72, v48, v49
    v_mfma_f32_16x16x32_bf16 v[60:63], v[104:107], v[180:183], v[60:63]
    v_cvt_pk_bf16_f32 v74, v52, v53
    v_mfma_f32_16x16x32_bf16 v[60:63], v[108:111], v[176:179], v[60:63]
    v_cvt_pk_bf16_f32 v73, v50, v51
    v_mfma_f32_16x16x32_bf16 v[60:63], v[112:115], v[172:175], v[60:63]
    v_cvt_pk_bf16_f32 v75, v54, v55
    v_mfma_f32_16x16x32_bf16 v[60:63], v[116:119], v[168:171], v[60:63]
    v_permlane16_swap_b32 v72, v74
    v_mfma_f32_16x16x32_bf16 v[60:63], v[120:123], v[164:167], v[60:63]
    s_nop 0
    v_permlane16_swap_b32 v73, v75
    s_waitcnt lgkmcnt(4)
    v_mfma_f32_16x16x32_bf16 v[60:63], v[96:99], v[188:191], v[60:63]
    ds_write_b128 v238, v[72:75] offset:2048
    s_waitcnt lgkmcnt(3)
    v_mfma_f32_16x16x32_bf16 v[60:63], v[124:127], v[160:163], v[60:63]
    s_nop 7
    v_cvt_pk_bf16_f32 v76, v56, v57
    v_cvt_pk_bf16_f32 v78, v60, v61
    v_cvt_pk_bf16_f32 v77, v58, v59
    v_cvt_pk_bf16_f32 v79, v62, v63
    v_permlane16_swap_b32 v76, v78
    s_nop 0
    v_permlane16_swap_b32 v77, v79
    ds_write_b128 v238, v[76:79] offset:3072
    s_waitcnt lgkmcnt(0)
    s_barrier
    ds_read_b64_tr_b16 v[96:97], v239 offset:0
    ds_read_b64_tr_b16 v[98:99], v239 offset:8
    ds_read_b64_tr_b16 v[100:101], v239 offset:1024
    ds_read_b64_tr_b16 v[102:103], v239 offset:1032
    ds_read_b64_tr_b16 v[104:105], v239 offset:2048
    ds_read_b64_tr_b16 v[106:107], v239 offset:2056
    ds_read_b64_tr_b16 v[108:109], v239 offset:3072
    ds_read_b64_tr_b16 v[110:111], v239 offset:3080
    s_waitcnt lgkmcnt(6)
    buffer_store_dwordx4 v[96:99], v12, s[8:11], s12 offen sc1
    s_add_u32 s12, s12, 4096
    s_waitcnt lgkmcnt(4)
    buffer_store_dwordx4 v[100:103], v12, s[8:11], s12 offen sc1
    s_add_u32 s12, s12, 4096
    s_waitcnt lgkmcnt(2)
    buffer_store_dwordx4 v[104:107], v12, s[8:11], s12 offen sc1
    s_add_u32 s12, s12, 4096
    s_waitcnt lgkmcnt(0)
    buffer_store_dwordx4 v[108:111], v12, s[8:11], s12 offen sc1
    v_accvgpr_read_b32 v64, a208
    v_accvgpr_read_b32 v65, a209
    v_accvgpr_read_b32 v66, a210
    v_accvgpr_read_b32 v67, a211
    v_accvgpr_read_b32 v68, a212
    v_accvgpr_read_b32 v69, a213
    v_accvgpr_read_b32 v70, a214
    s_waitcnt vmcnt(0)
    s_add_u32 s86, s86, 1
    s_barrier
    s_cmp_lg_u32 s4, 0
    s_cbranch_scc1 L_sig_8
    s_mov_b64 exec, 1
    v_mov_b32 v28, 0
    v_mov_b32 v29, s86
    buffer_store_dword v29, v28, s[8:11], s101 offen sc1
    s_mov_b64 exec, -1
L_sig_8:
    s_add_u32 m0, s82, 131072
    s_bfe_u32 s30, s64, 262144
    s_mul_i32 s30, s30, 458752
    buffer_load_dwordx4 v64, s[40:43], s30 offen offset:0  lds
    buffer_load_dwordx4 v65, s[40:43], s30 offen offset:1024  lds
    buffer_load_dwordx4 v66, s[40:43], s30 offen offset:2048  lds
    buffer_load_dwordx4 v67, s[40:43], s30 offen offset:3072  lds
    s_add_u32 m0, s82, 135168
    s_nop 0
    buffer_load_dwordx4 v68, s[40:43], s30 offen offset:0  lds
    buffer_load_dwordx4 v69, s[40:43], s30 offen offset:1024  lds
    buffer_load_dwordx4 v70, s[40:43], s30 offen offset:2048  lds
    v_and_b32 v4, 7, v0
    v_lshrrev_b32 v5, 3, v0
    v_lshrrev_b32 v6, 2, v5
    v_and_b32 v7, 3, v5
    v_lshlrev_b32 v6, 12, v6
    v_lshl_add_u32 v6, v7, 8, v6
    v_lshl_add_u32 v6, v4, 4, v6
    v_lshlrev_b32 v7, 11, v4
    v_lshl_add_u32 v7, v5, 4, v7
    v_lshlrev_b32 v15, 5, v4
    v_add_u32 v15, 159744, v15
    s_lshl_b32 s7, s4, 3
    v_add_u32 v14, s7, v15
    v_bfe_u32 v13, v3, 4, 1
    v_lshl_add_u32 v14, v13, 2, v14
    s_lshr_b32 s5, s84, 3
    s_lshl_b32 s12, s5, 17
    s_bfe_u32 s5, s84, 0x20001
    s_lshl_b32 s5, s5, 10
    s_add_u32 s12, s12, s5
    s_and_b32 s5, s84, 1
    s_lshl_b32 s5, s5, 7
    s_add_u32 s12, s12, s5
    s_add_u32 s12, s12, s85
    s_lshl_b32 s13, s84, 14
    v_and_b32 v9, 3, v4
    v_lshrrev_b32 v10, 2, v4
    v_lshlrev_b32 v8, 15, v5
    v_lshl_add_u32 v8, v9, 4, v8
    v_lshl_add_u32 v8, v10, 3, v8
    v_accvgpr_read_b32 v32, a224
    v_accvgpr_read_b32 v33, a225
    v_accvgpr_read_b32 v34, a226
    v_accvgpr_read_b32 v35, a227
    v_accvgpr_read_b32 v36, a228
    v_accvgpr_read_b32 v37, a229
    v_accvgpr_read_b32 v38, a230
    v_accvgpr_read_b32 v39, a231
    v_accvgpr_read_b32 v40, a232
    v_accvgpr_read_b32 v41, a233
    v_accvgpr_read_b32 v42, a234
    v_accvgpr_read_b32 v43, a235
    v_accvgpr_read_b32 v44, a236
    v_accvgpr_read_b32 v45, a237
    v_accvgpr_read_b32 v46, a238
    v_accvgpr_read_b32 v47, a239
    v_lshlrev_b32 v128, 16, v32
    v_and_b32 v129, 0xffff0000, v32
    v_lshlrev_b32 v130, 16, v33
    v_and_b32 v131, 0xffff0000, v33
    v_lshlrev_b32 v132, 16, v34
    v_and_b32 v133, 0xffff0000, v34
    v_lshlrev_b32 v134, 16, v35
    v_and_b32 v135, 0xffff0000, v35
    v_lshlrev_b32 v136, 16, v36
    v_and_b32 v137, 0xffff0000, v36
    v_lshlrev_b32 v138, 16, v37
    v_and_b32 v139, 0xffff0000, v37
    v_lshlrev_b32 v140, 16, v38
    v_and_b32 v141, 0xffff0000, v38
    v_lshlrev_b32 v142, 16, v39
    v_and_b32 v143, 0xffff0000, v39
    v_lshlrev_b32 v144, 16, v40
    v_and_b32 v145, 0xffff0000, v40
    v_lshlrev_b32 v146, 16, v41
    v_and_b32 v147, 0xffff0000, v41
    v_lshlrev_b32 v148, 16, v42
    v_and_b32 v149, 0xffff0000, v42
    v_lshlrev_b32 v150, 16, v43
    v_and_b32 v151, 0xffff0000, v43
    v_lshlrev_b32 v152, 16, v44
    v_and_b32 v153, 0xffff0000, v44
    v_lshlrev_b32 v154, 16, v45
    v_and_b32 v155, 0xffff0000, v45
    v_lshlrev_b32 v156, 16, v46
    v_and_b32 v157, 0xffff0000, v46
    v_lshlrev_b32 v158, 16, v47
    v_and_b32 v159, 0xffff0000, v47
    v_pk_add_f32 v[20:21], v[128:129], v[130:131]
    v_pk_mul_f32 v[22:23], v[128:129], v[128:129]
    v_pk_mul_f32 v[24:25], v[130:131], v[130:131]
    v_pk_add_f32 v[20:21], v[20:21], v[132:133]
    v_pk_fma_f32 v[22:23], v[132:133], v[132:133], v[22:23]
    v_pk_add_f32 v[20:21], v[20:21], v[134:135]
    v_pk_fma_f32 v[24:25], v[134:135], v[134:135], v[24:25]
    v_pk_add_f32 v[20:21], v[20:21], v[136:137]
    v_pk_fma_f32 v[22:23], v[136:137], v[136:137], v[22:23]
    v_pk_add_f32 v[20:21], v[20:21], v[138:139]
    v_pk_fma_f32 v[24:25], v[138:139], v[138:139], v[24:25]
    v_pk_add_f32 v[20:21], v[20:21], v[140:141]
    v_pk_fma_f32 v[22:23], v[140:141], v[140:141], v[22:23]
    v_pk_add_f32 v[20:21], v[20:21], v[142:143]
    v_pk_fma_f32 v[24:25], v[142:143], v[142:143], v[24:25]
    v_pk_add_f32 v[20:21], v[20:21], v[144:145]
    v_pk_fma_f32 v[22:23], v[144:145], v[144:145], v[22:23]
    v_pk_add_f32 v[20:21], v[20:21], v[146:147]
    v_pk_fma_f32 v[24:25], v[146:147], v[146:147], v[24:25]
    v_pk_add_f32 v[20:21], v[20:21], v[148:149]
    v_pk_fma_f32 v[22:23], v[148:149], v[148:149], v[22:23]
    v_pk_add_f32 v[20:21], v[20:21], v[150:151]
    v_pk_fma_f32 v[24:25], v[150:151], v[150:151], v[24:25]
    v_pk_add_f32 v[20:21], v[20:21], v[152:153]
    v_pk_fma_f32 v[22:23], v[152:153], v[152:153], v[22:23]
    v_pk_add_f32 v[20:21], v[20:21], v[154:155]
    v_pk_fma_f32 v[24:25], v[154:155], v[154:155], v[24:25]
    v_pk_add_f32 v[20:21], v[20:21], v[156:157]
    v_pk_fma_f32 v[22:23], v[156:157], v[156:157], v[22:23]
    v_pk_add_f32 v[20:21], v[20:21], v[158:159]
    v_pk_fma_f32 v[24:25], v[158:159], v[158:159], v[24:25]
    v_pk_add_f32 v[22:23], v[22:23], v[24:25]
    v_add_f32 v20, v20, v21
    v_add_f32 v21, v22, v23
    s_nop 1
    v_permlane16_swap_b32 v20, v21
    v_add_f32 v20, v20, v21
    s_nop 1
    v_add_f32_dpp v20, v20, v20 row_ror:8 row_mask:0xf bank_mask:0xf
    v_mov_b32 v22, v20
    s_nop 1
    v_permlane32_swap_b32 v20, v22
    v_add_f32 v20, v20, v22
    ds_write_b32 v14, v20 offset:0
    s_waitcnt lgkmcnt(0)
    s_barrier
    ds_read_b128 v[20:23], v15 offset:0
    ds_read_b128 v[24:27], v15 offset:16
    s_waitcnt lgkmcnt(0)
    v_pk_add_f32 v[20:21], v[20:21], v[22:23]
    v_pk_add_f32 v[24:25], v[24:25], v[26:27]
    v_pk_add_f32 v[20:21], v[20:21], v[24:25]
    v_mul_f32 v20, 0x3a800000, v20
    v_mul_f32 v21, 0x3a800000, v21
    v_fma_f32 v21, -v20, v20, v21
    v_max_f32 v21, 0, v21
    v_cvt_pk_bf16_f32 v21, v21, v21
    v_lshlrev_b32 v21, 16, v21
    v_add_f32 v21, 0x3727c5ac, v21
    v_cvt_pk_bf16_f32 v21, v21, v21
    v_lshlrev_b32 v21, 16, v21
    v_sqrt_f32 v21, v21
    v_cvt_pk_bf16_f32 v20, v20, v20
    v_lshlrev_b32 v20, 16, v20
    v_cvt_pk_bf16_f32 v21, v21, v21
    v_lshlrev_b32 v21, 16, v21
    v_rcp_f32 v16, v21
    s_nop 0
    v_mul_f32 v18, -v20, v16
    v_mov_b32 v17, v16
    v_mov_b32 v19, v18
    v_pk_fma_f32 v[192:193], v[128:129], v[16:17], v[18:19]
    v_pk_fma_f32 v[194:195], v[130:131], v[16:17], v[18:19]
    v_pk_fma_f32 v[196:197], v[132:133], v[16:17], v[18:19]
    v_pk_fma_f32 v[198:199], v[134:135], v[16:17], v[18:19]
    v_pk_fma_f32 v[200:201], v[136:137], v[16:17], v[18:19]
    v_pk_fma_f32 v[202:203], v[138:139], v[16:17], v[18:19]
    v_pk_fma_f32 v[204:205], v[140:141], v[16:17], v[18:19]
    v_pk_fma_f32 v[206:207], v[142:143], v[16:17], v[18:19]
    v_pk_fma_f32 v[208:209], v[144:145], v[16:17], v[18:19]
    v_pk_fma_f32 v[210:211], v[146:147], v[16:17], v[18:19]
    v_pk_fma_f32 v[212:213], v[148:149], v[16:17], v[18:19]
    v_pk_fma_f32 v[214:215], v[150:151], v[16:17], v[18:19]
    v_pk_fma_f32 v[216:217], v[152:153], v[16:17], v[18:19]
    v_pk_fma_f32 v[218:219], v[154:155], v[16:17], v[18:19]
    v_pk_fma_f32 v[220:221], v[156:157], v[16:17], v[18:19]
    v_pk_fma_f32 v[222:223], v[158:159], v[16:17], v[18:19]
    s_lshl_b32 s14, s84, 6
    s_add_u32 s14, s14, 29360128
    v_lshrrev_b32 v28, 4, v3
    v_lshlrev_b32 v28, 6, v28
    v_and_or_b32 v28, v3, 15, v28
    s_lshl_b32 s3, s4, 4
    v_add_lshl_u32 v28, v28, s3, 7
    s_mov_b32 s3, 0
L_poll_9:
    buffer_load_dword v29, v28, s[8:11], s87 offen sc1
    s_add_u32 s3, s3, 1
    s_waitcnt vmcnt(0)
    v_cmp_gt_u32 vcc, s86, v29
    s_and_b64 exec, exec, vcc
    s_cbranch_scc0 L_pexit_11
    s_cmp_lt_u32 s3, 400000
    s_cbranch_scc1 L_poll_9
L_pexit_11:
    s_mov_b64 exec, -1
L_pdone_10:
    s_add_u32 s16, s14, 0
    buffer_load_dwordx2 v[48:49], v8, s[8:11], s16 offen sc1
    s_add_u32 s16, s14, 16384
    buffer_load_dwordx2 v[50:51], v8, s[8:11], s16 offen sc1
    s_add_u32 s16, s14, 1048576
    buffer_load_dwordx2 v[52:53], v8, s[8:11], s16 offen sc1
    s_add_u32 s16, s14, 1064960
    buffer_load_dwordx2 v[54:55], v8, s[8:11], s16 offen sc1
    s_add_u32 s16, s14, 2097152
    buffer_load_dwordx2 v[56:57], v8, s[8:11], s16 offen sc1
    s_add_u32 s16, s14, 2113536
    buffer_load_dwordx2 v[58:59], v8, s[8:11], s16 offen sc1
    s_add_u32 s16, s14, 3145728
    buffer_load_dwordx2 v[60:61], v8, s[8:11], s16 offen sc1
    s_add_u32 s16, s14, 3162112
    buffer_load_dwordx2 v[62:63], v8, s[8:11], s16 offen sc1
    s_waitcnt vmcnt(6)
    v_lshlrev_b32 v22, 16, v48
    v_and_b32 v23, 0xffff0000, v48
    v_pk_fma_f32 v[96:97], v[192:193], v[22:23], v[128:129]
    v_pk_mul_f32 v[12:13], v[96:97], v[96:97]
    v_lshlrev_b32 v22, 16, v49
    v_and_b32 v23, 0xffff0000, v49
    v_pk_fma_f32 v[98:99], v[194:195], v[22:23], v[130:131]
    v_pk_add_f32 v[10:11], v[96:97], v[98:99]
    v_pk_fma_f32 v[12:13], v[98:99], v[98:99], v[12:13]
    v_lshlrev_b32 v22, 16, v50
    v_and_b32 v23, 0xffff0000, v50
    v_pk_fma_f32 v[100:101], v[196:197], v[22:23], v[132:133]
    v_pk_add_f32 v[10:11], v[10:11], v[100:101]
    v_pk_fma_f32 v[12:13], v[100:101], v[100:101], v[12:13]
    v_lshlrev_b32 v22, 16, v51
    v_and_b32 v23, 0xffff0000, v51
    v_pk_fma_f32 v[102:103], v[198:199], v[22:23], v[134:135]
    v_pk_add_f32 v[10:11], v[10:11], v[102:103]
    v_pk_fma_f32 v[12:13], v[102:103], v[102:103], v[12:13]
    s_waitcnt vmcnt(4)
    v_lshlrev_b32 v22, 16, v52
    v_and_b32 v23, 0xffff0000, v52
    v_pk_fma_f32 v[104:105], v[200:201], v[22:23], v[136:137]
    v_pk_add_f32 v[10:11], v[10:11], v[104:105]
    v_pk_fma_f32 v[12:13], v[104:105], v[104:105], v[12:13]
    v_lshlrev_b32 v22, 16, v53
    v_and_b32 v23, 0xffff0000, v53
    v_pk_fma_f32 v[106:107], v[202:203], v[22:23], v[138:139]
    v_pk_add_f32 v[10:11], v[10:11], v[106:107]
    v_pk_fma_f32 v[12:13], v[106:107], v[106:107], v[12:13]
    v_lshlrev_b32 v22, 16, v54
    v_and_b32 v23, 0xffff0000, v54
    v_pk_fma_f32 v[108:109], v[204:205], v[22:23], v[140:141]
    v_pk_add_f32 v[10:11], v[10:11], v[108:109]
    v_pk_fma_f32 v[12:13], v[108:109], v[108:109], v[12:13]
    v_lshlrev_b32 v22, 16, v55
    v_and_b32 v23, 0xffff0000, v55
    v_pk_fma_f32 v[110:111], v[206:207], v[22:23], v[142:143]
    v_pk_add_f32 v[10:11], v[10:11], v[110:111]
    v_pk_fma_f32 v[12:13], v[110:111], v[110:111], v[12:13]
    s_waitcnt vmcnt(2)
    v_lshlrev_b32 v22, 16, v56
    v_and_b32 v23, 0xffff0000, v56
    v_pk_fma_f32 v[112:113], v[208:209], v[22:23], v[144:145]
    v_pk_add_f32 v[10:11], v[10:11], v[112:113]
    v_pk_fma_f32 v[12:13], v[112:113], v[112:113], v[12:13]
    v_lshlrev_b32 v22, 16, v57
    v_and_b32 v23, 0xffff0000, v57
    v_pk_fma_f32 v[114:115], v[210:211], v[22:23], v[146:147]
    v_pk_add_f32 v[10:11], v[10:11], v[114:115]
    v_pk_fma_f32 v[12:13], v[114:115], v[114:115], v[12:13]
    v_lshlrev_b32 v22, 16, v58
    v_and_b32 v23, 0xffff0000, v58
    v_pk_fma_f32 v[116:117], v[212:213], v[22:23], v[148:149]
    v_pk_add_f32 v[10:11], v[10:11], v[116:117]
    v_pk_fma_f32 v[12:13], v[116:117], v[116:117], v[12:13]
    v_lshlrev_b32 v22, 16, v59
    v_and_b32 v23, 0xffff0000, v59
    v_pk_fma_f32 v[118:119], v[214:215], v[22:23], v[150:151]
    v_pk_add_f32 v[10:11], v[10:11], v[118:119]
    v_pk_fma_f32 v[12:13], v[118:119], v[118:119], v[12:13]
    s_waitcnt vmcnt(0)
    v_lshlrev_b32 v22, 16, v60
    v_and_b32 v23, 0xffff0000, v60
    v_pk_fma_f32 v[120:121], v[216:217], v[22:23], v[152:153]
    v_pk_add_f32 v[10:11], v[10:11], v[120:121]
    v_pk_fma_f32 v[12:13], v[120:121], v[120:121], v[12:13]
    v_lshlrev_b32 v22, 16, v61
    v_and_b32 v23, 0xffff0000, v61
    v_pk_fma_f32 v[122:123], v[218:219], v[22:23], v[154:155]
    v_pk_add_f32 v[10:11], v[10:11], v[122:123]
    v_pk_fma_f32 v[12:13], v[122:123], v[122:123], v[12:13]
    v_lshlrev_b32 v22, 16, v62
    v_and_b32 v23, 0xffff0000, v62
    v_pk_fma_f32 v[124:125], v[220:221], v[22:23], v[156:157]
    v_pk_add_f32 v[10:11], v[10:11], v[124:125]
    v_pk_fma_f32 v[12:13], v[124:125], v[124:125], v[12:13]
    v_lshlrev_b32 v22, 16, v63
    v_and_b32 v23, 0xffff0000, v63
    v_pk_fma_f32 v[126:127], v[222:223], v[22:23], v[158:159]
    v_pk_add_f32 v[10:11], v[10:11], v[126:127]
    v_pk_fma_f32 v[12:13], v[126:127], v[126:127], v[12:13]
    v_add_f32 v20, v10, v11
    v_add_f32 v21, v12, v13
    s_nop 1
    v_permlane16_swap_b32 v20, v21
    v_add_f32 v20, v20, v21
    s_nop 1
    v_add_f32_dpp v20, v20, v20 row_ror:8 row_mask:0xf bank_mask:0xf
    v_mov_b32 v22, v20
    s_nop 1
    v_permlane32_swap_b32 v20, v22
    v_add_f32 v20, v20, v22
    ds_write_b32 v14, v20 offset:256
    s_waitcnt lgkmcnt(0)
    s_barrier
    ds_read_b128 v[20:23], v15 offset:256
    ds_read_b128 v[24:27], v15 offset:272
    s_waitcnt lgkmcnt(0)
    v_pk_add_f32 v[20:21], v[20:21], v[22:23]
    v_pk_add_f32 v[24:25], v[24:25], v[26:27]
    v_pk_add_f32 v[20:21], v[20:21], v[24:25]
    v_mul_f32 v20, 0x3a800000, v20
    v_mul_f32 v21, 0x3a800000, v21
    v_fma_f32 v21, -v20, v20, v21
    v_max_f32 v21, 0, v21
    v_cvt_pk_bf16_f32 v21, v21, v21
    v_lshlrev_b32 v21, 16, v21
    v_add_f32 v21, 0x3727c5ac, v21
    v_cvt_pk_bf16_f32 v21, v21, v21
    v_lshlrev_b32 v21, 16, v21
    v_sqrt_f32 v21, v21
    v_cvt_pk_bf16_f32 v20, v20, v20
    v_lshlrev_b32 v20, 16, v20
    v_cvt_pk_bf16_f32 v21, v21, v21
    v_lshlrev_b32 v21, 16, v21
    v_rcp_f32 v16, v21
    s_nop 0
    v_mul_f32 v18, -v20, v16
    v_mov_b32 v17, v16
    v_mov_b32 v19, v18
    v_pk_fma_f32 v[20:21], v[96:97], v[16:17], v[18:19]
    v_cvt_pk_bf16_f32 v176, v20, v21
    v_pk_fma_f32 v[22:23], v[98:99], v[16:17], v[18:19]
    v_cvt_pk_bf16_f32 v177, v22, v23
    v_pk_fma_f32 v[20:21], v[100:101], v[16:17], v[18:19]
    v_cvt_pk_bf16_f32 v178, v20, v21
    v_pk_fma_f32 v[22:23], v[102:103], v[16:17], v[18:19]
    v_cvt_pk_bf16_f32 v179, v22, v23
    s_add_u32 s16, s12, 37748736
    buffer_store_dwordx4 v[176:179], v6, s[8:11], s16 offen sc1
    v_pk_fma_f32 v[20:21], v[104:105], v[16:17], v[18:19]
    v_cvt_pk_bf16_f32 v180, v20, v21
    v_pk_fma_f32 v[22:23], v[106:107], v[16:17], v[18:19]
    v_cvt_pk_bf16_f32 v181, v22, v23
    v_pk_fma_f32 v[20:21], v[108:109], v[16:17], v[18:19]
    v_cvt_pk_bf16_f32 v182, v20, v21
    v_pk_fma_f32 v[22:23], v[110:111], v[16:17], v[18:19]
    v_cvt_pk_bf16_f32 v183, v22, v23
    s_add_u32 s16, s12, 37781504
    buffer_store_dwordx4 v[180:183], v6, s[8:11], s16 offen sc1
    v_pk_fma_f32 v[20:21], v[112:113], v[16:17], v[18:19]
    v_cvt_pk_bf16_f32 v184, v20, v21
    v_pk_fma_f32 v[22:23], v[114:115], v[16:17], v[18:19]
    v_cvt_pk_bf16_f32 v185, v22, v23
    v_pk_fma_f32 v[20:21], v[116:117], v[16:17], v[18:19]
    v_cvt_pk_bf16_f32 v186, v20, v21
    v_pk_fma_f32 v[22:23], v[118:119], v[16:17], v[18:19]
    v_cvt_pk_bf16_f32 v187, v22, v23
    s_add_u32 s16, s12, 37814272
    buffer_store_dwordx4 v[184:187], v6, s[8:11], s16 offen sc1
    v_pk_fma_f32 v[20:21], v[120:121], v[16:17], v[18:19]
    v_cvt_pk_bf16_f32 v188, v20, v21
    v_pk_fma_f32 v[22:23], v[122:123], v[16:17], v[18:19]
    v_cvt_pk_bf16_f32 v189, v22, v23
    v_pk_fma_f32 v[20:21], v[124:125], v[16:17], v[18:19]
    v_cvt_pk_bf16_f32 v190, v20, v21
    v_pk_fma_f32 v[22:23], v[126:127], v[16:17], v[18:19]
    v_cvt_pk_bf16_f32 v191, v22, v23
    s_add_u32 s16, s12, 37847040
    buffer_store_dwordx4 v[188:191], v6, s[8:11], s16 offen sc1
    v_cvt_pk_bf16_f32 v160, v96, v97
    v_accvgpr_write_b32 a224, v160
    v_cvt_pk_bf16_f32 v161, v98, v99
    v_accvgpr_write_b32 a225, v161
    v_cvt_pk_bf16_f32 v162, v100, v101
    v_accvgpr_write_b32 a226, v162
    v_cvt_pk_bf16_f32 v163, v102, v103
    v_accvgpr_write_b32 a227, v163
    v_cvt_pk_bf16_f32 v164, v104, v105
    v_accvgpr_write_b32 a228, v164
    v_cvt_pk_bf16_f32 v165, v106, v107
    v_accvgpr_write_b32 a229, v165
    v_cvt_pk_bf16_f32 v166, v108, v109
    v_accvgpr_write_b32 a230, v166
    v_cvt_pk_bf16_f32 v167, v110, v111
    v_accvgpr_write_b32 a231, v167
    v_cvt_pk_bf16_f32 v168, v112, v113
    v_accvgpr_write_b32 a232, v168
    v_cvt_pk_bf16_f32 v169, v114, v115
    v_accvgpr_write_b32 a233, v169
    v_cvt_pk_bf16_f32 v170, v116, v117
    v_accvgpr_write_b32 a234, v170
    v_cvt_pk_bf16_f32 v171, v118, v119
    v_accvgpr_write_b32 a235, v171
    v_cvt_pk_bf16_f32 v172, v120, v121
    v_accvgpr_write_b32 a236, v172
    v_cvt_pk_bf16_f32 v173, v122, v123
    v_accvgpr_write_b32 a237, v173
    v_cvt_pk_bf16_f32 v174, v124, v125
    v_accvgpr_write_b32 a238, v174
    v_cvt_pk_bf16_f32 v175, v126, v127
    v_accvgpr_write_b32 a239, v175
    v_accvgpr_write_b32 a240, v48
    v_accvgpr_write_b32 a241, v49
    v_accvgpr_write_b32 a242, v50
    v_accvgpr_write_b32 a243, v51
    v_accvgpr_write_b32 a244, v52
    v_accvgpr_write_b32 a245, v53
    v_accvgpr_write_b32 a246, v54
    v_accvgpr_write_b32 a247, v55
    v_accvgpr_write_b32 a248, v56
    v_accvgpr_write_b32 a249, v57
    v_accvgpr_write_b32 a250, v58
    v_accvgpr_write_b32 a251, v59
    v_accvgpr_write_b32 a252, v60
    v_accvgpr_write_b32 a253, v61
    v_accvgpr_write_b32 a254, v62
    v_accvgpr_write_b32 a255, v63
    v_mov_b32 v27, v1
    v_bfrev_b32 v17, 1
    s_lshl_b32 s60, s84, 5
    s_add_u32 s60, s60, 22020096
L_layer:
    s_lshl_b32 s14, s96, 2
    s_add_u32 s14, s14, s4
    s_lshl_b32 s16, s14, 17
    s_add_u32 s16, s16, s85
    s_add_u32 s16, s16, 37748736
    v_cmp_eq_u32 vcc, 0, v0
    v_bfrev_b32 v2, 1
    s_nop 0
    v_cndmask_b32 v2, v2, v0, vcc
    s_and_b32 s5, s64, 15
    s_lshl_b32 s5, s5, 13
    s_add_u32 s26, s16, s5
    s_add_u32 s26, s26, 4864
    v_bfe_u32 v28, v3, 1, 2
    v_and_b32 v29, 1, v3
    v_lshlrev_b32 v28, 10, v28
    v_lshl_add_u32 v28, v29, 7, v28
    s_mov_b64 s[12:13], -1
    s_waitcnt vmcnt(0)
    buffer_load_dword v19, v28, s[8:11], s26 offen sc1
    s_barrier
    s_add_u32 s86, s86, 1
    v_mov_b32 v29, s86
    buffer_store_dword v29, v2, s[8:11], s101 offen sc1
    v_and_b32 v8, 15, v3
    v_lshlrev_b32 v8, 4, v8
    v_bfe_u32 v9, v3, 4, 1
    v_lshrrev_b32 v10, 5, v3
    v_lshl_add_u32 v8, v10, 8, v8
    v_lshl_add_u32 v4, v9, 9, v8
    v_lshl_add_u32 v5, v9, 10, v8
    v_lshrrev_b32 v10, 2, v3
    v_and_b32 v11, 3, v3
    v_mul_u32_u24 v10, 224, v10
    v_lshl_add_u32 v6, v11, 3, v10
    v_add_u32 v7, 0x10000, v6
    v_add_u32 v8, 0x20000, v6
    v_add_u32 v30, 4096, v1
    s_mul_i32 s18, s14, 458752
    s_add_u32 s18, s18, s85
    s_add_u32 s18, s18, 41943040
    s_lshr_b32 s7, s97, 4
    s_mul_i32 s7, s7, 114688
    s_add_u32 s18, s18, s7
    s_and_b32 s7, s97, 15
    s_lshr_b32 s5, s7, 1
    s_lshl_b32 s5, s5, 11
    s_and_b32 s6, s7, 1
    s_lshl_b32 s6, s6, 9
    s_add_u32 s5, s5, s6
    s_add_u32 s22, s18, s5
    s_add_u32 s22, s22, 98304
    s_add_u32 s23, s22, 229376
    s_lshl_b32 s7, s7, 11
    s_add_u32 s18, s18, s7
    s_add_u32 s19, s18, 229376
    s_add_u32 s20, s18, 32768
    s_add_u32 s21, s19, 32768
    s_add_u32 s24, s18, 65536
    s_add_u32 s25, s19, 65536
    s_lshl_b32 s5, s98, 2
    s_add_u32 s5, s5, s4
    s_mul_i32 s17, s5, 229376
    s_mul_i32 s7, s100, 114688
    s_add_u32 s17, s17, s7
    s_add_u32 s17, s17, s85
    s_add_u32 s17, s17, 41943040
    v_accvgpr_read_b32 v20, a208
    v_accvgpr_read_b32 v21, a209
    v_accvgpr_read_b32 v22, a210
    v_accvgpr_read_b32 v23, a211
    v_accvgpr_read_b32 v24, a212
    v_accvgpr_read_b32 v25, a213
    v_accvgpr_read_b32 v26, a214
    s_waitcnt vmcnt(1)
    v_cmp_eq_u32 vcc, -1, v19
    s_cmp_lg_u64 vcc, 0
    s_cbranch_scc1 L_probe
L_g1go:
    s_bfe_u32 s31, s64, 262144
    s_lshl_b32 s31, s31, 13
    s_add_u32 s31, s31, s16
    s_add_u32 s29, s31, 4096
    buffer_load_dwordx4 a[0:3], v1, s[8:11], s31 offen offset:0 sc1
    buffer_load_dwordx4 a[16:19], v1, s[8:11], s29 offen offset:0 sc1
    buffer_load_dwordx4 a[4:7], v1, s[8:11], s31 offen offset:1024 sc1
    buffer_load_dwordx4 a[20:23], v1, s[8:11], s29 offen offset:1024 sc1
    buffer_load_dwordx4 a[8:11], v1, s[8:11], s31 offen offset:2048 sc1
    buffer_load_dwordx4 a[24:27], v1, s[8:11], s29 offen offset:2048 sc1
    buffer_load_dwordx4 a[12:15], v1, s[8:11], s31 offen offset:3072 sc1
    buffer_load_dwordx4 a[28:31], v1, s[8:11], s29 offen offset:3072 sc1
    v_accvgpr_read_b32 v28, a204
    ds_read_b64_tr_b16 a[96:97], v8 offset:0
    ds_read_b64_tr_b16 a[98:99], v8 offset:3584
    ds_read_b64_tr_b16 a[100:101], v8 offset:7168
    ds_read_b64_tr_b16 a[102:103], v8 offset:10752
    ds_read_b64_tr_b16 a[104:105], v8 offset:14336
    ds_read_b64_tr_b16 a[106:107], v8 offset:17920
    ds_read_b64_tr_b16 a[108:109], v8 offset:21504
    ds_read_b64_tr_b16 a[110:111], v8 offset:25088
    ds_read_b64_tr_b16 a[112:113], v8 offset:32
    ds_read_b64_tr_b16 a[114:115], v8 offset:3616
    ds_read_b64_tr_b16 a[116:117], v8 offset:7200
    ds_read_b64_tr_b16 a[118:119], v8 offset:10784
    s_waitcnt vmcnt(6) lgkmcnt(8)
    v_mfma_f32_16x16x32_bf16 v[32:35], a[96:99], a[0:3], 0
    ds_read_b64_tr_b16 a[120:121], v8 offset:14368
    v_accvgpr_read_b32 v31, a201
    v_mfma_f32_16x16x32_bf16 v[32:35], a[100:103], a[16:19], v[32:35]
    buffer_load_dword v29, v28, s[8:11], s87 offen sc1
    s_waitcnt vmcnt(5)
    v_mfma_f32_16x16x32_bf16 v[36:39], a[100:103], a[20:23], 0
    ds_read_b64_tr_b16 a[122:123], v8 offset:17952
    v_mfma_f32_16x16x32_bf16 v[36:39], a[96:99], a[4:7], v[36:39]
    global_load_dword a200, v31, s[74:75]
    s_waitcnt vmcnt(4)
    v_mfma_f32_16x16x32_bf16 v[40:43], a[96:99], a[8:11], 0
    ds_read_b64_tr_b16 a[124:125], v8 offset:21536
    s_add_u32 m0, s82, 32768
    v_mfma_f32_16x16x32_bf16 v[40:43], a[100:103], a[24:27], v[40:43]
    s_bfe_u32 s30, s64, 262148
    s_waitcnt vmcnt(2)
    v_mfma_f32_16x16x32_bf16 v[44:47], a[100:103], a[28:31], 0
    ds_read_b64_tr_b16 a[126:127], v8 offset:25120
    s_mul_i32 s30, s30, 458752
    v_mfma_f32_16x16x32_bf16 v[44:47], a[96:99], a[12:15], v[44:47]
    s_waitcnt lgkmcnt(8)
    v_mfma_f32_16x16x32_bf16 v[60:63], a[104:107], a[12:15], 0
    ds_read_b64_tr_b16 a[128:129], v8 offset:64
    v_mfma_f32_16x16x32_bf16 v[60:63], a[108:111], a[28:31], v[60:63]
    buffer_load_dwordx4 v20, s[40:43], s30 offen offset:0  lds
    v_mfma_f32_16x16x32_bf16 v[56:59], a[108:111], a[24:27], 0
    ds_read_b64_tr_b16 a[130:131], v8 offset:3648
    v_mfma_f32_16x16x32_bf16 v[56:59], a[104:107], a[8:11], v[56:59]
    v_mfma_f32_16x16x32_bf16 v[52:55], a[104:107], a[4:7], 0
    ds_read_b64_tr_b16 a[132:133], v8 offset:7232
    v_mfma_f32_16x16x32_bf16 v[52:55], a[108:111], a[20:23], v[52:55]
    buffer_load_dwordx4 v21, s[40:43], s30 offen offset:1024  lds
    v_mfma_f32_16x16x32_bf16 v[48:51], a[108:111], a[16:19], 0
    ds_read_b64_tr_b16 a[134:135], v8 offset:10816
    v_mfma_f32_16x16x32_bf16 v[48:51], a[104:107], a[0:3], v[48:51]
    v_cmp_u_f32 vcc, v32, v36
    v_cmp_u_f32 s[6:7], v40, v44
    s_or_b64 vcc, vcc, s[6:7]
    s_and_b64 vcc, vcc, s[12:13]
    s_cbranch_scc1 L_strict
    s_waitcnt lgkmcnt(8)
    v_mfma_f32_16x16x32_bf16 v[64:67], a[112:115], a[0:3], 0
    ds_read_b64_tr_b16 a[96:97], v8 offset:14400
    v_mfma_f32_16x16x32_bf16 v[64:67], a[116:119], a[16:19], v[64:67]
    buffer_load_dwordx4 v22, s[40:43], s30 offen offset:2048  lds
    v_mfma_f32_16x16x32_bf16 v[68:71], a[116:119], a[20:23], 0
    ds_read_b64_tr_b16 a[98:99], v8 offset:17984
    v_mfma_f32_16x16x32_bf16 v[68:71], a[112:115], a[4:7], v[68:71]
    v_mfma_f32_16x16x32_bf16 v[72:75], a[112:115], a[8:11], 0
    ds_read_b64_tr_b16 a[100:101], v8 offset:21568
    v_mfma_f32_16x16x32_bf16 v[72:75], a[116:119], a[24:27], v[72:75]
    v_mfma_f32_16x16x32_bf16 v[76:79], a[116:119], a[28:31], 0
    ds_read_b64_tr_b16 a[102:103], v8 offset:25152
    v_mfma_f32_16x16x32_bf16 v[76:79], a[112:115], a[12:15], v[76:79]
    buffer_load_dwordx4 v23, s[40:43], s30 offen offset:3072  lds
    s_waitcnt lgkmcnt(8)
    v_mfma_f32_16x16x32_bf16 v[92:95], a[120:123], a[12:15], 0
    ds_read_b64_tr_b16 a[104:105], v8 offset:96
    s_add_u32 m0, s82, 36864
    v_mfma_f32_16x16x32_bf16 v[92:95], a[124:127], a[28:31], v[92:95]
    v_mfma_f32_16x16x32_bf16 v[88:91], a[124:127], a[24:27], 0
    ds_read_b64_tr_b16 a[106:107], v8 offset:3680
    v_mfma_f32_16x16x32_bf16 v[88:91], a[120:123], a[8:11], v[88:91]
    buffer_load_dwordx4 v24, s[40:43], s30 offen offset:0  lds
    v_mfma_f32_16x16x32_bf16 v[84:87], a[120:123], a[4:7], 0
    ds_read_b64_tr_b16 a[108:109], v8 offset:7264
    v_mfma_f32_16x16x32_bf16 v[84:87], a[124:127], a[20:23], v[84:87]
    v_mfma_f32_16x16x32_bf16 v[80:83], a[124:127], a[16:19], 0
    ds_read_b64_tr_b16 a[110:111], v8 offset:10848
    v_mfma_f32_16x16x32_bf16 v[80:83], a[120:123], a[0:3], v[80:83]
    buffer_load_dwordx4 v25, s[40:43], s30 offen offset:1024  lds
    s_waitcnt lgkmcnt(8)
    v_mfma_f32_16x16x32_bf16 v[96:99], a[128:131], a[0:3], 0
    ds_read_b64_tr_b16 a[112:113], v8 offset:14432
    v_mfma_f32_16x16x32_bf16 v[96:99], a[132:135], a[16:19], v[96:99]
    v_mfma_f32_16x16x32_bf16 v[100:103], a[132:135], a[20:23], 0
    ds_read_b64_tr_b16 a[114:115], v8 offset:18016
    v_mfma_f32_16x16x32_bf16 v[100:103], a[128:131], a[4:7], v[100:103]
    s_waitcnt vmcnt(7)
    v_cmp_le_u32 vcc, s86, v29
    s_cmp_eq_u64 vcc, -1
    s_cbranch_scc0 L_slow_15
L_back_16:
    v_mfma_f32_16x16x32_bf16 v[104:107], a[128:131], a[8:11], 0
    ds_read_b64_tr_b16 a[116:117], v8 offset:21600
    v_mfma_f32_16x16x32_bf16 v[104:107], a[132:135], a[24:27], v[104:107]
    buffer_load_dwordx4 v26, s[40:43], s30 offen offset:2048  lds
    v_mfma_f32_16x16x32_bf16 v[108:111], a[132:135], a[28:31], 0
    ds_read_b64_tr_b16 a[118:119], v8 offset:25184
    s_add_u32 m0, s82, 65536
    v_mfma_f32_16x16x32_bf16 v[108:111], a[128:131], a[12:15], v[108:111]
    s_bfe_u32 s30, s64, 262152
    s_waitcnt lgkmcnt(8)
    v_mfma_f32_16x16x32_bf16 v[124:127], a[96:99], a[12:15], 0
    ds_read_b64_tr_b16 a[120:121], v8 offset:128
    s_bfe_u32 s31, s64, 262148
    v_mfma_f32_16x16x32_bf16 v[124:127], a[100:103], a[28:31], v[124:127]
    s_lshl_b32 s31, s31, 13
    v_mfma_f32_16x16x32_bf16 v[120:123], a[100:103], a[24:27], 0
    ds_read_b64_tr_b16 a[122:123], v8 offset:3712
    s_add_u32 s31, s31, s16
    v_mfma_f32_16x16x32_bf16 v[120:123], a[96:99], a[8:11], v[120:123]
    buffer_load_dwordx4 a[32:35], v1, s[8:11], s31 offen offset:0 sc1
    v_mfma_f32_16x16x32_bf16 v[116:119], a[96:99], a[4:7], 0
    ds_read_b64_tr_b16 a[124:125], v8 offset:7296
    v_mfma_f32_16x16x32_bf16 v[116:119], a[100:103], a[20:23], v[116:119]
    v_mfma_f32_16x16x32_bf16 v[112:115], a[100:103], a[16:19], 0
    ds_read_b64_tr_b16 a[126:127], v8 offset:10880
    v_mfma_f32_16x16x32_bf16 v[112:115], a[96:99], a[0:3], v[112:115]
    buffer_load_dwordx4 a[36:39], v1, s[8:11], s31 offen offset:1024 sc1
    s_waitcnt lgkmcnt(8)
    v_mfma_f32_16x16x32_bf16 v[128:131], a[104:107], a[0:3], 0
    ds_read_b64_tr_b16 a[128:129], v8 offset:14464
    v_mfma_f32_16x16x32_bf16 v[128:131], a[108:111], a[16:19], v[128:131]
    v_mfma_f32_16x16x32_bf16 v[132:135], a[108:111], a[20:23], 0
    ds_read_b64_tr_b16 a[130:131], v8 offset:18048
    v_mfma_f32_16x16x32_bf16 v[132:135], a[104:107], a[4:7], v[132:135]
    buffer_load_dwordx4 a[40:43], v1, s[8:11], s31 offen offset:2048 sc1
    v_mfma_f32_16x16x32_bf16 v[136:139], a[104:107], a[8:11], 0
    ds_read_b64_tr_b16 a[132:133], v8 offset:21632
    v_mfma_f32_16x16x32_bf16 v[136:139], a[108:111], a[24:27], v[136:139]
    v_mfma_f32_16x16x32_bf16 v[140:143], a[108:111], a[28:31], 0
    ds_read_b64_tr_b16 a[134:135], v8 offset:25216
    v_mfma_f32_16x16x32_bf16 v[140:143], a[104:107], a[12:15], v[140:143]
    buffer_load_dwordx4 a[44:47], v1, s[8:11], s31 offen offset:3072 sc1
    s_waitcnt lgkmcnt(8)
    v_mfma_f32_16x16x32_bf16 v[156:159], a[112:115], a[12:15], 0
    ds_read_b64_tr_b16 a[96:97], v8 offset:160
    v_mfma_f32_16x16x32_bf16 v[156:159], a[116:119], a[28:31], v[156:159]
    v_mfma_f32_16x16x32_bf16 v[152:155], a[116:119], a[24:27], 0
    ds_read_b64_tr_b16 a[98:99], v8 offset:3744
    v_mfma_f32_16x16x32_bf16 v[152:155], a[112:115], a[8:11], v[152:155]
    buffer_load_dwordx4 a[48:51], v30, s[8:11], s31 offen offset:0 sc1
    v_mfma_f32_16x16x32_bf16 v[148:151], a[112:115], a[4:7], 0
    ds_read_b64_tr_b16 a[100:101], v8 offset:7328
    v_mfma_f32_16x16x32_bf16 v[148:151], a[116:119], a[20:23], v[148:151]
    v_mfma_f32_16x16x32_bf16 v[144:147], a[116:119], a[16:19], 0
    ds_read_b64_tr_b16 a[102:103], v8 offset:10912
    v_mfma_f32_16x16x32_bf16 v[144:147], a[112:115], a[0:3], v[144:147]
    s_waitcnt lgkmcnt(8)
    v_mfma_f32_16x16x32_bf16 v[160:163], a[120:123], a[0:3], 0
    ds_read_b64_tr_b16 a[104:105], v8 offset:14496
    v_mfma_f32_16x16x32_bf16 v[160:163], a[124:127], a[16:19], v[160:163]
    buffer_load_dwordx4 a[52:55], v30, s[8:11], s31 offen offset:1024 sc1
    v_mfma_f32_16x16x32_bf16 v[164:167], a[124:127], a[20:23], 0
    ds_read_b64_tr_b16 a[106:107], v8 offset:18080
    v_mfma_f32_16x16x32_bf16 v[164:167], a[120:123], a[4:7], v[164:167]
    v_mfma_f32_16x16x32_bf16 v[168:171], a[120:123], a[8:11], 0
    ds_read_b64_tr_b16 a[108:109], v8 offset:21664
    v_mfma_f32_16x16x32_bf16 v[168:171], a[124:127], a[24:27], v[168:171]
    buffer_load_dwordx4 a[56:59], v30, s[8:11], s31 offen offset:2048 sc1
    v_mfma_f32_16x16x32_bf16 v[172:175], a[124:127], a[28:31], 0
    ds_read_b64_tr_b16 a[110:111], v8 offset:25248
    v_mfma_f32_16x16x32_bf16 v[172:175], a[120:123], a[12:15], v[172:175]
    s_waitcnt lgkmcnt(8)
    v_mfma_f32_16x16x32_bf16 v[188:191], a[128:131], a[12:15], 0
    ds_read_b64_tr_b16 a[112:113], v8 offset:192
    v_mfma_f32_16x16x32_bf16 v[188:191], a[132:135], a[28:31], v[188:191]
    buffer_load_dwordx4 a[60:63], v30, s[8:11], s31 offen offset:3072 sc1
    v_mfma_f32_16x16x32_bf16 v[184:187], a[132:135], a[24:27], 0
    ds_read_b64_tr_b16 a[114:115], v8 offset:3776
    s_mul_i32 s30, s30, 458752
    v_mfma_f32_16x16x32_bf16 v[184:187], a[128:131], a[8:11], v[184:187]
    v_mfma_f32_16x16x32_bf16 v[180:183], a[128:131], a[4:7], 0
    ds_read_b64_tr_b16 a[116:117], v8 offset:7360
    v_mfma_f32_16x16x32_bf16 v[180:183], a[132:135], a[20:23], v[180:183]
    buffer_load_dwordx4 v20, s[40:43], s30 offen offset:0  lds
    v_mfma_f32_16x16x32_bf16 v[176:179], a[132:135], a[16:19], 0
    ds_read_b64_tr_b16 a[118:119], v8 offset:10944
    v_mfma_f32_16x16x32_bf16 v[176:179], a[128:131], a[0:3], v[176:179]
    s_waitcnt lgkmcnt(8)
    v_mfma_f32_16x16x32_bf16 v[192:195], a[96:99], a[0:3], 0
    ds_read_b64_tr_b16 a[120:121], v8 offset:14528
    v_mfma_f32_16x16x32_bf16 v[192:195], a[100:103], a[16:19], v[192:195]
    v_mfma_f32_16x16x32_bf16 v[196:199], a[100:103], a[20:23], 0
    ds_read_b64_tr_b16 a[122:123], v8 offset:18112
    v_mfma_f32_16x16x32_bf16 v[196:199], a[96:99], a[4:7], v[196:199]
    buffer_load_dwordx4 v21, s[40:43], s30 offen offset:1024  lds
    v_mfma_f32_16x16x32_bf16 v[200:203], a[96:99], a[8:11], 0
    ds_read_b64_tr_b16 a[124:125], v8 offset:21696
    v_mfma_f32_16x16x32_bf16 v[200:203], a[100:103], a[24:27], v[200:203]
    v_mfma_f32_16x16x32_bf16 v[204:207], a[100:103], a[28:31], 0
    ds_read_b64_tr_b16 a[126:127], v8 offset:25280
    v_mfma_f32_16x16x32_bf16 v[204:207], a[96:99], a[12:15], v[204:207]
    s_waitcnt lgkmcnt(8)
    v_mfma_f32_16x16x32_bf16 v[220:223], a[104:107], a[12:15], 0
    s_waitcnt vmcnt(10)
    s_barrier
    ds_read_b64_tr_b16 a[128:129], v6 offset:32768
    v_mfma_f32_16x16x32_bf16 v[220:223], a[108:111], a[28:31], v[220:223]
    buffer_load_dwordx4 v22, s[40:43], s30 offen offset:2048  lds
    v_mfma_f32_16x16x32_bf16 v[216:219], a[108:111], a[24:27], 0
    ds_read_b64_tr_b16 a[130:131], v6 offset:36352
    v_mfma_f32_16x16x32_bf16 v[216:219], a[104:107], a[8:11], v[216:219]
    v_mfma_f32_16x16x32_bf16 v[212:215], a[104:107], a[4:7], 0
    ds_read_b64_tr_b16 a[132:133], v6 offset:39936
    v_mfma_f32_16x16x32_bf16 v[212:215], a[108:111], a[20:23], v[212:215]
    v_mfma_f32_16x16x32_bf16 v[208:211], a[108:111], a[16:19], 0
    ds_read_b64_tr_b16 a[134:135], v6 offset:43520
    v_mfma_f32_16x16x32_bf16 v[208:211], a[104:107], a[0:3], v[208:211]
    buffer_load_dwordx4 v23, s[40:43], s30 offen offset:3072  lds
    s_waitcnt lgkmcnt(8)
    v_mfma_f32_16x16x32_bf16 v[224:227], a[112:115], a[0:3], 0
    ds_read_b64_tr_b16 a[96:97], v6 offset:47104
    s_add_u32 m0, s82, 69632
    v_mfma_f32_16x16x32_bf16 v[224:227], a[116:119], a[16:19], v[224:227]
    v_mfma_f32_16x16x32_bf16 v[228:231], a[116:119], a[20:23], 0
    ds_read_b64_tr_b16 a[98:99], v6 offset:50688
    v_mfma_f32_16x16x32_bf16 v[228:231], a[112:115], a[4:7], v[228:231]
    v_mfma_f32_16x16x32_bf16 v[232:235], a[112:115], a[8:11], 0
    ds_read_b64_tr_b16 a[100:101], v6 offset:54272
    v_mfma_f32_16x16x32_bf16 v[232:235], a[116:119], a[24:27], v[232:235]
    buffer_load_dwordx4 v24, s[40:43], s30 offen offset:0  lds
    v_mfma_f32_16x16x32_bf16 v[236:239], a[116:119], a[28:31], 0
    ds_read_b64_tr_b16 a[102:103], v6 offset:57856
    v_mfma_f32_16x16x32_bf16 v[236:239], a[112:115], a[12:15], v[236:239]
    s_waitcnt lgkmcnt(8)
    v_mfma_f32_16x16x32_bf16 v[252:255], a[120:123], a[12:15], 0
    ds_read_b64_tr_b16 a[104:105], v6 offset:32800
    v_mfma_f32_16x16x32_bf16 v[252:255], a[124:127], a[28:31], v[252:255]
    v_mfma_f32_16x16x32_bf16 v[248:251], a[124:127], a[24:27], 0
    ds_read_b64_tr_b16 a[106:107], v6 offset:36384
    v_mfma_f32_16x16x32_bf16 v[248:251], a[120:123], a[8:11], v[248:251]
    buffer_load_dwordx4 v25, s[40:43], s30 offen offset:1024  lds
    v_mfma_f32_16x16x32_bf16 v[244:247], a[120:123], a[4:7], 0
    ds_read_b64_tr_b16 a[108:109], v6 offset:39968
    v_mfma_f32_16x16x32_bf16 v[244:247], a[124:127], a[20:23], v[244:247]
    v_mfma_f32_16x16x32_bf16 v[240:243], a[124:127], a[16:19], 0
    ds_read_b64_tr_b16 a[110:111], v6 offset:43552
    v_mfma_f32_16x16x32_bf16 v[240:243], a[120:123], a[0:3], v[240:243]
    s_waitcnt vmcnt(6) lgkmcnt(8)
    v_mfma_f32_16x16x32_bf16 v[32:35], a[128:131], a[32:35], v[32:35]
    ds_read_b64_tr_b16 a[112:113], v6 offset:47136
    v_mfma_f32_16x16x32_bf16 v[32:35], a[132:135], a[48:51], v[32:35]
    buffer_load_dwordx4 v26, s[40:43], s30 offen offset:2048  lds
    v_mfma_f32_16x16x32_bf16 v[36:39], a[132:135], a[52:55], v[36:39]
    ds_read_b64_tr_b16 a[114:115], v6 offset:50720
    s_bfe_u32 s31, s64, 262152
    v_mfma_f32_16x16x32_bf16 v[36:39], a[128:131], a[36:39], v[36:39]
    s_lshl_b32 s31, s31, 13
    v_mfma_f32_16x16x32_bf16 v[40:43], a[128:131], a[40:43], v[40:43]
    ds_read_b64_tr_b16 a[116:117], v6 offset:54304
    s_add_u32 s31, s31, s16
    v_mfma_f32_16x16x32_bf16 v[40:43], a[132:135], a[56:59], v[40:43]
    v_mfma_f32_16x16x32_bf16 v[44:47], a[132:135], a[60:63], v[44:47]
    ds_read_b64_tr_b16 a[118:119], v6 offset:57888
    v_mfma_f32_16x16x32_bf16 v[44:47], a[128:131], a[44:47], v[44:47]
    buffer_load_dwordx4 a[64:67], v1, s[8:11], s31 offen offset:0 sc1
    s_waitcnt lgkmcnt(8)
    v_mfma_f32_16x16x32_bf16 v[60:63], a[96:99], a[44:47], v[60:63]
    ds_read_b64_tr_b16 a[120:121], v6 offset:32832
    v_mfma_f32_16x16x32_bf16 v[60:63], a[100:103], a[60:63], v[60:63]
    v_mfma_f32_16x16x32_bf16 v[56:59], a[100:103], a[56:59], v[56:59]
    ds_read_b64_tr_b16 a[122:123], v6 offset:36416
    v_mfma_f32_16x16x32_bf16 v[56:59], a[96:99], a[40:43], v[56:59]
    v_mfma_f32_16x16x32_bf16 v[52:55], a[96:99], a[36:39], v[52:55]
    ds_read_b64_tr_b16 a[124:125], v6 offset:40000
    v_mfma_f32_16x16x32_bf16 v[52:55], a[100:103], a[52:55], v[52:55]
    buffer_load_dwordx4 a[68:71], v1, s[8:11], s31 offen offset:1024 sc1
    v_mfma_f32_16x16x32_bf16 v[48:51], a[100:103], a[48:51], v[48:51]
    ds_read_b64_tr_b16 a[126:127], v6 offset:43584
    v_mfma_f32_16x16x32_bf16 v[48:51], a[96:99], a[32:35], v[48:51]
    s_waitcnt lgkmcnt(8)
    v_mfma_f32_16x16x32_bf16 v[64:67], a[104:107], a[32:35], v[64:67]
    ds_read_b64_tr_b16 a[128:129], v6 offset:47168
    v_mfma_f32_16x16x32_bf16 v[64:67], a[108:111], a[48:51], v[64:67]
    v_mfma_f32_16x16x32_bf16 v[68:71], a[108:111], a[52:55], v[68:71]
    ds_read_b64_tr_b16 a[130:131], v6 offset:50752
    v_mfma_f32_16x16x32_bf16 v[68:71], a[104:107], a[36:39], v[68:71]
    buffer_load_dwordx4 a[72:75], v1, s[8:11], s31 offen offset:2048 sc1
    v_mfma_f32_16x16x32_bf16 v[72:75], a[104:107], a[40:43], v[72:75]
    ds_read_b64_tr_b16 a[132:133], v6 offset:54336
    v_mfma_f32_16x16x32_bf16 v[72:75], a[108:111], a[56:59], v[72:75]
    v_mfma_f32_16x16x32_bf16 v[76:79], a[108:111], a[60:63], v[76:79]
    ds_read_b64_tr_b16 a[134:135], v6 offset:57920
    v_mfma_f32_16x16x32_bf16 v[76:79], a[104:107], a[44:47], v[76:79]
    s_waitcnt lgkmcnt(8)
    v_mfma_f32_16x16x32_bf16 v[92:95], a[112:115], a[44:47], v[92:95]
    ds_read_b64_tr_b16 a[96:97], v6 offset:32864
    v_mfma_f32_16x16x32_bf16 v[92:95], a[116:119], a[60:63], v[92:95]
    buffer_load_dwordx4 a[76:79], v1, s[8:11], s31 offen offset:3072 sc1
    v_mfma_f32_16x16x32_bf16 v[88:91], a[116:119], a[56:59], v[88:91]
    ds_read_b64_tr_b16 a[98:99], v6 offset:36448
    v_mfma_f32_16x16x32_bf16 v[88:91], a[112:115], a[40:43], v[88:91]
    v_mfma_f32_16x16x32_bf16 v[84:87], a[112:115], a[36:39], v[84:87]
    ds_read_b64_tr_b16 a[100:101], v6 offset:40032
    v_mfma_f32_16x16x32_bf16 v[84:87], a[116:119], a[52:55], v[84:87]
    v_mfma_f32_16x16x32_bf16 v[80:83], a[116:119], a[48:51], v[80:83]
    ds_read_b64_tr_b16 a[102:103], v6 offset:43616
    v_mfma_f32_16x16x32_bf16 v[80:83], a[112:115], a[32:35], v[80:83]
    s_waitcnt lgkmcnt(8)
    v_mfma_f32_16x16x32_bf16 v[96:99], a[120:123], a[32:35], v[96:99]
    ds_read_b64_tr_b16 a[104:105], v6 offset:47200
    v_mfma_f32_16x16x32_bf16 v[96:99], a[124:127], a[48:51], v[96:99]
    buffer_load_dwordx4 a[80:83], v30, s[8:11], s31 offen offset:0 sc1
    v_mfma_f32_16x16x32_bf16 v[100:103], a[124:127], a[52:55], v[100:103]
    ds_read_b64_tr_b16 a[106:107], v6 offset:50784
    v_mfma_f32_16x16x32_bf16 v[100:103], a[120:123], a[36:39], v[100:103]
    v_mfma_f32_16x16x32_bf16 v[104:107], a[120:123], a[40:43], v[104:107]
    ds_read_b64_tr_b16 a[108:109], v6 offset:54368
    v_mfma_f32_16x16x32_bf16 v[104:107], a[124:127], a[56:59], v[104:107]
    v_mfma_f32_16x16x32_bf16 v[108:111], a[124:127], a[60:63], v[108:111]
    ds_read_b64_tr_b16 a[110:111], v6 offset:57952
    v_mfma_f32_16x16x32_bf16 v[108:111], a[120:123], a[44:47], v[108:111]
    buffer_load_dwordx4 a[84:87], v30, s[8:11], s31 offen offset:1024 sc1
    s_waitcnt lgkmcnt(8)
    v_mfma_f32_16x16x32_bf16 v[124:127], a[128:131], a[44:47], v[124:127]
    ds_read_b64_tr_b16 a[112:113], v6 offset:32896
    v_mfma_f32_16x16x32_bf16 v[124:127], a[132:135], a[60:63], v[124:127]
    v_mfma_f32_16x16x32_bf16 v[120:123], a[132:135], a[56:59], v[120:123]
    ds_read_b64_tr_b16 a[114:115], v6 offset:36480
    v_mfma_f32_16x16x32_bf16 v[120:123], a[128:131], a[40:43], v[120:123]
    v_mfma_f32_16x16x32_bf16 v[116:119], a[128:131], a[36:39], v[116:119]
    ds_read_b64_tr_b16 a[116:117], v6 offset:40064
    v_mfma_f32_16x16x32_bf16 v[116:119], a[132:135], a[52:55], v[116:119]
    buffer_load_dwordx4 a[88:91], v30, s[8:11], s31 offen offset:2048 sc1
    v_mfma_f32_16x16x32_bf16 v[112:115], a[132:135], a[48:51], v[112:115]
    ds_read_b64_tr_b16 a[118:119], v6 offset:43648
    v_mfma_f32_16x16x32_bf16 v[112:115], a[128:131], a[32:35], v[112:115]
    s_waitcnt lgkmcnt(8)
    v_mfma_f32_16x16x32_bf16 v[128:131], a[96:99], a[32:35], v[128:131]
    ds_read_b64_tr_b16 a[120:121], v6 offset:47232
    v_mfma_f32_16x16x32_bf16 v[128:131], a[100:103], a[48:51], v[128:131]
    v_mfma_f32_16x16x32_bf16 v[132:135], a[100:103], a[52:55], v[132:135]
    ds_read_b64_tr_b16 a[122:123], v6 offset:50816
    v_mfma_f32_16x16x32_bf16 v[132:135], a[96:99], a[36:39], v[132:135]
    buffer_load_dwordx4 a[92:95], v30, s[8:11], s31 offen offset:3072 sc1
    v_mfma_f32_16x16x32_bf16 v[136:139], a[96:99], a[40:43], v[136:139]
    ds_read_b64_tr_b16 a[124:125], v6 offset:54400
    s_add_u32 m0, s82, 98304
    v_mfma_f32_16x16x32_bf16 v[136:139], a[100:103], a[56:59], v[136:139]
    s_bfe_u32 s30, s64, 262156
    v_mfma_f32_16x16x32_bf16 v[140:143], a[100:103], a[60:63], v[140:143]
    ds_read_b64_tr_b16 a[126:127], v6 offset:57984
    s_mul_i32 s30, s30, 458752
    v_mfma_f32_16x16x32_bf16 v[140:143], a[96:99], a[44:47], v[140:143]
    s_waitcnt lgkmcnt(8)
    v_mfma_f32_16x16x32_bf16 v[156:159], a[104:107], a[44:47], v[156:159]
    ds_read_b64_tr_b16 a[128:129], v6 offset:32928
    v_mfma_f32_16x16x32_bf16 v[156:159], a[108:111], a[60:63], v[156:159]
    buffer_load_dwordx4 v20, s[40:43], s30 offen offset:0  lds
    v_mfma_f32_16x16x32_bf16 v[152:155], a[108:111], a[56:59], v[152:155]
    ds_read_b64_tr_b16 a[130:131], v6 offset:36512
    v_mfma_f32_16x16x32_bf16 v[152:155], a[104:107], a[40:43], v[152:155]
    v_mfma_f32_16x16x32_bf16 v[148:151], a[104:107], a[36:39], v[148:151]
    ds_read_b64_tr_b16 a[132:133], v6 offset:40096
    v_mfma_f32_16x16x32_bf16 v[148:151], a[108:111], a[52:55], v[148:151]
    v_mfma_f32_16x16x32_bf16 v[144:147], a[108:111], a[48:51], v[144:147]
    ds_read_b64_tr_b16 a[134:135], v6 offset:43680
    v_mfma_f32_16x16x32_bf16 v[144:147], a[104:107], a[32:35], v[144:147]
    buffer_load_dwordx4 v21, s[40:43], s30 offen offset:1024  lds
    s_waitcnt lgkmcnt(8)
    v_mfma_f32_16x16x32_bf16 v[160:163], a[112:115], a[32:35], v[160:163]
    ds_read_b64_tr_b16 a[96:97], v6 offset:47264
    v_mfma_f32_16x16x32_bf16 v[160:163], a[116:119], a[48:51], v[160:163]
    v_mfma_f32_16x16x32_bf16 v[164:167], a[116:119], a[52:55], v[164:167]
    ds_read_b64_tr_b16 a[98:99], v6 offset:50848
    v_mfma_f32_16x16x32_bf16 v[164:167], a[112:115], a[36:39], v[164:167]
    v_mfma_f32_16x16x32_bf16 v[168:171], a[112:115], a[40:43], v[168:171]
    ds_read_b64_tr_b16 a[100:101], v6 offset:54432
    v_mfma_f32_16x16x32_bf16 v[168:171], a[116:119], a[56:59], v[168:171]
    buffer_load_dwordx4 v22, s[40:43], s30 offen offset:2048  lds
    v_mfma_f32_16x16x32_bf16 v[172:175], a[116:119], a[60:63], v[172:175]
    ds_read_b64_tr_b16 a[102:103], v6 offset:58016
    v_mfma_f32_16x16x32_bf16 v[172:175], a[112:115], a[44:47], v[172:175]
    s_waitcnt lgkmcnt(8)
    v_mfma_f32_16x16x32_bf16 v[188:191], a[120:123], a[44:47], v[188:191]
    ds_read_b64_tr_b16 a[104:105], v6 offset:32960
    v_mfma_f32_16x16x32_bf16 v[188:191], a[124:127], a[60:63], v[188:191]
    v_mfma_f32_16x16x32_bf16 v[184:187], a[124:127], a[56:59], v[184:187]
    ds_read_b64_tr_b16 a[106:107], v6 offset:36544
    v_mfma_f32_16x16x32_bf16 v[184:187], a[120:123], a[40:43], v[184:187]
    buffer_load_dwordx4 v23, s[40:43], s30 offen offset:3072  lds
    v_mfma_f32_16x16x32_bf16 v[180:183], a[120:123], a[36:39], v[180:183]
    ds_read_b64_tr_b16 a[108:109], v6 offset:40128
    s_add_u32 m0, s82, 102400
    v_mfma_f32_16x16x32_bf16 v[180:183], a[124:127], a[52:55], v[180:183]
    v_mfma_f32_16x16x32_bf16 v[176:179], a[124:127], a[48:51], v[176:179]
    ds_read_b64_tr_b16 a[110:111], v6 offset:43712
    v_mfma_f32_16x16x32_bf16 v[176:179], a[120:123], a[32:35], v[176:179]
    s_waitcnt lgkmcnt(8)
    v_mfma_f32_16x16x32_bf16 v[192:195], a[128:131], a[32:35], v[192:195]
    ds_read_b64_tr_b16 a[112:113], v6 offset:47296
    v_mfma_f32_16x16x32_bf16 v[192:195], a[132:135], a[48:51], v[192:195]
    buffer_load_dwordx4 v24, s[40:43], s30 offen offset:0  lds
    v_mfma_f32_16x16x32_bf16 v[196:199], a[132:135], a[52:55], v[196:199]
    ds_read_b64_tr_b16 a[114:115], v6 offset:50880
    v_mfma_f32_16x16x32_bf16 v[196:199], a[128:131], a[36:39], v[196:199]
    v_mfma_f32_16x16x32_bf16 v[200:203], a[128:131], a[40:43], v[200:203]
    ds_read_b64_tr_b16 a[116:117], v6 offset:54464
    v_mfma_f32_16x16x32_bf16 v[200:203], a[132:135], a[56:59], v[200:203]
    v_mfma_f32_16x16x32_bf16 v[204:207], a[132:135], a[60:63], v[204:207]
    ds_read_b64_tr_b16 a[118:119], v6 offset:58048
    v_mfma_f32_16x16x32_bf16 v[204:207], a[128:131], a[44:47], v[204:207]
    buffer_load_dwordx4 v25, s[40:43], s30 offen offset:1024  lds
    s_waitcnt lgkmcnt(8)
    v_mfma_f32_16x16x32_bf16 v[220:223], a[96:99], a[44:47], v[220:223]
    s_waitcnt vmcnt(14)
    s_barrier
    ds_read_b64_tr_b16 a[120:121], v7 offset:0
    v_mfma_f32_16x16x32_bf16 v[220:223], a[100:103], a[60:63], v[220:223]
    v_mfma_f32_16x16x32_bf16 v[216:219], a[100:103], a[56:59], v[216:219]
    ds_read_b64_tr_b16 a[122:123], v7 offset:3584
    v_mfma_f32_16x16x32_bf16 v[216:219], a[96:99], a[40:43], v[216:219]
    v_mfma_f32_16x16x32_bf16 v[212:215], a[96:99], a[36:39], v[212:215]
    ds_read_b64_tr_b16 a[124:125], v7 offset:7168
    v_mfma_f32_16x16x32_bf16 v[212:215], a[100:103], a[52:55], v[212:215]
    v_mfma_f32_16x16x32_bf16 v[208:211], a[100:103], a[48:51], v[208:211]
    ds_read_b64_tr_b16 a[126:127], v7 offset:10752
    v_mfma_f32_16x16x32_bf16 v[208:211], a[96:99], a[32:35], v[208:211]
    buffer_load_dwordx4 v26, s[40:43], s30 offen offset:2048  lds
    s_waitcnt lgkmcnt(8)
    v_mfma_f32_16x16x32_bf16 v[224:227], a[104:107], a[32:35], v[224:227]
    ds_read_b64_tr_b16 a[128:129], v7 offset:14336
    s_bfe_u32 s31, s64, 262156
    v_mfma_f32_16x16x32_bf16 v[224:227], a[108:111], a[48:51], v[224:227]
    s_lshl_b32 s31, s31, 13
    v_mfma_f32_16x16x32_bf16 v[228:231], a[108:111], a[52:55], v[228:231]
    ds_read_b64_tr_b16 a[130:131], v7 offset:17920
    s_add_u32 s31, s31, s16
    v_mfma_f32_16x16x32_bf16 v[228:231], a[104:107], a[36:39], v[228:231]
    v_mfma_f32_16x16x32_bf16 v[232:235], a[104:107], a[40:43], v[232:235]
    ds_read_b64_tr_b16 a[132:133], v7 offset:21504
    v_mfma_f32_16x16x32_bf16 v[232:235], a[108:111], a[56:59], v[232:235]
    buffer_load_dwordx4 a[0:3], v1, s[8:11], s31 offen offset:0 sc1
    v_mfma_f32_16x16x32_bf16 v[236:239], a[108:111], a[60:63], v[236:239]
    ds_read_b64_tr_b16 a[134:135], v7 offset:25088
    v_mfma_f32_16x16x32_bf16 v[236:239], a[104:107], a[44:47], v[236:239]
    s_waitcnt lgkmcnt(8)
    v_mfma_f32_16x16x32_bf16 v[252:255], a[112:115], a[44:47], v[252:255]
    ds_read_b64_tr_b16 a[96:97], v7 offset:32
    v_mfma_f32_16x16x32_bf16 v[252:255], a[116:119], a[60:63], v[252:255]
    v_mfma_f32_16x16x32_bf16 v[248:251], a[116:119], a[56:59], v[248:251]
    ds_read_b64_tr_b16 a[98:99], v7 offset:3616
    v_mfma_f32_16x16x32_bf16 v[248:251], a[112:115], a[40:43], v[248:251]
    buffer_load_dwordx4 a[4:7], v1, s[8:11], s31 offen offset:1024 sc1
    v_mfma_f32_16x16x32_bf16 v[244:247], a[112:115], a[36:39], v[244:247]
    ds_read_b64_tr_b16 a[100:101], v7 offset:7200
    v_mfma_f32_16x16x32_bf16 v[244:247], a[116:119], a[52:55], v[244:247]
    v_mfma_f32_16x16x32_bf16 v[240:243], a[116:119], a[48:51], v[240:243]
    ds_read_b64_tr_b16 a[102:103], v7 offset:10784
    v_mfma_f32_16x16x32_bf16 v[240:243], a[112:115], a[32:35], v[240:243]
    s_waitcnt vmcnt(9) lgkmcnt(8)
    v_mfma_f32_16x16x32_bf16 v[32:35], a[120:123], a[64:67], v[32:35]
    ds_read_b64_tr_b16 a[104:105], v7 offset:14368
    v_mfma_f32_16x16x32_bf16 v[32:35], a[124:127], a[80:83], v[32:35]
    buffer_load_dwordx4 a[8:11], v1, s[8:11], s31 offen offset:2048 sc1
    v_mfma_f32_16x16x32_bf16 v[36:39], a[124:127], a[84:87], v[36:39]
    ds_read_b64_tr_b16 a[106:107], v7 offset:17952
    v_mfma_f32_16x16x32_bf16 v[36:39], a[120:123], a[68:71], v[36:39]
    v_mfma_f32_16x16x32_bf16 v[40:43], a[120:123], a[72:75], v[40:43]
    ds_read_b64_tr_b16 a[108:109], v7 offset:21536
    v_mfma_f32_16x16x32_bf16 v[40:43], a[124:127], a[88:91], v[40:43]
    v_mfma_f32_16x16x32_bf16 v[44:47], a[124:127], a[92:95], v[44:47]
    ds_read_b64_tr_b16 a[110:111], v7 offset:25120
    v_mfma_f32_16x16x32_bf16 v[44:47], a[120:123], a[76:79], v[44:47]
    buffer_load_dwordx4 a[12:15], v1, s[8:11], s31 offen offset:3072 sc1
    s_waitcnt lgkmcnt(8)
    v_mfma_f32_16x16x32_bf16 v[60:63], a[128:131], a[76:79], v[60:63]
    ds_read_b64_tr_b16 a[112:113], v7 offset:64
    v_mfma_f32_16x16x32_bf16 v[60:63], a[132:135], a[92:95], v[60:63]
    v_mfma_f32_16x16x32_bf16 v[56:59], a[132:135], a[88:91], v[56:59]
    ds_read_b64_tr_b16 a[114:115], v7 offset:3648
    v_mfma_f32_16x16x32_bf16 v[56:59], a[128:131], a[72:75], v[56:59]
    v_mfma_f32_16x16x32_bf16 v[52:55], a[128:131], a[68:71], v[52:55]
    ds_read_b64_tr_b16 a[116:117], v7 offset:7232
    v_mfma_f32_16x16x32_bf16 v[52:55], a[132:135], a[84:87], v[52:55]
    buffer_load_dwordx4 a[16:19], v30, s[8:11], s31 offen offset:0 sc1
    v_mfma_f32_16x16x32_bf16 v[48:51], a[132:135], a[80:83], v[48:51]
    ds_read_b64_tr_b16 a[118:119], v7 offset:10816
    v_mfma_f32_16x16x32_bf16 v[48:51], a[128:131], a[64:67], v[48:51]
    s_waitcnt lgkmcnt(8)
    v_mfma_f32_16x16x32_bf16 v[64:67], a[96:99], a[64:67], v[64:67]
    ds_read_b64_tr_b16 a[120:121], v7 offset:14400
    v_mfma_f32_16x16x32_bf16 v[64:67], a[100:103], a[80:83], v[64:67]
    v_mfma_f32_16x16x32_bf16 v[68:71], a[100:103], a[84:87], v[68:71]
    ds_read_b64_tr_b16 a[122:123], v7 offset:17984
    v_mfma_f32_16x16x32_bf16 v[68:71], a[96:99], a[68:71], v[68:71]
    buffer_load_dwordx4 a[20:23], v30, s[8:11], s31 offen offset:1024 sc1
    v_mfma_f32_16x16x32_bf16 v[72:75], a[96:99], a[72:75], v[72:75]
    ds_read_b64_tr_b16 a[124:125], v7 offset:21568
    v_mfma_f32_16x16x32_bf16 v[72:75], a[100:103], a[88:91], v[72:75]
    v_mfma_f32_16x16x32_bf16 v[76:79], a[100:103], a[92:95], v[76:79]
    ds_read_b64_tr_b16 a[126:127], v7 offset:25152
    v_mfma_f32_16x16x32_bf16 v[76:79], a[96:99], a[76:79], v[76:79]
    s_waitcnt lgkmcnt(8)
    v_mfma_f32_16x16x32_bf16 v[92:95], a[104:107], a[76:79], v[92:95]
    ds_read_b64_tr_b16 a[128:129], v7 offset:96
    v_mfma_f32_16x16x32_bf16 v[92:95], a[108:111], a[92:95], v[92:95]
    buffer_load_dwordx4 a[24:27], v30, s[8:11], s31 offen offset:2048 sc1
    v_mfma_f32_16x16x32_bf16 v[88:91], a[108:111], a[88:91], v[88:91]
    ds_read_b64_tr_b16 a[130:131], v7 offset:3680
    v_mfma_f32_16x16x32_bf16 v[88:91], a[104:107], a[72:75], v[88:91]
    v_mfma_f32_16x16x32_bf16 v[84:87], a[104:107], a[68:71], v[84:87]
    ds_read_b64_tr_b16 a[132:133], v7 offset:7264
    v_mfma_f32_16x16x32_bf16 v[84:87], a[108:111], a[84:87], v[84:87]
    v_mfma_f32_16x16x32_bf16 v[80:83], a[108:111], a[80:83], v[80:83]
    ds_read_b64_tr_b16 a[134:135], v7 offset:10848
    v_mfma_f32_16x16x32_bf16 v[80:83], a[104:107], a[64:67], v[80:83]
    buffer_load_dwordx4 a[28:31], v30, s[8:11], s31 offen offset:3072 sc1
    s_waitcnt lgkmcnt(8)
    v_mfma_f32_16x16x32_bf16 v[96:99], a[112:115], a[64:67], v[96:99]
    ds_read_b64_tr_b16 a[96:97], v7 offset:14432
    s_add_u32 m0, s82, 0
    v_mfma_f32_16x16x32_bf16 v[96:99], a[116:119], a[80:83], v[96:99]
    s_bfe_u32 s30, s64, 262160
    v_mfma_f32_16x16x32_bf16 v[100:103], a[116:119], a[84:87], v[100:103]
    ds_read_b64_tr_b16 a[98:99], v7 offset:18016
    s_mul_i32 s30, s30, 458752
    v_mfma_f32_16x16x32_bf16 v[100:103], a[112:115], a[68:71], v[100:103]
    v_mfma_f32_16x16x32_bf16 v[104:107], a[112:115], a[72:75], v[104:107]
    ds_read_b64_tr_b16 a[100:101], v7 offset:21600
    v_mfma_f32_16x16x32_bf16 v[104:107], a[116:119], a[88:91], v[104:107]
    buffer_load_dwordx4 v20, s[40:43], s30 offen offset:0  lds
    v_mfma_f32_16x16x32_bf16 v[108:111], a[116:119], a[92:95], v[108:111]
    ds_read_b64_tr_b16 a[102:103], v7 offset:25184
    v_mfma_f32_16x16x32_bf16 v[108:111], a[112:115], a[76:79], v[108:111]
    s_waitcnt lgkmcnt(8)
    v_mfma_f32_16x16x32_bf16 v[124:127], a[120:123], a[76:79], v[124:127]
    ds_read_b64_tr_b16 a[104:105], v7 offset:128
    v_mfma_f32_16x16x32_bf16 v[124:127], a[124:127], a[92:95], v[124:127]
    v_mfma_f32_16x16x32_bf16 v[120:123], a[124:127], a[88:91], v[120:123]
    ds_read_b64_tr_b16 a[106:107], v7 offset:3712
    v_mfma_f32_16x16x32_bf16 v[120:123], a[120:123], a[72:75], v[120:123]
    v_mfma_f32_16x16x32_bf16 v[116:119], a[120:123], a[68:71], v[116:119]
    ds_read_b64_tr_b16 a[108:109], v7 offset:7296
    v_mfma_f32_16x16x32_bf16 v[116:119], a[124:127], a[84:87], v[116:119]
    buffer_load_dwordx4 v21, s[40:43], s30 offen offset:1024  lds
    v_mfma_f32_16x16x32_bf16 v[112:115], a[124:127], a[80:83], v[112:115]
    ds_read_b64_tr_b16 a[110:111], v7 offset:10880
    v_mfma_f32_16x16x32_bf16 v[112:115], a[120:123], a[64:67], v[112:115]
    s_waitcnt lgkmcnt(8)
    v_mfma_f32_16x16x32_bf16 v[128:131], a[128:131], a[64:67], v[128:131]
    ds_read_b64_tr_b16 a[112:113], v7 offset:14464
    v_mfma_f32_16x16x32_bf16 v[128:131], a[132:135], a[80:83], v[128:131]
    v_mfma_f32_16x16x32_bf16 v[132:135], a[132:135], a[84:87], v[132:135]
    ds_read_b64_tr_b16 a[114:115], v7 offset:18048
    v_mfma_f32_16x16x32_bf16 v[132:135], a[128:131], a[68:71], v[132:135]
    buffer_load_dwordx4 v22, s[40:43], s30 offen offset:2048  lds
    v_mfma_f32_16x16x32_bf16 v[136:139], a[128:131], a[72:75], v[136:139]
    ds_read_b64_tr_b16 a[116:117], v7 offset:21632
    v_mfma_f32_16x16x32_bf16 v[136:139], a[132:135], a[88:91], v[136:139]
    v_mfma_f32_16x16x32_bf16 v[140:143], a[132:135], a[92:95], v[140:143]
    ds_read_b64_tr_b16 a[118:119], v7 offset:25216
    v_mfma_f32_16x16x32_bf16 v[140:143], a[128:131], a[76:79], v[140:143]
    s_waitcnt lgkmcnt(8)
    v_mfma_f32_16x16x32_bf16 v[156:159], a[96:99], a[76:79], v[156:159]
    ds_read_b64_tr_b16 a[120:121], v7 offset:160
    v_mfma_f32_16x16x32_bf16 v[156:159], a[100:103], a[92:95], v[156:159]
    buffer_load_dwordx4 v23, s[40:43], s30 offen offset:3072  lds
    v_mfma_f32_16x16x32_bf16 v[152:155], a[100:103], a[88:91], v[152:155]
    ds_read_b64_tr_b16 a[122:123], v7 offset:3744
    s_add_u32 m0, s82, 4096
    v_mfma_f32_16x16x32_bf16 v[152:155], a[96:99], a[72:75], v[152:155]
    v_mfma_f32_16x16x32_bf16 v[148:151], a[96:99], a[68:71], v[148:151]
    ds_read_b64_tr_b16 a[124:125], v7 offset:7328
    v_mfma_f32_16x16x32_bf16 v[148:151], a[100:103], a[84:87], v[148:151]
    v_mfma_f32_16x16x32_bf16 v[144:147], a[100:103], a[80:83], v[144:147]
    ds_read_b64_tr_b16 a[126:127], v7 offset:10912
    v_mfma_f32_16x16x32_bf16 v[144:147], a[96:99], a[64:67], v[144:147]
    buffer_load_dwordx4 v24, s[40:43], s30 offen offset:0  lds
    s_waitcnt lgkmcnt(8)
    v_mfma_f32_16x16x32_bf16 v[160:163], a[104:107], a[64:67], v[160:163]
    ds_read_b64_tr_b16 a[128:129], v7 offset:14496
    v_mfma_f32_16x16x32_bf16 v[160:163], a[108:111], a[80:83], v[160:163]
    v_mfma_f32_16x16x32_bf16 v[164:167], a[108:111], a[84:87], v[164:167]
    ds_read_b64_tr_b16 a[130:131], v7 offset:18080
    v_mfma_f32_16x16x32_bf16 v[164:167], a[104:107], a[68:71], v[164:167]
    v_mfma_f32_16x16x32_bf16 v[168:171], a[104:107], a[72:75], v[168:171]
    ds_read_b64_tr_b16 a[132:133], v7 offset:21664
    v_mfma_f32_16x16x32_bf16 v[168:171], a[108:111], a[88:91], v[168:171]
    buffer_load_dwordx4 v25, s[40:43], s30 offen offset:1024  lds
    v_mfma_f32_16x16x32_bf16 v[172:175], a[108:111], a[92:95], v[172:175]
    ds_read_b64_tr_b16 a[134:135], v7 offset:25248
    v_mfma_f32_16x16x32_bf16 v[172:175], a[104:107], a[76:79], v[172:175]
    s_waitcnt lgkmcnt(8)
    v_mfma_f32_16x16x32_bf16 v[188:191], a[112:115], a[76:79], v[188:191]
    ds_read_b64_tr_b16 a[96:97], v7 offset:192
    v_mfma_f32_16x16x32_bf16 v[188:191], a[116:119], a[92:95], v[188:191]
    v_mfma_f32_16x16x32_bf16 v[184:187], a[116:119], a[88:91], v[184:187]
    ds_read_b64_tr_b16 a[98:99], v7 offset:3776
    v_mfma_f32_16x16x32_bf16 v[184:187], a[112:115], a[72:75], v[184:187]
    buffer_load_dwordx4 v26, s[40:43], s30 offen offset:2048  lds
    v_mfma_f32_16x16x32_bf16 v[180:183], a[112:115], a[68:71], v[180:183]
    ds_read_b64_tr_b16 a[100:101], v7 offset:7360
    s_bfe_u32 s31, s64, 262160
    v_mfma_f32_16x16x32_bf16 v[180:183], a[116:119], a[84:87], v[180:183]
    s_lshl_b32 s31, s31, 13
    v_mfma_f32_16x16x32_bf16 v[176:179], a[116:119], a[80:83], v[176:179]
    ds_read_b64_tr_b16 a[102:103], v7 offset:10944
    s_add_u32 s31, s31, s16
    v_mfma_f32_16x16x32_bf16 v[176:179], a[112:115], a[64:67], v[176:179]
    s_waitcnt lgkmcnt(8)
    v_mfma_f32_16x16x32_bf16 v[192:195], a[120:123], a[64:67], v[192:195]
    ds_read_b64_tr_b16 a[104:105], v7 offset:14528
    v_mfma_f32_16x16x32_bf16 v[192:195], a[124:127], a[80:83], v[192:195]
    buffer_load_dwordx4 a[32:35], v1, s[8:11], s31 offen offset:0 sc1
    v_mfma_f32_16x16x32_bf16 v[196:199], a[124:127], a[84:87], v[196:199]
    ds_read_b64_tr_b16 a[106:107], v7 offset:18112
    v_mfma_f32_16x16x32_bf16 v[196:199], a[120:123], a[68:71], v[196:199]
    v_mfma_f32_16x16x32_bf16 v[200:203], a[120:123], a[72:75], v[200:203]
    ds_read_b64_tr_b16 a[108:109], v7 offset:21696
    v_mfma_f32_16x16x32_bf16 v[200:203], a[124:127], a[88:91], v[200:203]
    v_mfma_f32_16x16x32_bf16 v[204:207], a[124:127], a[92:95], v[204:207]
    ds_read_b64_tr_b16 a[110:111], v7 offset:25280
    v_mfma_f32_16x16x32_bf16 v[204:207], a[120:123], a[76:79], v[204:207]
    buffer_load_dwordx4 a[36:39], v1, s[8:11], s31 offen offset:1024 sc1
    s_waitcnt lgkmcnt(8)
    v_mfma_f32_16x16x32_bf16 v[220:223], a[128:131], a[76:79], v[220:223]
    s_waitcnt vmcnt(17)
    s_barrier
    ds_read_b64_tr_b16 a[112:113], v7 offset:32768
    v_mfma_f32_16x16x32_bf16 v[220:223], a[132:135], a[92:95], v[220:223]
    v_mfma_f32_16x16x32_bf16 v[216:219], a[132:135], a[88:91], v[216:219]
    ds_read_b64_tr_b16 a[114:115], v7 offset:36352
    v_mfma_f32_16x16x32_bf16 v[216:219], a[128:131], a[72:75], v[216:219]
    v_mfma_f32_16x16x32_bf16 v[212:215], a[128:131], a[68:71], v[212:215]
    ds_read_b64_tr_b16 a[116:117], v7 offset:39936
    v_mfma_f32_16x16x32_bf16 v[212:215], a[132:135], a[84:87], v[212:215]
    buffer_load_dwordx4 a[40:43], v1, s[8:11], s31 offen offset:2048 sc1
    v_mfma_f32_16x16x32_bf16 v[208:211], a[132:135], a[80:83], v[208:211]
    ds_read_b64_tr_b16 a[118:119], v7 offset:43520
    v_mfma_f32_16x16x32_bf16 v[208:211], a[128:131], a[64:67], v[208:211]
    s_waitcnt lgkmcnt(8)
    v_mfma_f32_16x16x32_bf16 v[224:227], a[96:99], a[64:67], v[224:227]
    ds_read_b64_tr_b16 a[120:121], v7 offset:47104
    v_mfma_f32_16x16x32_bf16 v[224:227], a[100:103], a[80:83], v[224:227]
    v_mfma_f32_16x16x32_bf16 v[228:231], a[100:103], a[84:87], v[228:231]
    ds_read_b64_tr_b16 a[122:123], v7 offset:50688
    v_mfma_f32_16x16x32_bf16 v[228:231], a[96:99], a[68:71], v[228:231]
    buffer_load_dwordx4 a[44:47], v1, s[8:11], s31 offen offset:3072 sc1
    v_mfma_f32_16x16x32_bf16 v[232:235], a[96:99], a[72:75], v[232:235]
    ds_read_b64_tr_b16 a[124:125], v7 offset:54272
    v_mfma_f32_16x16x32_bf16 v[232:235], a[100:103], a[88:91], v[232:235]
    v_mfma_f32_16x16x32_bf16 v[236:239], a[100:103], a[92:95], v[236:239]
    ds_read_b64_tr_b16 a[126:127], v7 offset:57856
    v_mfma_f32_16x16x32_bf16 v[236:239], a[96:99], a[76:79], v[236:239]
    s_waitcnt lgkmcnt(8)
    v_mfma_f32_16x16x32_bf16 v[252:255], a[104:107], a[76:79], v[252:255]
    ds_read_b64_tr_b16 a[128:129], v7 offset:32800
    v_mfma_f32_16x16x32_bf16 v[252:255], a[108:111], a[92:95], v[252:255]
    v_mfma_f32_16x16x32_bf16 v[248:251], a[108:111], a[88:91], v[248:251]
    ds_read_b64_tr_b16 a[130:131], v7 offset:36384
    v_mfma_f32_16x16x32_bf16 v[248:251], a[104:107], a[72:75], v[248:251]
    buffer_load_dwordx4 a[48:51], v30, s[8:11], s31 offen offset:0 sc1
    v_mfma_f32_16x16x32_bf16 v[244:247], a[104:107], a[68:71], v[244:247]
    ds_read_b64_tr_b16 a[132:133], v7 offset:39968
    v_mfma_f32_16x16x32_bf16 v[244:247], a[108:111], a[84:87], v[244:247]
    v_mfma_f32_16x16x32_bf16 v[240:243], a[108:111], a[80:83], v[240:243]
    ds_read_b64_tr_b16 a[134:135], v7 offset:43552
    v_mfma_f32_16x16x32_bf16 v[240:243], a[104:107], a[64:67], v[240:243]
    s_waitcnt vmcnt(12) lgkmcnt(8)
    v_mfma_f32_16x16x32_bf16 v[32:35], a[112:115], a[0:3], v[32:35]
    ds_read_b64_tr_b16 a[96:97], v7 offset:47136
    v_mfma_f32_16x16x32_bf16 v[32:35], a[116:119], a[16:19], v[32:35]
    buffer_load_dwordx4 a[52:55], v30, s[8:11], s31 offen offset:1024 sc1
    v_mfma_f32_16x16x32_bf16 v[36:39], a[116:119], a[20:23], v[36:39]
    ds_read_b64_tr_b16 a[98:99], v7 offset:50720
    v_mfma_f32_16x16x32_bf16 v[36:39], a[112:115], a[4:7], v[36:39]
    v_mfma_f32_16x16x32_bf16 v[40:43], a[112:115], a[8:11], v[40:43]
    ds_read_b64_tr_b16 a[100:101], v7 offset:54304
    v_mfma_f32_16x16x32_bf16 v[40:43], a[116:119], a[24:27], v[40:43]
    v_mfma_f32_16x16x32_bf16 v[44:47], a[116:119], a[28:31], v[44:47]
    ds_read_b64_tr_b16 a[102:103], v7 offset:57888
    v_mfma_f32_16x16x32_bf16 v[44:47], a[112:115], a[12:15], v[44:47]
    buffer_load_dwordx4 a[56:59], v30, s[8:11], s31 offen offset:2048 sc1
    s_waitcnt lgkmcnt(8)
    v_mfma_f32_16x16x32_bf16 v[60:63], a[120:123], a[12:15], v[60:63]
    ds_read_b64_tr_b16 a[104:105], v7 offset:32832
    v_mfma_f32_16x16x32_bf16 v[60:63], a[124:127], a[28:31], v[60:63]
    v_mfma_f32_16x16x32_bf16 v[56:59], a[124:127], a[24:27], v[56:59]
    ds_read_b64_tr_b16 a[106:107], v7 offset:36416
    v_mfma_f32_16x16x32_bf16 v[56:59], a[120:123], a[8:11], v[56:59]
    v_mfma_f32_16x16x32_bf16 v[52:55], a[120:123], a[4:7], v[52:55]
    ds_read_b64_tr_b16 a[108:109], v7 offset:40000
    v_mfma_f32_16x16x32_bf16 v[52:55], a[124:127], a[20:23], v[52:55]
    buffer_load_dwordx4 a[60:63], v30, s[8:11], s31 offen offset:3072 sc1
    v_mfma_f32_16x16x32_bf16 v[48:51], a[124:127], a[16:19], v[48:51]
    ds_read_b64_tr_b16 a[110:111], v7 offset:43584
    s_add_u32 m0, s82, 32768
    v_mfma_f32_16x16x32_bf16 v[48:51], a[120:123], a[0:3], v[48:51]
    s_bfe_u32 s30, s64, 262164
    s_waitcnt lgkmcnt(8)
    v_mfma_f32_16x16x32_bf16 v[64:67], a[128:131], a[0:3], v[64:67]
    ds_read_b64_tr_b16 a[112:113], v7 offset:47168
    s_mul_i32 s30, s30, 458752
    v_mfma_f32_16x16x32_bf16 v[64:67], a[132:135], a[16:19], v[64:67]
    v_mfma_f32_16x16x32_bf16 v[68:71], a[132:135], a[20:23], v[68:71]
    ds_read_b64_tr_b16 a[114:115], v7 offset:50752
    v_mfma_f32_16x16x32_bf16 v[68:71], a[128:131], a[4:7], v[68:71]
    buffer_load_dwordx4 v20, s[40:43], s30 offen offset:0  lds
    v_mfma_f32_16x16x32_bf16 v[72:75], a[128:131], a[8:11], v[72:75]
    ds_read_b64_tr_b16 a[116:117], v7 offset:54336
    v_mfma_f32_16x16x32_bf16 v[72:75], a[132:135], a[24:27], v[72:75]
    v_mfma_f32_16x16x32_bf16 v[76:79], a[132:135], a[28:31], v[76:79]
    ds_read_b64_tr_b16 a[118:119], v7 offset:57920
    v_mfma_f32_16x16x32_bf16 v[76:79], a[128:131], a[12:15], v[76:79]
    s_waitcnt lgkmcnt(8)
    v_mfma_f32_16x16x32_bf16 v[92:95], a[96:99], a[12:15], v[92:95]
    ds_read_b64_tr_b16 a[120:121], v7 offset:32864
    v_mfma_f32_16x16x32_bf16 v[92:95], a[100:103], a[28:31], v[92:95]
    buffer_load_dwordx4 v21, s[40:43], s30 offen offset:1024  lds
    v_mfma_f32_16x16x32_bf16 v[88:91], a[100:103], a[24:27], v[88:91]
    ds_read_b64_tr_b16 a[122:123], v7 offset:36448
    v_mfma_f32_16x16x32_bf16 v[88:91], a[96:99], a[8:11], v[88:91]
    v_mfma_f32_16x16x32_bf16 v[84:87], a[96:99], a[4:7], v[84:87]
    ds_read_b64_tr_b16 a[124:125], v7 offset:40032
    v_mfma_f32_16x16x32_bf16 v[84:87], a[100:103], a[20:23], v[84:87]
    v_mfma_f32_16x16x32_bf16 v[80:83], a[100:103], a[16:19], v[80:83]
    ds_read_b64_tr_b16 a[126:127], v7 offset:43616
    v_mfma_f32_16x16x32_bf16 v[80:83], a[96:99], a[0:3], v[80:83]
    buffer_load_dwordx4 v22, s[40:43], s30 offen offset:2048  lds
    s_waitcnt lgkmcnt(8)
    v_mfma_f32_16x16x32_bf16 v[96:99], a[104:107], a[0:3], v[96:99]
    ds_read_b64_tr_b16 a[128:129], v7 offset:47200
    v_mfma_f32_16x16x32_bf16 v[96:99], a[108:111], a[16:19], v[96:99]
    v_mfma_f32_16x16x32_bf16 v[100:103], a[108:111], a[20:23], v[100:103]
    ds_read_b64_tr_b16 a[130:131], v7 offset:50784
    v_mfma_f32_16x16x32_bf16 v[100:103], a[104:107], a[4:7], v[100:103]
    v_mfma_f32_16x16x32_bf16 v[104:107], a[104:107], a[8:11], v[104:107]
    ds_read_b64_tr_b16 a[132:133], v7 offset:54368
    v_mfma_f32_16x16x32_bf16 v[104:107], a[108:111], a[24:27], v[104:107]
    buffer_load_dwordx4 v23, s[40:43], s30 offen offset:3072  lds
    v_mfma_f32_16x16x32_bf16 v[108:111], a[108:111], a[28:31], v[108:111]
    ds_read_b64_tr_b16 a[134:135], v7 offset:57952
    s_add_u32 m0, s82, 36864
    v_mfma_f32_16x16x32_bf16 v[108:111], a[104:107], a[12:15], v[108:111]
    s_waitcnt lgkmcnt(8)
    v_mfma_f32_16x16x32_bf16 v[124:127], a[112:115], a[12:15], v[124:127]
    ds_read_b64_tr_b16 a[96:97], v7 offset:32896
    v_mfma_f32_16x16x32_bf16 v[124:127], a[116:119], a[28:31], v[124:127]
    v_mfma_f32_16x16x32_bf16 v[120:123], a[116:119], a[24:27], v[120:123]
    ds_read_b64_tr_b16 a[98:99], v7 offset:36480
    v_mfma_f32_16x16x32_bf16 v[120:123], a[112:115], a[8:11], v[120:123]
    buffer_load_dwordx4 v24, s[40:43], s30 offen offset:0  lds
    v_mfma_f32_16x16x32_bf16 v[116:119], a[112:115], a[4:7], v[116:119]
    ds_read_b64_tr_b16 a[100:101], v7 offset:40064
    v_mfma_f32_16x16x32_bf16 v[116:119], a[116:119], a[20:23], v[116:119]
    v_mfma_f32_16x16x32_bf16 v[112:115], a[116:119], a[16:19], v[112:115]
    ds_read_b64_tr_b16 a[102:103], v7 offset:43648
    v_mfma_f32_16x16x32_bf16 v[112:115], a[112:115], a[0:3], v[112:115]
    s_waitcnt lgkmcnt(8)
    v_mfma_f32_16x16x32_bf16 v[128:131], a[120:123], a[0:3], v[128:131]
    ds_read_b64_tr_b16 a[104:105], v7 offset:47232
    v_mfma_f32_16x16x32_bf16 v[128:131], a[124:127], a[16:19], v[128:131]
    buffer_load_dwordx4 v25, s[40:43], s30 offen offset:1024  lds
    v_mfma_f32_16x16x32_bf16 v[132:135], a[124:127], a[20:23], v[132:135]
    ds_read_b64_tr_b16 a[106:107], v7 offset:50816
    v_mfma_f32_16x16x32_bf16 v[132:135], a[120:123], a[4:7], v[132:135]
    v_mfma_f32_16x16x32_bf16 v[136:139], a[120:123], a[8:11], v[136:139]
    ds_read_b64_tr_b16 a[108:109], v7 offset:54400
    v_mfma_f32_16x16x32_bf16 v[136:139], a[124:127], a[24:27], v[136:139]
    v_mfma_f32_16x16x32_bf16 v[140:143], a[124:127], a[28:31], v[140:143]
    ds_read_b64_tr_b16 a[110:111], v7 offset:57984
    v_mfma_f32_16x16x32_bf16 v[140:143], a[120:123], a[12:15], v[140:143]
    s_waitcnt lgkmcnt(8)
    v_mfma_f32_16x16x32_bf16 v[156:159], a[128:131], a[12:15], v[156:159]
    ds_read_b64_tr_b16 a[112:113], v7 offset:32928
    v_mfma_f32_16x16x32_bf16 v[156:159], a[132:135], a[28:31], v[156:159]
    buffer_load_dwordx4 v26, s[40:43], s30 offen offset:2048  lds
    v_mfma_f32_16x16x32_bf16 v[152:155], a[132:135], a[24:27], v[152:155]
    ds_read_b64_tr_b16 a[114:115], v7 offset:36512
    s_bfe_u32 s31, s64, 262164
    v_mfma_f32_16x16x32_bf16 v[152:155], a[128:131], a[8:11], v[152:155]
    s_lshl_b32 s31, s31, 13
    v_mfma_f32_16x16x32_bf16 v[148:151], a[128:131], a[4:7], v[148:151]
    ds_read_b64_tr_b16 a[116:117], v7 offset:40096
    s_add_u32 s31, s31, s16
    v_mfma_f32_16x16x32_bf16 v[148:151], a[132:135], a[20:23], v[148:151]
    v_mfma_f32_16x16x32_bf16 v[144:147], a[132:135], a[16:19], v[144:147]
    ds_read_b64_tr_b16 a[118:119], v7 offset:43680
    v_mfma_f32_16x16x32_bf16 v[144:147], a[128:131], a[0:3], v[144:147]
    buffer_load_dwordx4 a[64:67], v1, s[8:11], s31 offen offset:0 sc1
    s_waitcnt lgkmcnt(8)
    v_mfma_f32_16x16x32_bf16 v[160:163], a[96:99], a[0:3], v[160:163]
    ds_read_b64_tr_b16 a[120:121], v7 offset:47264
    v_mfma_f32_16x16x32_bf16 v[160:163], a[100:103], a[16:19], v[160:163]
    v_mfma_f32_16x16x32_bf16 v[164:167], a[100:103], a[20:23], v[164:167]
    ds_read_b64_tr_b16 a[122:123], v7 offset:50848
    v_mfma_f32_16x16x32_bf16 v[164:167], a[96:99], a[4:7], v[164:167]
    v_mfma_f32_16x16x32_bf16 v[168:171], a[96:99], a[8:11], v[168:171]
    ds_read_b64_tr_b16 a[124:125], v7 offset:54432
    v_mfma_f32_16x16x32_bf16 v[168:171], a[100:103], a[24:27], v[168:171]
    buffer_load_dwordx4 a[68:71], v1, s[8:11], s31 offen offset:1024 sc1
    v_mfma_f32_16x16x32_bf16 v[172:175], a[100:103], a[28:31], v[172:175]
    ds_read_b64_tr_b16 a[126:127], v7 offset:58016
    v_mfma_f32_16x16x32_bf16 v[172:175], a[96:99], a[12:15], v[172:175]
    s_waitcnt lgkmcnt(8)
    v_mfma_f32_16x16x32_bf16 v[188:191], a[104:107], a[12:15], v[188:191]
    ds_read_b64_tr_b16 a[128:129], v7 offset:32960
    v_mfma_f32_16x16x32_bf16 v[188:191], a[108:111], a[28:31], v[188:191]
    v_mfma_f32_16x16x32_bf16 v[184:187], a[108:111], a[24:27], v[184:187]
    ds_read_b64_tr_b16 a[130:131], v7 offset:36544
    v_mfma_f32_16x16x32_bf16 v[184:187], a[104:107], a[8:11], v[184:187]
    buffer_load_dwordx4 a[72:75], v1, s[8:11], s31 offen offset:2048 sc1
    v_mfma_f32_16x16x32_bf16 v[180:183], a[104:107], a[4:7], v[180:183]
    ds_read_b64_tr_b16 a[132:133], v7 offset:40128
    v_mfma_f32_16x16x32_bf16 v[180:183], a[108:111], a[20:23], v[180:183]
    v_mfma_f32_16x16x32_bf16 v[176:179], a[108:111], a[16:19], v[176:179]
    ds_read_b64_tr_b16 a[134:135], v7 offset:43712
    v_mfma_f32_16x16x32_bf16 v[176:179], a[104:107], a[0:3], v[176:179]
    s_waitcnt lgkmcnt(8)
    v_mfma_f32_16x16x32_bf16 v[192:195], a[112:115], a[0:3], v[192:195]
    ds_read_b64_tr_b16 a[96:97], v7 offset:47296
    v_mfma_f32_16x16x32_bf16 v[192:195], a[116:119], a[16:19], v[192:195]
    buffer_load_dwordx4 a[76:79], v1, s[8:11], s31 offen offset:3072 sc1
    v_mfma_f32_16x16x32_bf16 v[196:199], a[116:119], a[20:23], v[196:199]
    ds_read_b64_tr_b16 a[98:99], v7 offset:50880
    v_mfma_f32_16x16x32_bf16 v[196:199], a[112:115], a[4:7], v[196:199]
    v_mfma_f32_16x16x32_bf16 v[200:203], a[112:115], a[8:11], v[200:203]
    ds_read_b64_tr_b16 a[100:101], v7 offset:54464
    v_mfma_f32_16x16x32_bf16 v[200:203], a[116:119], a[24:27], v[200:203]
    v_mfma_f32_16x16x32_bf16 v[204:207], a[116:119], a[28:31], v[204:207]
    ds_read_b64_tr_b16 a[102:103], v7 offset:58048
    v_mfma_f32_16x16x32_bf16 v[204:207], a[112:115], a[12:15], v[204:207]
    buffer_load_dwordx4 a[80:83], v30, s[8:11], s31 offen offset:0 sc1
    s_waitcnt lgkmcnt(8)
    v_mfma_f32_16x16x32_bf16 v[220:223], a[120:123], a[12:15], v[220:223]
    s_waitcnt vmcnt(20)
    s_barrier
    ds_read_b64_tr_b16 a[104:105], v6 offset:0
    v_mfma_f32_16x16x32_bf16 v[220:223], a[124:127], a[28:31], v[220:223]
    v_mfma_f32_16x16x32_bf16 v[216:219], a[124:127], a[24:27], v[216:219]
    ds_read_b64_tr_b16 a[106:107], v6 offset:3584
    v_mfma_f32_16x16x32_bf16 v[216:219], a[120:123], a[8:11], v[216:219]
    v_mfma_f32_16x16x32_bf16 v[212:215], a[120:123], a[4:7], v[212:215]
    ds_read_b64_tr_b16 a[108:109], v6 offset:7168
    v_mfma_f32_16x16x32_bf16 v[212:215], a[124:127], a[20:23], v[212:215]
    buffer_load_dwordx4 a[84:87], v30, s[8:11], s31 offen offset:1024 sc1
    v_mfma_f32_16x16x32_bf16 v[208:211], a[124:127], a[16:19], v[208:211]
    ds_read_b64_tr_b16 a[110:111], v6 offset:10752
    v_mfma_f32_16x16x32_bf16 v[208:211], a[120:123], a[0:3], v[208:211]
    s_waitcnt lgkmcnt(8)
    v_mfma_f32_16x16x32_bf16 v[224:227], a[128:131], a[0:3], v[224:227]
    ds_read_b64_tr_b16 a[112:113], v6 offset:14336
    v_mfma_f32_16x16x32_bf16 v[224:227], a[132:135], a[16:19], v[224:227]
    v_mfma_f32_16x16x32_bf16 v[228:231], a[132:135], a[20:23], v[228:231]
    ds_read_b64_tr_b16 a[114:115], v6 offset:17920
    v_mfma_f32_16x16x32_bf16 v[228:231], a[128:131], a[4:7], v[228:231]
    buffer_load_dwordx4 a[88:91], v30, s[8:11], s31 offen offset:2048 sc1
    v_mfma_f32_16x16x32_bf16 v[232:235], a[128:131], a[8:11], v[232:235]
    ds_read_b64_tr_b16 a[116:117], v6 offset:21504
    v_mfma_f32_16x16x32_bf16 v[232:235], a[132:135], a[24:27], v[232:235]
    v_mfma_f32_16x16x32_bf16 v[236:239], a[132:135], a[28:31], v[236:239]
    ds_read_b64_tr_b16 a[118:119], v6 offset:25088
    v_mfma_f32_16x16x32_bf16 v[236:239], a[128:131], a[12:15], v[236:239]
    s_waitcnt lgkmcnt(8)
    v_mfma_f32_16x16x32_bf16 v[252:255], a[96:99], a[12:15], v[252:255]
    ds_read_b64_tr_b16 a[120:121], v6 offset:32
    v_mfma_f32_16x16x32_bf16 v[252:255], a[100:103], a[28:31], v[252:255]
    buffer_load_dwordx4 a[92:95], v30, s[8:11], s31 offen offset:3072 sc1
    v_mfma_f32_16x16x32_bf16 v[248:251], a[100:103], a[24:27], v[248:251]
    ds_read_b64_tr_b16 a[122:123], v6 offset:3616
    v_accvgpr_read_b32 v31, a201
    v_mfma_f32_16x16x32_bf16 v[248:251], a[96:99], a[8:11], v[248:251]
    v_mfma_f32_16x16x32_bf16 v[244:247], a[96:99], a[4:7], v[244:247]
    ds_read_b64_tr_b16 a[124:125], v6 offset:7200
    v_mfma_f32_16x16x32_bf16 v[244:247], a[100:103], a[20:23], v[244:247]
    v_mfma_f32_16x16x32_bf16 v[240:243], a[100:103], a[16:19], v[240:243]
    ds_read_b64_tr_b16 a[126:127], v6 offset:10784
    v_mfma_f32_16x16x32_bf16 v[240:243], a[96:99], a[0:3], v[240:243]
    global_load_dword a200, v31, s[74:75]
    s_waitcnt vmcnt(16) lgkmcnt(8)
    v_mfma_f32_16x16x32_bf16 v[32:35], a[104:107], a[32:35], v[32:35]
    ds_read_b64_tr_b16 a[128:129], v6 offset:14368
    s_add_u32 m0, s82, 65536
    v_mfma_f32_16x16x32_bf16 v[32:35], a[108:111], a[48:51], v[32:35]
    s_bfe_u32 s30, s64, 262168
    v_mfma_f32_16x16x32_bf16 v[36:39], a[108:111], a[52:55], v[36:39]
    ds_read_b64_tr_b16 a[130:131], v6 offset:17952
    s_mul_i32 s30, s30, 458752
    v_mfma_f32_16x16x32_bf16 v[36:39], a[104:107], a[36:39], v[36:39]
    v_mfma_f32_16x16x32_bf16 v[40:43], a[104:107], a[40:43], v[40:43]
    ds_read_b64_tr_b16 a[132:133], v6 offset:21536
    v_mfma_f32_16x16x32_bf16 v[40:43], a[108:111], a[56:59], v[40:43]
    v_mfma_f32_16x16x32_bf16 v[44:47], a[108:111], a[60:63], v[44:47]
    ds_read_b64_tr_b16 a[134:135], v6 offset:25120
    v_mfma_f32_16x16x32_bf16 v[44:47], a[104:107], a[44:47], v[44:47]
    buffer_load_dwordx4 v20, s[40:43], s30 offen offset:0  lds
    s_waitcnt lgkmcnt(8)
    v_mfma_f32_16x16x32_bf16 v[60:63], a[112:115], a[44:47], v[60:63]
    ds_read_b64_tr_b16 a[96:97], v6 offset:64
    v_mfma_f32_16x16x32_bf16 v[60:63], a[116:119], a[60:63], v[60:63]
    v_mfma_f32_16x16x32_bf16 v[56:59], a[116:119], a[56:59], v[56:59]
    ds_read_b64_tr_b16 a[98:99], v6 offset:3648
    v_mfma_f32_16x16x32_bf16 v[56:59], a[112:115], a[40:43], v[56:59]
    v_mfma_f32_16x16x32_bf16 v[52:55], a[112:115], a[36:39], v[52:55]
    ds_read_b64_tr_b16 a[100:101], v6 offset:7232
    v_mfma_f32_16x16x32_bf16 v[52:55], a[116:119], a[52:55], v[52:55]
    buffer_load_dwordx4 v21, s[40:43], s30 offen offset:1024  lds
    v_mfma_f32_16x16x32_bf16 v[48:51], a[116:119], a[48:51], v[48:51]
    ds_read_b64_tr_b16 a[102:103], v6 offset:10816
    v_mfma_f32_16x16x32_bf16 v[48:51], a[112:115], a[32:35], v[48:51]
    s_waitcnt lgkmcnt(8)
    v_mfma_f32_16x16x32_bf16 v[64:67], a[120:123], a[32:35], v[64:67]
    ds_read_b64_tr_b16 a[104:105], v6 offset:14400
    v_mfma_f32_16x16x32_bf16 v[64:67], a[124:127], a[48:51], v[64:67]
    v_mfma_f32_16x16x32_bf16 v[68:71], a[124:127], a[52:55], v[68:71]
    ds_read_b64_tr_b16 a[106:107], v6 offset:17984
    v_mfma_f32_16x16x32_bf16 v[68:71], a[120:123], a[36:39], v[68:71]
    buffer_load_dwordx4 v22, s[40:43], s30 offen offset:2048  lds
    v_mfma_f32_16x16x32_bf16 v[72:75], a[120:123], a[40:43], v[72:75]
    ds_read_b64_tr_b16 a[108:109], v6 offset:21568
    v_mfma_f32_16x16x32_bf16 v[72:75], a[124:127], a[56:59], v[72:75]
    v_mfma_f32_16x16x32_bf16 v[76:79], a[124:127], a[60:63], v[76:79]
    ds_read_b64_tr_b16 a[110:111], v6 offset:25152
    v_mfma_f32_16x16x32_bf16 v[76:79], a[120:123], a[44:47], v[76:79]
    s_waitcnt lgkmcnt(8)
    v_mfma_f32_16x16x32_bf16 v[92:95], a[128:131], a[44:47], v[92:95]
    ds_read_b64_tr_b16 a[112:113], v6 offset:96
    v_mfma_f32_16x16x32_bf16 v[92:95], a[132:135], a[60:63], v[92:95]
    buffer_load_dwordx4 v23, s[40:43], s30 offen offset:3072  lds
    v_mfma_f32_16x16x32_bf16 v[88:91], a[132:135], a[56:59], v[88:91]
    ds_read_b64_tr_b16 a[114:115], v6 offset:3680
    s_add_u32 m0, s82, 69632
    v_mfma_f32_16x16x32_bf16 v[88:91], a[128:131], a[40:43], v[88:91]
    v_mfma_f32_16x16x32_bf16 v[84:87], a[128:131], a[36:39], v[84:87]
    ds_read_b64_tr_b16 a[116:117], v6 offset:7264
    v_mfma_f32_16x16x32_bf16 v[84:87], a[132:135], a[52:55], v[84:87]
    v_mfma_f32_16x16x32_bf16 v[80:83], a[132:135], a[48:51], v[80:83]
    ds_read_b64_tr_b16 a[118:119], v6 offset:10848
    v_mfma_f32_16x16x32_bf16 v[80:83], a[128:131], a[32:35], v[80:83]
    buffer_load_dwordx4 v24, s[40:43], s30 offen offset:0  lds
    s_waitcnt lgkmcnt(8)
    v_mfma_f32_16x16x32_bf16 v[96:99], a[96:99], a[32:35], v[96:99]
    ds_read_b64_tr_b16 a[120:121], v6 offset:14432
    v_mfma_f32_16x16x32_bf16 v[96:99], a[100:103], a[48:51], v[96:99]
    v_mfma_f32_16x16x32_bf16 v[100:103], a[100:103], a[52:55], v[100:103]
    ds_read_b64_tr_b16 a[122:123], v6 offset:18016
    v_mfma_f32_16x16x32_bf16 v[100:103], a[96:99], a[36:39], v[100:103]
    v_mfma_f32_16x16x32_bf16 v[104:107], a[96:99], a[40:43], v[104:107]
    ds_read_b64_tr_b16 a[124:125], v6 offset:21600
    v_mfma_f32_16x16x32_bf16 v[104:107], a[100:103], a[56:59], v[104:107]
    buffer_load_dwordx4 v25, s[40:43], s30 offen offset:1024  lds
    v_mfma_f32_16x16x32_bf16 v[108:111], a[100:103], a[60:63], v[108:111]
    ds_read_b64_tr_b16 a[126:127], v6 offset:25184
    v_mfma_f32_16x16x32_bf16 v[108:111], a[96:99], a[44:47], v[108:111]
    s_waitcnt lgkmcnt(8)
    v_mfma_f32_16x16x32_bf16 v[124:127], a[104:107], a[44:47], v[124:127]
    ds_read_b64_tr_b16 a[128:129], v6 offset:128
    v_mfma_f32_16x16x32_bf16 v[124:127], a[108:111], a[60:63], v[124:127]
    v_mfma_f32_16x16x32_bf16 v[120:123], a[108:111], a[56:59], v[120:123]
    ds_read_b64_tr_b16 a[130:131], v6 offset:3712
    v_mfma_f32_16x16x32_bf16 v[120:123], a[104:107], a[40:43], v[120:123]
    buffer_load_dwordx4 v26, s[40:43], s30 offen offset:2048  lds
    v_mfma_f32_16x16x32_bf16 v[116:119], a[104:107], a[36:39], v[116:119]
    ds_read_b64_tr_b16 a[132:133], v6 offset:7296
    s_bfe_u32 s31, s64, 262168
    v_mfma_f32_16x16x32_bf16 v[116:119], a[108:111], a[52:55], v[116:119]
    s_lshl_b32 s31, s31, 13
    v_mfma_f32_16x16x32_bf16 v[112:115], a[108:111], a[48:51], v[112:115]
    ds_read_b64_tr_b16 a[134:135], v6 offset:10880
    s_add_u32 s31, s31, s16
    v_mfma_f32_16x16x32_bf16 v[112:115], a[104:107], a[32:35], v[112:115]
    s_waitcnt lgkmcnt(8)
    v_mfma_f32_16x16x32_bf16 v[128:131], a[112:115], a[32:35], v[128:131]
    ds_read_b64_tr_b16 a[96:97], v6 offset:14464
    v_mfma_f32_16x16x32_bf16 v[128:131], a[116:119], a[48:51], v[128:131]
    buffer_load_dwordx4 a[0:3], v1, s[8:11], s31 offen offset:0 sc1
    v_mfma_f32_16x16x32_bf16 v[132:135], a[116:119], a[52:55], v[132:135]
    ds_read_b64_tr_b16 a[98:99], v6 offset:18048
    v_mfma_f32_16x16x32_bf16 v[132:135], a[112:115], a[36:39], v[132:135]
    v_mfma_f32_16x16x32_bf16 v[136:139], a[112:115], a[40:43], v[136:139]
    ds_read_b64_tr_b16 a[100:101], v6 offset:21632
    v_mfma_f32_16x16x32_bf16 v[136:139], a[116:119], a[56:59], v[136:139]
    v_mfma_f32_16x16x32_bf16 v[140:143], a[116:119], a[60:63], v[140:143]
    ds_read_b64_tr_b16 a[102:103], v6 offset:25216
    v_mfma_f32_16x16x32_bf16 v[140:143], a[112:115], a[44:47], v[140:143]
    buffer_load_dwordx4 a[4:7], v1, s[8:11], s31 offen offset:1024 sc1
    s_waitcnt lgkmcnt(8)
    v_mfma_f32_16x16x32_bf16 v[156:159], a[120:123], a[44:47], v[156:159]
    ds_read_b64_tr_b16 a[104:105], v6 offset:160
    v_mfma_f32_16x16x32_bf16 v[156:159], a[124:127], a[60:63], v[156:159]
    v_mfma_f32_16x16x32_bf16 v[152:155], a[124:127], a[56:59], v[152:155]
    ds_read_b64_tr_b16 a[106:107], v6 offset:3744
    v_mfma_f32_16x16x32_bf16 v[152:155], a[120:123], a[40:43], v[152:155]
    v_mfma_f32_16x16x32_bf16 v[148:151], a[120:123], a[36:39], v[148:151]
    ds_read_b64_tr_b16 a[108:109], v6 offset:7328
    v_mfma_f32_16x16x32_bf16 v[148:151], a[124:127], a[52:55], v[148:151]
    buffer_load_dwordx4 a[8:11], v1, s[8:11], s31 offen offset:2048 sc1
    v_mfma_f32_16x16x32_bf16 v[144:147], a[124:127], a[48:51], v[144:147]
    ds_read_b64_tr_b16 a[110:111], v6 offset:10912
    v_mfma_f32_16x16x32_bf16 v[144:147], a[120:123], a[32:35], v[144:147]
    s_waitcnt lgkmcnt(8)
    v_mfma_f32_16x16x32_bf16 v[160:163], a[128:131], a[32:35], v[160:163]
    ds_read_b64_tr_b16 a[112:113], v6 offset:14496
    v_mfma_f32_16x16x32_bf16 v[160:163], a[132:135], a[48:51], v[160:163]
    v_mfma_f32_16x16x32_bf16 v[164:167], a[132:135], a[52:55], v[164:167]
    ds_read_b64_tr_b16 a[114:115], v6 offset:18080
    v_mfma_f32_16x16x32_bf16 v[164:167], a[128:131], a[36:39], v[164:167]
    v_mfma_f32_16x16x32_bf16 v[168:171], a[128:131], a[40:43], v[168:171]
    ds_read_b64_tr_b16 a[116:117], v6 offset:21664
    v_mfma_f32_16x16x32_bf16 v[168:171], a[132:135], a[56:59], v[168:171]
    buffer_load_dwordx4 a[12:15], v1, s[8:11], s31 offen offset:3072 sc1
    v_mfma_f32_16x16x32_bf16 v[172:175], a[132:135], a[60:63], v[172:175]
    ds_read_b64_tr_b16 a[118:119], v6 offset:25248
    v_mfma_f32_16x16x32_bf16 v[172:175], a[128:131], a[44:47], v[172:175]
    s_waitcnt lgkmcnt(8)
    v_mfma_f32_16x16x32_bf16 v[188:191], a[96:99], a[44:47], v[188:191]
    ds_read_b64_tr_b16 a[120:121], v6 offset:192
    v_mfma_f32_16x16x32_bf16 v[188:191], a[100:103], a[60:63], v[188:191]
    v_mfma_f32_16x16x32_bf16 v[184:187], a[100:103], a[56:59], v[184:187]
    ds_read_b64_tr_b16 a[122:123], v6 offset:3776
    v_mfma_f32_16x16x32_bf16 v[184:187], a[96:99], a[40:43], v[184:187]
    buffer_load_dwordx4 a[16:19], v30, s[8:11], s31 offen offset:0 sc1
    v_mfma_f32_16x16x32_bf16 v[180:183], a[96:99], a[36:39], v[180:183]
    ds_read_b64_tr_b16 a[124:125], v6 offset:7360
    v_mfma_f32_16x16x32_bf16 v[180:183], a[100:103], a[52:55], v[180:183]
    v_mfma_f32_16x16x32_bf16 v[176:179], a[100:103], a[48:51], v[176:179]
    ds_read_b64_tr_b16 a[126:127], v6 offset:10944
    v_mfma_f32_16x16x32_bf16 v[176:179], a[96:99], a[32:35], v[176:179]
    s_waitcnt lgkmcnt(8)
    v_mfma_f32_16x16x32_bf16 v[192:195], a[104:107], a[32:35], v[192:195]
    ds_read_b64_tr_b16 a[128:129], v6 offset:14528
    v_mfma_f32_16x16x32_bf16 v[192:195], a[108:111], a[48:51], v[192:195]
    buffer_load_dwordx4 a[20:23], v30, s[8:11], s31 offen offset:1024 sc1
    v_mfma_f32_16x16x32_bf16 v[196:199], a[108:111], a[52:55], v[196:199]
    ds_read_b64_tr_b16 a[130:131], v6 offset:18112
    v_mfma_f32_16x16x32_bf16 v[196:199], a[104:107], a[36:39], v[196:199]
    v_mfma_f32_16x16x32_bf16 v[200:203], a[104:107], a[40:43], v[200:203]
    ds_read_b64_tr_b16 a[132:133], v6 offset:21696
    v_mfma_f32_16x16x32_bf16 v[200:203], a[108:111], a[56:59], v[200:203]
    v_mfma_f32_16x16x32_bf16 v[204:207], a[108:111], a[60:63], v[204:207]
    ds_read_b64_tr_b16 a[134:135], v6 offset:25280
    v_mfma_f32_16x16x32_bf16 v[204:207], a[104:107], a[44:47], v[204:207]
    buffer_load_dwordx4 a[24:27], v30, s[8:11], s31 offen offset:2048 sc1
    s_waitcnt lgkmcnt(8)
    v_mfma_f32_16x16x32_bf16 v[220:223], a[112:115], a[44:47], v[220:223]
    s_waitcnt vmcnt(23)
    s_barrier
    ds_read_b64_tr_b16 a[96:97], v6 offset:32768
    v_mfma_f32_16x16x32_bf16 v[220:223], a[116:119], a[60:63], v[220:223]
    v_mfma_f32_16x16x32_bf16 v[216:219], a[116:119], a[56:59], v[216:219]
    ds_read_b64_tr_b16 a[98:99], v6 offset:36352
    v_mfma_f32_16x16x32_bf16 v[216:219], a[112:115], a[40:43], v[216:219]
    v_mfma_f32_16x16x32_bf16 v[212:215], a[112:115], a[36:39], v[212:215]
    ds_read_b64_tr_b16 a[100:101], v6 offset:39936
    v_mfma_f32_16x16x32_bf16 v[212:215], a[116:119], a[52:55], v[212:215]
    buffer_load_dwordx4 a[28:31], v30, s[8:11], s31 offen offset:3072 sc1
    v_mfma_f32_16x16x32_bf16 v[208:211], a[116:119], a[48:51], v[208:211]
    ds_read_b64_tr_b16 a[102:103], v6 offset:43520
    s_add_u32 m0, s82, 98304
    v_mfma_f32_16x16x32_bf16 v[208:211], a[112:115], a[32:35], v[208:211]
    s_bfe_u32 s30, s64, 262172
    s_waitcnt lgkmcnt(8)
    v_mfma_f32_16x16x32_bf16 v[224:227], a[120:123], a[32:35], v[224:227]
    ds_read_b64_tr_b16 a[104:105], v6 offset:47104
    s_mul_i32 s30, s30, 458752
    v_mfma_f32_16x16x32_bf16 v[224:227], a[124:127], a[48:51], v[224:227]
    v_mfma_f32_16x16x32_bf16 v[228:231], a[124:127], a[52:55], v[228:231]
    ds_read_b64_tr_b16 a[106:107], v6 offset:50688
    v_mfma_f32_16x16x32_bf16 v[228:231], a[120:123], a[36:39], v[228:231]
    buffer_load_dwordx4 v20, s[40:43], s30 offen offset:0  lds
    v_mfma_f32_16x16x32_bf16 v[232:235], a[120:123], a[40:43], v[232:235]
    ds_read_b64_tr_b16 a[108:109], v6 offset:54272
    v_mfma_f32_16x16x32_bf16 v[232:235], a[124:127], a[56:59], v[232:235]
    v_mfma_f32_16x16x32_bf16 v[236:239], a[124:127], a[60:63], v[236:239]
    ds_read_b64_tr_b16 a[110:111], v6 offset:57856
    v_mfma_f32_16x16x32_bf16 v[236:239], a[120:123], a[44:47], v[236:239]
    s_waitcnt lgkmcnt(8)
    v_mfma_f32_16x16x32_bf16 v[252:255], a[128:131], a[44:47], v[252:255]
    ds_read_b64_tr_b16 a[112:113], v6 offset:32800
    v_mfma_f32_16x16x32_bf16 v[252:255], a[132:135], a[60:63], v[252:255]
    buffer_load_dwordx4 v21, s[40:43], s30 offen offset:1024  lds
    v_mfma_f32_16x16x32_bf16 v[248:251], a[132:135], a[56:59], v[248:251]
    ds_read_b64_tr_b16 a[114:115], v6 offset:36384
    v_mfma_f32_16x16x32_bf16 v[248:251], a[128:131], a[40:43], v[248:251]
    v_mfma_f32_16x16x32_bf16 v[244:247], a[128:131], a[36:39], v[244:247]
    ds_read_b64_tr_b16 a[116:117], v6 offset:39968
    v_mfma_f32_16x16x32_bf16 v[244:247], a[132:135], a[52:55], v[244:247]
    v_mfma_f32_16x16x32_bf16 v[240:243], a[132:135], a[48:51], v[240:243]
    ds_read_b64_tr_b16 a[118:119], v6 offset:43552
    v_mfma_f32_16x16x32_bf16 v[240:243], a[128:131], a[32:35], v[240:243]
    buffer_load_dwordx4 v22, s[40:43], s30 offen offset:2048  lds
    s_waitcnt vmcnt(19) lgkmcnt(8)
    v_mfma_f32_16x16x32_bf16 v[32:35], a[96:99], a[64:67], v[32:35]
    ds_read_b64_tr_b16 a[120:121], v6 offset:47136
    v_mfma_f32_16x16x32_bf16 v[32:35], a[100:103], a[80:83], v[32:35]
    v_mfma_f32_16x16x32_bf16 v[36:39], a[100:103], a[84:87], v[36:39]
    ds_read_b64_tr_b16 a[122:123], v6 offset:50720
    v_mfma_f32_16x16x32_bf16 v[36:39], a[96:99], a[68:71], v[36:39]
    v_mfma_f32_16x16x32_bf16 v[40:43], a[96:99], a[72:75], v[40:43]
    ds_read_b64_tr_b16 a[124:125], v6 offset:54304
    v_mfma_f32_16x16x32_bf16 v[40:43], a[100:103], a[88:91], v[40:43]
    buffer_load_dwordx4 v23, s[40:43], s30 offen offset:3072  lds
    v_mfma_f32_16x16x32_bf16 v[44:47], a[100:103], a[92:95], v[44:47]
    ds_read_b64_tr_b16 a[126:127], v6 offset:57888
    s_add_u32 m0, s82, 102400
    v_mfma_f32_16x16x32_bf16 v[44:47], a[96:99], a[76:79], v[44:47]
    s_waitcnt lgkmcnt(8)
    v_mfma_f32_16x16x32_bf16 v[60:63], a[104:107], a[76:79], v[60:63]
    ds_read_b64_tr_b16 a[128:129], v6 offset:32832
    v_mfma_f32_16x16x32_bf16 v[60:63], a[108:111], a[92:95], v[60:63]
    v_mfma_f32_16x16x32_bf16 v[56:59], a[108:111], a[88:91], v[56:59]
    ds_read_b64_tr_b16 a[130:131], v6 offset:36416
    v_mfma_f32_16x16x32_bf16 v[56:59], a[104:107], a[72:75], v[56:59]
    buffer_load_dwordx4 v24, s[40:43], s30 offen offset:0  lds
    v_mfma_f32_16x16x32_bf16 v[52:55], a[104:107], a[68:71], v[52:55]
    ds_read_b64_tr_b16 a[132:133], v6 offset:40000
    v_mfma_f32_16x16x32_bf16 v[52:55], a[108:111], a[84:87], v[52:55]
    v_mfma_f32_16x16x32_bf16 v[48:51], a[108:111], a[80:83], v[48:51]
    ds_read_b64_tr_b16 a[134:135], v6 offset:43584
    v_mfma_f32_16x16x32_bf16 v[48:51], a[104:107], a[64:67], v[48:51]
    s_waitcnt lgkmcnt(8)
    v_mfma_f32_16x16x32_bf16 v[64:67], a[112:115], a[64:67], v[64:67]
    ds_read_b64_tr_b16 a[96:97], v6 offset:47168
    v_mfma_f32_16x16x32_bf16 v[64:67], a[116:119], a[80:83], v[64:67]
    v_mfma_f32_16x16x32_bf16 v[68:71], a[116:119], a[84:87], v[68:71]
    ds_read_b64_tr_b16 a[98:99], v6 offset:50752
    v_mfma_f32_16x16x32_bf16 v[68:71], a[112:115], a[68:71], v[68:71]
    buffer_load_dwordx4 v25, s[40:43], s30 offen offset:1024  lds
    v_mfma_f32_16x16x32_bf16 v[72:75], a[112:115], a[72:75], v[72:75]
    ds_read_b64_tr_b16 a[100:101], v6 offset:54336
    v_mfma_f32_16x16x32_bf16 v[72:75], a[116:119], a[88:91], v[72:75]
    v_mfma_f32_16x16x32_bf16 v[76:79], a[116:119], a[92:95], v[76:79]
    ds_read_b64_tr_b16 a[102:103], v6 offset:57920
    v_mfma_f32_16x16x32_bf16 v[76:79], a[112:115], a[76:79], v[76:79]
    s_waitcnt lgkmcnt(8)
    v_mfma_f32_16x16x32_bf16 v[92:95], a[120:123], a[76:79], v[92:95]
    ds_read_b64_tr_b16 a[104:105], v6 offset:32864
    v_mfma_f32_16x16x32_bf16 v[92:95], a[124:127], a[92:95], v[92:95]
    buffer_load_dwordx4 v26, s[40:43], s30 offen offset:2048  lds
    v_mfma_f32_16x16x32_bf16 v[88:91], a[124:127], a[88:91], v[88:91]
    ds_read_b64_tr_b16 a[106:107], v6 offset:36448
    s_bfe_u32 s31, s64, 262172
    v_mfma_f32_16x16x32_bf16 v[88:91], a[120:123], a[72:75], v[88:91]
    s_lshl_b32 s31, s31, 13
    v_mfma_f32_16x16x32_bf16 v[84:87], a[120:123], a[68:71], v[84:87]
    ds_read_b64_tr_b16 a[108:109], v6 offset:40032
    s_add_u32 s31, s31, s16
    v_mfma_f32_16x16x32_bf16 v[84:87], a[124:127], a[84:87], v[84:87]
    v_mfma_f32_16x16x32_bf16 v[80:83], a[124:127], a[80:83], v[80:83]
    ds_read_b64_tr_b16 a[110:111], v6 offset:43616
    v_mfma_f32_16x16x32_bf16 v[80:83], a[120:123], a[64:67], v[80:83]
    buffer_load_dwordx4 a[32:35], v1, s[8:11], s31 offen offset:0 sc1
    s_waitcnt lgkmcnt(8)
    v_mfma_f32_16x16x32_bf16 v[96:99], a[128:131], a[64:67], v[96:99]
    ds_read_b64_tr_b16 a[112:113], v6 offset:47200
    v_mfma_f32_16x16x32_bf16 v[96:99], a[132:135], a[80:83], v[96:99]
    v_mfma_f32_16x16x32_bf16 v[100:103], a[132:135], a[84:87], v[100:103]
    ds_read_b64_tr_b16 a[114:115], v6 offset:50784
    v_mfma_f32_16x16x32_bf16 v[100:103], a[128:131], a[68:71], v[100:103]
    v_mfma_f32_16x16x32_bf16 v[104:107], a[128:131], a[72:75], v[104:107]
    ds_read_b64_tr_b16 a[116:117], v6 offset:54368
    v_mfma_f32_16x16x32_bf16 v[104:107], a[132:135], a[88:91], v[104:107]
    buffer_load_dwordx4 a[36:39], v1, s[8:11], s31 offen offset:1024 sc1
    v_mfma_f32_16x16x32_bf16 v[108:111], a[132:135], a[92:95], v[108:111]
    ds_read_b64_tr_b16 a[118:119], v6 offset:57952
    v_mfma_f32_16x16x32_bf16 v[108:111], a[128:131], a[76:79], v[108:111]
    s_waitcnt lgkmcnt(8)
    v_mfma_f32_16x16x32_bf16 v[124:127], a[96:99], a[76:79], v[124:127]
    ds_read_b64_tr_b16 a[120:121], v6 offset:32896
    v_mfma_f32_16x16x32_bf16 v[124:127], a[100:103], a[92:95], v[124:127]
    v_mfma_f32_16x16x32_bf16 v[120:123], a[100:103], a[88:91], v[120:123]
    ds_read_b64_tr_b16 a[122:123], v6 offset:36480
    v_mfma_f32_16x16x32_bf16 v[120:123], a[96:99], a[72:75], v[120:123]
    buffer_load_dwordx4 a[40:43], v1, s[8:11], s31 offen offset:2048 sc1
    v_mfma_f32_16x16x32_bf16 v[116:119], a[96:99], a[68:71], v[116:119]
    ds_read_b64_tr_b16 a[124:125], v6 offset:40064
    v_mfma_f32_16x16x32_bf16 v[116:119], a[100:103], a[84:87], v[116:119]
    v_mfma_f32_16x16x32_bf16 v[112:115], a[100:103], a[80:83], v[112:115]
    ds_read_b64_tr_b16 a[126:127], v6 offset:43648
    v_mfma_f32_16x16x32_bf16 v[112:115], a[96:99], a[64:67], v[112:115]
    s_waitcnt lgkmcnt(8)
    v_mfma_f32_16x16x32_bf16 v[128:131], a[104:107], a[64:67], v[128:131]
    ds_read_b64_tr_b16 a[128:129], v6 offset:47232
    v_mfma_f32_16x16x32_bf16 v[128:131], a[108:111], a[80:83], v[128:131]
    buffer_load_dwordx4 a[44:47], v1, s[8:11], s31 offen offset:3072 sc1
    v_mfma_f32_16x16x32_bf16 v[132:135], a[108:111], a[84:87], v[132:135]
    ds_read_b64_tr_b16 a[130:131], v6 offset:50816
    v_mfma_f32_16x16x32_bf16 v[132:135], a[104:107], a[68:71], v[132:135]
    v_mfma_f32_16x16x32_bf16 v[136:139], a[104:107], a[72:75], v[136:139]
    ds_read_b64_tr_b16 a[132:133], v6 offset:54400
    v_mfma_f32_16x16x32_bf16 v[136:139], a[108:111], a[88:91], v[136:139]
    v_mfma_f32_16x16x32_bf16 v[140:143], a[108:111], a[92:95], v[140:143]
    ds_read_b64_tr_b16 a[134:135], v6 offset:57984
    v_mfma_f32_16x16x32_bf16 v[140:143], a[104:107], a[76:79], v[140:143]
    buffer_load_dwordx4 a[48:51], v30, s[8:11], s31 offen offset:0 sc1
    s_waitcnt lgkmcnt(8)
    v_mfma_f32_16x16x32_bf16 v[156:159], a[112:115], a[76:79], v[156:159]
    ds_read_b64_tr_b16 a[96:97], v6 offset:32928
    v_mfma_f32_16x16x32_bf16 v[156:159], a[116:119], a[92:95], v[156:159]
    v_mfma_f32_16x16x32_bf16 v[152:155], a[116:119], a[88:91], v[152:155]
    ds_read_b64_tr_b16 a[98:99], v6 offset:36512
    v_mfma_f32_16x16x32_bf16 v[152:155], a[112:115], a[72:75], v[152:155]
    v_mfma_f32_16x16x32_bf16 v[148:151], a[112:115], a[68:71], v[148:151]
    ds_read_b64_tr_b16 a[100:101], v6 offset:40096
    v_mfma_f32_16x16x32_bf16 v[148:151], a[116:119], a[84:87], v[148:151]
    buffer_load_dwordx4 a[52:55], v30, s[8:11], s31 offen offset:1024 sc1
    v_mfma_f32_16x16x32_bf16 v[144:147], a[116:119], a[80:83], v[144:147]
    ds_read_b64_tr_b16 a[102:103], v6 offset:43680
    v_mfma_f32_16x16x32_bf16 v[144:147], a[112:115], a[64:67], v[144:147]
    s_waitcnt lgkmcnt(8)
    v_mfma_f32_16x16x32_bf16 v[160:163], a[120:123], a[64:67], v[160:163]
    ds_read_b64_tr_b16 a[104:105], v6 offset:47264
    v_mfma_f32_16x16x32_bf16 v[160:163], a[124:127], a[80:83], v[160:163]
    v_mfma_f32_16x16x32_bf16 v[164:167], a[124:127], a[84:87], v[164:167]
    ds_read_b64_tr_b16 a[106:107], v6 offset:50848
    v_mfma_f32_16x16x32_bf16 v[164:167], a[120:123], a[68:71], v[164:167]
    buffer_load_dwordx4 a[56:59], v30, s[8:11], s31 offen offset:2048 sc1
    v_mfma_f32_16x16x32_bf16 v[168:171], a[120:123], a[72:75], v[168:171]
    ds_read_b64_tr_b16 a[108:109], v6 offset:54432
    v_mfma_f32_16x16x32_bf16 v[168:171], a[124:127], a[88:91], v[168:171]
    v_mfma_f32_16x16x32_bf16 v[172:175], a[124:127], a[92:95], v[172:175]
    ds_read_b64_tr_b16 a[110:111], v6 offset:58016
    v_mfma_f32_16x16x32_bf16 v[172:175], a[120:123], a[76:79], v[172:175]
    s_waitcnt lgkmcnt(8)
    v_mfma_f32_16x16x32_bf16 v[188:191], a[128:131], a[76:79], v[188:191]
    ds_read_b64_tr_b16 a[112:113], v6 offset:32960
    v_mfma_f32_16x16x32_bf16 v[188:191], a[132:135], a[92:95], v[188:191]
    buffer_load_dwordx4 a[60:63], v30, s[8:11], s31 offen offset:3072 sc1
    v_mfma_f32_16x16x32_bf16 v[184:187], a[132:135], a[88:91], v[184:187]
    ds_read_b64_tr_b16 a[114:115], v6 offset:36544
    v_mfma_f32_16x16x32_bf16 v[184:187], a[128:131], a[72:75], v[184:187]
    v_mfma_f32_16x16x32_bf16 v[180:183], a[128:131], a[68:71], v[180:183]
    ds_read_b64_tr_b16 a[116:117], v6 offset:40128
    v_mfma_f32_16x16x32_bf16 v[180:183], a[132:135], a[84:87], v[180:183]
    v_mfma_f32_16x16x32_bf16 v[176:179], a[132:135], a[80:83], v[176:179]
    ds_read_b64_tr_b16 a[118:119], v6 offset:43712
    v_mfma_f32_16x16x32_bf16 v[176:179], a[128:131], a[64:67], v[176:179]
    s_waitcnt lgkmcnt(8)
    v_mfma_f32_16x16x32_bf16 v[192:195], a[96:99], a[64:67], v[192:195]
    ds_read_b64_tr_b16 a[120:121], v6 offset:47296
    v_mfma_f32_16x16x32_bf16 v[192:195], a[100:103], a[80:83], v[192:195]
    buffer_store_dword a196, v17, s[8:11], s60 offen sc1
    v_mfma_f32_16x16x32_bf16 v[196:199], a[100:103], a[84:87], v[196:199]
    ds_read_b64_tr_b16 a[122:123], v6 offset:50880
    v_mfma_f32_16x16x32_bf16 v[196:199], a[96:99], a[68:71], v[196:199]
    buffer_store_dwordx4 a[180:183], v27, s[8:11], s56 offen sc1
    v_mfma_f32_16x16x32_bf16 v[200:203], a[96:99], a[72:75], v[200:203]
    ds_read_b64_tr_b16 a[124:125], v6 offset:54464
    v_mfma_f32_16x16x32_bf16 v[200:203], a[100:103], a[88:91], v[200:203]
    v_mfma_f32_16x16x32_bf16 v[204:207], a[100:103], a[92:95], v[204:207]
    ds_read_b64_tr_b16 a[126:127], v6 offset:58048
    v_mfma_f32_16x16x32_bf16 v[204:207], a[96:99], a[76:79], v[204:207]
    buffer_store_dwordx4 a[184:187], v27, s[8:11], s57 offen sc1
    s_waitcnt lgkmcnt(8)
    v_mfma_f32_16x16x32_bf16 v[220:223], a[104:107], a[76:79], v[220:223]
    s_waitcnt vmcnt(26)
    s_barrier
    ds_read_b64_tr_b16 a[128:129], v7 offset:0
    v_mfma_f32_16x16x32_bf16 v[220:223], a[108:111], a[92:95], v[220:223]
    v_mfma_f32_16x16x32_bf16 v[216:219], a[108:111], a[88:91], v[216:219]
    ds_read_b64_tr_b16 a[130:131], v7 offset:3584
    v_mfma_f32_16x16x32_bf16 v[216:219], a[104:107], a[72:75], v[216:219]
    buffer_store_dwordx4 a[188:191], v27, s[8:11], s58 offen sc1
    v_mfma_f32_16x16x32_bf16 v[212:215], a[104:107], a[68:71], v[212:215]
    ds_read_b64_tr_b16 a[132:133], v7 offset:7168
    v_mfma_f32_16x16x32_bf16 v[212:215], a[108:111], a[84:87], v[212:215]
    v_mfma_f32_16x16x32_bf16 v[208:211], a[108:111], a[80:83], v[208:211]
    ds_read_b64_tr_b16 a[134:135], v7 offset:10752
    v_mfma_f32_16x16x32_bf16 v[208:211], a[104:107], a[64:67], v[208:211]
    buffer_store_dwordx4 a[192:195], v27, s[8:11], s59 offen sc1
    s_waitcnt lgkmcnt(8)
    v_mfma_f32_16x16x32_bf16 v[224:227], a[112:115], a[64:67], v[224:227]
    ds_read_b64_tr_b16 a[96:97], v7 offset:14336
    s_add_u32 m0, s82, 0
    v_mfma_f32_16x16x32_bf16 v[224:227], a[116:119], a[80:83], v[224:227]
    s_bfe_u32 s30, s65, 262144
    v_mfma_f32_16x16x32_bf16 v[228:231], a[116:119], a[84:87], v[228:231]
    ds_read_b64_tr_b16 a[98:99], v7 offset:17920
    s_mul_i32 s30, s30, 458752
    v_mfma_f32_16x16x32_bf16 v[228:231], a[112:115], a[68:71], v[228:231]
    v_mfma_f32_16x16x32_bf16 v[232:235], a[112:115], a[72:75], v[232:235]
    ds_read_b64_tr_b16 a[100:101], v7 offset:21504
    v_mfma_f32_16x16x32_bf16 v[232:235], a[116:119], a[88:91], v[232:235]
    v_mfma_f32_16x16x32_bf16 v[236:239], a[116:119], a[92:95], v[236:239]
    ds_read_b64_tr_b16 a[102:103], v7 offset:25088
    v_mfma_f32_16x16x32_bf16 v[236:239], a[112:115], a[76:79], v[236:239]
    s_waitcnt lgkmcnt(8)
    v_mfma_f32_16x16x32_bf16 v[252:255], a[120:123], a[76:79], v[252:255]
    ds_read_b64_tr_b16 a[104:105], v7 offset:32
    v_mfma_f32_16x16x32_bf16 v[252:255], a[124:127], a[92:95], v[252:255]
    v_mfma_f32_16x16x32_bf16 v[248:251], a[124:127], a[88:91], v[248:251]
    ds_read_b64_tr_b16 a[106:107], v7 offset:3616
    v_mfma_f32_16x16x32_bf16 v[248:251], a[120:123], a[72:75], v[248:251]
    v_mfma_f32_16x16x32_bf16 v[244:247], a[120:123], a[68:71], v[244:247]
    ds_read_b64_tr_b16 a[108:109], v7 offset:7200
    v_mfma_f32_16x16x32_bf16 v[244:247], a[124:127], a[84:87], v[244:247]
    v_mfma_f32_16x16x32_bf16 v[240:243], a[124:127], a[80:83], v[240:243]
    ds_read_b64_tr_b16 a[110:111], v7 offset:10784
    v_mfma_f32_16x16x32_bf16 v[240:243], a[120:123], a[64:67], v[240:243]
    s_waitcnt vmcnt(20) lgkmcnt(8)
    v_mfma_f32_16x16x32_bf16 v[32:35], a[128:131], a[0:3], v[32:35]
    ds_read_b64_tr_b16 a[112:113], v7 offset:14368
    v_mfma_f32_16x16x32_bf16 v[32:35], a[132:135], a[16:19], v[32:35]
    v_mfma_f32_16x16x32_bf16 v[36:39], a[132:135], a[20:23], v[36:39]
    ds_read_b64_tr_b16 a[114:115], v7 offset:17952
    v_mfma_f32_16x16x32_bf16 v[36:39], a[128:131], a[4:7], v[36:39]
    v_mfma_f32_16x16x32_bf16 v[40:43], a[128:131], a[8:11], v[40:43]
    ds_read_b64_tr_b16 a[116:117], v7 offset:21536
    v_mfma_f32_16x16x32_bf16 v[40:43], a[132:135], a[24:27], v[40:43]
    v_mfma_f32_16x16x32_bf16 v[44:47], a[132:135], a[28:31], v[44:47]
    ds_read_b64_tr_b16 a[118:119], v7 offset:25120
    v_mfma_f32_16x16x32_bf16 v[44:47], a[128:131], a[12:15], v[44:47]
    s_waitcnt lgkmcnt(8)
    v_mfma_f32_16x16x32_bf16 v[60:63], a[96:99], a[12:15], v[60:63]
    ds_read_b64_tr_b16 a[120:121], v7 offset:64
    v_mfma_f32_16x16x32_bf16 v[60:63], a[100:103], a[28:31], v[60:63]
    v_mfma_f32_16x16x32_bf16 v[56:59], a[100:103], a[24:27], v[56:59]
    ds_read_b64_tr_b16 a[122:123], v7 offset:3648
    v_mfma_f32_16x16x32_bf16 v[56:59], a[96:99], a[8:11], v[56:59]
    v_mfma_f32_16x16x32_bf16 v[52:55], a[96:99], a[4:7], v[52:55]
    ds_read_b64_tr_b16 a[124:125], v7 offset:7232
    v_mfma_f32_16x16x32_bf16 v[52:55], a[100:103], a[20:23], v[52:55]
    buffer_load_dwordx4 v20, s[40:43], s30 offen offset:0  lds
    v_mfma_f32_16x16x32_bf16 v[48:51], a[100:103], a[16:19], v[48:51]
    ds_read_b64_tr_b16 a[126:127], v7 offset:10816
    v_mfma_f32_16x16x32_bf16 v[48:51], a[96:99], a[0:3], v[48:51]
    s_waitcnt lgkmcnt(8)
    v_mfma_f32_16x16x32_bf16 v[64:67], a[104:107], a[0:3], v[64:67]
    ds_read_b64_tr_b16 a[128:129], v7 offset:14400
    v_mfma_f32_16x16x32_bf16 v[64:67], a[108:111], a[16:19], v[64:67]
    v_mfma_f32_16x16x32_bf16 v[68:71], a[108:111], a[20:23], v[68:71]
    ds_read_b64_tr_b16 a[130:131], v7 offset:17984
    v_mfma_f32_16x16x32_bf16 v[68:71], a[104:107], a[4:7], v[68:71]
    buffer_load_dwordx4 v21, s[40:43], s30 offen offset:1024  lds
    v_mfma_f32_16x16x32_bf16 v[72:75], a[104:107], a[8:11], v[72:75]
    ds_read_b64_tr_b16 a[132:133], v7 offset:21568
    v_mfma_f32_16x16x32_bf16 v[72:75], a[108:111], a[24:27], v[72:75]
    v_mfma_f32_16x16x32_bf16 v[76:79], a[108:111], a[28:31], v[76:79]
    ds_read_b64_tr_b16 a[134:135], v7 offset:25152
    v_mfma_f32_16x16x32_bf16 v[76:79], a[104:107], a[12:15], v[76:79]
    s_waitcnt lgkmcnt(8)
    v_mfma_f32_16x16x32_bf16 v[92:95], a[112:115], a[12:15], v[92:95]
    ds_read_b64_tr_b16 a[96:97], v7 offset:96
    v_mfma_f32_16x16x32_bf16 v[92:95], a[116:119], a[28:31], v[92:95]
    buffer_load_dwordx4 v22, s[40:43], s30 offen offset:2048  lds
    v_mfma_f32_16x16x32_bf16 v[88:91], a[116:119], a[24:27], v[88:91]
    ds_read_b64_tr_b16 a[98:99], v7 offset:3680
    v_mfma_f32_16x16x32_bf16 v[88:91], a[112:115], a[8:11], v[88:91]
    v_mfma_f32_16x16x32_bf16 v[84:87], a[112:115], a[4:7], v[84:87]
    ds_read_b64_tr_b16 a[100:101], v7 offset:7264
    v_mfma_f32_16x16x32_bf16 v[84:87], a[116:119], a[20:23], v[84:87]
    v_mfma_f32_16x16x32_bf16 v[80:83], a[116:119], a[16:19], v[80:83]
    ds_read_b64_tr_b16 a[102:103], v7 offset:10848
    v_mfma_f32_16x16x32_bf16 v[80:83], a[112:115], a[0:3], v[80:83]
    buffer_load_dwordx4 v23, s[40:43], s30 offen offset:3072  lds
    s_waitcnt lgkmcnt(8)
    v_mfma_f32_16x16x32_bf16 v[96:99], a[120:123], a[0:3], v[96:99]
    ds_read_b64_tr_b16 a[104:105], v7 offset:14432
    s_add_u32 m0, s82, 4096
    v_mfma_f32_16x16x32_bf16 v[96:99], a[124:127], a[16:19], v[96:99]
    v_mfma_f32_16x16x32_bf16 v[100:103], a[124:127], a[20:23], v[100:103]
    ds_read_b64_tr_b16 a[106:107], v7 offset:18016
    v_mfma_f32_16x16x32_bf16 v[100:103], a[120:123], a[4:7], v[100:103]
    v_mfma_f32_16x16x32_bf16 v[104:107], a[120:123], a[8:11], v[104:107]
    ds_read_b64_tr_b16 a[108:109], v7 offset:21600
    v_mfma_f32_16x16x32_bf16 v[104:107], a[124:127], a[24:27], v[104:107]
    buffer_load_dwordx4 v24, s[40:43], s30 offen offset:0  lds
    v_mfma_f32_16x16x32_bf16 v[108:111], a[124:127], a[28:31], v[108:111]
    ds_read_b64_tr_b16 a[110:111], v7 offset:25184
    v_mfma_f32_16x16x32_bf16 v[108:111], a[120:123], a[12:15], v[108:111]
    s_waitcnt lgkmcnt(8)
    v_mfma_f32_16x16x32_bf16 v[124:127], a[128:131], a[12:15], v[124:127]
    ds_read_b64_tr_b16 a[112:113], v7 offset:128
    v_mfma_f32_16x16x32_bf16 v[124:127], a[132:135], a[28:31], v[124:127]
    v_mfma_f32_16x16x32_bf16 v[120:123], a[132:135], a[24:27], v[120:123]
    ds_read_b64_tr_b16 a[114:115], v7 offset:3712
    v_mfma_f32_16x16x32_bf16 v[120:123], a[128:131], a[8:11], v[120:123]
    buffer_load_dwordx4 v25, s[40:43], s30 offen offset:1024  lds
    v_mfma_f32_16x16x32_bf16 v[116:119], a[128:131], a[4:7], v[116:119]
    ds_read_b64_tr_b16 a[116:117], v7 offset:7296
    v_mfma_f32_16x16x32_bf16 v[116:119], a[132:135], a[20:23], v[116:119]
    v_mfma_f32_16x16x32_bf16 v[112:115], a[132:135], a[16:19], v[112:115]
    ds_read_b64_tr_b16 a[118:119], v7 offset:10880
    v_mfma_f32_16x16x32_bf16 v[112:115], a[128:131], a[0:3], v[112:115]
    s_waitcnt lgkmcnt(8)
    v_mfma_f32_16x16x32_bf16 v[128:131], a[96:99], a[0:3], v[128:131]
    ds_read_b64_tr_b16 a[120:121], v7 offset:14464
    v_mfma_f32_16x16x32_bf16 v[128:131], a[100:103], a[16:19], v[128:131]
    buffer_load_dwordx4 v26, s[40:43], s30 offen offset:2048  lds
    v_mfma_f32_16x16x32_bf16 v[132:135], a[100:103], a[20:23], v[132:135]
    ds_read_b64_tr_b16 a[122:123], v7 offset:18048
    s_bfe_u32 s31, s65, 262144
    v_mfma_f32_16x16x32_bf16 v[132:135], a[96:99], a[4:7], v[132:135]
    s_lshl_b32 s31, s31, 13
    v_mfma_f32_16x16x32_bf16 v[136:139], a[96:99], a[8:11], v[136:139]
    ds_read_b64_tr_b16 a[124:125], v7 offset:21632
    s_add_u32 s31, s31, s16
    v_mfma_f32_16x16x32_bf16 v[136:139], a[100:103], a[24:27], v[136:139]
    v_mfma_f32_16x16x32_bf16 v[140:143], a[100:103], a[28:31], v[140:143]
    ds_read_b64_tr_b16 a[126:127], v7 offset:25216
    v_mfma_f32_16x16x32_bf16 v[140:143], a[96:99], a[12:15], v[140:143]
    buffer_load_dwordx4 a[64:67], v1, s[8:11], s31 offen offset:0 sc1
    s_waitcnt lgkmcnt(8)
    v_mfma_f32_16x16x32_bf16 v[156:159], a[104:107], a[12:15], v[156:159]
    ds_read_b64_tr_b16 a[128:129], v7 offset:160
    v_mfma_f32_16x16x32_bf16 v[156:159], a[108:111], a[28:31], v[156:159]
    v_mfma_f32_16x16x32_bf16 v[152:155], a[108:111], a[24:27], v[152:155]
    ds_read_b64_tr_b16 a[130:131], v7 offset:3744
    v_mfma_f32_16x16x32_bf16 v[152:155], a[104:107], a[8:11], v[152:155]
    v_mfma_f32_16x16x32_bf16 v[148:151], a[104:107], a[4:7], v[148:151]
    ds_read_b64_tr_b16 a[132:133], v7 offset:7328
    v_mfma_f32_16x16x32_bf16 v[148:151], a[108:111], a[20:23], v[148:151]
    buffer_load_dwordx4 a[68:71], v1, s[8:11], s31 offen offset:1024 sc1
    v_mfma_f32_16x16x32_bf16 v[144:147], a[108:111], a[16:19], v[144:147]
    ds_read_b64_tr_b16 a[134:135], v7 offset:10912
    v_mfma_f32_16x16x32_bf16 v[144:147], a[104:107], a[0:3], v[144:147]
    s_waitcnt lgkmcnt(8)
    v_mfma_f32_16x16x32_bf16 v[160:163], a[112:115], a[0:3], v[160:163]
    ds_read_b64_tr_b16 a[96:97], v7 offset:14496
    v_mfma_f32_16x16x32_bf16 v[160:163], a[116:119], a[16:19], v[160:163]
    v_mfma_f32_16x16x32_bf16 v[164:167], a[116:119], a[20:23], v[164:167]
    ds_read_b64_tr_b16 a[98:99], v7 offset:18080
    v_mfma_f32_16x16x32_bf16 v[164:167], a[112:115], a[4:7], v[164:167]
    buffer_load_dwordx4 a[72:75], v1, s[8:11], s31 offen offset:2048 sc1
    v_mfma_f32_16x16x32_bf16 v[168:171], a[112:115], a[8:11], v[168:171]
    ds_read_b64_tr_b16 a[100:101], v7 offset:21664
    v_mfma_f32_16x16x32_bf16 v[168:171], a[116:119], a[24:27], v[168:171]
    v_mfma_f32_16x16x32_bf16 v[172:175], a[116:119], a[28:31], v[172:175]
    ds_read_b64_tr_b16 a[102:103], v7 offset:25248
    v_mfma_f32_16x16x32_bf16 v[172:175], a[112:115], a[12:15], v[172:175]
    s_waitcnt lgkmcnt(8)
    v_mfma_f32_16x16x32_bf16 v[188:191], a[120:123], a[12:15], v[188:191]
    ds_read_b64_tr_b16 a[104:105], v7 offset:192
    v_mfma_f32_16x16x32_bf16 v[188:191], a[124:127], a[28:31], v[188:191]
    v_mfma_f32_16x16x32_bf16 v[184:187], a[124:127], a[24:27], v[184:187]
    ds_read_b64_tr_b16 a[106:107], v7 offset:3776
    v_mfma_f32_16x16x32_bf16 v[184:187], a[120:123], a[8:11], v[184:187]
    buffer_load_dwordx4 a[76:79], v1, s[8:11], s31 offen offset:3072 sc1
    v_mfma_f32_16x16x32_bf16 v[180:183], a[120:123], a[4:7], v[180:183]
    ds_read_b64_tr_b16 a[108:109], v7 offset:7360
    v_mfma_f32_16x16x32_bf16 v[180:183], a[124:127], a[20:23], v[180:183]
    v_mfma_f32_16x16x32_bf16 v[176:179], a[124:127], a[16:19], v[176:179]
    ds_read_b64_tr_b16 a[110:111], v7 offset:10944
    v_mfma_f32_16x16x32_bf16 v[176:179], a[120:123], a[0:3], v[176:179]
    s_waitcnt lgkmcnt(8)
    v_mfma_f32_16x16x32_bf16 v[192:195], a[128:131], a[0:3], v[192:195]
    ds_read_b64_tr_b16 a[112:113], v7 offset:14528
    v_mfma_f32_16x16x32_bf16 v[192:195], a[132:135], a[16:19], v[192:195]
    buffer_load_dwordx4 a[80:83], v30, s[8:11], s31 offen offset:0 sc1
    v_mfma_f32_16x16x32_bf16 v[196:199], a[132:135], a[20:23], v[196:199]
    ds_read_b64_tr_b16 a[114:115], v7 offset:18112
    v_mfma_f32_16x16x32_bf16 v[196:199], a[128:131], a[4:7], v[196:199]
    v_mfma_f32_16x16x32_bf16 v[200:203], a[128:131], a[8:11], v[200:203]
    ds_read_b64_tr_b16 a[116:117], v7 offset:21696
    v_mfma_f32_16x16x32_bf16 v[200:203], a[132:135], a[24:27], v[200:203]
    v_mfma_f32_16x16x32_bf16 v[204:207], a[132:135], a[28:31], v[204:207]
    ds_read_b64_tr_b16 a[118:119], v7 offset:25280
    v_mfma_f32_16x16x32_bf16 v[204:207], a[128:131], a[12:15], v[204:207]
    buffer_load_dwordx4 a[84:87], v30, s[8:11], s31 offen offset:1024 sc1
    s_waitcnt lgkmcnt(8)
    v_mfma_f32_16x16x32_bf16 v[220:223], a[96:99], a[12:15], v[220:223]
    s_waitcnt vmcnt(26)
    s_barrier
    ds_read_b64_tr_b16 a[120:121], v7 offset:32768
    v_mfma_f32_16x16x32_bf16 v[220:223], a[100:103], a[28:31], v[220:223]
    v_mfma_f32_16x16x32_bf16 v[216:219], a[100:103], a[24:27], v[216:219]
    ds_read_b64_tr_b16 a[122:123], v7 offset:36352
    v_mfma_f32_16x16x32_bf16 v[216:219], a[96:99], a[8:11], v[216:219]
    v_mfma_f32_16x16x32_bf16 v[212:215], a[96:99], a[4:7], v[212:215]
    ds_read_b64_tr_b16 a[124:125], v7 offset:39936
    v_mfma_f32_16x16x32_bf16 v[212:215], a[100:103], a[20:23], v[212:215]
    buffer_load_dwordx4 a[88:91], v30, s[8:11], s31 offen offset:2048 sc1
    v_mfma_f32_16x16x32_bf16 v[208:211], a[100:103], a[16:19], v[208:211]
    ds_read_b64_tr_b16 a[126:127], v7 offset:43520
    v_mfma_f32_16x16x32_bf16 v[208:211], a[96:99], a[0:3], v[208:211]
    s_waitcnt lgkmcnt(8)
    v_mfma_f32_16x16x32_bf16 v[224:227], a[104:107], a[0:3], v[224:227]
    ds_read_b64_tr_b16 a[128:129], v7 offset:47104
    v_mfma_f32_16x16x32_bf16 v[224:227], a[108:111], a[16:19], v[224:227]
    v_mfma_f32_16x16x32_bf16 v[228:231], a[108:111], a[20:23], v[228:231]
    ds_read_b64_tr_b16 a[130:131], v7 offset:50688
    v_mfma_f32_16x16x32_bf16 v[228:231], a[104:107], a[4:7], v[228:231]
    buffer_load_dwordx4 a[92:95], v30, s[8:11], s31 offen offset:3072 sc1
    v_mfma_f32_16x16x32_bf16 v[232:235], a[104:107], a[8:11], v[232:235]
    ds_read_b64_tr_b16 a[132:133], v7 offset:54272
    s_add_u32 m0, s82, 32768
    v_mfma_f32_16x16x32_bf16 v[232:235], a[108:111], a[24:27], v[232:235]
    s_bfe_u32 s30, s65, 262148
    v_mfma_f32_16x16x32_bf16 v[236:239], a[108:111], a[28:31], v[236:239]
    ds_read_b64_tr_b16 a[134:135], v7 offset:57856
    s_mul_i32 s30, s30, 458752
    v_mfma_f32_16x16x32_bf16 v[236:239], a[104:107], a[12:15], v[236:239]
    s_waitcnt lgkmcnt(8)
    v_mfma_f32_16x16x32_bf16 v[252:255], a[112:115], a[12:15], v[252:255]
    ds_read_b64_tr_b16 a[96:97], v7 offset:32800
    v_mfma_f32_16x16x32_bf16 v[252:255], a[116:119], a[28:31], v[252:255]
    buffer_load_dwordx4 v20, s[40:43], s30 offen offset:0  lds
    v_mfma_f32_16x16x32_bf16 v[248:251], a[116:119], a[24:27], v[248:251]
    ds_read_b64_tr_b16 a[98:99], v7 offset:36384
    v_mfma_f32_16x16x32_bf16 v[248:251], a[112:115], a[8:11], v[248:251]
    v_mfma_f32_16x16x32_bf16 v[244:247], a[112:115], a[4:7], v[244:247]
    ds_read_b64_tr_b16 a[100:101], v7 offset:39968
    v_mfma_f32_16x16x32_bf16 v[244:247], a[116:119], a[20:23], v[244:247]
    v_mfma_f32_16x16x32_bf16 v[240:243], a[116:119], a[16:19], v[240:243]
    ds_read_b64_tr_b16 a[102:103], v7 offset:43552
    v_mfma_f32_16x16x32_bf16 v[240:243], a[112:115], a[0:3], v[240:243]
    buffer_load_dwordx4 v21, s[40:43], s30 offen offset:1024  lds
    s_waitcnt vmcnt(22) lgkmcnt(8)
    v_mfma_f32_16x16x32_bf16 v[32:35], a[120:123], a[32:35], v[32:35]
    ds_read_b64_tr_b16 a[104:105], v7 offset:47136
    v_mfma_f32_16x16x32_bf16 v[32:35], a[124:127], a[48:51], v[32:35]
    v_mfma_f32_16x16x32_bf16 v[36:39], a[124:127], a[52:55], v[36:39]
    ds_read_b64_tr_b16 a[106:107], v7 offset:50720
    v_mfma_f32_16x16x32_bf16 v[36:39], a[120:123], a[36:39], v[36:39]
    v_mfma_f32_16x16x32_bf16 v[40:43], a[120:123], a[40:43], v[40:43]
    ds_read_b64_tr_b16 a[108:109], v7 offset:54304
    v_mfma_f32_16x16x32_bf16 v[40:43], a[124:127], a[56:59], v[40:43]
    buffer_load_dwordx4 v22, s[40:43], s30 offen offset:2048  lds
    v_mfma_f32_16x16x32_bf16 v[44:47], a[124:127], a[60:63], v[44:47]
    ds_read_b64_tr_b16 a[110:111], v7 offset:57888
    v_mfma_f32_16x16x32_bf16 v[44:47], a[120:123], a[44:47], v[44:47]
    s_waitcnt lgkmcnt(8)
    v_mfma_f32_16x16x32_bf16 v[60:63], a[128:131], a[44:47], v[60:63]
    ds_read_b64_tr_b16 a[112:113], v7 offset:32832
    v_mfma_f32_16x16x32_bf16 v[60:63], a[132:135], a[60:63], v[60:63]
    v_mfma_f32_16x16x32_bf16 v[56:59], a[132:135], a[56:59], v[56:59]
    ds_read_b64_tr_b16 a[114:115], v7 offset:36416
    v_mfma_f32_16x16x32_bf16 v[56:59], a[128:131], a[40:43], v[56:59]
    buffer_load_dwordx4 v23, s[40:43], s30 offen offset:3072  lds
    v_mfma_f32_16x16x32_bf16 v[52:55], a[128:131], a[36:39], v[52:55]
    ds_read_b64_tr_b16 a[116:117], v7 offset:40000
    s_add_u32 m0, s82, 36864
    v_mfma_f32_16x16x32_bf16 v[52:55], a[132:135], a[52:55], v[52:55]
    v_mfma_f32_16x16x32_bf16 v[48:51], a[132:135], a[48:51], v[48:51]
    ds_read_b64_tr_b16 a[118:119], v7 offset:43584
    v_mfma_f32_16x16x32_bf16 v[48:51], a[128:131], a[32:35], v[48:51]
    s_waitcnt lgkmcnt(8)
    v_mfma_f32_16x16x32_bf16 v[64:67], a[96:99], a[32:35], v[64:67]
    ds_read_b64_tr_b16 a[120:121], v7 offset:47168
    v_mfma_f32_16x16x32_bf16 v[64:67], a[100:103], a[48:51], v[64:67]
    buffer_load_dwordx4 v24, s[40:43], s30 offen offset:0  lds
    v_mfma_f32_16x16x32_bf16 v[68:71], a[100:103], a[52:55], v[68:71]
    ds_read_b64_tr_b16 a[122:123], v7 offset:50752
    v_mfma_f32_16x16x32_bf16 v[68:71], a[96:99], a[36:39], v[68:71]
    v_mfma_f32_16x16x32_bf16 v[72:75], a[96:99], a[40:43], v[72:75]
    ds_read_b64_tr_b16 a[124:125], v7 offset:54336
    v_mfma_f32_16x16x32_bf16 v[72:75], a[100:103], a[56:59], v[72:75]
    v_mfma_f32_16x16x32_bf16 v[76:79], a[100:103], a[60:63], v[76:79]
    ds_read_b64_tr_b16 a[126:127], v7 offset:57920
    v_mfma_f32_16x16x32_bf16 v[76:79], a[96:99], a[44:47], v[76:79]
    s_waitcnt lgkmcnt(8)
    v_mfma_f32_16x16x32_bf16 v[92:95], a[104:107], a[44:47], v[92:95]
    ds_read_b64_tr_b16 a[128:129], v7 offset:32864
    v_mfma_f32_16x16x32_bf16 v[92:95], a[108:111], a[60:63], v[92:95]
    buffer_load_dwordx4 v25, s[40:43], s30 offen offset:1024  lds
    v_mfma_f32_16x16x32_bf16 v[88:91], a[108:111], a[56:59], v[88:91]
    ds_read_b64_tr_b16 a[130:131], v7 offset:36448
    v_mfma_f32_16x16x32_bf16 v[88:91], a[104:107], a[40:43], v[88:91]
    v_mfma_f32_16x16x32_bf16 v[84:87], a[104:107], a[36:39], v[84:87]
    ds_read_b64_tr_b16 a[132:133], v7 offset:40032
    v_mfma_f32_16x16x32_bf16 v[84:87], a[108:111], a[52:55], v[84:87]
    v_mfma_f32_16x16x32_bf16 v[80:83], a[108:111], a[48:51], v[80:83]
    ds_read_b64_tr_b16 a[134:135], v7 offset:43616
    v_mfma_f32_16x16x32_bf16 v[80:83], a[104:107], a[32:35], v[80:83]
    buffer_load_dwordx4 v26, s[40:43], s30 offen offset:2048  lds
    s_waitcnt lgkmcnt(8)
    v_mfma_f32_16x16x32_bf16 v[96:99], a[112:115], a[32:35], v[96:99]
    ds_read_b64_tr_b16 a[96:97], v7 offset:47200
    s_bfe_u32 s31, s65, 262148
    v_mfma_f32_16x16x32_bf16 v[96:99], a[116:119], a[48:51], v[96:99]
    s_lshl_b32 s31, s31, 13
    v_mfma_f32_16x16x32_bf16 v[100:103], a[116:119], a[52:55], v[100:103]
    ds_read_b64_tr_b16 a[98:99], v7 offset:50784
    s_add_u32 s31, s31, s16
    v_mfma_f32_16x16x32_bf16 v[100:103], a[112:115], a[36:39], v[100:103]
    v_mfma_f32_16x16x32_bf16 v[104:107], a[112:115], a[40:43], v[104:107]
    ds_read_b64_tr_b16 a[100:101], v7 offset:54368
    v_mfma_f32_16x16x32_bf16 v[104:107], a[116:119], a[56:59], v[104:107]
    buffer_load_dwordx4 a[0:3], v1, s[8:11], s31 offen offset:0 sc1
    v_mfma_f32_16x16x32_bf16 v[108:111], a[116:119], a[60:63], v[108:111]
    ds_read_b64_tr_b16 a[102:103], v7 offset:57952
    v_mfma_f32_16x16x32_bf16 v[108:111], a[112:115], a[44:47], v[108:111]
    s_waitcnt lgkmcnt(8)
    v_mfma_f32_16x16x32_bf16 v[124:127], a[120:123], a[44:47], v[124:127]
    ds_read_b64_tr_b16 a[104:105], v7 offset:32896
    v_mfma_f32_16x16x32_bf16 v[124:127], a[124:127], a[60:63], v[124:127]
    v_mfma_f32_16x16x32_bf16 v[120:123], a[124:127], a[56:59], v[120:123]
    ds_read_b64_tr_b16 a[106:107], v7 offset:36480
    v_mfma_f32_16x16x32_bf16 v[120:123], a[120:123], a[40:43], v[120:123]
    buffer_load_dwordx4 a[4:7], v1, s[8:11], s31 offen offset:1024 sc1
    v_mfma_f32_16x16x32_bf16 v[116:119], a[120:123], a[36:39], v[116:119]
    ds_read_b64_tr_b16 a[108:109], v7 offset:40064
    v_mfma_f32_16x16x32_bf16 v[116:119], a[124:127], a[52:55], v[116:119]
    v_mfma_f32_16x16x32_bf16 v[112:115], a[124:127], a[48:51], v[112:115]
    ds_read_b64_tr_b16 a[110:111], v7 offset:43648
    v_mfma_f32_16x16x32_bf16 v[112:115], a[120:123], a[32:35], v[112:115]
    s_waitcnt lgkmcnt(8)
    v_mfma_f32_16x16x32_bf16 v[128:131], a[128:131], a[32:35], v[128:131]
    ds_read_b64_tr_b16 a[112:113], v7 offset:47232
    v_mfma_f32_16x16x32_bf16 v[128:131], a[132:135], a[48:51], v[128:131]
    buffer_load_dwordx4 a[8:11], v1, s[8:11], s31 offen offset:2048 sc1
    v_mfma_f32_16x16x32_bf16 v[132:135], a[132:135], a[52:55], v[132:135]
    ds_read_b64_tr_b16 a[114:115], v7 offset:50816
    v_mfma_f32_16x16x32_bf16 v[132:135], a[128:131], a[36:39], v[132:135]
    v_mfma_f32_16x16x32_bf16 v[136:139], a[128:131], a[40:43], v[136:139]
    ds_read_b64_tr_b16 a[116:117], v7 offset:54400
    v_mfma_f32_16x16x32_bf16 v[136:139], a[132:135], a[56:59], v[136:139]
    v_mfma_f32_16x16x32_bf16 v[140:143], a[132:135], a[60:63], v[140:143]
    ds_read_b64_tr_b16 a[118:119], v7 offset:57984
    v_mfma_f32_16x16x32_bf16 v[140:143], a[128:131], a[44:47], v[140:143]
    buffer_load_dwordx4 a[12:15], v1, s[8:11], s31 offen offset:3072 sc1
    s_waitcnt lgkmcnt(8)
    v_mfma_f32_16x16x32_bf16 v[156:159], a[96:99], a[44:47], v[156:159]
    ds_read_b64_tr_b16 a[120:121], v7 offset:32928
    v_mfma_f32_16x16x32_bf16 v[156:159], a[100:103], a[60:63], v[156:159]
    v_mfma_f32_16x16x32_bf16 v[152:155], a[100:103], a[56:59], v[152:155]
    ds_read_b64_tr_b16 a[122:123], v7 offset:36512
    v_mfma_f32_16x16x32_bf16 v[152:155], a[96:99], a[40:43], v[152:155]
    v_mfma_f32_16x16x32_bf16 v[148:151], a[96:99], a[36:39], v[148:151]
    ds_read_b64_tr_b16 a[124:125], v7 offset:40096
    v_mfma_f32_16x16x32_bf16 v[148:151], a[100:103], a[52:55], v[148:151]
    buffer_load_dwordx4 a[16:19], v30, s[8:11], s31 offen offset:0 sc1
    v_mfma_f32_16x16x32_bf16 v[144:147], a[100:103], a[48:51], v[144:147]
    ds_read_b64_tr_b16 a[126:127], v7 offset:43680
    v_mfma_f32_16x16x32_bf16 v[144:147], a[96:99], a[32:35], v[144:147]
    s_waitcnt lgkmcnt(8)
    v_mfma_f32_16x16x32_bf16 v[160:163], a[104:107], a[32:35], v[160:163]
    ds_read_b64_tr_b16 a[128:129], v7 offset:47264
    v_mfma_f32_16x16x32_bf16 v[160:163], a[108:111], a[48:51], v[160:163]
    v_mfma_f32_16x16x32_bf16 v[164:167], a[108:111], a[52:55], v[164:167]
    ds_read_b64_tr_b16 a[130:131], v7 offset:50848
    v_mfma_f32_16x16x32_bf16 v[164:167], a[104:107], a[36:39], v[164:167]
    buffer_load_dwordx4 a[20:23], v30, s[8:11], s31 offen offset:1024 sc1
    v_mfma_f32_16x16x32_bf16 v[168:171], a[104:107], a[40:43], v[168:171]
    ds_read_b64_tr_b16 a[132:133], v7 offset:54432
    v_mfma_f32_16x16x32_bf16 v[168:171], a[108:111], a[56:59], v[168:171]
    v_mfma_f32_16x16x32_bf16 v[172:175], a[108:111], a[60:63], v[172:175]
    ds_read_b64_tr_b16 a[134:135], v7 offset:58016
    v_mfma_f32_16x16x32_bf16 v[172:175], a[104:107], a[44:47], v[172:175]
    s_waitcnt lgkmcnt(8)
    v_mfma_f32_16x16x32_bf16 v[188:191], a[112:115], a[44:47], v[188:191]
    ds_read_b64_tr_b16 a[96:97], v7 offset:32960
    v_mfma_f32_16x16x32_bf16 v[188:191], a[116:119], a[60:63], v[188:191]
    buffer_load_dwordx4 a[24:27], v30, s[8:11], s31 offen offset:2048 sc1
    v_mfma_f32_16x16x32_bf16 v[184:187], a[116:119], a[56:59], v[184:187]
    ds_read_b64_tr_b16 a[98:99], v7 offset:36544
    v_mfma_f32_16x16x32_bf16 v[184:187], a[112:115], a[40:43], v[184:187]
    v_mfma_f32_16x16x32_bf16 v[180:183], a[112:115], a[36:39], v[180:183]
    ds_read_b64_tr_b16 a[100:101], v7 offset:40128
    v_mfma_f32_16x16x32_bf16 v[180:183], a[116:119], a[52:55], v[180:183]
    v_mfma_f32_16x16x32_bf16 v[176:179], a[116:119], a[48:51], v[176:179]
    ds_read_b64_tr_b16 a[102:103], v7 offset:43712
    v_mfma_f32_16x16x32_bf16 v[176:179], a[112:115], a[32:35], v[176:179]
    buffer_load_dwordx4 a[28:31], v30, s[8:11], s31 offen offset:3072 sc1
    s_waitcnt lgkmcnt(8)
    v_mfma_f32_16x16x32_bf16 v[192:195], a[120:123], a[32:35], v[192:195]
    ds_read_b64_tr_b16 a[104:105], v7 offset:47296
    v_accvgpr_read_b32 v31, a201
    v_mfma_f32_16x16x32_bf16 v[192:195], a[124:127], a[48:51], v[192:195]
    v_mfma_f32_16x16x32_bf16 v[196:199], a[124:127], a[52:55], v[196:199]
    ds_read_b64_tr_b16 a[106:107], v7 offset:50880
    v_mfma_f32_16x16x32_bf16 v[196:199], a[120:123], a[36:39], v[196:199]
    v_mfma_f32_16x16x32_bf16 v[200:203], a[120:123], a[40:43], v[200:203]
    ds_read_b64_tr_b16 a[108:109], v7 offset:54464
    v_mfma_f32_16x16x32_bf16 v[200:203], a[124:127], a[56:59], v[200:203]
    v_mfma_f32_16x16x32_bf16 v[204:207], a[124:127], a[60:63], v[204:207]
    ds_read_b64_tr_b16 a[110:111], v7 offset:58048
    v_mfma_f32_16x16x32_bf16 v[204:207], a[120:123], a[44:47], v[204:207]
    global_load_dword a200, v31, s[74:75]
    s_waitcnt lgkmcnt(8)
    v_mfma_f32_16x16x32_bf16 v[220:223], a[128:131], a[44:47], v[220:223]
    s_waitcnt vmcnt(24)
    s_barrier
    ds_read_b64_tr_b16 a[112:113], v6 offset:0
    s_add_u32 m0, s82, 65536
    v_mfma_f32_16x16x32_bf16 v[220:223], a[132:135], a[60:63], v[220:223]
    s_bfe_u32 s30, s65, 262152
    v_mfma_f32_16x16x32_bf16 v[216:219], a[132:135], a[56:59], v[216:219]
    ds_read_b64_tr_b16 a[114:115], v6 offset:3584
    s_mul_i32 s30, s30, 458752
    v_mfma_f32_16x16x32_bf16 v[216:219], a[128:131], a[40:43], v[216:219]
    v_mfma_f32_16x16x32_bf16 v[212:215], a[128:131], a[36:39], v[212:215]
    ds_read_b64_tr_b16 a[116:117], v6 offset:7168
    v_mfma_f32_16x16x32_bf16 v[212:215], a[132:135], a[52:55], v[212:215]
    buffer_load_dwordx4 v20, s[40:43], s30 offen offset:0  lds
    v_mfma_f32_16x16x32_bf16 v[208:211], a[132:135], a[48:51], v[208:211]
    ds_read_b64_tr_b16 a[118:119], v6 offset:10752
    v_mfma_f32_16x16x32_bf16 v[208:211], a[128:131], a[32:35], v[208:211]
    s_waitcnt lgkmcnt(8)
    v_mfma_f32_16x16x32_bf16 v[224:227], a[96:99], a[32:35], v[224:227]
    ds_read_b64_tr_b16 a[120:121], v6 offset:14336
    v_mfma_f32_16x16x32_bf16 v[224:227], a[100:103], a[48:51], v[224:227]
    v_mfma_f32_16x16x32_bf16 v[228:231], a[100:103], a[52:55], v[228:231]
    ds_read_b64_tr_b16 a[122:123], v6 offset:17920
    v_mfma_f32_16x16x32_bf16 v[228:231], a[96:99], a[36:39], v[228:231]
    buffer_load_dwordx4 v21, s[40:43], s30 offen offset:1024  lds
    v_mfma_f32_16x16x32_bf16 v[232:235], a[96:99], a[40:43], v[232:235]
    ds_read_b64_tr_b16 a[124:125], v6 offset:21504
    v_mfma_f32_16x16x32_bf16 v[232:235], a[100:103], a[56:59], v[232:235]
    v_mfma_f32_16x16x32_bf16 v[236:239], a[100:103], a[60:63], v[236:239]
    ds_read_b64_tr_b16 a[126:127], v6 offset:25088
    v_mfma_f32_16x16x32_bf16 v[236:239], a[96:99], a[44:47], v[236:239]
    s_waitcnt lgkmcnt(8)
    v_mfma_f32_16x16x32_bf16 v[252:255], a[104:107], a[44:47], v[252:255]
    ds_read_b64_tr_b16 a[128:129], v6 offset:32
    v_mfma_f32_16x16x32_bf16 v[252:255], a[108:111], a[60:63], v[252:255]
    buffer_load_dwordx4 v22, s[40:43], s30 offen offset:2048  lds
    v_mfma_f32_16x16x32_bf16 v[248:251], a[108:111], a[56:59], v[248:251]
    ds_read_b64_tr_b16 a[130:131], v6 offset:3616
    v_mfma_f32_16x16x32_bf16 v[248:251], a[104:107], a[40:43], v[248:251]
    v_mfma_f32_16x16x32_bf16 v[244:247], a[104:107], a[36:39], v[244:247]
    ds_read_b64_tr_b16 a[132:133], v6 offset:7200
    v_mfma_f32_16x16x32_bf16 v[244:247], a[108:111], a[52:55], v[244:247]
    v_mfma_f32_16x16x32_bf16 v[240:243], a[108:111], a[48:51], v[240:243]
    ds_read_b64_tr_b16 a[134:135], v6 offset:10784
    v_mfma_f32_16x16x32_bf16 v[240:243], a[104:107], a[32:35], v[240:243]
    buffer_load_dwordx4 v23, s[40:43], s30 offen offset:3072  lds
    s_waitcnt vmcnt(20) lgkmcnt(8)
    v_mfma_f32_16x16x32_bf16 v[32:35], a[112:115], a[64:67], v[32:35]
    ds_read_b64_tr_b16 a[96:97], v6 offset:14368
    s_add_u32 m0, s82, 69632
    v_mfma_f32_16x16x32_bf16 v[32:35], a[116:119], a[80:83], v[32:35]
    v_mfma_f32_16x16x32_bf16 v[36:39], a[116:119], a[84:87], v[36:39]
    ds_read_b64_tr_b16 a[98:99], v6 offset:17952
    v_mfma_f32_16x16x32_bf16 v[36:39], a[112:115], a[68:71], v[36:39]
    v_mfma_f32_16x16x32_bf16 v[40:43], a[112:115], a[72:75], v[40:43]
    ds_read_b64_tr_b16 a[100:101], v6 offset:21536
    v_mfma_f32_16x16x32_bf16 v[40:43], a[116:119], a[88:91], v[40:43]
    buffer_load_dwordx4 v24, s[40:43], s30 offen offset:0  lds
    v_mfma_f32_16x16x32_bf16 v[44:47], a[116:119], a[92:95], v[44:47]
    ds_read_b64_tr_b16 a[102:103], v6 offset:25120
    v_mfma_f32_16x16x32_bf16 v[44:47], a[112:115], a[76:79], v[44:47]
    s_waitcnt lgkmcnt(8)
    v_mfma_f32_16x16x32_bf16 v[60:63], a[120:123], a[76:79], v[60:63]
    ds_read_b64_tr_b16 a[104:105], v6 offset:64
    v_mfma_f32_16x16x32_bf16 v[60:63], a[124:127], a[92:95], v[60:63]
    v_mfma_f32_16x16x32_bf16 v[56:59], a[124:127], a[88:91], v[56:59]
    ds_read_b64_tr_b16 a[106:107], v6 offset:3648
    v_mfma_f32_16x16x32_bf16 v[56:59], a[120:123], a[72:75], v[56:59]
    buffer_load_dwordx4 v25, s[40:43], s30 offen offset:1024  lds
    v_mfma_f32_16x16x32_bf16 v[52:55], a[120:123], a[68:71], v[52:55]
    ds_read_b64_tr_b16 a[108:109], v6 offset:7232
    v_mfma_f32_16x16x32_bf16 v[52:55], a[124:127], a[84:87], v[52:55]
    v_mfma_f32_16x16x32_bf16 v[48:51], a[124:127], a[80:83], v[48:51]
    ds_read_b64_tr_b16 a[110:111], v6 offset:10816
    v_mfma_f32_16x16x32_bf16 v[48:51], a[120:123], a[64:67], v[48:51]
    s_waitcnt lgkmcnt(8)
    v_mfma_f32_16x16x32_bf16 v[64:67], a[128:131], a[64:67], v[64:67]
    ds_read_b64_tr_b16 a[112:113], v6 offset:14400
    v_mfma_f32_16x16x32_bf16 v[64:67], a[132:135], a[80:83], v[64:67]
    buffer_load_dwordx4 v26, s[40:43], s30 offen offset:2048  lds
    v_mfma_f32_16x16x32_bf16 v[68:71], a[132:135], a[84:87], v[68:71]
    ds_read_b64_tr_b16 a[114:115], v6 offset:17984
    s_bfe_u32 s31, s65, 262152
    v_mfma_f32_16x16x32_bf16 v[68:71], a[128:131], a[68:71], v[68:71]
    s_lshl_b32 s31, s31, 13
    v_mfma_f32_16x16x32_bf16 v[72:75], a[128:131], a[72:75], v[72:75]
    ds_read_b64_tr_b16 a[116:117], v6 offset:21568
    s_add_u32 s31, s31, s16
    v_mfma_f32_16x16x32_bf16 v[72:75], a[132:135], a[88:91], v[72:75]
    v_mfma_f32_16x16x32_bf16 v[76:79], a[132:135], a[92:95], v[76:79]
    ds_read_b64_tr_b16 a[118:119], v6 offset:25152
    v_mfma_f32_16x16x32_bf16 v[76:79], a[128:131], a[76:79], v[76:79]
    buffer_load_dwordx4 a[32:35], v1, s[8:11], s31 offen offset:0 sc1
    s_waitcnt lgkmcnt(8)
    v_mfma_f32_16x16x32_bf16 v[92:95], a[96:99], a[76:79], v[92:95]
    ds_read_b64_tr_b16 a[120:121], v6 offset:96
    v_mfma_f32_16x16x32_bf16 v[92:95], a[100:103], a[92:95], v[92:95]
    v_mfma_f32_16x16x32_bf16 v[88:91], a[100:103], a[88:91], v[88:91]
    ds_read_b64_tr_b16 a[122:123], v6 offset:3680
    v_mfma_f32_16x16x32_bf16 v[88:91], a[96:99], a[72:75], v[88:91]
    v_mfma_f32_16x16x32_bf16 v[84:87], a[96:99], a[68:71], v[84:87]
    ds_read_b64_tr_b16 a[124:125], v6 offset:7264
    v_mfma_f32_16x16x32_bf16 v[84:87], a[100:103], a[84:87], v[84:87]
    buffer_load_dwordx4 a[36:39], v1, s[8:11], s31 offen offset:1024 sc1
    v_mfma_f32_16x16x32_bf16 v[80:83], a[100:103], a[80:83], v[80:83]
    ds_read_b64_tr_b16 a[126:127], v6 offset:10848
    v_mfma_f32_16x16x32_bf16 v[80:83], a[96:99], a[64:67], v[80:83]
    s_waitcnt lgkmcnt(8)
    v_mfma_f32_16x16x32_bf16 v[96:99], a[104:107], a[64:67], v[96:99]
    ds_read_b64_tr_b16 a[128:129], v6 offset:14432
    v_mfma_f32_16x16x32_bf16 v[96:99], a[108:111], a[80:83], v[96:99]
    v_mfma_f32_16x16x32_bf16 v[100:103], a[108:111], a[84:87], v[100:103]
    ds_read_b64_tr_b16 a[130:131], v6 offset:18016
    v_mfma_f32_16x16x32_bf16 v[100:103], a[104:107], a[68:71], v[100:103]
    v_mfma_f32_16x16x32_bf16 v[104:107], a[104:107], a[72:75], v[104:107]
    ds_read_b64_tr_b16 a[132:133], v6 offset:21600
    v_mfma_f32_16x16x32_bf16 v[104:107], a[108:111], a[88:91], v[104:107]
    buffer_load_dwordx4 a[40:43], v1, s[8:11], s31 offen offset:2048 sc1
    v_mfma_f32_16x16x32_bf16 v[108:111], a[108:111], a[92:95], v[108:111]
    ds_read_b64_tr_b16 a[134:135], v6 offset:25184
    v_mfma_f32_16x16x32_bf16 v[108:111], a[104:107], a[76:79], v[108:111]
    s_waitcnt lgkmcnt(8)
    v_mfma_f32_16x16x32_bf16 v[124:127], a[112:115], a[76:79], v[124:127]
    ds_read_b64_tr_b16 a[96:97], v6 offset:128
    v_mfma_f32_16x16x32_bf16 v[124:127], a[116:119], a[92:95], v[124:127]
    v_mfma_f32_16x16x32_bf16 v[120:123], a[116:119], a[88:91], v[120:123]
    ds_read_b64_tr_b16 a[98:99], v6 offset:3712
    v_mfma_f32_16x16x32_bf16 v[120:123], a[112:115], a[72:75], v[120:123]
    buffer_load_dwordx4 a[44:47], v1, s[8:11], s31 offen offset:3072 sc1
    v_mfma_f32_16x16x32_bf16 v[116:119], a[112:115], a[68:71], v[116:119]
    ds_read_b64_tr_b16 a[100:101], v6 offset:7296
    v_mfma_f32_16x16x32_bf16 v[116:119], a[116:119], a[84:87], v[116:119]
    v_mfma_f32_16x16x32_bf16 v[112:115], a[116:119], a[80:83], v[112:115]
    ds_read_b64_tr_b16 a[102:103], v6 offset:10880
    v_mfma_f32_16x16x32_bf16 v[112:115], a[112:115], a[64:67], v[112:115]
    s_waitcnt lgkmcnt(8)
    v_mfma_f32_16x16x32_bf16 v[128:131], a[120:123], a[64:67], v[128:131]
    ds_read_b64_tr_b16 a[104:105], v6 offset:14464
    v_mfma_f32_16x16x32_bf16 v[128:131], a[124:127], a[80:83], v[128:131]
    buffer_load_dwordx4 a[48:51], v30, s[8:11], s31 offen offset:0 sc1
    v_mfma_f32_16x16x32_bf16 v[132:135], a[124:127], a[84:87], v[132:135]
    ds_read_b64_tr_b16 a[106:107], v6 offset:18048
    v_mfma_f32_16x16x32_bf16 v[132:135], a[120:123], a[68:71], v[132:135]
    v_mfma_f32_16x16x32_bf16 v[136:139], a[120:123], a[72:75], v[136:139]
    ds_read_b64_tr_b16 a[108:109], v6 offset:21632
    v_mfma_f32_16x16x32_bf16 v[136:139], a[124:127], a[88:91], v[136:139]
    v_mfma_f32_16x16x32_bf16 v[140:143], a[124:127], a[92:95], v[140:143]
    ds_read_b64_tr_b16 a[110:111], v6 offset:25216
    v_mfma_f32_16x16x32_bf16 v[140:143], a[120:123], a[76:79], v[140:143]
    buffer_load_dwordx4 a[52:55], v30, s[8:11], s31 offen offset:1024 sc1
    s_waitcnt lgkmcnt(8)
    v_mfma_f32_16x16x32_bf16 v[156:159], a[128:131], a[76:79], v[156:159]
    ds_read_b64_tr_b16 a[112:113], v6 offset:160
    v_mfma_f32_16x16x32_bf16 v[156:159], a[132:135], a[92:95], v[156:159]
    v_mfma_f32_16x16x32_bf16 v[152:155], a[132:135], a[88:91], v[152:155]
    ds_read_b64_tr_b16 a[114:115], v6 offset:3744
    v_mfma_f32_16x16x32_bf16 v[152:155], a[128:131], a[72:75], v[152:155]
    v_mfma_f32_16x16x32_bf16 v[148:151], a[128:131], a[68:71], v[148:151]
    ds_read_b64_tr_b16 a[116:117], v6 offset:7328
    v_mfma_f32_16x16x32_bf16 v[148:151], a[132:135], a[84:87], v[148:151]
    buffer_load_dwordx4 a[56:59], v30, s[8:11], s31 offen offset:2048 sc1
    v_mfma_f32_16x16x32_bf16 v[144:147], a[132:135], a[80:83], v[144:147]
    ds_read_b64_tr_b16 a[118:119], v6 offset:10912
    v_mfma_f32_16x16x32_bf16 v[144:147], a[128:131], a[64:67], v[144:147]
    s_waitcnt lgkmcnt(8)
    v_mfma_f32_16x16x32_bf16 v[160:163], a[96:99], a[64:67], v[160:163]
    ds_read_b64_tr_b16 a[120:121], v6 offset:14496
    v_mfma_f32_16x16x32_bf16 v[160:163], a[100:103], a[80:83], v[160:163]
    v_mfma_f32_16x16x32_bf16 v[164:167], a[100:103], a[84:87], v[164:167]
    ds_read_b64_tr_b16 a[122:123], v6 offset:18080
    v_mfma_f32_16x16x32_bf16 v[164:167], a[96:99], a[68:71], v[164:167]
    buffer_load_dwordx4 a[60:63], v30, s[8:11], s31 offen offset:3072 sc1
    v_mfma_f32_16x16x32_bf16 v[168:171], a[96:99], a[72:75], v[168:171]
    ds_read_b64_tr_b16 a[124:125], v6 offset:21664
    v_mfma_f32_16x16x32_bf16 v[168:171], a[100:103], a[88:91], v[168:171]
    v_mfma_f32_16x16x32_bf16 v[172:175], a[100:103], a[92:95], v[172:175]
    ds_read_b64_tr_b16 a[126:127], v6 offset:25248
    v_mfma_f32_16x16x32_bf16 v[172:175], a[96:99], a[76:79], v[172:175]
    s_waitcnt lgkmcnt(8)
    v_mfma_f32_16x16x32_bf16 v[188:191], a[104:107], a[76:79], v[188:191]
    ds_read_b64_tr_b16 a[128:129], v6 offset:192
    v_mfma_f32_16x16x32_bf16 v[188:191], a[108:111], a[92:95], v[188:191]
    v_mfma_f32_16x16x32_bf16 v[184:187], a[108:111], a[88:91], v[184:187]
    ds_read_b64_tr_b16 a[130:131], v6 offset:3776
    v_mfma_f32_16x16x32_bf16 v[184:187], a[104:107], a[72:75], v[184:187]
    v_mfma_f32_16x16x32_bf16 v[180:183], a[104:107], a[68:71], v[180:183]
    ds_read_b64_tr_b16 a[132:133], v6 offset:7360
    v_mfma_f32_16x16x32_bf16 v[180:183], a[108:111], a[84:87], v[180:183]
    v_mfma_f32_16x16x32_bf16 v[176:179], a[108:111], a[80:83], v[176:179]
    ds_read_b64_tr_b16 a[134:135], v6 offset:10944
    v_mfma_f32_16x16x32_bf16 v[176:179], a[104:107], a[64:67], v[176:179]
    s_waitcnt lgkmcnt(8)
    v_mfma_f32_16x16x32_bf16 v[192:195], a[112:115], a[64:67], v[192:195]
    ds_read_b64_tr_b16 a[96:97], v6 offset:14528
    v_mfma_f32_16x16x32_bf16 v[192:195], a[116:119], a[80:83], v[192:195]
    v_mfma_f32_16x16x32_bf16 v[196:199], a[116:119], a[84:87], v[196:199]
    ds_read_b64_tr_b16 a[98:99], v6 offset:18112
    v_mfma_f32_16x16x32_bf16 v[196:199], a[112:115], a[68:71], v[196:199]
    v_mfma_f32_16x16x32_bf16 v[200:203], a[112:115], a[72:75], v[200:203]
    ds_read_b64_tr_b16 a[100:101], v6 offset:21696
    v_mfma_f32_16x16x32_bf16 v[200:203], a[116:119], a[88:91], v[200:203]
    v_mfma_f32_16x16x32_bf16 v[204:207], a[116:119], a[92:95], v[204:207]
    ds_read_b64_tr_b16 a[102:103], v6 offset:25280
    v_mfma_f32_16x16x32_bf16 v[204:207], a[112:115], a[76:79], v[204:207]
    s_waitcnt lgkmcnt(8)
    v_mfma_f32_16x16x32_bf16 v[220:223], a[120:123], a[76:79], v[220:223]
    s_waitcnt vmcnt(24)
    s_barrier
    ds_read_b64_tr_b16 a[104:105], v6 offset:32768
    s_add_u32 m0, s82, 98304
    v_mfma_f32_16x16x32_bf16 v[220:223], a[124:127], a[92:95], v[220:223]
    s_bfe_u32 s30, s65, 262156
    s_mul_i32 s30, s30, 458752
    v_mfma_f32_16x16x32_bf16 v[216:219], a[124:127], a[88:91], v[216:219]
    ds_read_b64_tr_b16 a[106:107], v6 offset:36352
    v_mfma_f32_16x16x32_bf16 v[216:219], a[120:123], a[72:75], v[216:219]
    buffer_load_dwordx4 v20, s[40:43], s30 offen offset:0  lds
    v_mfma_f32_16x16x32_bf16 v[212:215], a[120:123], a[68:71], v[212:215]
    ds_read_b64_tr_b16 a[108:109], v6 offset:39936
    v_mfma_f32_16x16x32_bf16 v[212:215], a[124:127], a[84:87], v[212:215]
    v_mfma_f32_16x16x32_bf16 v[208:211], a[124:127], a[80:83], v[208:211]
    ds_read_b64_tr_b16 a[110:111], v6 offset:43520
    v_mfma_f32_16x16x32_bf16 v[208:211], a[120:123], a[64:67], v[208:211]
    s_waitcnt lgkmcnt(8)
    v_mfma_f32_16x16x32_bf16 v[224:227], a[128:131], a[64:67], v[224:227]
    ds_read_b64_tr_b16 a[112:113], v6 offset:47104
    v_mfma_f32_16x16x32_bf16 v[224:227], a[132:135], a[80:83], v[224:227]
    buffer_load_dwordx4 v21, s[40:43], s30 offen offset:1024  lds
    v_mfma_f32_16x16x32_bf16 v[228:231], a[132:135], a[84:87], v[228:231]
    ds_read_b64_tr_b16 a[114:115], v6 offset:50688
    v_mfma_f32_16x16x32_bf16 v[228:231], a[128:131], a[68:71], v[228:231]
    v_mfma_f32_16x16x32_bf16 v[232:235], a[128:131], a[72:75], v[232:235]
    ds_read_b64_tr_b16 a[116:117], v6 offset:54272
    v_mfma_f32_16x16x32_bf16 v[232:235], a[132:135], a[88:91], v[232:235]
    v_mfma_f32_16x16x32_bf16 v[236:239], a[132:135], a[92:95], v[236:239]
    ds_read_b64_tr_b16 a[118:119], v6 offset:57856
    v_mfma_f32_16x16x32_bf16 v[236:239], a[128:131], a[76:79], v[236:239]
    buffer_load_dwordx4 v22, s[40:43], s30 offen offset:2048  lds
    s_waitcnt lgkmcnt(8)
    v_mfma_f32_16x16x32_bf16 v[252:255], a[96:99], a[76:79], v[252:255]
    ds_read_b64_tr_b16 a[120:121], v6 offset:32800
    v_mfma_f32_16x16x32_bf16 v[252:255], a[100:103], a[92:95], v[252:255]
    v_mfma_f32_16x16x32_bf16 v[248:251], a[100:103], a[88:91], v[248:251]
    ds_read_b64_tr_b16 a[122:123], v6 offset:36384
    v_mfma_f32_16x16x32_bf16 v[248:251], a[96:99], a[72:75], v[248:251]
    v_mfma_f32_16x16x32_bf16 v[244:247], a[96:99], a[68:71], v[244:247]
    ds_read_b64_tr_b16 a[124:125], v6 offset:39968
    v_mfma_f32_16x16x32_bf16 v[244:247], a[100:103], a[84:87], v[244:247]
    buffer_load_dwordx4 v23, s[40:43], s30 offen offset:3072  lds
    v_mfma_f32_16x16x32_bf16 v[240:243], a[100:103], a[80:83], v[240:243]
    ds_read_b64_tr_b16 a[126:127], v6 offset:43552
    s_add_u32 m0, s82, 102400
    v_mfma_f32_16x16x32_bf16 v[240:243], a[96:99], a[64:67], v[240:243]
    s_waitcnt vmcnt(20) lgkmcnt(8)
    v_mfma_f32_16x16x32_bf16 v[32:35], a[104:107], a[0:3], v[32:35]
    ds_read_b64_tr_b16 a[128:129], v6 offset:47136
    v_mfma_f32_16x16x32_bf16 v[32:35], a[108:111], a[16:19], v[32:35]
    v_mfma_f32_16x16x32_bf16 v[36:39], a[108:111], a[20:23], v[36:39]
    ds_read_b64_tr_b16 a[130:131], v6 offset:50720
    v_mfma_f32_16x16x32_bf16 v[36:39], a[104:107], a[4:7], v[36:39]
    buffer_load_dwordx4 v24, s[40:43], s30 offen offset:0  lds
    v_mfma_f32_16x16x32_bf16 v[40:43], a[104:107], a[8:11], v[40:43]
    ds_read_b64_tr_b16 a[132:133], v6 offset:54304
    v_mfma_f32_16x16x32_bf16 v[40:43], a[108:111], a[24:27], v[40:43]
    v_mfma_f32_16x16x32_bf16 v[44:47], a[108:111], a[28:31], v[44:47]
    ds_read_b64_tr_b16 a[134:135], v6 offset:57888
    v_mfma_f32_16x16x32_bf16 v[44:47], a[104:107], a[12:15], v[44:47]
    s_waitcnt lgkmcnt(8)
    v_mfma_f32_16x16x32_bf16 v[60:63], a[112:115], a[12:15], v[60:63]
    ds_read_b64_tr_b16 a[96:97], v6 offset:32832
    v_mfma_f32_16x16x32_bf16 v[60:63], a[116:119], a[28:31], v[60:63]
    buffer_load_dwordx4 v25, s[40:43], s30 offen offset:1024  lds
    v_mfma_f32_16x16x32_bf16 v[56:59], a[116:119], a[24:27], v[56:59]
    ds_read_b64_tr_b16 a[98:99], v6 offset:36416
    v_mfma_f32_16x16x32_bf16 v[56:59], a[112:115], a[8:11], v[56:59]
    v_mfma_f32_16x16x32_bf16 v[52:55], a[112:115], a[4:7], v[52:55]
    ds_read_b64_tr_b16 a[100:101], v6 offset:40000
    v_mfma_f32_16x16x32_bf16 v[52:55], a[116:119], a[20:23], v[52:55]
    v_mfma_f32_16x16x32_bf16 v[48:51], a[116:119], a[16:19], v[48:51]
    ds_read_b64_tr_b16 a[102:103], v6 offset:43584
    v_mfma_f32_16x16x32_bf16 v[48:51], a[112:115], a[0:3], v[48:51]
    buffer_load_dwordx4 v26, s[40:43], s30 offen offset:2048  lds
    s_waitcnt lgkmcnt(8)
    v_mfma_f32_16x16x32_bf16 v[64:67], a[120:123], a[0:3], v[64:67]
    ds_read_b64_tr_b16 a[104:105], v6 offset:47168
    s_bfe_u32 s31, s65, 262156
    v_mfma_f32_16x16x32_bf16 v[64:67], a[124:127], a[16:19], v[64:67]
    s_lshl_b32 s31, s31, 13
    v_mfma_f32_16x16x32_bf16 v[68:71], a[124:127], a[20:23], v[68:71]
    ds_read_b64_tr_b16 a[106:107], v6 offset:50752
    s_add_u32 s31, s31, s16
    v_mfma_f32_16x16x32_bf16 v[68:71], a[120:123], a[4:7], v[68:71]
    v_mfma_f32_16x16x32_bf16 v[72:75], a[120:123], a[8:11], v[72:75]
    ds_read_b64_tr_b16 a[108:109], v6 offset:54336
    v_mfma_f32_16x16x32_bf16 v[72:75], a[124:127], a[24:27], v[72:75]
    buffer_load_dwordx4 a[64:67], v1, s[8:11], s31 offen offset:0 sc1
    v_mfma_f32_16x16x32_bf16 v[76:79], a[124:127], a[28:31], v[76:79]
    ds_read_b64_tr_b16 a[110:111], v6 offset:57920
    v_mfma_f32_16x16x32_bf16 v[76:79], a[120:123], a[12:15], v[76:79]
    s_waitcnt lgkmcnt(8)
    v_mfma_f32_16x16x32_bf16 v[92:95], a[128:131], a[12:15], v[92:95]
    ds_read_b64_tr_b16 a[112:113], v6 offset:32864
    v_mfma_f32_16x16x32_bf16 v[92:95], a[132:135], a[28:31], v[92:95]
    v_mfma_f32_16x16x32_bf16 v[88:91], a[132:135], a[24:27], v[88:91]
    ds_read_b64_tr_b16 a[114:115], v6 offset:36448
    v_mfma_f32_16x16x32_bf16 v[88:91], a[128:131], a[8:11], v[88:91]
    buffer_load_dwordx4 a[68:71], v1, s[8:11], s31 offen offset:1024 sc1
    v_mfma_f32_16x16x32_bf16 v[84:87], a[128:131], a[4:7], v[84:87]
    ds_read_b64_tr_b16 a[116:117], v6 offset:40032
    v_mfma_f32_16x16x32_bf16 v[84:87], a[132:135], a[20:23], v[84:87]
    v_mfma_f32_16x16x32_bf16 v[80:83], a[132:135], a[16:19], v[80:83]
    ds_read_b64_tr_b16 a[118:119], v6 offset:43616
    v_mfma_f32_16x16x32_bf16 v[80:83], a[128:131], a[0:3], v[80:83]
    s_waitcnt lgkmcnt(8)
    v_mfma_f32_16x16x32_bf16 v[96:99], a[96:99], a[0:3], v[96:99]
    ds_read_b64_tr_b16 a[120:121], v6 offset:47200
    v_mfma_f32_16x16x32_bf16 v[96:99], a[100:103], a[16:19], v[96:99]
    buffer_load_dwordx4 a[72:75], v1, s[8:11], s31 offen offset:2048 sc1
    v_mfma_f32_16x16x32_bf16 v[100:103], a[100:103], a[20:23], v[100:103]
    ds_read_b64_tr_b16 a[122:123], v6 offset:50784
    v_mfma_f32_16x16x32_bf16 v[100:103], a[96:99], a[4:7], v[100:103]
    v_mfma_f32_16x16x32_bf16 v[104:107], a[96:99], a[8:11], v[104:107]
    ds_read_b64_tr_b16 a[124:125], v6 offset:54368
    v_mfma_f32_16x16x32_bf16 v[104:107], a[100:103], a[24:27], v[104:107]
    v_mfma_f32_16x16x32_bf16 v[108:111], a[100:103], a[28:31], v[108:111]
    ds_read_b64_tr_b16 a[126:127], v6 offset:57952
    v_mfma_f32_16x16x32_bf16 v[108:111], a[96:99], a[12:15], v[108:111]
    s_waitcnt lgkmcnt(8)
    v_mfma_f32_16x16x32_bf16 v[124:127], a[104:107], a[12:15], v[124:127]
    ds_read_b64_tr_b16 a[128:129], v6 offset:32896
    v_mfma_f32_16x16x32_bf16 v[124:127], a[108:111], a[28:31], v[124:127]
    buffer_load_dwordx4 a[76:79], v1, s[8:11], s31 offen offset:3072 sc1
    v_mfma_f32_16x16x32_bf16 v[120:123], a[108:111], a[24:27], v[120:123]
    ds_read_b64_tr_b16 a[130:131], v6 offset:36480
    v_mfma_f32_16x16x32_bf16 v[120:123], a[104:107], a[8:11], v[120:123]
    v_mfma_f32_16x16x32_bf16 v[116:119], a[104:107], a[4:7], v[116:119]
    ds_read_b64_tr_b16 a[132:133], v6 offset:40064
    v_mfma_f32_16x16x32_bf16 v[116:119], a[108:111], a[20:23], v[116:119]
    v_mfma_f32_16x16x32_bf16 v[112:115], a[108:111], a[16:19], v[112:115]
    ds_read_b64_tr_b16 a[134:135], v6 offset:43648
    v_mfma_f32_16x16x32_bf16 v[112:115], a[104:107], a[0:3], v[112:115]
    buffer_load_dwordx4 a[80:83], v30, s[8:11], s31 offen offset:0 sc1
    s_waitcnt lgkmcnt(8)
    v_mfma_f32_16x16x32_bf16 v[128:131], a[112:115], a[0:3], v[128:131]
    ds_read_b64_tr_b16 a[96:97], v6 offset:47232
    v_mfma_f32_16x16x32_bf16 v[128:131], a[116:119], a[16:19], v[128:131]
    v_mfma_f32_16x16x32_bf16 v[132:135], a[116:119], a[20:23], v[132:135]
    ds_read_b64_tr_b16 a[98:99], v6 offset:50816
    v_mfma_f32_16x16x32_bf16 v[132:135], a[112:115], a[4:7], v[132:135]
    v_mfma_f32_16x16x32_bf16 v[136:139], a[112:115], a[8:11], v[136:139]
    ds_read_b64_tr_b16 a[100:101], v6 offset:54400
    v_mfma_f32_16x16x32_bf16 v[136:139], a[116:119], a[24:27], v[136:139]
    buffer_load_dwordx4 a[84:87], v30, s[8:11], s31 offen offset:1024 sc1
    v_mfma_f32_16x16x32_bf16 v[140:143], a[116:119], a[28:31], v[140:143]
    ds_read_b64_tr_b16 a[102:103], v6 offset:57984
    v_mfma_f32_16x16x32_bf16 v[140:143], a[112:115], a[12:15], v[140:143]
    s_waitcnt lgkmcnt(8)
    v_mfma_f32_16x16x32_bf16 v[156:159], a[120:123], a[12:15], v[156:159]
    ds_read_b64_tr_b16 a[104:105], v6 offset:32928
    v_mfma_f32_16x16x32_bf16 v[156:159], a[124:127], a[28:31], v[156:159]
    v_mfma_f32_16x16x32_bf16 v[152:155], a[124:127], a[24:27], v[152:155]
    ds_read_b64_tr_b16 a[106:107], v6 offset:36512
    v_mfma_f32_16x16x32_bf16 v[152:155], a[120:123], a[8:11], v[152:155]
    buffer_load_dwordx4 a[88:91], v30, s[8:11], s31 offen offset:2048 sc1
    v_mfma_f32_16x16x32_bf16 v[148:151], a[120:123], a[4:7], v[148:151]
    ds_read_b64_tr_b16 a[108:109], v6 offset:40096
    v_mfma_f32_16x16x32_bf16 v[148:151], a[124:127], a[20:23], v[148:151]
    v_mfma_f32_16x16x32_bf16 v[144:147], a[124:127], a[16:19], v[144:147]
    ds_read_b64_tr_b16 a[110:111], v6 offset:43680
    v_mfma_f32_16x16x32_bf16 v[144:147], a[120:123], a[0:3], v[144:147]
    s_waitcnt lgkmcnt(8)
    v_mfma_f32_16x16x32_bf16 v[160:163], a[128:131], a[0:3], v[160:163]
    ds_read_b64_tr_b16 a[112:113], v6 offset:47264
    v_mfma_f32_16x16x32_bf16 v[160:163], a[132:135], a[16:19], v[160:163]
    buffer_load_dwordx4 a[92:95], v30, s[8:11], s31 offen offset:3072 sc1
    v_mfma_f32_16x16x32_bf16 v[164:167], a[132:135], a[20:23], v[164:167]
    ds_read_b64_tr_b16 a[114:115], v6 offset:50848
    v_mfma_f32_16x16x32_bf16 v[164:167], a[128:131], a[4:7], v[164:167]
    v_mfma_f32_16x16x32_bf16 v[168:171], a[128:131], a[8:11], v[168:171]
    ds_read_b64_tr_b16 a[116:117], v6 offset:54432
    v_mfma_f32_16x16x32_bf16 v[168:171], a[132:135], a[24:27], v[168:171]
    v_mfma_f32_16x16x32_bf16 v[172:175], a[132:135], a[28:31], v[172:175]
    ds_read_b64_tr_b16 a[118:119], v6 offset:58016
    v_mfma_f32_16x16x32_bf16 v[172:175], a[128:131], a[12:15], v[172:175]
    s_waitcnt lgkmcnt(8)
    v_mfma_f32_16x16x32_bf16 v[188:191], a[96:99], a[12:15], v[188:191]
    ds_read_b64_tr_b16 a[120:121], v6 offset:32960
    v_mfma_f32_16x16x32_bf16 v[188:191], a[100:103], a[28:31], v[188:191]
    v_mfma_f32_16x16x32_bf16 v[184:187], a[100:103], a[24:27], v[184:187]
    ds_read_b64_tr_b16 a[122:123], v6 offset:36544
    v_mfma_f32_16x16x32_bf16 v[184:187], a[96:99], a[8:11], v[184:187]
    v_mfma_f32_16x16x32_bf16 v[180:183], a[96:99], a[4:7], v[180:183]
    ds_read_b64_tr_b16 a[124:125], v6 offset:40128
    v_mfma_f32_16x16x32_bf16 v[180:183], a[100:103], a[20:23], v[180:183]
    v_mfma_f32_16x16x32_bf16 v[176:179], a[100:103], a[16:19], v[176:179]
    ds_read_b64_tr_b16 a[126:127], v6 offset:43712
    v_mfma_f32_16x16x32_bf16 v[176:179], a[96:99], a[0:3], v[176:179]
    s_waitcnt lgkmcnt(8)
    v_mfma_f32_16x16x32_bf16 v[192:195], a[104:107], a[0:3], v[192:195]
    ds_read_b64_tr_b16 a[128:129], v6 offset:47296
    v_mfma_f32_16x16x32_bf16 v[192:195], a[108:111], a[16:19], v[192:195]
    v_mfma_f32_16x16x32_bf16 v[196:199], a[108:111], a[20:23], v[196:199]
    ds_read_b64_tr_b16 a[130:131], v6 offset:50880
    v_mfma_f32_16x16x32_bf16 v[196:199], a[104:107], a[4:7], v[196:199]
    v_mfma_f32_16x16x32_bf16 v[200:203], a[104:107], a[8:11], v[200:203]
    ds_read_b64_tr_b16 a[132:133], v6 offset:54464
    v_mfma_f32_16x16x32_bf16 v[200:203], a[108:111], a[24:27], v[200:203]
    v_mfma_f32_16x16x32_bf16 v[204:207], a[108:111], a[28:31], v[204:207]
    ds_read_b64_tr_b16 a[134:135], v6 offset:58048
    v_mfma_f32_16x16x32_bf16 v[204:207], a[104:107], a[12:15], v[204:207]
    s_waitcnt lgkmcnt(8)
    v_mfma_f32_16x16x32_bf16 v[220:223], a[112:115], a[12:15], v[220:223]
    s_waitcnt vmcnt(23)
    s_barrier
    ds_read_b64_tr_b16 a[96:97], v7 offset:0
    s_add_u32 m0, s82, 0
    v_mfma_f32_16x16x32_bf16 v[220:223], a[116:119], a[28:31], v[220:223]
    s_bfe_u32 s30, s65, 262160
    s_mul_i32 s30, s30, 458752
    v_mfma_f32_16x16x32_bf16 v[216:219], a[116:119], a[24:27], v[216:219]
    ds_read_b64_tr_b16 a[98:99], v7 offset:3584
    v_mfma_f32_16x16x32_bf16 v[216:219], a[112:115], a[8:11], v[216:219]
    buffer_load_dwordx4 v20, s[40:43], s30 offen offset:0  lds
    v_mfma_f32_16x16x32_bf16 v[212:215], a[112:115], a[4:7], v[212:215]
    ds_read_b64_tr_b16 a[100:101], v7 offset:7168
    v_mfma_f32_16x16x32_bf16 v[212:215], a[116:119], a[20:23], v[212:215]
    v_mfma_f32_16x16x32_bf16 v[208:211], a[116:119], a[16:19], v[208:211]
    ds_read_b64_tr_b16 a[102:103], v7 offset:10752
    v_mfma_f32_16x16x32_bf16 v[208:211], a[112:115], a[0:3], v[208:211]
    s_waitcnt lgkmcnt(8)
    v_mfma_f32_16x16x32_bf16 v[224:227], a[120:123], a[0:3], v[224:227]
    ds_read_b64_tr_b16 a[104:105], v7 offset:14336
    v_mfma_f32_16x16x32_bf16 v[224:227], a[124:127], a[16:19], v[224:227]
    buffer_load_dwordx4 v21, s[40:43], s30 offen offset:1024  lds
    v_mfma_f32_16x16x32_bf16 v[228:231], a[124:127], a[20:23], v[228:231]
    ds_read_b64_tr_b16 a[106:107], v7 offset:17920
    v_mfma_f32_16x16x32_bf16 v[228:231], a[120:123], a[4:7], v[228:231]
    v_mfma_f32_16x16x32_bf16 v[232:235], a[120:123], a[8:11], v[232:235]
    ds_read_b64_tr_b16 a[108:109], v7 offset:21504
    v_mfma_f32_16x16x32_bf16 v[232:235], a[124:127], a[24:27], v[232:235]
    v_mfma_f32_16x16x32_bf16 v[236:239], a[124:127], a[28:31], v[236:239]
    ds_read_b64_tr_b16 a[110:111], v7 offset:25088
    v_mfma_f32_16x16x32_bf16 v[236:239], a[120:123], a[12:15], v[236:239]
    buffer_load_dwordx4 v22, s[40:43], s30 offen offset:2048  lds
    s_waitcnt lgkmcnt(8)
    v_mfma_f32_16x16x32_bf16 v[252:255], a[128:131], a[12:15], v[252:255]
    ds_read_b64_tr_b16 a[112:113], v7 offset:32
    v_mfma_f32_16x16x32_bf16 v[252:255], a[132:135], a[28:31], v[252:255]
    v_mfma_f32_16x16x32_bf16 v[248:251], a[132:135], a[24:27], v[248:251]
    ds_read_b64_tr_b16 a[114:115], v7 offset:3616
    v_mfma_f32_16x16x32_bf16 v[248:251], a[128:131], a[8:11], v[248:251]
    v_mfma_f32_16x16x32_bf16 v[244:247], a[128:131], a[4:7], v[244:247]
    ds_read_b64_tr_b16 a[116:117], v7 offset:7200
    v_mfma_f32_16x16x32_bf16 v[244:247], a[132:135], a[20:23], v[244:247]
    buffer_load_dwordx4 v23, s[40:43], s30 offen offset:3072  lds
    v_mfma_f32_16x16x32_bf16 v[240:243], a[132:135], a[16:19], v[240:243]
    ds_read_b64_tr_b16 a[118:119], v7 offset:10784
    s_add_u32 m0, s82, 4096
    v_mfma_f32_16x16x32_bf16 v[240:243], a[128:131], a[0:3], v[240:243]
    s_waitcnt vmcnt(19) lgkmcnt(8)
    v_mfma_f32_16x16x32_bf16 v[32:35], a[96:99], a[32:35], v[32:35]
    ds_read_b64_tr_b16 a[120:121], v7 offset:14368
    v_mfma_f32_16x16x32_bf16 v[32:35], a[100:103], a[48:51], v[32:35]
    v_mfma_f32_16x16x32_bf16 v[36:39], a[100:103], a[52:55], v[36:39]
    ds_read_b64_tr_b16 a[122:123], v7 offset:17952
    v_mfma_f32_16x16x32_bf16 v[36:39], a[96:99], a[36:39], v[36:39]
    buffer_load_dwordx4 v24, s[40:43], s30 offen offset:0  lds
    v_mfma_f32_16x16x32_bf16 v[40:43], a[96:99], a[40:43], v[40:43]
    ds_read_b64_tr_b16 a[124:125], v7 offset:21536
    v_mfma_f32_16x16x32_bf16 v[40:43], a[100:103], a[56:59], v[40:43]
    v_mfma_f32_16x16x32_bf16 v[44:47], a[100:103], a[60:63], v[44:47]
    ds_read_b64_tr_b16 a[126:127], v7 offset:25120
    v_mfma_f32_16x16x32_bf16 v[44:47], a[96:99], a[44:47], v[44:47]
    s_waitcnt lgkmcnt(8)
    v_mfma_f32_16x16x32_bf16 v[60:63], a[104:107], a[44:47], v[60:63]
    ds_read_b64_tr_b16 a[128:129], v7 offset:64
    v_mfma_f32_16x16x32_bf16 v[60:63], a[108:111], a[60:63], v[60:63]
    buffer_load_dwordx4 v25, s[40:43], s30 offen offset:1024  lds
    v_mfma_f32_16x16x32_bf16 v[56:59], a[108:111], a[56:59], v[56:59]
    ds_read_b64_tr_b16 a[130:131], v7 offset:3648
    v_mfma_f32_16x16x32_bf16 v[56:59], a[104:107], a[40:43], v[56:59]
    v_mfma_f32_16x16x32_bf16 v[52:55], a[104:107], a[36:39], v[52:55]
    ds_read_b64_tr_b16 a[132:133], v7 offset:7232
    v_mfma_f32_16x16x32_bf16 v[52:55], a[108:111], a[52:55], v[52:55]
    v_mfma_f32_16x16x32_bf16 v[48:51], a[108:111], a[48:51], v[48:51]
    ds_read_b64_tr_b16 a[134:135], v7 offset:10816
    v_mfma_f32_16x16x32_bf16 v[48:51], a[104:107], a[32:35], v[48:51]
    buffer_load_dwordx4 v26, s[40:43], s30 offen offset:2048  lds
    s_waitcnt lgkmcnt(8)
    v_mfma_f32_16x16x32_bf16 v[64:67], a[112:115], a[32:35], v[64:67]
    ds_read_b64_tr_b16 a[96:97], v7 offset:14400
    s_bfe_u32 s31, s65, 262160
    v_mfma_f32_16x16x32_bf16 v[64:67], a[116:119], a[48:51], v[64:67]
    s_lshl_b32 s31, s31, 13
    v_mfma_f32_16x16x32_bf16 v[68:71], a[116:119], a[52:55], v[68:71]
    ds_read_b64_tr_b16 a[98:99], v7 offset:17984
    s_add_u32 s31, s31, s16
    v_mfma_f32_16x16x32_bf16 v[68:71], a[112:115], a[36:39], v[68:71]
    v_mfma_f32_16x16x32_bf16 v[72:75], a[112:115], a[40:43], v[72:75]
    ds_read_b64_tr_b16 a[100:101], v7 offset:21568
    v_mfma_f32_16x16x32_bf16 v[72:75], a[116:119], a[56:59], v[72:75]
    buffer_load_dwordx4 a[0:3], v1, s[8:11], s31 offen offset:0 sc1
    v_mfma_f32_16x16x32_bf16 v[76:79], a[116:119], a[60:63], v[76:79]
    ds_read_b64_tr_b16 a[102:103], v7 offset:25152
    v_mfma_f32_16x16x32_bf16 v[76:79], a[112:115], a[44:47], v[76:79]
    s_waitcnt lgkmcnt(8)
    v_mfma_f32_16x16x32_bf16 v[92:95], a[120:123], a[44:47], v[92:95]
    ds_read_b64_tr_b16 a[104:105], v7 offset:96
    v_mfma_f32_16x16x32_bf16 v[92:95], a[124:127], a[60:63], v[92:95]
    v_mfma_f32_16x16x32_bf16 v[88:91], a[124:127], a[56:59], v[88:91]
    ds_read_b64_tr_b16 a[106:107], v7 offset:3680
    v_mfma_f32_16x16x32_bf16 v[88:91], a[120:123], a[40:43], v[88:91]
    buffer_load_dwordx4 a[4:7], v1, s[8:11], s31 offen offset:1024 sc1
    v_mfma_f32_16x16x32_bf16 v[84:87], a[120:123], a[36:39], v[84:87]
    ds_read_b64_tr_b16 a[108:109], v7 offset:7264
    v_mfma_f32_16x16x32_bf16 v[84:87], a[124:127], a[52:55], v[84:87]
    v_mfma_f32_16x16x32_bf16 v[80:83], a[124:127], a[48:51], v[80:83]
    ds_read_b64_tr_b16 a[110:111], v7 offset:10848
    v_mfma_f32_16x16x32_bf16 v[80:83], a[120:123], a[32:35], v[80:83]
    s_waitcnt lgkmcnt(8)
    v_mfma_f32_16x16x32_bf16 v[96:99], a[128:131], a[32:35], v[96:99]
    ds_read_b64_tr_b16 a[112:113], v7 offset:14432
    v_mfma_f32_16x16x32_bf16 v[96:99], a[132:135], a[48:51], v[96:99]
    buffer_load_dwordx4 a[8:11], v1, s[8:11], s31 offen offset:2048 sc1
    v_mfma_f32_16x16x32_bf16 v[100:103], a[132:135], a[52:55], v[100:103]
    ds_read_b64_tr_b16 a[114:115], v7 offset:18016
    v_mfma_f32_16x16x32_bf16 v[100:103], a[128:131], a[36:39], v[100:103]
    v_mfma_f32_16x16x32_bf16 v[104:107], a[128:131], a[40:43], v[104:107]
    ds_read_b64_tr_b16 a[116:117], v7 offset:21600
    v_mfma_f32_16x16x32_bf16 v[104:107], a[132:135], a[56:59], v[104:107]
    v_mfma_f32_16x16x32_bf16 v[108:111], a[132:135], a[60:63], v[108:111]
    ds_read_b64_tr_b16 a[118:119], v7 offset:25184
    v_mfma_f32_16x16x32_bf16 v[108:111], a[128:131], a[44:47], v[108:111]
    s_waitcnt lgkmcnt(8)
    v_mfma_f32_16x16x32_bf16 v[124:127], a[96:99], a[44:47], v[124:127]
    ds_read_b64_tr_b16 a[120:121], v7 offset:128
    v_mfma_f32_16x16x32_bf16 v[124:127], a[100:103], a[60:63], v[124:127]
    buffer_load_dwordx4 a[12:15], v1, s[8:11], s31 offen offset:3072 sc1
    v_mfma_f32_16x16x32_bf16 v[120:123], a[100:103], a[56:59], v[120:123]
    ds_read_b64_tr_b16 a[122:123], v7 offset:3712
    v_mfma_f32_16x16x32_bf16 v[120:123], a[96:99], a[40:43], v[120:123]
    v_mfma_f32_16x16x32_bf16 v[116:119], a[96:99], a[36:39], v[116:119]
    ds_read_b64_tr_b16 a[124:125], v7 offset:7296
    v_mfma_f32_16x16x32_bf16 v[116:119], a[100:103], a[52:55], v[116:119]
    v_mfma_f32_16x16x32_bf16 v[112:115], a[100:103], a[48:51], v[112:115]
    ds_read_b64_tr_b16 a[126:127], v7 offset:10880
    v_mfma_f32_16x16x32_bf16 v[112:115], a[96:99], a[32:35], v[112:115]
    buffer_load_dwordx4 a[16:19], v30, s[8:11], s31 offen offset:0 sc1
    s_waitcnt lgkmcnt(8)
    v_mfma_f32_16x16x32_bf16 v[128:131], a[104:107], a[32:35], v[128:131]
    ds_read_b64_tr_b16 a[128:129], v7 offset:14464
    v_mfma_f32_16x16x32_bf16 v[128:131], a[108:111], a[48:51], v[128:131]
    v_mfma_f32_16x16x32_bf16 v[132:135], a[108:111], a[52:55], v[132:135]
    ds_read_b64_tr_b16 a[130:131], v7 offset:18048
    v_mfma_f32_16x16x32_bf16 v[132:135], a[104:107], a[36:39], v[132:135]
    v_mfma_f32_16x16x32_bf16 v[136:139], a[104:107], a[40:43], v[136:139]
    ds_read_b64_tr_b16 a[132:133], v7 offset:21632
    v_mfma_f32_16x16x32_bf16 v[136:139], a[108:111], a[56:59], v[136:139]
    buffer_load_dwordx4 a[20:23], v30, s[8:11], s31 offen offset:1024 sc1
    v_mfma_f32_16x16x32_bf16 v[140:143], a[108:111], a[60:63], v[140:143]
    ds_read_b64_tr_b16 a[134:135], v7 offset:25216
    v_mfma_f32_16x16x32_bf16 v[140:143], a[104:107], a[44:47], v[140:143]
    s_waitcnt lgkmcnt(8)
    v_mfma_f32_16x16x32_bf16 v[156:159], a[112:115], a[44:47], v[156:159]
    ds_read_b64_tr_b16 a[96:97], v7 offset:160
    v_mfma_f32_16x16x32_bf16 v[156:159], a[116:119], a[60:63], v[156:159]
    v_mfma_f32_16x16x32_bf16 v[152:155], a[116:119], a[56:59], v[152:155]
    ds_read_b64_tr_b16 a[98:99], v7 offset:3744
    v_mfma_f32_16x16x32_bf16 v[152:155], a[112:115], a[40:43], v[152:155]
    buffer_load_dwordx4 a[24:27], v30, s[8:11], s31 offen offset:2048 sc1
    v_mfma_f32_16x16x32_bf16 v[148:151], a[112:115], a[36:39], v[148:151]
    ds_read_b64_tr_b16 a[100:101], v7 offset:7328
    v_mfma_f32_16x16x32_bf16 v[148:151], a[116:119], a[52:55], v[148:151]
    v_mfma_f32_16x16x32_bf16 v[144:147], a[116:119], a[48:51], v[144:147]
    ds_read_b64_tr_b16 a[102:103], v7 offset:10912
    v_mfma_f32_16x16x32_bf16 v[144:147], a[112:115], a[32:35], v[144:147]
    s_waitcnt lgkmcnt(8)
    v_mfma_f32_16x16x32_bf16 v[160:163], a[120:123], a[32:35], v[160:163]
    ds_read_b64_tr_b16 a[104:105], v7 offset:14496
    v_mfma_f32_16x16x32_bf16 v[160:163], a[124:127], a[48:51], v[160:163]
    buffer_load_dwordx4 a[28:31], v30, s[8:11], s31 offen offset:3072 sc1
    v_mfma_f32_16x16x32_bf16 v[164:167], a[124:127], a[52:55], v[164:167]
    ds_read_b64_tr_b16 a[106:107], v7 offset:18080
    v_mfma_f32_16x16x32_bf16 v[164:167], a[120:123], a[36:39], v[164:167]
    v_mfma_f32_16x16x32_bf16 v[168:171], a[120:123], a[40:43], v[168:171]
    ds_read_b64_tr_b16 a[108:109], v7 offset:21664
    v_mfma_f32_16x16x32_bf16 v[168:171], a[124:127], a[56:59], v[168:171]
    v_mfma_f32_16x16x32_bf16 v[172:175], a[124:127], a[60:63], v[172:175]
    ds_read_b64_tr_b16 a[110:111], v7 offset:25248
    v_mfma_f32_16x16x32_bf16 v[172:175], a[120:123], a[44:47], v[172:175]
    s_waitcnt lgkmcnt(8)
    v_mfma_f32_16x16x32_bf16 v[188:191], a[128:131], a[44:47], v[188:191]
    ds_read_b64_tr_b16 a[112:113], v7 offset:192
    v_mfma_f32_16x16x32_bf16 v[188:191], a[132:135], a[60:63], v[188:191]
    v_mfma_f32_16x16x32_bf16 v[184:187], a[132:135], a[56:59], v[184:187]
    ds_read_b64_tr_b16 a[114:115], v7 offset:3776
    v_mfma_f32_16x16x32_bf16 v[184:187], a[128:131], a[40:43], v[184:187]
    v_mfma_f32_16x16x32_bf16 v[180:183], a[128:131], a[36:39], v[180:183]
    ds_read_b64_tr_b16 a[116:117], v7 offset:7360
    v_mfma_f32_16x16x32_bf16 v[180:183], a[132:135], a[52:55], v[180:183]
    v_mfma_f32_16x16x32_bf16 v[176:179], a[132:135], a[48:51], v[176:179]
    ds_read_b64_tr_b16 a[118:119], v7 offset:10944
    v_mfma_f32_16x16x32_bf16 v[176:179], a[128:131], a[32:35], v[176:179]
    s_waitcnt lgkmcnt(8)
    v_mfma_f32_16x16x32_bf16 v[192:195], a[96:99], a[32:35], v[192:195]
    ds_read_b64_tr_b16 a[120:121], v7 offset:14528
    v_accvgpr_read_b32 v31, a201
    v_mfma_f32_16x16x32_bf16 v[192:195], a[100:103], a[48:51], v[192:195]
    global_load_dword a200, v31, s[74:75]
    v_mfma_f32_16x16x32_bf16 v[196:199], a[100:103], a[52:55], v[196:199]
    ds_read_b64_tr_b16 a[122:123], v7 offset:18112
    v_mfma_f32_16x16x32_bf16 v[196:199], a[96:99], a[36:39], v[196:199]
    v_mfma_f32_16x16x32_bf16 v[200:203], a[96:99], a[40:43], v[200:203]
    ds_read_b64_tr_b16 a[124:125], v7 offset:21696
    v_mfma_f32_16x16x32_bf16 v[200:203], a[100:103], a[56:59], v[200:203]
    v_mfma_f32_16x16x32_bf16 v[204:207], a[100:103], a[60:63], v[204:207]
    ds_read_b64_tr_b16 a[126:127], v7 offset:25280
    v_mfma_f32_16x16x32_bf16 v[204:207], a[96:99], a[44:47], v[204:207]
    s_waitcnt lgkmcnt(8)
    v_mfma_f32_16x16x32_bf16 v[220:223], a[104:107], a[44:47], v[220:223]
    s_waitcnt vmcnt(24)
    s_barrier
    ds_read_b64_tr_b16 a[128:129], v7 offset:32768
    s_add_u32 m0, s82, 32768
    v_mfma_f32_16x16x32_bf16 v[220:223], a[108:111], a[60:63], v[220:223]
    s_bfe_u32 s30, s65, 262164
    s_mul_i32 s30, s30, 458752
    v_mfma_f32_16x16x32_bf16 v[216:219], a[108:111], a[56:59], v[216:219]
    ds_read_b64_tr_b16 a[130:131], v7 offset:36352
    v_mfma_f32_16x16x32_bf16 v[216:219], a[104:107], a[40:43], v[216:219]
    buffer_load_dwordx4 v20, s[40:43], s30 offen offset:0  lds
    v_mfma_f32_16x16x32_bf16 v[212:215], a[104:107], a[36:39], v[212:215]
    ds_read_b64_tr_b16 a[132:133], v7 offset:39936
    v_mfma_f32_16x16x32_bf16 v[212:215], a[108:111], a[52:55], v[212:215]
    v_mfma_f32_16x16x32_bf16 v[208:211], a[108:111], a[48:51], v[208:211]
    ds_read_b64_tr_b16 a[134:135], v7 offset:43520
    v_mfma_f32_16x16x32_bf16 v[208:211], a[104:107], a[32:35], v[208:211]
    s_waitcnt lgkmcnt(8)
    v_mfma_f32_16x16x32_bf16 v[224:227], a[112:115], a[32:35], v[224:227]
    ds_read_b64_tr_b16 a[96:97], v7 offset:47104
    v_mfma_f32_16x16x32_bf16 v[224:227], a[116:119], a[48:51], v[224:227]
    buffer_load_dwordx4 v21, s[40:43], s30 offen offset:1024  lds
    v_mfma_f32_16x16x32_bf16 v[228:231], a[116:119], a[52:55], v[228:231]
    ds_read_b64_tr_b16 a[98:99], v7 offset:50688
    v_mfma_f32_16x16x32_bf16 v[228:231], a[112:115], a[36:39], v[228:231]
    v_mfma_f32_16x16x32_bf16 v[232:235], a[112:115], a[40:43], v[232:235]
    ds_read_b64_tr_b16 a[100:101], v7 offset:54272
    v_mfma_f32_16x16x32_bf16 v[232:235], a[116:119], a[56:59], v[232:235]
    v_mfma_f32_16x16x32_bf16 v[236:239], a[116:119], a[60:63], v[236:239]
    ds_read_b64_tr_b16 a[102:103], v7 offset:57856
    v_mfma_f32_16x16x32_bf16 v[236:239], a[112:115], a[44:47], v[236:239]
    buffer_load_dwordx4 v22, s[40:43], s30 offen offset:2048  lds
    s_waitcnt lgkmcnt(8)
    v_mfma_f32_16x16x32_bf16 v[252:255], a[120:123], a[44:47], v[252:255]
    ds_read_b64_tr_b16 a[104:105], v7 offset:32800
    v_mfma_f32_16x16x32_bf16 v[252:255], a[124:127], a[60:63], v[252:255]
    v_mfma_f32_16x16x32_bf16 v[248:251], a[124:127], a[56:59], v[248:251]
    ds_read_b64_tr_b16 a[106:107], v7 offset:36384
    v_mfma_f32_16x16x32_bf16 v[248:251], a[120:123], a[40:43], v[248:251]
    v_mfma_f32_16x16x32_bf16 v[244:247], a[120:123], a[36:39], v[244:247]
    ds_read_b64_tr_b16 a[108:109], v7 offset:39968
    v_mfma_f32_16x16x32_bf16 v[244:247], a[124:127], a[52:55], v[244:247]
    buffer_load_dwordx4 v23, s[40:43], s30 offen offset:3072  lds
    v_mfma_f32_16x16x32_bf16 v[240:243], a[124:127], a[48:51], v[240:243]
    ds_read_b64_tr_b16 a[110:111], v7 offset:43552
    s_add_u32 m0, s82, 36864
    v_mfma_f32_16x16x32_bf16 v[240:243], a[120:123], a[32:35], v[240:243]
    s_waitcnt vmcnt(20) lgkmcnt(8)
    v_mfma_f32_16x16x32_bf16 v[32:35], a[128:131], a[64:67], v[32:35]
    ds_read_b64_tr_b16 a[112:113], v7 offset:47136
    v_mfma_f32_16x16x32_bf16 v[32:35], a[132:135], a[80:83], v[32:35]
    v_mfma_f32_16x16x32_bf16 v[36:39], a[132:135], a[84:87], v[36:39]
    ds_read_b64_tr_b16 a[114:115], v7 offset:50720
    v_mfma_f32_16x16x32_bf16 v[36:39], a[128:131], a[68:71], v[36:39]
    buffer_load_dwordx4 v24, s[40:43], s30 offen offset:0  lds
    v_mfma_f32_16x16x32_bf16 v[40:43], a[128:131], a[72:75], v[40:43]
    ds_read_b64_tr_b16 a[116:117], v7 offset:54304
    v_mfma_f32_16x16x32_bf16 v[40:43], a[132:135], a[88:91], v[40:43]
    v_mfma_f32_16x16x32_bf16 v[44:47], a[132:135], a[92:95], v[44:47]
    ds_read_b64_tr_b16 a[118:119], v7 offset:57888
    v_mfma_f32_16x16x32_bf16 v[44:47], a[128:131], a[76:79], v[44:47]
    s_waitcnt lgkmcnt(8)
    v_mfma_f32_16x16x32_bf16 v[60:63], a[96:99], a[76:79], v[60:63]
    ds_read_b64_tr_b16 a[120:121], v7 offset:32832
    v_mfma_f32_16x16x32_bf16 v[60:63], a[100:103], a[92:95], v[60:63]
    buffer_load_dwordx4 v25, s[40:43], s30 offen offset:1024  lds
    v_mfma_f32_16x16x32_bf16 v[56:59], a[100:103], a[88:91], v[56:59]
    ds_read_b64_tr_b16 a[122:123], v7 offset:36416
    v_mfma_f32_16x16x32_bf16 v[56:59], a[96:99], a[72:75], v[56:59]
    v_mfma_f32_16x16x32_bf16 v[52:55], a[96:99], a[68:71], v[52:55]
    ds_read_b64_tr_b16 a[124:125], v7 offset:40000
    v_mfma_f32_16x16x32_bf16 v[52:55], a[100:103], a[84:87], v[52:55]
    v_mfma_f32_16x16x32_bf16 v[48:51], a[100:103], a[80:83], v[48:51]
    ds_read_b64_tr_b16 a[126:127], v7 offset:43584
    v_mfma_f32_16x16x32_bf16 v[48:51], a[96:99], a[64:67], v[48:51]
    buffer_load_dwordx4 v26, s[40:43], s30 offen offset:2048  lds
    s_waitcnt lgkmcnt(8)
    v_mfma_f32_16x16x32_bf16 v[64:67], a[104:107], a[64:67], v[64:67]
    ds_read_b64_tr_b16 a[128:129], v7 offset:47168
    s_bfe_u32 s31, s65, 262164
    v_mfma_f32_16x16x32_bf16 v[64:67], a[108:111], a[80:83], v[64:67]
    s_lshl_b32 s31, s31, 13
    v_mfma_f32_16x16x32_bf16 v[68:71], a[108:111], a[84:87], v[68:71]
    ds_read_b64_tr_b16 a[130:131], v7 offset:50752
    s_add_u32 s31, s31, s16
    v_mfma_f32_16x16x32_bf16 v[68:71], a[104:107], a[68:71], v[68:71]
    v_mfma_f32_16x16x32_bf16 v[72:75], a[104:107], a[72:75], v[72:75]
    ds_read_b64_tr_b16 a[132:133], v7 offset:54336
    v_mfma_f32_16x16x32_bf16 v[72:75], a[108:111], a[88:91], v[72:75]
    buffer_load_dwordx4 a[32:35], v1, s[8:11], s31 offen offset:0 sc1
    v_mfma_f32_16x16x32_bf16 v[76:79], a[108:111], a[92:95], v[76:79]
    ds_read_b64_tr_b16 a[134:135], v7 offset:57920
    v_mfma_f32_16x16x32_bf16 v[76:79], a[104:107], a[76:79], v[76:79]
    s_waitcnt lgkmcnt(8)
    v_mfma_f32_16x16x32_bf16 v[92:95], a[112:115], a[76:79], v[92:95]
    ds_read_b64_tr_b16 a[96:97], v7 offset:32864
    v_mfma_f32_16x16x32_bf16 v[92:95], a[116:119], a[92:95], v[92:95]
    v_mfma_f32_16x16x32_bf16 v[88:91], a[116:119], a[88:91], v[88:91]
    ds_read_b64_tr_b16 a[98:99], v7 offset:36448
    v_mfma_f32_16x16x32_bf16 v[88:91], a[112:115], a[72:75], v[88:91]
    buffer_load_dwordx4 a[36:39], v1, s[8:11], s31 offen offset:1024 sc1
    v_mfma_f32_16x16x32_bf16 v[84:87], a[112:115], a[68:71], v[84:87]
    ds_read_b64_tr_b16 a[100:101], v7 offset:40032
    v_mfma_f32_16x16x32_bf16 v[84:87], a[116:119], a[84:87], v[84:87]
    v_mfma_f32_16x16x32_bf16 v[80:83], a[116:119], a[80:83], v[80:83]
    ds_read_b64_tr_b16 a[102:103], v7 offset:43616
    v_mfma_f32_16x16x32_bf16 v[80:83], a[112:115], a[64:67], v[80:83]
    s_waitcnt lgkmcnt(8)
    v_mfma_f32_16x16x32_bf16 v[96:99], a[120:123], a[64:67], v[96:99]
    ds_read_b64_tr_b16 a[104:105], v7 offset:47200
    v_mfma_f32_16x16x32_bf16 v[96:99], a[124:127], a[80:83], v[96:99]
    buffer_load_dwordx4 a[40:43], v1, s[8:11], s31 offen offset:2048 sc1
    v_mfma_f32_16x16x32_bf16 v[100:103], a[124:127], a[84:87], v[100:103]
    ds_read_b64_tr_b16 a[106:107], v7 offset:50784
    v_mfma_f32_16x16x32_bf16 v[100:103], a[120:123], a[68:71], v[100:103]
    v_mfma_f32_16x16x32_bf16 v[104:107], a[120:123], a[72:75], v[104:107]
    ds_read_b64_tr_b16 a[108:109], v7 offset:54368
    v_mfma_f32_16x16x32_bf16 v[104:107], a[124:127], a[88:91], v[104:107]
    v_mfma_f32_16x16x32_bf16 v[108:111], a[124:127], a[92:95], v[108:111]
    ds_read_b64_tr_b16 a[110:111], v7 offset:57952
    v_mfma_f32_16x16x32_bf16 v[108:111], a[120:123], a[76:79], v[108:111]
    s_waitcnt lgkmcnt(8)
    v_mfma_f32_16x16x32_bf16 v[124:127], a[128:131], a[76:79], v[124:127]
    ds_read_b64_tr_b16 a[112:113], v7 offset:32896
    v_mfma_f32_16x16x32_bf16 v[124:127], a[132:135], a[92:95], v[124:127]
    buffer_load_dwordx4 a[44:47], v1, s[8:11], s31 offen offset:3072 sc1
    v_mfma_f32_16x16x32_bf16 v[120:123], a[132:135], a[88:91], v[120:123]
    ds_read_b64_tr_b16 a[114:115], v7 offset:36480
    v_mfma_f32_16x16x32_bf16 v[120:123], a[128:131], a[72:75], v[120:123]
    v_mfma_f32_16x16x32_bf16 v[116:119], a[128:131], a[68:71], v[116:119]
    ds_read_b64_tr_b16 a[116:117], v7 offset:40064
    v_mfma_f32_16x16x32_bf16 v[116:119], a[132:135], a[84:87], v[116:119]
    v_mfma_f32_16x16x32_bf16 v[112:115], a[132:135], a[80:83], v[112:115]
    ds_read_b64_tr_b16 a[118:119], v7 offset:43648
    v_mfma_f32_16x16x32_bf16 v[112:115], a[128:131], a[64:67], v[112:115]
    buffer_load_dwordx4 a[48:51], v30, s[8:11], s31 offen offset:0 sc1
    s_waitcnt lgkmcnt(8)
    v_mfma_f32_16x16x32_bf16 v[128:131], a[96:99], a[64:67], v[128:131]
    ds_read_b64_tr_b16 a[120:121], v7 offset:47232
    v_mfma_f32_16x16x32_bf16 v[128:131], a[100:103], a[80:83], v[128:131]
    v_mfma_f32_16x16x32_bf16 v[132:135], a[100:103], a[84:87], v[132:135]
    ds_read_b64_tr_b16 a[122:123], v7 offset:50816
    v_mfma_f32_16x16x32_bf16 v[132:135], a[96:99], a[68:71], v[132:135]
    v_mfma_f32_16x16x32_bf16 v[136:139], a[96:99], a[72:75], v[136:139]
    ds_read_b64_tr_b16 a[124:125], v7 offset:54400
    v_mfma_f32_16x16x32_bf16 v[136:139], a[100:103], a[88:91], v[136:139]
    buffer_load_dwordx4 a[52:55], v30, s[8:11], s31 offen offset:1024 sc1
    v_mfma_f32_16x16x32_bf16 v[140:143], a[100:103], a[92:95], v[140:143]
    ds_read_b64_tr_b16 a[126:127], v7 offset:57984
    v_mfma_f32_16x16x32_bf16 v[140:143], a[96:99], a[76:79], v[140:143]
    s_waitcnt lgkmcnt(8)
    v_mfma_f32_16x16x32_bf16 v[156:159], a[104:107], a[76:79], v[156:159]
    ds_read_b64_tr_b16 a[128:129], v7 offset:32928
    v_mfma_f32_16x16x32_bf16 v[156:159], a[108:111], a[92:95], v[156:159]
    v_mfma_f32_16x16x32_bf16 v[152:155], a[108:111], a[88:91], v[152:155]
    ds_read_b64_tr_b16 a[130:131], v7 offset:36512
    v_mfma_f32_16x16x32_bf16 v[152:155], a[104:107], a[72:75], v[152:155]
    buffer_load_dwordx4 a[56:59], v30, s[8:11], s31 offen offset:2048 sc1
    v_mfma_f32_16x16x32_bf16 v[148:151], a[104:107], a[68:71], v[148:151]
    ds_read_b64_tr_b16 a[132:133], v7 offset:40096
    v_mfma_f32_16x16x32_bf16 v[148:151], a[108:111], a[84:87], v[148:151]
    v_mfma_f32_16x16x32_bf16 v[144:147], a[108:111], a[80:83], v[144:147]
    ds_read_b64_tr_b16 a[134:135], v7 offset:43680
    v_mfma_f32_16x16x32_bf16 v[144:147], a[104:107], a[64:67], v[144:147]
    s_waitcnt lgkmcnt(8)
    v_mfma_f32_16x16x32_bf16 v[160:163], a[112:115], a[64:67], v[160:163]
    ds_read_b64_tr_b16 a[96:97], v7 offset:47264
    v_mfma_f32_16x16x32_bf16 v[160:163], a[116:119], a[80:83], v[160:163]
    buffer_load_dwordx4 a[60:63], v30, s[8:11], s31 offen offset:3072 sc1
    v_mfma_f32_16x16x32_bf16 v[164:167], a[116:119], a[84:87], v[164:167]
    ds_read_b64_tr_b16 a[98:99], v7 offset:50848
    v_mfma_f32_16x16x32_bf16 v[164:167], a[112:115], a[68:71], v[164:167]
    v_mfma_f32_16x16x32_bf16 v[168:171], a[112:115], a[72:75], v[168:171]
    ds_read_b64_tr_b16 a[100:101], v7 offset:54432
    v_mfma_f32_16x16x32_bf16 v[168:171], a[116:119], a[88:91], v[168:171]
    v_mfma_f32_16x16x32_bf16 v[172:175], a[116:119], a[92:95], v[172:175]
    ds_read_b64_tr_b16 a[102:103], v7 offset:58016
    v_mfma_f32_16x16x32_bf16 v[172:175], a[112:115], a[76:79], v[172:175]
    s_waitcnt lgkmcnt(8)
    v_mfma_f32_16x16x32_bf16 v[188:191], a[120:123], a[76:79], v[188:191]
    ds_read_b64_tr_b16 a[104:105], v7 offset:32960
    v_mfma_f32_16x16x32_bf16 v[188:191], a[124:127], a[92:95], v[188:191]
    v_mfma_f32_16x16x32_bf16 v[184:187], a[124:127], a[88:91], v[184:187]
    ds_read_b64_tr_b16 a[106:107], v7 offset:36544
    v_mfma_f32_16x16x32_bf16 v[184:187], a[120:123], a[72:75], v[184:187]
    v_mfma_f32_16x16x32_bf16 v[180:183], a[120:123], a[68:71], v[180:183]
    ds_read_b64_tr_b16 a[108:109], v7 offset:40128
    v_mfma_f32_16x16x32_bf16 v[180:183], a[124:127], a[84:87], v[180:183]
    v_mfma_f32_16x16x32_bf16 v[176:179], a[124:127], a[80:83], v[176:179]
    ds_read_b64_tr_b16 a[110:111], v7 offset:43712
    v_mfma_f32_16x16x32_bf16 v[176:179], a[120:123], a[64:67], v[176:179]
    s_waitcnt lgkmcnt(8)
    v_mfma_f32_16x16x32_bf16 v[192:195], a[128:131], a[64:67], v[192:195]
    ds_read_b64_tr_b16 a[112:113], v7 offset:47296
    v_mfma_f32_16x16x32_bf16 v[192:195], a[132:135], a[80:83], v[192:195]
    v_mfma_f32_16x16x32_bf16 v[196:199], a[132:135], a[84:87], v[196:199]
    ds_read_b64_tr_b16 a[114:115], v7 offset:50880
    v_mfma_f32_16x16x32_bf16 v[196:199], a[128:131], a[68:71], v[196:199]
    v_mfma_f32_16x16x32_bf16 v[200:203], a[128:131], a[72:75], v[200:203]
    ds_read_b64_tr_b16 a[116:117], v7 offset:54464
    v_mfma_f32_16x16x32_bf16 v[200:203], a[132:135], a[88:91], v[200:203]
    v_mfma_f32_16x16x32_bf16 v[204:207], a[132:135], a[92:95], v[204:207]
    ds_read_b64_tr_b16 a[118:119], v7 offset:58048
    v_mfma_f32_16x16x32_bf16 v[204:207], a[128:131], a[76:79], v[204:207]
    s_waitcnt lgkmcnt(8)
    v_mfma_f32_16x16x32_bf16 v[220:223], a[96:99], a[76:79], v[220:223]
    s_waitcnt vmcnt(24)
    s_barrier
    ds_read_b64_tr_b16 a[120:121], v6 offset:0
    s_add_u32 m0, s82, 65536
    v_mfma_f32_16x16x32_bf16 v[220:223], a[100:103], a[92:95], v[220:223]
    s_bfe_u32 s30, s65, 262168
    s_mul_i32 s30, s30, 458752
    v_mfma_f32_16x16x32_bf16 v[216:219], a[100:103], a[88:91], v[216:219]
    ds_read_b64_tr_b16 a[122:123], v6 offset:3584
    v_mfma_f32_16x16x32_bf16 v[216:219], a[96:99], a[72:75], v[216:219]
    buffer_load_dwordx4 v20, s[40:43], s30 offen offset:0  lds
    v_mfma_f32_16x16x32_bf16 v[212:215], a[96:99], a[68:71], v[212:215]
    ds_read_b64_tr_b16 a[124:125], v6 offset:7168
    v_mfma_f32_16x16x32_bf16 v[212:215], a[100:103], a[84:87], v[212:215]
    v_mfma_f32_16x16x32_bf16 v[208:211], a[100:103], a[80:83], v[208:211]
    ds_read_b64_tr_b16 a[126:127], v6 offset:10752
    v_mfma_f32_16x16x32_bf16 v[208:211], a[96:99], a[64:67], v[208:211]
    s_waitcnt lgkmcnt(8)
    v_mfma_f32_16x16x32_bf16 v[224:227], a[104:107], a[64:67], v[224:227]
    ds_read_b64_tr_b16 a[128:129], v6 offset:14336
    v_mfma_f32_16x16x32_bf16 v[224:227], a[108:111], a[80:83], v[224:227]
    buffer_load_dwordx4 v21, s[40:43], s30 offen offset:1024  lds
    v_mfma_f32_16x16x32_bf16 v[228:231], a[108:111], a[84:87], v[228:231]
    ds_read_b64_tr_b16 a[130:131], v6 offset:17920
    v_mfma_f32_16x16x32_bf16 v[228:231], a[104:107], a[68:71], v[228:231]
    v_mfma_f32_16x16x32_bf16 v[232:235], a[104:107], a[72:75], v[232:235]
    ds_read_b64_tr_b16 a[132:133], v6 offset:21504
    v_mfma_f32_16x16x32_bf16 v[232:235], a[108:111], a[88:91], v[232:235]
    v_mfma_f32_16x16x32_bf16 v[236:239], a[108:111], a[92:95], v[236:239]
    ds_read_b64_tr_b16 a[134:135], v6 offset:25088
    v_mfma_f32_16x16x32_bf16 v[236:239], a[104:107], a[76:79], v[236:239]
    buffer_load_dwordx4 v22, s[40:43], s30 offen offset:2048  lds
    s_waitcnt lgkmcnt(8)
    v_mfma_f32_16x16x32_bf16 v[252:255], a[112:115], a[76:79], v[252:255]
    ds_read_b64_tr_b16 a[96:97], v6 offset:32
    v_mfma_f32_16x16x32_bf16 v[252:255], a[116:119], a[92:95], v[252:255]
    v_mfma_f32_16x16x32_bf16 v[248:251], a[116:119], a[88:91], v[248:251]
    ds_read_b64_tr_b16 a[98:99], v6 offset:3616
    v_mfma_f32_16x16x32_bf16 v[248:251], a[112:115], a[72:75], v[248:251]
    v_mfma_f32_16x16x32_bf16 v[244:247], a[112:115], a[68:71], v[244:247]
    ds_read_b64_tr_b16 a[100:101], v6 offset:7200
    v_mfma_f32_16x16x32_bf16 v[244:247], a[116:119], a[84:87], v[244:247]
    buffer_load_dwordx4 v23, s[40:43], s30 offen offset:3072  lds
    v_mfma_f32_16x16x32_bf16 v[240:243], a[116:119], a[80:83], v[240:243]
    ds_read_b64_tr_b16 a[102:103], v6 offset:10784
    s_add_u32 m0, s82, 69632
    v_mfma_f32_16x16x32_bf16 v[240:243], a[112:115], a[64:67], v[240:243]
    s_waitcnt vmcnt(20) lgkmcnt(8)
    v_mfma_f32_16x16x32_bf16 v[32:35], a[120:123], a[0:3], v[32:35]
    ds_read_b64_tr_b16 a[104:105], v6 offset:14368
    v_mfma_f32_16x16x32_bf16 v[32:35], a[124:127], a[16:19], v[32:35]
    v_mfma_f32_16x16x32_bf16 v[36:39], a[124:127], a[20:23], v[36:39]
    ds_read_b64_tr_b16 a[106:107], v6 offset:17952
    v_mfma_f32_16x16x32_bf16 v[36:39], a[120:123], a[4:7], v[36:39]
    buffer_load_dwordx4 v24, s[40:43], s30 offen offset:0  lds
    v_mfma_f32_16x16x32_bf16 v[40:43], a[120:123], a[8:11], v[40:43]
    ds_read_b64_tr_b16 a[108:109], v6 offset:21536
    v_mfma_f32_16x16x32_bf16 v[40:43], a[124:127], a[24:27], v[40:43]
    v_mfma_f32_16x16x32_bf16 v[44:47], a[124:127], a[28:31], v[44:47]
    ds_read_b64_tr_b16 a[110:111], v6 offset:25120
    v_mfma_f32_16x16x32_bf16 v[44:47], a[120:123], a[12:15], v[44:47]
    s_waitcnt lgkmcnt(8)
    v_mfma_f32_16x16x32_bf16 v[60:63], a[128:131], a[12:15], v[60:63]
    ds_read_b64_tr_b16 a[112:113], v6 offset:64
    v_mfma_f32_16x16x32_bf16 v[60:63], a[132:135], a[28:31], v[60:63]
    buffer_load_dwordx4 v25, s[40:43], s30 offen offset:1024  lds
    v_mfma_f32_16x16x32_bf16 v[56:59], a[132:135], a[24:27], v[56:59]
    ds_read_b64_tr_b16 a[114:115], v6 offset:3648
    v_mfma_f32_16x16x32_bf16 v[56:59], a[128:131], a[8:11], v[56:59]
    v_mfma_f32_16x16x32_bf16 v[52:55], a[128:131], a[4:7], v[52:55]
    ds_read_b64_tr_b16 a[116:117], v6 offset:7232
    v_mfma_f32_16x16x32_bf16 v[52:55], a[132:135], a[20:23], v[52:55]
    v_mfma_f32_16x16x32_bf16 v[48:51], a[132:135], a[16:19], v[48:51]
    ds_read_b64_tr_b16 a[118:119], v6 offset:10816
    v_mfma_f32_16x16x32_bf16 v[48:51], a[128:131], a[0:3], v[48:51]
    buffer_load_dwordx4 v26, s[40:43], s30 offen offset:2048  lds
    s_waitcnt lgkmcnt(8)
    v_mfma_f32_16x16x32_bf16 v[64:67], a[96:99], a[0:3], v[64:67]
    ds_read_b64_tr_b16 a[120:121], v6 offset:14400
    s_bfe_u32 s31, s65, 262168
    v_mfma_f32_16x16x32_bf16 v[64:67], a[100:103], a[16:19], v[64:67]
    s_lshl_b32 s31, s31, 13
    v_mfma_f32_16x16x32_bf16 v[68:71], a[100:103], a[20:23], v[68:71]
    ds_read_b64_tr_b16 a[122:123], v6 offset:17984
    s_add_u32 s31, s31, s16
    v_mfma_f32_16x16x32_bf16 v[68:71], a[96:99], a[4:7], v[68:71]
    v_mfma_f32_16x16x32_bf16 v[72:75], a[96:99], a[8:11], v[72:75]
    ds_read_b64_tr_b16 a[124:125], v6 offset:21568
    v_mfma_f32_16x16x32_bf16 v[72:75], a[100:103], a[24:27], v[72:75]
    buffer_load_dwordx4 a[64:67], v1, s[8:11], s31 offen offset:0 sc1
    v_mfma_f32_16x16x32_bf16 v[76:79], a[100:103], a[28:31], v[76:79]
    ds_read_b64_tr_b16 a[126:127], v6 offset:25152
    v_mfma_f32_16x16x32_bf16 v[76:79], a[96:99], a[12:15], v[76:79]
    s_waitcnt lgkmcnt(8)
    v_mfma_f32_16x16x32_bf16 v[92:95], a[104:107], a[12:15], v[92:95]
    ds_read_b64_tr_b16 a[128:129], v6 offset:96
    v_mfma_f32_16x16x32_bf16 v[92:95], a[108:111], a[28:31], v[92:95]
    v_mfma_f32_16x16x32_bf16 v[88:91], a[108:111], a[24:27], v[88:91]
    ds_read_b64_tr_b16 a[130:131], v6 offset:3680
    v_mfma_f32_16x16x32_bf16 v[88:91], a[104:107], a[8:11], v[88:91]
    buffer_load_dwordx4 a[68:71], v1, s[8:11], s31 offen offset:1024 sc1
    v_mfma_f32_16x16x32_bf16 v[84:87], a[104:107], a[4:7], v[84:87]
    ds_read_b64_tr_b16 a[132:133], v6 offset:7264
    v_mfma_f32_16x16x32_bf16 v[84:87], a[108:111], a[20:23], v[84:87]
    v_mfma_f32_16x16x32_bf16 v[80:83], a[108:111], a[16:19], v[80:83]
    ds_read_b64_tr_b16 a[134:135], v6 offset:10848
    v_mfma_f32_16x16x32_bf16 v[80:83], a[104:107], a[0:3], v[80:83]
    s_waitcnt lgkmcnt(8)
    v_mfma_f32_16x16x32_bf16 v[96:99], a[112:115], a[0:3], v[96:99]
    ds_read_b64_tr_b16 a[96:97], v6 offset:14432
    v_mfma_f32_16x16x32_bf16 v[96:99], a[116:119], a[16:19], v[96:99]
    buffer_load_dwordx4 a[72:75], v1, s[8:11], s31 offen offset:2048 sc1
    v_mfma_f32_16x16x32_bf16 v[100:103], a[116:119], a[20:23], v[100:103]
    ds_read_b64_tr_b16 a[98:99], v6 offset:18016
    v_mfma_f32_16x16x32_bf16 v[100:103], a[112:115], a[4:7], v[100:103]
    v_mfma_f32_16x16x32_bf16 v[104:107], a[112:115], a[8:11], v[104:107]
    ds_read_b64_tr_b16 a[100:101], v6 offset:21600
    v_mfma_f32_16x16x32_bf16 v[104:107], a[116:119], a[24:27], v[104:107]
    v_mfma_f32_16x16x32_bf16 v[108:111], a[116:119], a[28:31], v[108:111]
    ds_read_b64_tr_b16 a[102:103], v6 offset:25184
    v_mfma_f32_16x16x32_bf16 v[108:111], a[112:115], a[12:15], v[108:111]
    s_waitcnt lgkmcnt(8)
    v_mfma_f32_16x16x32_bf16 v[124:127], a[120:123], a[12:15], v[124:127]
    ds_read_b64_tr_b16 a[104:105], v6 offset:128
    v_mfma_f32_16x16x32_bf16 v[124:127], a[124:127], a[28:31], v[124:127]
    buffer_load_dwordx4 a[76:79], v1, s[8:11], s31 offen offset:3072 sc1
    v_mfma_f32_16x16x32_bf16 v[120:123], a[124:127], a[24:27], v[120:123]
    ds_read_b64_tr_b16 a[106:107], v6 offset:3712
    v_mfma_f32_16x16x32_bf16 v[120:123], a[120:123], a[8:11], v[120:123]
    v_mfma_f32_16x16x32_bf16 v[116:119], a[120:123], a[4:7], v[116:119]
    ds_read_b64_tr_b16 a[108:109], v6 offset:7296
    v_mfma_f32_16x16x32_bf16 v[116:119], a[124:127], a[20:23], v[116:119]
    v_mfma_f32_16x16x32_bf16 v[112:115], a[124:127], a[16:19], v[112:115]
    ds_read_b64_tr_b16 a[110:111], v6 offset:10880
    v_mfma_f32_16x16x32_bf16 v[112:115], a[120:123], a[0:3], v[112:115]
    buffer_load_dwordx4 a[80:83], v30, s[8:11], s31 offen offset:0 sc1
    s_waitcnt lgkmcnt(8)
    v_mfma_f32_16x16x32_bf16 v[128:131], a[128:131], a[0:3], v[128:131]
    ds_read_b64_tr_b16 a[112:113], v6 offset:14464
    v_mfma_f32_16x16x32_bf16 v[128:131], a[132:135], a[16:19], v[128:131]
    v_mfma_f32_16x16x32_bf16 v[132:135], a[132:135], a[20:23], v[132:135]
    ds_read_b64_tr_b16 a[114:115], v6 offset:18048
    v_mfma_f32_16x16x32_bf16 v[132:135], a[128:131], a[4:7], v[132:135]
    v_mfma_f32_16x16x32_bf16 v[136:139], a[128:131], a[8:11], v[136:139]
    ds_read_b64_tr_b16 a[116:117], v6 offset:21632
    v_mfma_f32_16x16x32_bf16 v[136:139], a[132:135], a[24:27], v[136:139]
    buffer_load_dwordx4 a[84:87], v30, s[8:11], s31 offen offset:1024 sc1
    v_mfma_f32_16x16x32_bf16 v[140:143], a[132:135], a[28:31], v[140:143]
    ds_read_b64_tr_b16 a[118:119], v6 offset:25216
    v_mfma_f32_16x16x32_bf16 v[140:143], a[128:131], a[12:15], v[140:143]
    s_waitcnt lgkmcnt(8)
    v_mfma_f32_16x16x32_bf16 v[156:159], a[96:99], a[12:15], v[156:159]
    ds_read_b64_tr_b16 a[120:121], v6 offset:160
    v_mfma_f32_16x16x32_bf16 v[156:159], a[100:103], a[28:31], v[156:159]
    v_mfma_f32_16x16x32_bf16 v[152:155], a[100:103], a[24:27], v[152:155]
    ds_read_b64_tr_b16 a[122:123], v6 offset:3744
    v_mfma_f32_16x16x32_bf16 v[152:155], a[96:99], a[8:11], v[152:155]
    buffer_load_dwordx4 a[88:91], v30, s[8:11], s31 offen offset:2048 sc1
    v_mfma_f32_16x16x32_bf16 v[148:151], a[96:99], a[4:7], v[148:151]
    ds_read_b64_tr_b16 a[124:125], v6 offset:7328
    v_mfma_f32_16x16x32_bf16 v[148:151], a[100:103], a[20:23], v[148:151]
    v_mfma_f32_16x16x32_bf16 v[144:147], a[100:103], a[16:19], v[144:147]
    ds_read_b64_tr_b16 a[126:127], v6 offset:10912
    v_mfma_f32_16x16x32_bf16 v[144:147], a[96:99], a[0:3], v[144:147]
    s_waitcnt lgkmcnt(8)
    v_mfma_f32_16x16x32_bf16 v[160:163], a[104:107], a[0:3], v[160:163]
    ds_read_b64_tr_b16 a[128:129], v6 offset:14496
    v_mfma_f32_16x16x32_bf16 v[160:163], a[108:111], a[16:19], v[160:163]
    buffer_load_dwordx4 a[92:95], v30, s[8:11], s31 offen offset:3072 sc1
    v_mfma_f32_16x16x32_bf16 v[164:167], a[108:111], a[20:23], v[164:167]
    ds_read_b64_tr_b16 a[130:131], v6 offset:18080
    v_mfma_f32_16x16x32_bf16 v[164:167], a[104:107], a[4:7], v[164:167]
    v_mfma_f32_16x16x32_bf16 v[168:171], a[104:107], a[8:11], v[168:171]
    ds_read_b64_tr_b16 a[132:133], v6 offset:21664
    v_mfma_f32_16x16x32_bf16 v[168:171], a[108:111], a[24:27], v[168:171]
    v_mfma_f32_16x16x32_bf16 v[172:175], a[108:111], a[28:31], v[172:175]
    ds_read_b64_tr_b16 a[134:135], v6 offset:25248
    v_mfma_f32_16x16x32_bf16 v[172:175], a[104:107], a[12:15], v[172:175]
    s_waitcnt lgkmcnt(8)
    v_mfma_f32_16x16x32_bf16 v[188:191], a[112:115], a[12:15], v[188:191]
    ds_read_b64_tr_b16 a[96:97], v6 offset:192
    v_mfma_f32_16x16x32_bf16 v[188:191], a[116:119], a[28:31], v[188:191]
    v_mfma_f32_16x16x32_bf16 v[184:187], a[116:119], a[24:27], v[184:187]
    ds_read_b64_tr_b16 a[98:99], v6 offset:3776
    v_mfma_f32_16x16x32_bf16 v[184:187], a[112:115], a[8:11], v[184:187]
    v_mfma_f32_16x16x32_bf16 v[180:183], a[112:115], a[4:7], v[180:183]
    ds_read_b64_tr_b16 a[100:101], v6 offset:7360
    v_mfma_f32_16x16x32_bf16 v[180:183], a[116:119], a[20:23], v[180:183]
    v_mfma_f32_16x16x32_bf16 v[176:179], a[116:119], a[16:19], v[176:179]
    ds_read_b64_tr_b16 a[102:103], v6 offset:10944
    v_mfma_f32_16x16x32_bf16 v[176:179], a[112:115], a[0:3], v[176:179]
    s_waitcnt lgkmcnt(8)
    v_mfma_f32_16x16x32_bf16 v[192:195], a[120:123], a[0:3], v[192:195]
    ds_read_b64_tr_b16 a[104:105], v6 offset:14528
    v_mfma_f32_16x16x32_bf16 v[192:195], a[124:127], a[16:19], v[192:195]
    v_mfma_f32_16x16x32_bf16 v[196:199], a[124:127], a[20:23], v[196:199]
    ds_read_b64_tr_b16 a[106:107], v6 offset:18112
    v_mfma_f32_16x16x32_bf16 v[196:199], a[120:123], a[4:7], v[196:199]
    v_mfma_f32_16x16x32_bf16 v[200:203], a[120:123], a[8:11], v[200:203]
    ds_read_b64_tr_b16 a[108:109], v6 offset:21696
    v_mfma_f32_16x16x32_bf16 v[200:203], a[124:127], a[24:27], v[200:203]
    v_mfma_f32_16x16x32_bf16 v[204:207], a[124:127], a[28:31], v[204:207]
    ds_read_b64_tr_b16 a[110:111], v6 offset:25280
    v_mfma_f32_16x16x32_bf16 v[204:207], a[120:123], a[12:15], v[204:207]
    s_waitcnt lgkmcnt(8)
    v_mfma_f32_16x16x32_bf16 v[220:223], a[128:131], a[12:15], v[220:223]
    s_waitcnt vmcnt(23)
    s_barrier
    ds_read_b64_tr_b16 a[112:113], v6 offset:32768
    s_add_u32 m0, s82, 98304
    v_mfma_f32_16x16x32_bf16 v[220:223], a[132:135], a[28:31], v[220:223]
    s_bfe_u32 s30, s65, 262172
    s_mul_i32 s30, s30, 458752
    v_mfma_f32_16x16x32_bf16 v[216:219], a[132:135], a[24:27], v[216:219]
    ds_read_b64_tr_b16 a[114:115], v6 offset:36352
    v_mfma_f32_16x16x32_bf16 v[216:219], a[128:131], a[8:11], v[216:219]
    buffer_load_dwordx4 v20, s[40:43], s30 offen offset:0  lds
    v_mfma_f32_16x16x32_bf16 v[212:215], a[128:131], a[4:7], v[212:215]
    ds_read_b64_tr_b16 a[116:117], v6 offset:39936
    v_mfma_f32_16x16x32_bf16 v[212:215], a[132:135], a[20:23], v[212:215]
    v_mfma_f32_16x16x32_bf16 v[208:211], a[132:135], a[16:19], v[208:211]
    ds_read_b64_tr_b16 a[118:119], v6 offset:43520
    v_mfma_f32_16x16x32_bf16 v[208:211], a[128:131], a[0:3], v[208:211]
    s_waitcnt lgkmcnt(8)
    v_mfma_f32_16x16x32_bf16 v[224:227], a[96:99], a[0:3], v[224:227]
    ds_read_b64_tr_b16 a[120:121], v6 offset:47104
    v_mfma_f32_16x16x32_bf16 v[224:227], a[100:103], a[16:19], v[224:227]
    buffer_load_dwordx4 v21, s[40:43], s30 offen offset:1024  lds
    v_mfma_f32_16x16x32_bf16 v[228:231], a[100:103], a[20:23], v[228:231]
    ds_read_b64_tr_b16 a[122:123], v6 offset:50688
    v_mfma_f32_16x16x32_bf16 v[228:231], a[96:99], a[4:7], v[228:231]
    v_mfma_f32_16x16x32_bf16 v[232:235], a[96:99], a[8:11], v[232:235]
    ds_read_b64_tr_b16 a[124:125], v6 offset:54272
    v_mfma_f32_16x16x32_bf16 v[232:235], a[100:103], a[24:27], v[232:235]
    v_mfma_f32_16x16x32_bf16 v[236:239], a[100:103], a[28:31], v[236:239]
    ds_read_b64_tr_b16 a[126:127], v6 offset:57856
    v_mfma_f32_16x16x32_bf16 v[236:239], a[96:99], a[12:15], v[236:239]
    buffer_load_dwordx4 v22, s[40:43], s30 offen offset:2048  lds
    s_waitcnt lgkmcnt(8)
    v_mfma_f32_16x16x32_bf16 v[252:255], a[104:107], a[12:15], v[252:255]
    ds_read_b64_tr_b16 a[128:129], v6 offset:32800
    v_mfma_f32_16x16x32_bf16 v[252:255], a[108:111], a[28:31], v[252:255]
    v_mfma_f32_16x16x32_bf16 v[248:251], a[108:111], a[24:27], v[248:251]
    ds_read_b64_tr_b16 a[130:131], v6 offset:36384
    v_mfma_f32_16x16x32_bf16 v[248:251], a[104:107], a[8:11], v[248:251]
    v_mfma_f32_16x16x32_bf16 v[244:247], a[104:107], a[4:7], v[244:247]
    ds_read_b64_tr_b16 a[132:133], v6 offset:39968
    v_mfma_f32_16x16x32_bf16 v[244:247], a[108:111], a[20:23], v[244:247]
    buffer_load_dwordx4 v23, s[40:43], s30 offen offset:3072  lds
    v_mfma_f32_16x16x32_bf16 v[240:243], a[108:111], a[16:19], v[240:243]
    ds_read_b64_tr_b16 a[134:135], v6 offset:43552
    s_add_u32 m0, s82, 102400
    v_mfma_f32_16x16x32_bf16 v[240:243], a[104:107], a[0:3], v[240:243]
    s_waitcnt vmcnt(19) lgkmcnt(8)
    v_mfma_f32_16x16x32_bf16 v[32:35], a[112:115], a[32:35], v[32:35]
    ds_read_b64_tr_b16 a[96:97], v6 offset:47136
    v_mfma_f32_16x16x32_bf16 v[32:35], a[116:119], a[48:51], v[32:35]
    v_mfma_f32_16x16x32_bf16 v[36:39], a[116:119], a[52:55], v[36:39]
    ds_read_b64_tr_b16 a[98:99], v6 offset:50720
    v_mfma_f32_16x16x32_bf16 v[36:39], a[112:115], a[36:39], v[36:39]
    buffer_load_dwordx4 v24, s[40:43], s30 offen offset:0  lds
    v_mfma_f32_16x16x32_bf16 v[40:43], a[112:115], a[40:43], v[40:43]
    ds_read_b64_tr_b16 a[100:101], v6 offset:54304
    v_mfma_f32_16x16x32_bf16 v[40:43], a[116:119], a[56:59], v[40:43]
    v_mfma_f32_16x16x32_bf16 v[44:47], a[116:119], a[60:63], v[44:47]
    ds_read_b64_tr_b16 a[102:103], v6 offset:57888
    v_mfma_f32_16x16x32_bf16 v[44:47], a[112:115], a[44:47], v[44:47]
    s_waitcnt lgkmcnt(8)
    v_mfma_f32_16x16x32_bf16 v[60:63], a[120:123], a[44:47], v[60:63]
    ds_read_b64_tr_b16 a[104:105], v6 offset:32832
    v_mfma_f32_16x16x32_bf16 v[60:63], a[124:127], a[60:63], v[60:63]
    buffer_load_dwordx4 v25, s[40:43], s30 offen offset:1024  lds
    v_mfma_f32_16x16x32_bf16 v[56:59], a[124:127], a[56:59], v[56:59]
    ds_read_b64_tr_b16 a[106:107], v6 offset:36416
    v_mfma_f32_16x16x32_bf16 v[56:59], a[120:123], a[40:43], v[56:59]
    v_mfma_f32_16x16x32_bf16 v[52:55], a[120:123], a[36:39], v[52:55]
    ds_read_b64_tr_b16 a[108:109], v6 offset:40000
    v_mfma_f32_16x16x32_bf16 v[52:55], a[124:127], a[52:55], v[52:55]
    v_mfma_f32_16x16x32_bf16 v[48:51], a[124:127], a[48:51], v[48:51]
    ds_read_b64_tr_b16 a[110:111], v6 offset:43584
    v_mfma_f32_16x16x32_bf16 v[48:51], a[120:123], a[32:35], v[48:51]
    buffer_load_dwordx4 v26, s[40:43], s30 offen offset:2048  lds
    s_waitcnt lgkmcnt(8)
    v_mfma_f32_16x16x32_bf16 v[64:67], a[128:131], a[32:35], v[64:67]
    ds_read_b64_tr_b16 a[112:113], v6 offset:47168
    s_bfe_u32 s31, s65, 262172
    v_mfma_f32_16x16x32_bf16 v[64:67], a[132:135], a[48:51], v[64:67]
    s_lshl_b32 s31, s31, 13
    v_mfma_f32_16x16x32_bf16 v[68:71], a[132:135], a[52:55], v[68:71]
    ds_read_b64_tr_b16 a[114:115], v6 offset:50752
    s_add_u32 s31, s31, s16
    v_mfma_f32_16x16x32_bf16 v[68:71], a[128:131], a[36:39], v[68:71]
    v_mfma_f32_16x16x32_bf16 v[72:75], a[128:131], a[40:43], v[72:75]
    ds_read_b64_tr_b16 a[116:117], v6 offset:54336
    v_mfma_f32_16x16x32_bf16 v[72:75], a[132:135], a[56:59], v[72:75]
    buffer_load_dwordx4 a[0:3], v1, s[8:11], s31 offen offset:0 sc1
    v_mfma_f32_16x16x32_bf16 v[76:79], a[132:135], a[60:63], v[76:79]
    ds_read_b64_tr_b16 a[118:119], v6 offset:57920
    v_mfma_f32_16x16x32_bf16 v[76:79], a[128:131], a[44:47], v[76:79]
    s_waitcnt lgkmcnt(8)
    v_mfma_f32_16x16x32_bf16 v[92:95], a[96:99], a[44:47], v[92:95]
    ds_read_b64_tr_b16 a[120:121], v6 offset:32864
    v_mfma_f32_16x16x32_bf16 v[92:95], a[100:103], a[60:63], v[92:95]
    v_mfma_f32_16x16x32_bf16 v[88:91], a[100:103], a[56:59], v[88:91]
    ds_read_b64_tr_b16 a[122:123], v6 offset:36448
    v_mfma_f32_16x16x32_bf16 v[88:91], a[96:99], a[40:43], v[88:91]
    buffer_load_dwordx4 a[4:7], v1, s[8:11], s31 offen offset:1024 sc1
    v_mfma_f32_16x16x32_bf16 v[84:87], a[96:99], a[36:39], v[84:87]
    ds_read_b64_tr_b16 a[124:125], v6 offset:40032
    v_mfma_f32_16x16x32_bf16 v[84:87], a[100:103], a[52:55], v[84:87]
    v_mfma_f32_16x16x32_bf16 v[80:83], a[100:103], a[48:51], v[80:83]
    ds_read_b64_tr_b16 a[126:127], v6 offset:43616
    v_mfma_f32_16x16x32_bf16 v[80:83], a[96:99], a[32:35], v[80:83]
    s_waitcnt lgkmcnt(8)
    v_mfma_f32_16x16x32_bf16 v[96:99], a[104:107], a[32:35], v[96:99]
    ds_read_b64_tr_b16 a[128:129], v6 offset:47200
    v_mfma_f32_16x16x32_bf16 v[96:99], a[108:111], a[48:51], v[96:99]
    buffer_load_dwordx4 a[8:11], v1, s[8:11], s31 offen offset:2048 sc1
    v_mfma_f32_16x16x32_bf16 v[100:103], a[108:111], a[52:55], v[100:103]
    ds_read_b64_tr_b16 a[130:131], v6 offset:50784
    v_mfma_f32_16x16x32_bf16 v[100:103], a[104:107], a[36:39], v[100:103]
    v_mfma_f32_16x16x32_bf16 v[104:107], a[104:107], a[40:43], v[104:107]
    ds_read_b64_tr_b16 a[132:133], v6 offset:54368
    v_mfma_f32_16x16x32_bf16 v[104:107], a[108:111], a[56:59], v[104:107]
    v_mfma_f32_16x16x32_bf16 v[108:111], a[108:111], a[60:63], v[108:111]
    ds_read_b64_tr_b16 a[134:135], v6 offset:57952
    v_mfma_f32_16x16x32_bf16 v[108:111], a[104:107], a[44:47], v[108:111]
    s_waitcnt lgkmcnt(8)
    v_mfma_f32_16x16x32_bf16 v[124:127], a[112:115], a[44:47], v[124:127]
    ds_read_b64_tr_b16 a[96:97], v6 offset:32896
    v_mfma_f32_16x16x32_bf16 v[124:127], a[116:119], a[60:63], v[124:127]
    buffer_load_dwordx4 a[12:15], v1, s[8:11], s31 offen offset:3072 sc1
    v_mfma_f32_16x16x32_bf16 v[120:123], a[116:119], a[56:59], v[120:123]
    ds_read_b64_tr_b16 a[98:99], v6 offset:36480
    v_mfma_f32_16x16x32_bf16 v[120:123], a[112:115], a[40:43], v[120:123]
    v_mfma_f32_16x16x32_bf16 v[116:119], a[112:115], a[36:39], v[116:119]
    ds_read_b64_tr_b16 a[100:101], v6 offset:40064
    v_mfma_f32_16x16x32_bf16 v[116:119], a[116:119], a[52:55], v[116:119]
    v_mfma_f32_16x16x32_bf16 v[112:115], a[116:119], a[48:51], v[112:115]
    ds_read_b64_tr_b16 a[102:103], v6 offset:43648
    v_mfma_f32_16x16x32_bf16 v[112:115], a[112:115], a[32:35], v[112:115]
    buffer_load_dwordx4 a[16:19], v30, s[8:11], s31 offen offset:0 sc1
    s_waitcnt lgkmcnt(8)
    v_mfma_f32_16x16x32_bf16 v[128:131], a[120:123], a[32:35], v[128:131]
    ds_read_b64_tr_b16 a[104:105], v6 offset:47232
    v_mfma_f32_16x16x32_bf16 v[128:131], a[124:127], a[48:51], v[128:131]
    v_mfma_f32_16x16x32_bf16 v[132:135], a[124:127], a[52:55], v[132:135]
    ds_read_b64_tr_b16 a[106:107], v6 offset:50816
    v_mfma_f32_16x16x32_bf16 v[132:135], a[120:123], a[36:39], v[132:135]
    v_mfma_f32_16x16x32_bf16 v[136:139], a[120:123], a[40:43], v[136:139]
    ds_read_b64_tr_b16 a[108:109], v6 offset:54400
    v_mfma_f32_16x16x32_bf16 v[136:139], a[124:127], a[56:59], v[136:139]
    buffer_load_dwordx4 a[20:23], v30, s[8:11], s31 offen offset:1024 sc1
    v_mfma_f32_16x16x32_bf16 v[140:143], a[124:127], a[60:63], v[140:143]
    ds_read_b64_tr_b16 a[110:111], v6 offset:57984
    v_mfma_f32_16x16x32_bf16 v[140:143], a[120:123], a[44:47], v[140:143]
    s_waitcnt lgkmcnt(8)
    v_mfma_f32_16x16x32_bf16 v[156:159], a[128:131], a[44:47], v[156:159]
    ds_read_b64_tr_b16 a[112:113], v6 offset:32928
    v_mfma_f32_16x16x32_bf16 v[156:159], a[132:135], a[60:63], v[156:159]
    v_mfma_f32_16x16x32_bf16 v[152:155], a[132:135], a[56:59], v[152:155]
    ds_read_b64_tr_b16 a[114:115], v6 offset:36512
    v_mfma_f32_16x16x32_bf16 v[152:155], a[128:131], a[40:43], v[152:155]
    buffer_load_dwordx4 a[24:27], v30, s[8:11], s31 offen offset:2048 sc1
    v_mfma_f32_16x16x32_bf16 v[148:151], a[128:131], a[36:39], v[148:151]
    ds_read_b64_tr_b16 a[116:117], v6 offset:40096
    v_mfma_f32_16x16x32_bf16 v[148:151], a[132:135], a[52:55], v[148:151]
    v_mfma_f32_16x16x32_bf16 v[144:147], a[132:135], a[48:51], v[144:147]
    ds_read_b64_tr_b16 a[118:119], v6 offset:43680
    v_mfma_f32_16x16x32_bf16 v[144:147], a[128:131], a[32:35], v[144:147]
    s_waitcnt lgkmcnt(8)
    v_mfma_f32_16x16x32_bf16 v[160:163], a[96:99], a[32:35], v[160:163]
    ds_read_b64_tr_b16 a[120:121], v6 offset:47264
    v_mfma_f32_16x16x32_bf16 v[160:163], a[100:103], a[48:51], v[160:163]
    buffer_load_dwordx4 a[28:31], v30, s[8:11], s31 offen offset:3072 sc1
    v_mfma_f32_16x16x32_bf16 v[164:167], a[100:103], a[52:55], v[164:167]
    ds_read_b64_tr_b16 a[122:123], v6 offset:50848
    v_accvgpr_read_b32 v31, a201
    v_mfma_f32_16x16x32_bf16 v[164:167], a[96:99], a[36:39], v[164:167]
    v_mfma_f32_16x16x32_bf16 v[168:171], a[96:99], a[40:43], v[168:171]
    ds_read_b64_tr_b16 a[124:125], v6 offset:54432
    v_mfma_f32_16x16x32_bf16 v[168:171], a[100:103], a[56:59], v[168:171]
    v_mfma_f32_16x16x32_bf16 v[172:175], a[100:103], a[60:63], v[172:175]
    ds_read_b64_tr_b16 a[126:127], v6 offset:58016
    v_mfma_f32_16x16x32_bf16 v[172:175], a[96:99], a[44:47], v[172:175]
    global_load_dword a200, v31, s[74:75]
    s_waitcnt lgkmcnt(8)
    v_mfma_f32_16x16x32_bf16 v[188:191], a[104:107], a[44:47], v[188:191]
    ds_read_b64_tr_b16 a[128:129], v6 offset:32960
    v_mfma_f32_16x16x32_bf16 v[188:191], a[108:111], a[60:63], v[188:191]
    v_mfma_f32_16x16x32_bf16 v[184:187], a[108:111], a[56:59], v[184:187]
    ds_read_b64_tr_b16 a[130:131], v6 offset:36544
    v_mfma_f32_16x16x32_bf16 v[184:187], a[104:107], a[40:43], v[184:187]
    v_mfma_f32_16x16x32_bf16 v[180:183], a[104:107], a[36:39], v[180:183]
    ds_read_b64_tr_b16 a[132:133], v6 offset:40128
    v_mfma_f32_16x16x32_bf16 v[180:183], a[108:111], a[52:55], v[180:183]
    v_mfma_f32_16x16x32_bf16 v[176:179], a[108:111], a[48:51], v[176:179]
    ds_read_b64_tr_b16 a[134:135], v6 offset:43712
    v_mfma_f32_16x16x32_bf16 v[176:179], a[104:107], a[32:35], v[176:179]
    s_waitcnt lgkmcnt(8)
    v_mfma_f32_16x16x32_bf16 v[192:195], a[112:115], a[32:35], v[192:195]
    ds_read_b64_tr_b16 a[96:97], v6 offset:47296
    v_mfma_f32_16x16x32_bf16 v[192:195], a[116:119], a[48:51], v[192:195]
    v_mfma_f32_16x16x32_bf16 v[196:199], a[116:119], a[52:55], v[196:199]
    ds_read_b64_tr_b16 a[98:99], v6 offset:50880
    v_mfma_f32_16x16x32_bf16 v[196:199], a[112:115], a[36:39], v[196:199]
    v_mfma_f32_16x16x32_bf16 v[200:203], a[112:115], a[40:43], v[200:203]
    ds_read_b64_tr_b16 a[100:101], v6 offset:54464
    v_mfma_f32_16x16x32_bf16 v[200:203], a[116:119], a[56:59], v[200:203]
    v_mfma_f32_16x16x32_bf16 v[204:207], a[116:119], a[60:63], v[204:207]
    ds_read_b64_tr_b16 a[102:103], v6 offset:58048
    v_mfma_f32_16x16x32_bf16 v[204:207], a[112:115], a[44:47], v[204:207]
    s_waitcnt lgkmcnt(8)
    v_mfma_f32_16x16x32_bf16 v[220:223], a[120:123], a[44:47], v[220:223]
    s_waitcnt vmcnt(9)
    s_barrier
    ds_read_b64_tr_b16 a[104:105], v7 offset:0
    v_accvgpr_read_b32 v20, a215
    v_mfma_f32_16x16x32_bf16 v[220:223], a[124:127], a[60:63], v[220:223]
    v_accvgpr_read_b32 v21, a216
    v_accvgpr_read_b32 v22, a217
    v_mfma_f32_16x16x32_bf16 v[216:219], a[124:127], a[56:59], v[216:219]
    ds_read_b64_tr_b16 a[106:107], v7 offset:3584
    v_accvgpr_read_b32 v23, a218
    v_mfma_f32_16x16x32_bf16 v[216:219], a[120:123], a[40:43], v[216:219]
    v_accvgpr_read_b32 v24, a219
    v_accvgpr_read_b32 v25, a220
    v_mfma_f32_16x16x32_bf16 v[212:215], a[120:123], a[36:39], v[212:215]
    ds_read_b64_tr_b16 a[108:109], v7 offset:7168
    v_accvgpr_read_b32 v26, a221
    v_mfma_f32_16x16x32_bf16 v[212:215], a[124:127], a[52:55], v[212:215]
    v_accvgpr_read_b32 v27, a222
    s_add_u32 m0, s83, 0
    v_mfma_f32_16x16x32_bf16 v[208:211], a[124:127], a[48:51], v[208:211]
    ds_read_b64_tr_b16 a[110:111], v7 offset:10752
    s_bfe_u32 s30, s68, 524288
    v_mfma_f32_16x16x32_bf16 v[208:211], a[120:123], a[32:35], v[208:211]
    s_lshl_b32 s30, s30, 16
    buffer_load_dwordx4 v20, s[44:47], s30 offen offset:0  lds
    s_waitcnt lgkmcnt(8)
    v_mfma_f32_16x16x32_bf16 v[224:227], a[128:131], a[32:35], v[224:227]
    ds_read_b64_tr_b16 a[112:113], v7 offset:32768
    v_mfma_f32_16x16x32_bf16 v[224:227], a[132:135], a[48:51], v[224:227]
    v_mfma_f32_16x16x32_bf16 v[228:231], a[132:135], a[52:55], v[228:231]
    ds_read_b64_tr_b16 a[114:115], v7 offset:36352
    v_mfma_f32_16x16x32_bf16 v[228:231], a[128:131], a[36:39], v[228:231]
    v_mfma_f32_16x16x32_bf16 v[232:235], a[128:131], a[40:43], v[232:235]
    ds_read_b64_tr_b16 a[116:117], v7 offset:39936
    v_mfma_f32_16x16x32_bf16 v[232:235], a[132:135], a[56:59], v[232:235]
    buffer_load_dwordx4 v21, s[44:47], s30 offen offset:1024  lds
    v_mfma_f32_16x16x32_bf16 v[236:239], a[132:135], a[60:63], v[236:239]
    ds_read_b64_tr_b16 a[118:119], v7 offset:43520
    v_mfma_f32_16x16x32_bf16 v[236:239], a[128:131], a[44:47], v[236:239]
    s_waitcnt lgkmcnt(8)
    v_mfma_f32_16x16x32_bf16 v[252:255], a[96:99], a[44:47], v[252:255]
    s_barrier
    ds_read_b64_tr_b16 a[120:121], v7 offset:14336
    v_mfma_f32_16x16x32_bf16 v[252:255], a[100:103], a[60:63], v[252:255]
    v_mfma_f32_16x16x32_bf16 v[248:251], a[100:103], a[56:59], v[248:251]
    ds_read_b64_tr_b16 a[122:123], v7 offset:17920
    v_mfma_f32_16x16x32_bf16 v[248:251], a[96:99], a[40:43], v[248:251]
    buffer_load_dwordx4 v22, s[44:47], s30 offen offset:2048  lds
    v_mfma_f32_16x16x32_bf16 v[244:247], a[96:99], a[36:39], v[244:247]
    ds_read_b64_tr_b16 a[124:125], v7 offset:21504
    v_mfma_f32_16x16x32_bf16 v[244:247], a[100:103], a[52:55], v[244:247]
    v_mfma_f32_16x16x32_bf16 v[240:243], a[100:103], a[48:51], v[240:243]
    ds_read_b64_tr_b16 a[126:127], v7 offset:25088
    v_mfma_f32_16x16x32_bf16 v[240:243], a[96:99], a[32:35], v[240:243]
    s_waitcnt vmcnt(4) lgkmcnt(4)
    v_mfma_f32_16x16x32_bf16 v[32:35], a[104:107], a[64:67], v[32:35]
    ds_read_b64_tr_b16 a[128:129], v7 offset:47104
    v_mfma_f32_16x16x32_bf16 v[32:35], a[108:111], a[80:83], v[32:35]
    buffer_load_dwordx4 v23, s[44:47], s30 offen offset:3072  lds
    v_mfma_f32_16x16x32_bf16 v[32:35], a[112:115], a[0:3], v[32:35]
    ds_read_b64_tr_b16 a[130:131], v7 offset:50688
    s_add_u32 m0, s83, 4096
    v_mfma_f32_16x16x32_bf16 v[32:35], a[116:119], a[16:19], v[32:35]
    v_mfma_f32_16x16x32_bf16 v[36:39], a[116:119], a[20:23], v[36:39]
    ds_read_b64_tr_b16 a[132:133], v7 offset:54272
    v_mfma_f32_16x16x32_bf16 v[36:39], a[112:115], a[4:7], v[36:39]
    v_mfma_f32_16x16x32_bf16 v[36:39], a[108:111], a[84:87], v[36:39]
    ds_read_b64_tr_b16 a[134:135], v7 offset:57856
    v_mfma_f32_16x16x32_bf16 v[36:39], a[104:107], a[68:71], v[36:39]
    buffer_load_dwordx4 v24, s[44:47], s30 offen offset:0  lds
    v_mfma_f32_16x16x32_bf16 v[40:43], a[104:107], a[72:75], v[40:43]
    ds_read_b64_tr_b16 a[96:97], v7 offset:32
    v_mfma_f32_16x16x32_bf16 v[40:43], a[108:111], a[88:91], v[40:43]
    v_mfma_f32_16x16x32_bf16 v[40:43], a[112:115], a[8:11], v[40:43]
    ds_read_b64_tr_b16 a[98:99], v7 offset:3616
    v_mfma_f32_16x16x32_bf16 v[40:43], a[116:119], a[24:27], v[40:43]
    v_mfma_f32_16x16x32_bf16 v[44:47], a[116:119], a[28:31], v[44:47]
    ds_read_b64_tr_b16 a[100:101], v7 offset:7200
    v_mfma_f32_16x16x32_bf16 v[44:47], a[112:115], a[12:15], v[44:47]
    buffer_load_dwordx4 v25, s[44:47], s30 offen offset:1024  lds
    v_mfma_f32_16x16x32_bf16 v[44:47], a[108:111], a[92:95], v[44:47]
    ds_read_b64_tr_b16 a[102:103], v7 offset:10784
    v_mfma_f32_16x16x32_bf16 v[44:47], a[104:107], a[76:79], v[44:47]
    s_waitcnt lgkmcnt(4)
    v_mfma_f32_16x16x32_bf16 v[60:63], a[120:123], a[76:79], v[60:63]
    ds_read_b64_tr_b16 a[104:105], v7 offset:32800
    v_mfma_f32_16x16x32_bf16 v[60:63], a[124:127], a[92:95], v[60:63]
    v_mfma_f32_16x16x32_bf16 v[60:63], a[128:131], a[12:15], v[60:63]
    ds_read_b64_tr_b16 a[106:107], v7 offset:36384
    v_mfma_f32_16x16x32_bf16 v[60:63], a[132:135], a[28:31], v[60:63]
    buffer_load_dwordx4 v26, s[44:47], s30 offen offset:2048  lds
    v_mfma_f32_16x16x32_bf16 v[56:59], a[132:135], a[24:27], v[56:59]
    ds_read_b64_tr_b16 a[108:109], v7 offset:39968
    v_mfma_f32_16x16x32_bf16 v[56:59], a[128:131], a[8:11], v[56:59]
    v_mfma_f32_16x16x32_bf16 v[56:59], a[124:127], a[88:91], v[56:59]
    ds_read_b64_tr_b16 a[110:111], v7 offset:43552
    v_mfma_f32_16x16x32_bf16 v[56:59], a[120:123], a[72:75], v[56:59]
    v_mfma_f32_16x16x32_bf16 v[52:55], a[120:123], a[68:71], v[52:55]
    ds_read_b64_tr_b16 a[112:113], v7 offset:14368
    v_mfma_f32_16x16x32_bf16 v[52:55], a[124:127], a[84:87], v[52:55]
    buffer_load_dwordx4 v27, s[44:47], s30 offen offset:3072  lds
    v_mfma_f32_16x16x32_bf16 v[52:55], a[128:131], a[4:7], v[52:55]
    ds_read_b64_tr_b16 a[114:115], v7 offset:17952
    s_add_u32 m0, s83, 32768
    v_mfma_f32_16x16x32_bf16 v[52:55], a[132:135], a[20:23], v[52:55]
    s_bfe_u32 s30, s68, 524296
    v_mfma_f32_16x16x32_bf16 v[48:51], a[132:135], a[16:19], v[48:51]
    ds_read_b64_tr_b16 a[116:117], v7 offset:21536
    s_lshl_b32 s30, s30, 16
    v_mfma_f32_16x16x32_bf16 v[48:51], a[128:131], a[0:3], v[48:51]
    v_mfma_f32_16x16x32_bf16 v[48:51], a[124:127], a[80:83], v[48:51]
    ds_read_b64_tr_b16 a[118:119], v7 offset:25120
    v_mfma_f32_16x16x32_bf16 v[48:51], a[120:123], a[64:67], v[48:51]
    buffer_load_dwordx4 v20, s[44:47], s30 offen offset:0  lds
    s_waitcnt lgkmcnt(4)
    v_mfma_f32_16x16x32_bf16 v[64:67], a[96:99], a[64:67], v[64:67]
    ds_read_b64_tr_b16 a[120:121], v7 offset:47136
    v_mfma_f32_16x16x32_bf16 v[64:67], a[100:103], a[80:83], v[64:67]
    v_mfma_f32_16x16x32_bf16 v[64:67], a[104:107], a[0:3], v[64:67]
    ds_read_b64_tr_b16 a[122:123], v7 offset:50720
    v_mfma_f32_16x16x32_bf16 v[64:67], a[108:111], a[16:19], v[64:67]
    v_mfma_f32_16x16x32_bf16 v[68:71], a[108:111], a[20:23], v[68:71]
    ds_read_b64_tr_b16 a[124:125], v7 offset:54304
    v_mfma_f32_16x16x32_bf16 v[68:71], a[104:107], a[4:7], v[68:71]
    buffer_load_dwordx4 v21, s[44:47], s30 offen offset:1024  lds
    v_mfma_f32_16x16x32_bf16 v[68:71], a[100:103], a[84:87], v[68:71]
    ds_read_b64_tr_b16 a[126:127], v7 offset:57888
    v_mfma_f32_16x16x32_bf16 v[68:71], a[96:99], a[68:71], v[68:71]
    v_mfma_f32_16x16x32_bf16 v[72:75], a[96:99], a[72:75], v[72:75]
    ds_read_b64_tr_b16 a[128:129], v7 offset:64
    v_mfma_f32_16x16x32_bf16 v[72:75], a[100:103], a[88:91], v[72:75]
    v_mfma_f32_16x16x32_bf16 v[72:75], a[104:107], a[8:11], v[72:75]
    ds_read_b64_tr_b16 a[130:131], v7 offset:3648
    v_mfma_f32_16x16x32_bf16 v[72:75], a[108:111], a[24:27], v[72:75]
    v_mfma_f32_16x16x32_bf16 v[76:79], a[108:111], a[28:31], v[76:79]
    ds_read_b64_tr_b16 a[132:133], v7 offset:7232
    v_mfma_f32_16x16x32_bf16 v[76:79], a[104:107], a[12:15], v[76:79]
    buffer_load_dwordx4 v22, s[44:47], s30 offen offset:2048  lds
    v_mfma_f32_16x16x32_bf16 v[76:79], a[100:103], a[92:95], v[76:79]
    ds_read_b64_tr_b16 a[134:135], v7 offset:10816
    v_mfma_f32_16x16x32_bf16 v[76:79], a[96:99], a[76:79], v[76:79]
    s_waitcnt lgkmcnt(4)
    v_mfma_f32_16x16x32_bf16 v[92:95], a[112:115], a[76:79], v[92:95]
    ds_read_b64_tr_b16 a[96:97], v7 offset:32832
    v_mul_f32 v44, v44, v60
    v_mfma_f32_16x16x32_bf16 v[92:95], a[116:119], a[92:95], v[92:95]
    v_mul_f32 v45, v45, v61
    v_mul_f32 v46, v46, v62
    v_mfma_f32_16x16x32_bf16 v[92:95], a[120:123], a[12:15], v[92:95]
    ds_read_b64_tr_b16 a[98:99], v7 offset:36416
    v_mul_f32 v47, v47, v63
    v_mfma_f32_16x16x32_bf16 v[92:95], a[124:127], a[28:31], v[92:95]
    buffer_load_dwordx4 v23, s[44:47], s30 offen offset:3072  lds
    v_mfma_f32_16x16x32_bf16 v[88:91], a[124:127], a[24:27], v[88:91]
    ds_read_b64_tr_b16 a[100:101], v7 offset:40000
    s_add_u32 m0, s83, 36864
    v_mfma_f32_16x16x32_bf16 v[88:91], a[120:123], a[8:11], v[88:91]
    v_mfma_f32_16x16x32_bf16 v[88:91], a[116:119], a[88:91], v[88:91]
    ds_read_b64_tr_b16 a[102:103], v7 offset:43584
    v_mfma_f32_16x16x32_bf16 v[88:91], a[112:115], a[72:75], v[88:91]
    v_mul_f32 v76, v76, v92
    v_mul_f32 v77, v77, v93
    v_mfma_f32_16x16x32_bf16 v[84:87], a[112:115], a[68:71], v[84:87]
    ds_read_b64_tr_b16 a[104:105], v7 offset:14400
    v_mul_f32 v78, v78, v94
    v_mfma_f32_16x16x32_bf16 v[84:87], a[116:119], a[84:87], v[84:87]
    buffer_load_dwordx4 v24, s[44:47], s30 offen offset:0  lds
    v_mul_f32 v79, v79, v95
    v_mfma_f32_16x16x32_bf16 v[84:87], a[120:123], a[4:7], v[84:87]
    ds_read_b64_tr_b16 a[106:107], v7 offset:17984
    v_cvt_pk_bf16_f32 v8, v44, v45
    v_mfma_f32_16x16x32_bf16 v[84:87], a[124:127], a[20:23], v[84:87]
    v_cvt_pk_bf16_f32 v10, v76, v77
    v_cvt_pk_bf16_f32 v9, v46, v47
    v_mfma_f32_16x16x32_bf16 v[80:83], a[124:127], a[16:19], v[80:83]
    ds_read_b64_tr_b16 a[108:109], v7 offset:21568
    v_cvt_pk_bf16_f32 v11, v78, v79
    v_mfma_f32_16x16x32_bf16 v[80:83], a[120:123], a[0:3], v[80:83]
    v_permlane16_swap_b32 v8, v10
    v_mul_f32 v40, v40, v56
    v_mfma_f32_16x16x32_bf16 v[80:83], a[116:119], a[80:83], v[80:83]
    ds_read_b64_tr_b16 a[110:111], v7 offset:25152
    v_permlane16_swap_b32 v9, v11
    v_mfma_f32_16x16x32_bf16 v[80:83], a[112:115], a[64:67], v[80:83]
    buffer_load_dwordx4 v25, s[44:47], s30 offen offset:1024  lds
    buffer_store_dwordx4 v[8:11], v4, s[8:11], s19 offen offset:1024 sc1
    s_waitcnt lgkmcnt(4)
    v_mfma_f32_16x16x32_bf16 v[96:99], a[128:131], a[64:67], v[96:99]
    ds_read_b64_tr_b16 a[112:113], v7 offset:47168
    v_mul_f32 v41, v41, v57
    v_mfma_f32_16x16x32_bf16 v[96:99], a[132:135], a[80:83], v[96:99]
    v_mul_f32 v42, v42, v58
    v_mul_f32 v43, v43, v59
    v_mfma_f32_16x16x32_bf16 v[96:99], a[96:99], a[0:3], v[96:99]
    ds_read_b64_tr_b16 a[114:115], v7 offset:50752
    v_mul_f32 v72, v72, v88
    v_mfma_f32_16x16x32_bf16 v[96:99], a[100:103], a[16:19], v[96:99]
    v_mul_f32 v73, v73, v89
    v_mul_f32 v74, v74, v90
    v_mfma_f32_16x16x32_bf16 v[100:103], a[100:103], a[20:23], v[100:103]
    ds_read_b64_tr_b16 a[116:117], v7 offset:54336
    v_mul_f32 v75, v75, v91
    v_mfma_f32_16x16x32_bf16 v[100:103], a[96:99], a[4:7], v[100:103]
    buffer_load_dwordx4 v26, s[44:47], s30 offen offset:2048  lds
    v_cvt_pk_bf16_f32 v12, v40, v41
    v_mfma_f32_16x16x32_bf16 v[100:103], a[132:135], a[84:87], v[100:103]
    ds_read_b64_tr_b16 a[118:119], v7 offset:57920
    v_cvt_pk_bf16_f32 v14, v72, v73
    v_mfma_f32_16x16x32_bf16 v[100:103], a[128:131], a[68:71], v[100:103]
    v_cvt_pk_bf16_f32 v13, v42, v43
    v_cvt_pk_bf16_f32 v15, v74, v75
    v_mfma_f32_16x16x32_bf16 v[104:107], a[128:131], a[72:75], v[104:107]
    ds_read_b64_tr_b16 a[120:121], v7 offset:96
    v_permlane16_swap_b32 v12, v14
    v_mfma_f32_16x16x32_bf16 v[104:107], a[132:135], a[88:91], v[104:107]
    v_mul_f32 v36, v36, v52
    v_permlane16_swap_b32 v13, v15
    v_mfma_f32_16x16x32_bf16 v[104:107], a[96:99], a[8:11], v[104:107]
    ds_read_b64_tr_b16 a[122:123], v7 offset:3680
    buffer_store_dwordx4 v[12:15], v4, s[8:11], s19 offen offset:0 sc1
    v_mfma_f32_16x16x32_bf16 v[104:107], a[100:103], a[24:27], v[104:107]
    buffer_load_dwordx4 v27, s[44:47], s30 offen offset:3072  lds
    v_mul_f32 v37, v37, v53
    v_mfma_f32_16x16x32_bf16 v[108:111], a[100:103], a[28:31], v[108:111]
    ds_read_b64_tr_b16 a[124:125], v7 offset:7264
    v_mul_f32 v38, v38, v54
    v_mfma_f32_16x16x32_bf16 v[108:111], a[96:99], a[12:15], v[108:111]
    v_mul_f32 v39, v39, v55
    v_mul_f32 v68, v68, v84
    v_mfma_f32_16x16x32_bf16 v[108:111], a[132:135], a[92:95], v[108:111]
    ds_read_b64_tr_b16 a[126:127], v7 offset:10848
    v_mul_f32 v69, v69, v85
    v_mfma_f32_16x16x32_bf16 v[108:111], a[128:131], a[76:79], v[108:111]
    v_mul_f32 v70, v70, v86
    v_mul_f32 v71, v71, v87
    s_waitcnt lgkmcnt(4)
    v_mfma_f32_16x16x32_bf16 v[124:127], a[104:107], a[76:79], v[124:127]
    ds_read_b64_tr_b16 a[128:129], v7 offset:32864
    v_cvt_pk_bf16_f32 v16, v36, v37
    v_mfma_f32_16x16x32_bf16 v[124:127], a[108:111], a[92:95], v[124:127]
    v_cvt_pk_bf16_f32 v18, v68, v69
    v_cvt_pk_bf16_f32 v17, v38, v39
    v_mfma_f32_16x16x32_bf16 v[124:127], a[112:115], a[12:15], v[124:127]
    ds_read_b64_tr_b16 a[130:131], v7 offset:36448
    v_cvt_pk_bf16_f32 v19, v70, v71
    v_mfma_f32_16x16x32_bf16 v[124:127], a[116:119], a[28:31], v[124:127]
    v_permlane16_swap_b32 v16, v18
    v_mul_f32 v32, v32, v48
    v_mfma_f32_16x16x32_bf16 v[120:123], a[116:119], a[24:27], v[120:123]
    ds_read_b64_tr_b16 a[132:133], v7 offset:40032
    v_permlane16_swap_b32 v17, v19
    v_mfma_f32_16x16x32_bf16 v[120:123], a[112:115], a[8:11], v[120:123]
    buffer_store_dwordx4 v[16:19], v4, s[8:11], s18 offen offset:1024 sc1
    v_mul_f32 v33, v33, v49
    v_mfma_f32_16x16x32_bf16 v[120:123], a[108:111], a[88:91], v[120:123]
    ds_read_b64_tr_b16 a[134:135], v7 offset:43616
    v_mul_f32 v34, v34, v50
    v_mfma_f32_16x16x32_bf16 v[120:123], a[104:107], a[72:75], v[120:123]
    v_mul_f32 v35, v35, v51
    v_mul_f32 v64, v64, v80
    v_mfma_f32_16x16x32_bf16 v[116:119], a[104:107], a[68:71], v[116:119]
    ds_read_b64_tr_b16 a[96:97], v7 offset:14432
    v_mul_f32 v65, v65, v81
    v_mfma_f32_16x16x32_bf16 v[116:119], a[108:111], a[84:87], v[116:119]
    v_mul_f32 v66, v66, v82
    v_mul_f32 v67, v67, v83
    v_mfma_f32_16x16x32_bf16 v[116:119], a[112:115], a[4:7], v[116:119]
    ds_read_b64_tr_b16 a[98:99], v7 offset:18016
    v_cvt_pk_bf16_f32 v8, v32, v33
    v_mfma_f32_16x16x32_bf16 v[116:119], a[116:119], a[20:23], v[116:119]
    v_cvt_pk_bf16_f32 v10, v64, v65
    v_cvt_pk_bf16_f32 v9, v34, v35
    v_mfma_f32_16x16x32_bf16 v[112:115], a[116:119], a[16:19], v[112:115]
    ds_read_b64_tr_b16 a[100:101], v7 offset:21600
    v_cvt_pk_bf16_f32 v11, v66, v67
    v_mfma_f32_16x16x32_bf16 v[112:115], a[112:115], a[0:3], v[112:115]
    v_permlane16_swap_b32 v8, v10
    v_permlane16_swap_b32 v9, v11
    v_mfma_f32_16x16x32_bf16 v[112:115], a[108:111], a[80:83], v[112:115]
    ds_read_b64_tr_b16 a[102:103], v7 offset:25184
    buffer_store_dwordx4 v[8:11], v4, s[8:11], s18 offen offset:0 sc1
    v_mfma_f32_16x16x32_bf16 v[112:115], a[104:107], a[64:67], v[112:115]
    s_waitcnt lgkmcnt(4)
    v_mfma_f32_16x16x32_bf16 v[128:131], a[120:123], a[64:67], v[128:131]
    ds_read_b64_tr_b16 a[104:105], v7 offset:47200
    v_mfma_f32_16x16x32_bf16 v[128:131], a[124:127], a[80:83], v[128:131]
    v_mfma_f32_16x16x32_bf16 v[128:131], a[128:131], a[0:3], v[128:131]
    ds_read_b64_tr_b16 a[106:107], v7 offset:50784
    v_mfma_f32_16x16x32_bf16 v[128:131], a[132:135], a[16:19], v[128:131]
    v_mfma_f32_16x16x32_bf16 v[132:135], a[132:135], a[20:23], v[132:135]
    ds_read_b64_tr_b16 a[108:109], v7 offset:54368
    v_mfma_f32_16x16x32_bf16 v[132:135], a[128:131], a[4:7], v[132:135]
    v_mfma_f32_16x16x32_bf16 v[132:135], a[124:127], a[84:87], v[132:135]
    ds_read_b64_tr_b16 a[110:111], v7 offset:57952
    v_mfma_f32_16x16x32_bf16 v[132:135], a[120:123], a[68:71], v[132:135]
    v_mfma_f32_16x16x32_bf16 v[136:139], a[120:123], a[72:75], v[136:139]
    ds_read_b64_tr_b16 a[112:113], v7 offset:128
    v_mfma_f32_16x16x32_bf16 v[136:139], a[124:127], a[88:91], v[136:139]
    v_mfma_f32_16x16x32_bf16 v[136:139], a[128:131], a[8:11], v[136:139]
    ds_read_b64_tr_b16 a[114:115], v7 offset:3712
    v_mfma_f32_16x16x32_bf16 v[136:139], a[132:135], a[24:27], v[136:139]
    v_mfma_f32_16x16x32_bf16 v[140:143], a[132:135], a[28:31], v[140:143]
    ds_read_b64_tr_b16 a[116:117], v7 offset:7296
    v_mfma_f32_16x16x32_bf16 v[140:143], a[128:131], a[12:15], v[140:143]
    v_mfma_f32_16x16x32_bf16 v[140:143], a[124:127], a[92:95], v[140:143]
    ds_read_b64_tr_b16 a[118:119], v7 offset:10880
    v_mfma_f32_16x16x32_bf16 v[140:143], a[120:123], a[76:79], v[140:143]
    s_waitcnt lgkmcnt(4)
    v_mfma_f32_16x16x32_bf16 v[156:159], a[96:99], a[76:79], v[156:159]
    ds_read_b64_tr_b16 a[120:121], v7 offset:32896
    v_mul_f32 v108, v108, v124
    v_mfma_f32_16x16x32_bf16 v[156:159], a[100:103], a[92:95], v[156:159]
    v_mul_f32 v109, v109, v125
    v_mul_f32 v110, v110, v126
    v_mfma_f32_16x16x32_bf16 v[156:159], a[104:107], a[12:15], v[156:159]
    ds_read_b64_tr_b16 a[122:123], v7 offset:36480
    v_mul_f32 v111, v111, v127
    v_mfma_f32_16x16x32_bf16 v[156:159], a[108:111], a[28:31], v[156:159]
    v_mfma_f32_16x16x32_bf16 v[152:155], a[108:111], a[24:27], v[152:155]
    ds_read_b64_tr_b16 a[124:125], v7 offset:40064
    v_mfma_f32_16x16x32_bf16 v[152:155], a[104:107], a[8:11], v[152:155]
    v_mfma_f32_16x16x32_bf16 v[152:155], a[100:103], a[88:91], v[152:155]
    ds_read_b64_tr_b16 a[126:127], v7 offset:43648
    v_mfma_f32_16x16x32_bf16 v[152:155], a[96:99], a[72:75], v[152:155]
    v_mfma_f32_16x16x32_bf16 v[148:151], a[96:99], a[68:71], v[148:151]
    ds_read_b64_tr_b16 a[128:129], v7 offset:14464
    v_mul_f32 v140, v140, v156
    v_mfma_f32_16x16x32_bf16 v[148:151], a[100:103], a[84:87], v[148:151]
    v_mul_f32 v141, v141, v157
    v_mul_f32 v142, v142, v158
    v_mfma_f32_16x16x32_bf16 v[148:151], a[104:107], a[4:7], v[148:151]
    ds_read_b64_tr_b16 a[130:131], v7 offset:18048
    v_mul_f32 v143, v143, v159
    v_mfma_f32_16x16x32_bf16 v[148:151], a[108:111], a[20:23], v[148:151]
    v_cvt_pk_bf16_f32 v12, v108, v109
    v_cvt_pk_bf16_f32 v14, v140, v141
    v_mfma_f32_16x16x32_bf16 v[144:147], a[108:111], a[16:19], v[144:147]
    ds_read_b64_tr_b16 a[132:133], v7 offset:21632
    v_cvt_pk_bf16_f32 v13, v110, v111
    v_mfma_f32_16x16x32_bf16 v[144:147], a[104:107], a[0:3], v[144:147]
    v_cvt_pk_bf16_f32 v15, v142, v143
    v_permlane16_swap_b32 v12, v14
    v_mfma_f32_16x16x32_bf16 v[144:147], a[100:103], a[80:83], v[144:147]
    ds_read_b64_tr_b16 a[134:135], v7 offset:25216
    v_mul_f32 v104, v104, v120
    v_mfma_f32_16x16x32_bf16 v[144:147], a[96:99], a[64:67], v[144:147]
    v_permlane16_swap_b32 v13, v15
    buffer_store_dwordx4 v[12:15], v4, s[8:11], s21 offen offset:1024 sc1
    s_waitcnt lgkmcnt(4)
    v_mfma_f32_16x16x32_bf16 v[160:163], a[112:115], a[64:67], v[160:163]
    ds_read_b64_tr_b16 a[96:97], v7 offset:47232
    v_mul_f32 v105, v105, v121
    v_mfma_f32_16x16x32_bf16 v[160:163], a[116:119], a[80:83], v[160:163]
    v_mul_f32 v106, v106, v122
    v_mul_f32 v107, v107, v123
    v_mfma_f32_16x16x32_bf16 v[160:163], a[120:123], a[0:3], v[160:163]
    ds_read_b64_tr_b16 a[98:99], v7 offset:50816
    v_mul_f32 v136, v136, v152
    v_mfma_f32_16x16x32_bf16 v[160:163], a[124:127], a[16:19], v[160:163]
    v_mul_f32 v137, v137, v153
    v_mul_f32 v138, v138, v154
    v_mfma_f32_16x16x32_bf16 v[164:167], a[124:127], a[20:23], v[164:167]
    ds_read_b64_tr_b16 a[100:101], v7 offset:54400
    v_mul_f32 v139, v139, v155
    v_mfma_f32_16x16x32_bf16 v[164:167], a[120:123], a[4:7], v[164:167]
    v_cvt_pk_bf16_f32 v16, v104, v105
    v_cvt_pk_bf16_f32 v18, v136, v137
    v_mfma_f32_16x16x32_bf16 v[164:167], a[116:119], a[84:87], v[164:167]
    ds_read_b64_tr_b16 a[102:103], v7 offset:57984
    v_cvt_pk_bf16_f32 v17, v106, v107
    v_mfma_f32_16x16x32_bf16 v[164:167], a[112:115], a[68:71], v[164:167]
    v_cvt_pk_bf16_f32 v19, v138, v139
    v_permlane16_swap_b32 v16, v18
    v_mfma_f32_16x16x32_bf16 v[168:171], a[112:115], a[72:75], v[168:171]
    ds_read_b64_tr_b16 a[104:105], v7 offset:160
    v_mul_f32 v100, v100, v116
    v_mfma_f32_16x16x32_bf16 v[168:171], a[116:119], a[88:91], v[168:171]
    v_permlane16_swap_b32 v17, v19
    buffer_store_dwordx4 v[16:19], v4, s[8:11], s21 offen offset:0 sc1
    v_mfma_f32_16x16x32_bf16 v[168:171], a[120:123], a[8:11], v[168:171]
    ds_read_b64_tr_b16 a[106:107], v7 offset:3744
    v_mul_f32 v101, v101, v117
    v_mfma_f32_16x16x32_bf16 v[168:171], a[124:127], a[24:27], v[168:171]
    v_mul_f32 v102, v102, v118
    v_mul_f32 v103, v103, v119
    v_mfma_f32_16x16x32_bf16 v[172:175], a[124:127], a[28:31], v[172:175]
    ds_read_b64_tr_b16 a[108:109], v7 offset:7328
    v_mul_f32 v132, v132, v148
    v_mfma_f32_16x16x32_bf16 v[172:175], a[120:123], a[12:15], v[172:175]
    v_mul_f32 v133, v133, v149
    v_mul_f32 v134, v134, v150
    v_mfma_f32_16x16x32_bf16 v[172:175], a[116:119], a[92:95], v[172:175]
    ds_read_b64_tr_b16 a[110:111], v7 offset:10912
    v_mul_f32 v135, v135, v151
    v_mfma_f32_16x16x32_bf16 v[172:175], a[112:115], a[76:79], v[172:175]
    v_cvt_pk_bf16_f32 v8, v100, v101
    v_cvt_pk_bf16_f32 v10, v132, v133
    s_waitcnt lgkmcnt(4)
    v_mfma_f32_16x16x32_bf16 v[188:191], a[128:131], a[76:79], v[188:191]
    ds_read_b64_tr_b16 a[112:113], v7 offset:32928
    v_cvt_pk_bf16_f32 v9, v102, v103
    v_mfma_f32_16x16x32_bf16 v[188:191], a[132:135], a[92:95], v[188:191]
    v_cvt_pk_bf16_f32 v11, v134, v135
    v_permlane16_swap_b32 v8, v10
    v_mfma_f32_16x16x32_bf16 v[188:191], a[96:99], a[12:15], v[188:191]
    ds_read_b64_tr_b16 a[114:115], v7 offset:36512
    v_mul_f32 v96, v96, v112
    v_mfma_f32_16x16x32_bf16 v[188:191], a[100:103], a[28:31], v[188:191]
    v_permlane16_swap_b32 v9, v11
    buffer_store_dwordx4 v[8:11], v4, s[8:11], s20 offen offset:1024 sc1
    v_mfma_f32_16x16x32_bf16 v[184:187], a[100:103], a[24:27], v[184:187]
    ds_read_b64_tr_b16 a[116:117], v7 offset:40096
    v_mul_f32 v97, v97, v113
    v_mfma_f32_16x16x32_bf16 v[184:187], a[96:99], a[8:11], v[184:187]
    s_waitcnt vmcnt(3)
    s_barrier
    s_add_u32 s86, s86, 1
    v_mov_b32 v29, s86
    buffer_store_dword v29, v2, s[8:11], s101 offen sc1
    v_mfma_f32_16x16x32_bf16 v[184:187], a[132:135], a[88:91], v[184:187]
    ds_read_b64_tr_b16 a[118:119], v7 offset:43680
    v_mul_f32 v98, v98, v114
    v_mfma_f32_16x16x32_bf16 v[184:187], a[128:131], a[72:75], v[184:187]
    v_mul_f32 v99, v99, v115
    v_mul_f32 v128, v128, v144
    v_mfma_f32_16x16x32_bf16 v[180:183], a[128:131], a[68:71], v[180:183]
    ds_read_b64_tr_b16 a[120:121], v7 offset:14496
    v_mul_f32 v129, v129, v145
    v_mfma_f32_16x16x32_bf16 v[180:183], a[132:135], a[84:87], v[180:183]
    v_mul_f32 v130, v130, v146
    v_mul_f32 v131, v131, v147
    v_mfma_f32_16x16x32_bf16 v[180:183], a[96:99], a[4:7], v[180:183]
    ds_read_b64_tr_b16 a[122:123], v7 offset:18080
    v_cvt_pk_bf16_f32 v12, v96, v97
    v_mfma_f32_16x16x32_bf16 v[180:183], a[100:103], a[20:23], v[180:183]
    v_cvt_pk_bf16_f32 v14, v128, v129
    v_cvt_pk_bf16_f32 v13, v98, v99
    v_mfma_f32_16x16x32_bf16 v[176:179], a[100:103], a[16:19], v[176:179]
    ds_read_b64_tr_b16 a[124:125], v7 offset:21664
    v_cvt_pk_bf16_f32 v15, v130, v131
    v_mfma_f32_16x16x32_bf16 v[176:179], a[96:99], a[0:3], v[176:179]
    v_permlane16_swap_b32 v12, v14
    v_permlane16_swap_b32 v13, v15
    v_mfma_f32_16x16x32_bf16 v[176:179], a[132:135], a[80:83], v[176:179]
    ds_read_b64_tr_b16 a[126:127], v7 offset:25248
    buffer_store_dwordx4 v[12:15], v4, s[8:11], s20 offen offset:0 sc1
    v_mfma_f32_16x16x32_bf16 v[176:179], a[128:131], a[64:67], v[176:179]
    s_waitcnt lgkmcnt(4)
    v_mfma_f32_16x16x32_bf16 v[192:195], a[104:107], a[64:67], v[192:195]
    ds_read_b64_tr_b16 a[128:129], v7 offset:47264
    v_mfma_f32_16x16x32_bf16 v[192:195], a[108:111], a[80:83], v[192:195]
    v_mfma_f32_16x16x32_bf16 v[192:195], a[112:115], a[0:3], v[192:195]
    ds_read_b64_tr_b16 a[130:131], v7 offset:50848
    v_mfma_f32_16x16x32_bf16 v[192:195], a[116:119], a[16:19], v[192:195]
    v_mfma_f32_16x16x32_bf16 v[196:199], a[116:119], a[20:23], v[196:199]
    ds_read_b64_tr_b16 a[132:133], v7 offset:54432
    v_mfma_f32_16x16x32_bf16 v[196:199], a[112:115], a[4:7], v[196:199]
    v_mfma_f32_16x16x32_bf16 v[196:199], a[108:111], a[84:87], v[196:199]
    ds_read_b64_tr_b16 a[134:135], v7 offset:58016
    v_mfma_f32_16x16x32_bf16 v[196:199], a[104:107], a[68:71], v[196:199]
    v_mfma_f32_16x16x32_bf16 v[200:203], a[104:107], a[72:75], v[200:203]
    ds_read_b64_tr_b16 a[96:97], v7 offset:192
    v_mfma_f32_16x16x32_bf16 v[200:203], a[108:111], a[88:91], v[200:203]
    v_mfma_f32_16x16x32_bf16 v[200:203], a[112:115], a[8:11], v[200:203]
    ds_read_b64_tr_b16 a[98:99], v7 offset:3776
    v_mfma_f32_16x16x32_bf16 v[200:203], a[116:119], a[24:27], v[200:203]
    v_mfma_f32_16x16x32_bf16 v[204:207], a[116:119], a[28:31], v[204:207]
    ds_read_b64_tr_b16 a[100:101], v7 offset:7360
    v_mfma_f32_16x16x32_bf16 v[204:207], a[112:115], a[12:15], v[204:207]
    v_mfma_f32_16x16x32_bf16 v[204:207], a[108:111], a[92:95], v[204:207]
    ds_read_b64_tr_b16 a[102:103], v7 offset:10944
    v_mfma_f32_16x16x32_bf16 v[204:207], a[104:107], a[76:79], v[204:207]
    s_waitcnt lgkmcnt(4)
    v_mfma_f32_16x16x32_bf16 v[220:223], a[120:123], a[76:79], v[220:223]
    ds_read_b64_tr_b16 a[104:105], v7 offset:32960
    v_mul_f32 v172, v172, v188
    v_mfma_f32_16x16x32_bf16 v[220:223], a[124:127], a[92:95], v[220:223]
    v_mul_f32 v173, v173, v189
    v_mul_f32 v174, v174, v190
    v_mfma_f32_16x16x32_bf16 v[220:223], a[128:131], a[12:15], v[220:223]
    ds_read_b64_tr_b16 a[106:107], v7 offset:36544
    v_mul_f32 v175, v175, v191
    v_mfma_f32_16x16x32_bf16 v[220:223], a[132:135], a[28:31], v[220:223]
    v_mfma_f32_16x16x32_bf16 v[216:219], a[132:135], a[24:27], v[216:219]
    ds_read_b64_tr_b16 a[108:109], v7 offset:40128
    v_mfma_f32_16x16x32_bf16 v[216:219], a[128:131], a[8:11], v[216:219]
    v_mfma_f32_16x16x32_bf16 v[216:219], a[124:127], a[88:91], v[216:219]
    ds_read_b64_tr_b16 a[110:111], v7 offset:43712
    v_mfma_f32_16x16x32_bf16 v[216:219], a[120:123], a[72:75], v[216:219]
    v_mfma_f32_16x16x32_bf16 v[212:215], a[120:123], a[68:71], v[212:215]
    ds_read_b64_tr_b16 a[112:113], v7 offset:14528
    v_mul_f32 v204, v204, v220
    v_mfma_f32_16x16x32_bf16 v[212:215], a[124:127], a[84:87], v[212:215]
    v_mul_f32 v205, v205, v221
    v_mul_f32 v206, v206, v222
    v_mfma_f32_16x16x32_bf16 v[212:215], a[128:131], a[4:7], v[212:215]
    ds_read_b64_tr_b16 a[114:115], v7 offset:18112
    v_mul_f32 v207, v207, v223
    v_mfma_f32_16x16x32_bf16 v[212:215], a[132:135], a[20:23], v[212:215]
    v_cvt_pk_bf16_f32 v16, v172, v173
    v_cvt_pk_bf16_f32 v18, v204, v205
    v_mfma_f32_16x16x32_bf16 v[208:211], a[132:135], a[16:19], v[208:211]
    ds_read_b64_tr_b16 a[116:117], v7 offset:21696
    v_cvt_pk_bf16_f32 v17, v174, v175
    v_mfma_f32_16x16x32_bf16 v[208:211], a[128:131], a[0:3], v[208:211]
    v_accvgpr_read_b32 v28, a205
    buffer_load_dword v29, v28, s[8:11], s87 offen sc1
    v_mfma_f32_16x16x32_bf16 v[208:211], a[124:127], a[80:83], v[208:211]
    ds_read_b64_tr_b16 a[118:119], v7 offset:25280
    v_cvt_pk_bf16_f32 v19, v206, v207
    v_mfma_f32_16x16x32_bf16 v[208:211], a[120:123], a[64:67], v[208:211]
    v_permlane16_swap_b32 v16, v18
    v_mul_f32 v168, v168, v184
    s_waitcnt lgkmcnt(4)
    v_mfma_f32_16x16x32_bf16 v[224:227], a[96:99], a[64:67], v[224:227]
    ds_read_b64_tr_b16 a[120:121], v7 offset:47296
    v_permlane16_swap_b32 v17, v19
    v_mfma_f32_16x16x32_bf16 v[224:227], a[100:103], a[80:83], v[224:227]
    buffer_store_dwordx4 v[16:19], v4, s[8:11], s25 offen offset:1024 sc1
    v_mul_f32 v169, v169, v185
    v_mfma_f32_16x16x32_bf16 v[224:227], a[104:107], a[0:3], v[224:227]
    ds_read_b64_tr_b16 a[122:123], v7 offset:50880
    v_mul_f32 v170, v170, v186
    v_mfma_f32_16x16x32_bf16 v[224:227], a[108:111], a[16:19], v[224:227]
    v_mul_f32 v171, v171, v187
    v_mul_f32 v200, v200, v216
    v_mfma_f32_16x16x32_bf16 v[228:231], a[108:111], a[20:23], v[228:231]
    ds_read_b64_tr_b16 a[124:125], v7 offset:54464
    v_mul_f32 v201, v201, v217
    v_mfma_f32_16x16x32_bf16 v[228:231], a[104:107], a[4:7], v[228:231]
    v_mul_f32 v202, v202, v218
    v_mul_f32 v203, v203, v219
    v_mfma_f32_16x16x32_bf16 v[228:231], a[100:103], a[84:87], v[228:231]
    ds_read_b64_tr_b16 a[126:127], v7 offset:58048
    v_cvt_pk_bf16_f32 v8, v168, v169
    v_mfma_f32_16x16x32_bf16 v[228:231], a[96:99], a[68:71], v[228:231]
    v_cvt_pk_bf16_f32 v10, v200, v201
    v_cvt_pk_bf16_f32 v9, v170, v171
    v_mfma_f32_16x16x32_bf16 v[232:235], a[96:99], a[72:75], v[232:235]
    v_cvt_pk_bf16_f32 v11, v202, v203
    v_permlane16_swap_b32 v8, v10
    v_mfma_f32_16x16x32_bf16 v[232:235], a[100:103], a[88:91], v[232:235]
    v_mul_f32 v164, v164, v180
    v_permlane16_swap_b32 v9, v11
    v_mfma_f32_16x16x32_bf16 v[232:235], a[104:107], a[8:11], v[232:235]
    buffer_store_dwordx4 v[8:11], v4, s[8:11], s25 offen offset:0 sc1
    v_mul_f32 v165, v165, v181
    v_mfma_f32_16x16x32_bf16 v[232:235], a[108:111], a[24:27], v[232:235]
    v_mul_f32 v166, v166, v182
    v_mul_f32 v167, v167, v183
    v_mfma_f32_16x16x32_bf16 v[236:239], a[108:111], a[28:31], v[236:239]
    v_mul_f32 v196, v196, v212
    v_mul_f32 v197, v197, v213
    v_mfma_f32_16x16x32_bf16 v[236:239], a[104:107], a[12:15], v[236:239]
    v_mul_f32 v198, v198, v214
    v_mul_f32 v199, v199, v215
    v_mfma_f32_16x16x32_bf16 v[236:239], a[100:103], a[92:95], v[236:239]
    v_cvt_pk_bf16_f32 v12, v164, v165
    v_cvt_pk_bf16_f32 v14, v196, v197
    v_mfma_f32_16x16x32_bf16 v[236:239], a[96:99], a[76:79], v[236:239]
    v_cvt_pk_bf16_f32 v13, v166, v167
    v_cvt_pk_bf16_f32 v15, v198, v199
    s_waitcnt lgkmcnt(0)
    v_mfma_f32_16x16x32_bf16 v[252:255], a[112:115], a[76:79], v[252:255]
    v_permlane16_swap_b32 v12, v14
    v_mul_f32 v160, v160, v176
    v_mfma_f32_16x16x32_bf16 v[252:255], a[116:119], a[92:95], v[252:255]
    v_permlane16_swap_b32 v13, v15
    buffer_store_dwordx4 v[12:15], v4, s[8:11], s24 offen offset:1024 sc1
    v_mfma_f32_16x16x32_bf16 v[252:255], a[120:123], a[12:15], v[252:255]
    v_mul_f32 v161, v161, v177
    v_mul_f32 v162, v162, v178
    v_mfma_f32_16x16x32_bf16 v[252:255], a[124:127], a[28:31], v[252:255]
    v_mul_f32 v163, v163, v179
    v_mul_f32 v192, v192, v208
    v_mfma_f32_16x16x32_bf16 v[248:251], a[124:127], a[24:27], v[248:251]
    v_mul_f32 v193, v193, v209
    v_mul_f32 v194, v194, v210
    v_mfma_f32_16x16x32_bf16 v[248:251], a[120:123], a[8:11], v[248:251]
    v_mul_f32 v195, v195, v211
    v_cvt_pk_bf16_f32 v16, v160, v161
    v_mfma_f32_16x16x32_bf16 v[248:251], a[116:119], a[88:91], v[248:251]
    v_cvt_pk_bf16_f32 v18, v192, v193
    v_cvt_pk_bf16_f32 v17, v162, v163
    v_mfma_f32_16x16x32_bf16 v[248:251], a[112:115], a[72:75], v[248:251]
    v_cvt_pk_bf16_f32 v19, v194, v195
    v_permlane16_swap_b32 v16, v18
    v_mfma_f32_16x16x32_bf16 v[244:247], a[112:115], a[68:71], v[244:247]
    v_permlane16_swap_b32 v17, v19
    buffer_store_dwordx4 v[16:19], v4, s[8:11], s24 offen offset:0 sc1
    v_mfma_f32_16x16x32_bf16 v[244:247], a[116:119], a[84:87], v[244:247]
    v_mfma_f32_16x16x32_bf16 v[244:247], a[120:123], a[4:7], v[244:247]
    v_mfma_f32_16x16x32_bf16 v[244:247], a[124:127], a[20:23], v[244:247]
    v_mul_f32 v232, v232, v248
    v_mul_f32 v233, v233, v249
    v_mfma_f32_16x16x32_bf16 v[240:243], a[124:127], a[16:19], v[240:243]
    v_mul_f32 v234, v234, v250
    v_mul_f32 v235, v235, v251
    v_mfma_f32_16x16x32_bf16 v[240:243], a[120:123], a[0:3], v[240:243]
    v_mul_f32 v236, v236, v252
    v_mul_f32 v237, v237, v253
    v_mfma_f32_16x16x32_bf16 v[240:243], a[116:119], a[80:83], v[240:243]
    v_mul_f32 v238, v238, v254
    v_mul_f32 v239, v239, v255
    v_mfma_f32_16x16x32_bf16 v[240:243], a[112:115], a[64:67], v[240:243]
    v_cvt_pk_bf16_f32 v8, v232, v233
    v_cvt_pk_bf16_f32 v10, v236, v237
    s_waitcnt vmcnt(4)
    s_cmp_eq_u32 s4, 0
    s_cselect_b32 s19, s86, 0
    v_cmp_le_u32 vcc, s19, v29
    s_cmp_eq_u64 vcc, -1
    s_cbranch_scc0 L_slow_20
L_back_21:
    s_barrier
    s_bfe_u32 s31, s66, 262144
    s_lshl_b32 s31, s31, 13
    s_add_u32 s31, s31, s17
    s_add_u32 s29, s31, 4096
    buffer_load_dwordx4 a[0:3], v1, s[8:11], s31 offen offset:0 sc1
    buffer_load_dwordx4 a[8:11], v1, s[8:11], s31 offen offset:2048 sc1
    buffer_load_dwordx4 a[16:19], v1, s[8:11], s29 offen offset:0 sc1
    buffer_load_dwordx4 a[24:27], v1, s[8:11], s29 offen offset:2048 sc1
    buffer_load_dwordx4 a[4:7], v1, s[8:11], s31 offen offset:1024 sc1
    buffer_load_dwordx4 a[12:15], v1, s[8:11], s31 offen offset:3072 sc1
    buffer_load_dwordx4 a[20:23], v1, s[8:11], s29 offen offset:1024 sc1
    buffer_load_dwordx4 a[28:31], v1, s[8:11], s29 offen offset:3072 sc1
    v_cvt_pk_bf16_f32 v9, v234, v235
    v_cvt_pk_bf16_f32 v11, v238, v239
    v_permlane16_swap_b32 v8, v10
    v_pk_mul_f32 v[224:225], v[224:225], v[240:241]
    v_permlane16_swap_b32 v9, v11
    buffer_store_dwordx4 v[8:11], v5, s[8:11], s23 offen offset:0 sc1
    v_pk_mul_f32 v[226:227], v[226:227], v[242:243]
    v_pk_mul_f32 v[228:229], v[228:229], v[244:245]
    v_pk_mul_f32 v[230:231], v[230:231], v[246:247]
    v_cvt_pk_bf16_f32 v12, v224, v225
    v_cvt_pk_bf16_f32 v14, v228, v229
    v_cvt_pk_bf16_f32 v13, v226, v227
    v_cvt_pk_bf16_f32 v15, v230, v231
    v_permlane16_swap_b32 v12, v14
    s_nop 0
    v_permlane16_swap_b32 v13, v15
    buffer_store_dwordx4 v[12:15], v5, s[8:11], s22 offen offset:0 sc1
    s_lshl_b32 s14, s98, 2
    s_add_u32 s14, s14, s4
    s_mul_i32 s16, s14, 229376
    s_mul_i32 s7, s100, 114688
    s_add_u32 s16, s16, s7
    s_add_u32 s16, s16, s85
    s_add_u32 s16, s16, 41943040
    s_lshr_b32 s7, s14, 1
    s_lshl_b32 s20, s7, 17
    s_lshl_b32 s7, s99, 14
    s_add_u32 s20, s20, s7
    s_and_b32 s7, s14, 1
    s_lshl_b32 s7, s7, 11
    s_add_u32 s20, s20, s7
    s_lshl_b32 s7, s100, 22
    s_add_u32 s20, s20, s7
    s_add_u32 s20, s20, s85
    s_add_u32 s20, s20, 58720256
    s_lshl_b32 s7, s100, 13
    s_add_u32 s20, s20, s7
    s_add_u32 s21, s20, 4096
    s_xor_b32 s22, s20, 8192
    s_add_u32 s23, s22, 4096
    v_lshrrev_b32 v6, 2, v3
    v_and_b32 v31, 3, v3
    v_and_b32 v5, 7, v6
    v_lshlrev_b32 v5, 5, v5
    v_lshlrev_b32 v6, 8, v6
    v_lshl_add_u32 v6, v31, 3, v6
    v_xor_b32 v31, 0, v5
    v_add_u32 v100, v6, v31
    v_add_u32 v108, 0x10000, v100
    v_xor_b32 v31, 32, v5
    v_add_u32 v101, v6, v31
    v_add_u32 v109, 0x10000, v101
    v_xor_b32 v31, 64, v5
    v_add_u32 v102, v6, v31
    v_add_u32 v110, 0x10000, v102
    v_xor_b32 v31, 96, v5
    v_add_u32 v103, v6, v31
    v_add_u32 v111, 0x10000, v103
    v_xor_b32 v31, 128, v5
    v_add_u32 v104, v6, v31
    v_add_u32 v112, 0x10000, v104
    v_xor_b32 v31, 160, v5
    v_add_u32 v105, v6, v31
    v_add_u32 v113, 0x10000, v105
    v_xor_b32 v31, 192, v5
    v_add_u32 v106, v6, v31
    v_add_u32 v114, 0x10000, v106
    v_xor_b32 v31, 224, v5
    v_add_u32 v107, v6, v31
    v_add_u32 v115, 0x10000, v107
    ds_read_b64_tr_b16 a[128:129], v100 offset:0
    ds_read_b64_tr_b16 a[130:131], v100 offset:4096
    ds_read_b64_tr_b16 a[132:133], v100 offset:8192
    ds_read_b64_tr_b16 a[134:135], v100 offset:12288
    ds_read_b64_tr_b16 a[136:137], v100 offset:16384
    ds_read_b64_tr_b16 a[138:139], v100 offset:20480
    ds_read_b64_tr_b16 a[140:141], v100 offset:24576
    ds_read_b64_tr_b16 a[142:143], v100 offset:28672
    ds_read_b64_tr_b16 a[144:145], v101 offset:0
    ds_read_b64_tr_b16 a[146:147], v101 offset:4096
    ds_read_b64_tr_b16 a[148:149], v101 offset:8192
    ds_read_b64_tr_b16 a[150:151], v101 offset:12288
    ds_read_b64_tr_b16 a[152:153], v101 offset:16384
    ds_read_b64_tr_b16 a[154:155], v101 offset:20480
    s_waitcnt vmcnt(6) lgkmcnt(6)
    v_mfma_f32_16x16x32_bf16 v[32:35], a[128:131], a[0:3], 0
    ds_read_b64_tr_b16 a[156:157], v101 offset:24576
    s_bfe_u32 s31, s66, 262148
    v_mfma_f32_16x16x32_bf16 v[32:35], a[132:135], a[8:11], v[32:35]
    ds_read_b64_tr_b16 a[158:159], v101 offset:28672
    s_lshl_b32 s31, s31, 13
    s_add_u32 s31, s31, s17
    v_mfma_f32_16x16x32_bf16 v[32:35], a[136:139], a[16:19], v[32:35]
    ds_read_b64_tr_b16 a[160:161], v102 offset:0
    v_mfma_f32_16x16x32_bf16 v[32:35], a[140:143], a[24:27], v[32:35]
    ds_read_b64_tr_b16 a[162:163], v102 offset:4096
    buffer_load_dwordx4 a[32:35], v1, s[8:11], s31 offen offset:0 sc1
    s_waitcnt vmcnt(3)
    v_mfma_f32_16x16x32_bf16 v[36:39], a[140:143], a[28:31], 0
    ds_read_b64_tr_b16 a[164:165], v102 offset:8192
    v_mfma_f32_16x16x32_bf16 v[36:39], a[136:139], a[20:23], v[36:39]
    ds_read_b64_tr_b16 a[166:167], v102 offset:12288
    buffer_load_dwordx4 a[36:39], v1, s[8:11], s31 offen offset:1024 sc1
    v_mfma_f32_16x16x32_bf16 v[36:39], a[132:135], a[12:15], v[36:39]
    ds_read_b64_tr_b16 a[168:169], v102 offset:16384
    v_mfma_f32_16x16x32_bf16 v[36:39], a[128:131], a[4:7], v[36:39]
    ds_read_b64_tr_b16 a[170:171], v102 offset:20480
    s_waitcnt lgkmcnt(6)
    v_mfma_f32_16x16x32_bf16 v[44:47], a[144:147], a[4:7], 0
    ds_read_b64_tr_b16 a[128:129], v102 offset:24576
    v_mfma_f32_16x16x32_bf16 v[44:47], a[148:151], a[12:15], v[44:47]
    ds_read_b64_tr_b16 a[130:131], v102 offset:28672
    buffer_load_dwordx4 a[40:43], v1, s[8:11], s31 offen offset:2048 sc1
    v_mfma_f32_16x16x32_bf16 v[44:47], a[152:155], a[20:23], v[44:47]
    ds_read_b64_tr_b16 a[132:133], v103 offset:0
    v_mfma_f32_16x16x32_bf16 v[44:47], a[156:159], a[28:31], v[44:47]
    ds_read_b64_tr_b16 a[134:135], v103 offset:4096
    v_mfma_f32_16x16x32_bf16 v[40:43], a[156:159], a[24:27], 0
    ds_read_b64_tr_b16 a[136:137], v103 offset:8192
    v_mfma_f32_16x16x32_bf16 v[40:43], a[152:155], a[16:19], v[40:43]
    ds_read_b64_tr_b16 a[138:139], v103 offset:12288
    buffer_load_dwordx4 a[44:47], v1, s[8:11], s31 offen offset:3072 sc1
    v_mfma_f32_16x16x32_bf16 v[40:43], a[148:151], a[8:11], v[40:43]
    ds_read_b64_tr_b16 a[140:141], v103 offset:16384
    v_mfma_f32_16x16x32_bf16 v[40:43], a[144:147], a[0:3], v[40:43]
    ds_read_b64_tr_b16 a[142:143], v103 offset:20480
    s_waitcnt lgkmcnt(6)
    v_mfma_f32_16x16x32_bf16 v[48:51], a[160:163], a[0:3], 0
    ds_read_b64_tr_b16 a[144:145], v103 offset:24576
    v_mfma_f32_16x16x32_bf16 v[48:51], a[164:167], a[8:11], v[48:51]
    ds_read_b64_tr_b16 a[146:147], v103 offset:28672
    buffer_load_dwordx4 a[48:51], v30, s[8:11], s31 offen offset:0 sc1
    v_mfma_f32_16x16x32_bf16 v[48:51], a[168:171], a[16:19], v[48:51]
    ds_read_b64_tr_b16 a[148:149], v104 offset:0
    v_mfma_f32_16x16x32_bf16 v[48:51], a[128:131], a[24:27], v[48:51]
    ds_read_b64_tr_b16 a[150:151], v104 offset:4096
    v_mfma_f32_16x16x32_bf16 v[52:55], a[128:131], a[28:31], 0
    ds_read_b64_tr_b16 a[152:153], v104 offset:8192
    v_mfma_f32_16x16x32_bf16 v[52:55], a[168:171], a[20:23], v[52:55]
    ds_read_b64_tr_b16 a[154:155], v104 offset:12288
    buffer_load_dwordx4 a[52:55], v30, s[8:11], s31 offen offset:1024 sc1
    v_mfma_f32_16x16x32_bf16 v[52:55], a[164:167], a[12:15], v[52:55]
    ds_read_b64_tr_b16 a[156:157], v104 offset:16384
    v_mfma_f32_16x16x32_bf16 v[52:55], a[160:163], a[4:7], v[52:55]
    ds_read_b64_tr_b16 a[158:159], v104 offset:20480
    s_waitcnt lgkmcnt(6)
    v_mfma_f32_16x16x32_bf16 v[60:63], a[132:135], a[4:7], 0
    ds_read_b64_tr_b16 a[160:161], v104 offset:24576
    v_mfma_f32_16x16x32_bf16 v[60:63], a[136:139], a[12:15], v[60:63]
    ds_read_b64_tr_b16 a[162:163], v104 offset:28672
    buffer_load_dwordx4 a[56:59], v30, s[8:11], s31 offen offset:2048 sc1
    v_mfma_f32_16x16x32_bf16 v[60:63], a[140:143], a[20:23], v[60:63]
    ds_read_b64_tr_b16 a[164:165], v105 offset:0
    v_mfma_f32_16x16x32_bf16 v[60:63], a[144:147], a[28:31], v[60:63]
    ds_read_b64_tr_b16 a[166:167], v105 offset:4096
    buffer_load_dwordx4 a[60:63], v30, s[8:11], s31 offen offset:3072 sc1
    v_mfma_f32_16x16x32_bf16 v[56:59], a[144:147], a[24:27], 0
    ds_read_b64_tr_b16 a[168:169], v105 offset:8192
    s_add_u32 m0, s83, 65536
    v_mfma_f32_16x16x32_bf16 v[56:59], a[140:143], a[16:19], v[56:59]
    ds_read_b64_tr_b16 a[170:171], v105 offset:12288
    s_waitcnt vmcnt(8)
    s_barrier
    s_add_u32 s86, s86, 1
    v_mov_b32 v29, s86
    buffer_store_dword v29, v2, s[8:11], s101 offen sc1
    s_bfe_u32 s30, s68, 524304
    v_mfma_f32_16x16x32_bf16 v[56:59], a[136:139], a[8:11], v[56:59]
    ds_read_b64_tr_b16 a[128:129], v105 offset:16384
    s_lshl_b32 s30, s30, 16
    v_mfma_f32_16x16x32_bf16 v[56:59], a[132:135], a[0:3], v[56:59]
    ds_read_b64_tr_b16 a[130:131], v105 offset:20480
    buffer_load_dwordx4 v20, s[44:47], s30 offen offset:0  lds
    s_waitcnt lgkmcnt(6)
    v_mfma_f32_16x16x32_bf16 v[64:67], a[148:151], a[0:3], 0
    ds_read_b64_tr_b16 a[132:133], v105 offset:24576
    v_mfma_f32_16x16x32_bf16 v[64:67], a[152:155], a[8:11], v[64:67]
    ds_read_b64_tr_b16 a[134:135], v105 offset:28672
    v_mfma_f32_16x16x32_bf16 v[64:67], a[156:159], a[16:19], v[64:67]
    ds_read_b64_tr_b16 a[136:137], v106 offset:0
    v_mfma_f32_16x16x32_bf16 v[64:67], a[160:163], a[24:27], v[64:67]
    ds_read_b64_tr_b16 a[138:139], v106 offset:4096
    buffer_load_dwordx4 v21, s[44:47], s30 offen offset:1024  lds
    v_mfma_f32_16x16x32_bf16 v[68:71], a[160:163], a[28:31], 0
    ds_read_b64_tr_b16 a[140:141], v106 offset:8192
    v_mfma_f32_16x16x32_bf16 v[68:71], a[156:159], a[20:23], v[68:71]
    ds_read_b64_tr_b16 a[142:143], v106 offset:12288
    v_mfma_f32_16x16x32_bf16 v[68:71], a[152:155], a[12:15], v[68:71]
    ds_read_b64_tr_b16 a[144:145], v106 offset:16384
    v_mfma_f32_16x16x32_bf16 v[68:71], a[148:151], a[4:7], v[68:71]
    ds_read_b64_tr_b16 a[146:147], v106 offset:20480
    buffer_load_dwordx4 v22, s[44:47], s30 offen offset:2048  lds
    s_waitcnt lgkmcnt(6)
    v_mfma_f32_16x16x32_bf16 v[76:79], a[164:167], a[4:7], 0
    ds_read_b64_tr_b16 a[148:149], v106 offset:24576
    v_mfma_f32_16x16x32_bf16 v[76:79], a[168:171], a[12:15], v[76:79]
    ds_read_b64_tr_b16 a[150:151], v106 offset:28672
    v_mfma_f32_16x16x32_bf16 v[76:79], a[128:131], a[20:23], v[76:79]
    ds_read_b64_tr_b16 a[152:153], v107 offset:0
    v_mfma_f32_16x16x32_bf16 v[76:79], a[132:135], a[28:31], v[76:79]
    ds_read_b64_tr_b16 a[154:155], v107 offset:4096
    buffer_load_dwordx4 v23, s[44:47], s30 offen offset:3072  lds
    v_mfma_f32_16x16x32_bf16 v[72:75], a[132:135], a[24:27], 0
    ds_read_b64_tr_b16 a[156:157], v107 offset:8192
    s_add_u32 m0, s83, 69632
    v_mfma_f32_16x16x32_bf16 v[72:75], a[128:131], a[16:19], v[72:75]
    ds_read_b64_tr_b16 a[158:159], v107 offset:12288
    v_mfma_f32_16x16x32_bf16 v[72:75], a[168:171], a[8:11], v[72:75]
    ds_read_b64_tr_b16 a[160:161], v107 offset:16384
    v_mfma_f32_16x16x32_bf16 v[72:75], a[164:167], a[0:3], v[72:75]
    ds_read_b64_tr_b16 a[162:163], v107 offset:20480
    buffer_load_dwordx4 v24, s[44:47], s30 offen offset:0  lds
    s_waitcnt lgkmcnt(6)
    v_mfma_f32_16x16x32_bf16 v[80:83], a[136:139], a[0:3], 0
    ds_read_b64_tr_b16 a[164:165], v107 offset:24576
    v_mfma_f32_16x16x32_bf16 v[80:83], a[140:143], a[8:11], v[80:83]
    ds_read_b64_tr_b16 a[166:167], v107 offset:28672
    v_mfma_f32_16x16x32_bf16 v[80:83], a[144:147], a[16:19], v[80:83]
    ds_read_b64_tr_b16 a[168:169], v100 offset:32768
    v_mfma_f32_16x16x32_bf16 v[80:83], a[148:151], a[24:27], v[80:83]
    ds_read_b64_tr_b16 a[170:171], v100 offset:36864
    buffer_load_dwordx4 v25, s[44:47], s30 offen offset:1024  lds
    v_mfma_f32_16x16x32_bf16 v[84:87], a[148:151], a[28:31], 0
    ds_read_b64_tr_b16 a[128:129], v100 offset:40960
    v_mfma_f32_16x16x32_bf16 v[84:87], a[144:147], a[20:23], v[84:87]
    ds_read_b64_tr_b16 a[130:131], v100 offset:45056
    v_mfma_f32_16x16x32_bf16 v[84:87], a[140:143], a[12:15], v[84:87]
    ds_read_b64_tr_b16 a[132:133], v100 offset:49152
    v_mfma_f32_16x16x32_bf16 v[84:87], a[136:139], a[4:7], v[84:87]
    ds_read_b64_tr_b16 a[134:135], v100 offset:53248
    buffer_load_dwordx4 v26, s[44:47], s30 offen offset:2048  lds
    s_waitcnt lgkmcnt(6)
    v_mfma_f32_16x16x32_bf16 v[92:95], a[152:155], a[4:7], 0
    ds_read_b64_tr_b16 a[136:137], v100 offset:57344
    v_mfma_f32_16x16x32_bf16 v[92:95], a[156:159], a[12:15], v[92:95]
    ds_read_b64_tr_b16 a[138:139], v100 offset:61440
    buffer_load_dwordx4 v27, s[44:47], s30 offen offset:3072  lds
    v_mfma_f32_16x16x32_bf16 v[92:95], a[160:163], a[20:23], v[92:95]
    ds_read_b64_tr_b16 a[140:141], v101 offset:32768
    s_bfe_u32 s31, s66, 262152
    v_mfma_f32_16x16x32_bf16 v[92:95], a[164:167], a[28:31], v[92:95]
    ds_read_b64_tr_b16 a[142:143], v101 offset:36864
    s_lshl_b32 s31, s31, 13
    v_mfma_f32_16x16x32_bf16 v[88:91], a[164:167], a[24:27], 0
    ds_read_b64_tr_b16 a[144:145], v101 offset:40960
    s_add_u32 s31, s31, s17
    v_mfma_f32_16x16x32_bf16 v[88:91], a[160:163], a[16:19], v[88:91]
    ds_read_b64_tr_b16 a[146:147], v101 offset:45056
    buffer_load_dwordx4 a[64:67], v1, s[8:11], s31 offen offset:0 sc1
    v_mfma_f32_16x16x32_bf16 v[88:91], a[156:159], a[8:11], v[88:91]
    ds_read_b64_tr_b16 a[148:149], v101 offset:49152
    v_mfma_f32_16x16x32_bf16 v[88:91], a[152:155], a[0:3], v[88:91]
    ds_read_b64_tr_b16 a[150:151], v101 offset:53248
    s_waitcnt vmcnt(10) lgkmcnt(6)
    v_mfma_f32_16x16x32_bf16 v[32:35], a[168:171], a[32:35], v[32:35]
    ds_read_b64_tr_b16 a[152:153], v101 offset:57344
    v_mfma_f32_16x16x32_bf16 v[32:35], a[128:131], a[40:43], v[32:35]
    ds_read_b64_tr_b16 a[154:155], v101 offset:61440
    buffer_load_dwordx4 a[68:71], v1, s[8:11], s31 offen offset:1024 sc1
    v_mfma_f32_16x16x32_bf16 v[32:35], a[132:135], a[48:51], v[32:35]
    ds_read_b64_tr_b16 a[156:157], v102 offset:32768
    v_mfma_f32_16x16x32_bf16 v[32:35], a[136:139], a[56:59], v[32:35]
    ds_read_b64_tr_b16 a[158:159], v102 offset:36864
    v_mfma_f32_16x16x32_bf16 v[36:39], a[136:139], a[60:63], v[36:39]
    ds_read_b64_tr_b16 a[160:161], v102 offset:40960
    v_mfma_f32_16x16x32_bf16 v[36:39], a[132:135], a[52:55], v[36:39]
    ds_read_b64_tr_b16 a[162:163], v102 offset:45056
    buffer_load_dwordx4 a[72:75], v1, s[8:11], s31 offen offset:2048 sc1
    v_mfma_f32_16x16x32_bf16 v[36:39], a[128:131], a[44:47], v[36:39]
    ds_read_b64_tr_b16 a[164:165], v102 offset:49152
    v_mfma_f32_16x16x32_bf16 v[36:39], a[168:171], a[36:39], v[36:39]
    ds_read_b64_tr_b16 a[166:167], v102 offset:53248
    s_waitcnt lgkmcnt(6)
    v_mfma_f32_16x16x32_bf16 v[44:47], a[140:143], a[36:39], v[44:47]
    ds_read_b64_tr_b16 a[168:169], v102 offset:57344
    v_mfma_f32_16x16x32_bf16 v[44:47], a[144:147], a[44:47], v[44:47]
    ds_read_b64_tr_b16 a[170:171], v102 offset:61440
    buffer_load_dwordx4 a[76:79], v1, s[8:11], s31 offen offset:3072 sc1
    v_mfma_f32_16x16x32_bf16 v[44:47], a[148:151], a[52:55], v[44:47]
    ds_read_b64_tr_b16 a[128:129], v103 offset:32768
    v_mfma_f32_16x16x32_bf16 v[44:47], a[152:155], a[60:63], v[44:47]
    ds_read_b64_tr_b16 a[130:131], v103 offset:36864
    v_mfma_f32_16x16x32_bf16 v[40:43], a[152:155], a[56:59], v[40:43]
    ds_read_b64_tr_b16 a[132:133], v103 offset:40960
    v_mfma_f32_16x16x32_bf16 v[40:43], a[148:151], a[48:51], v[40:43]
    ds_read_b64_tr_b16 a[134:135], v103 offset:45056
    buffer_load_dwordx4 a[80:83], v30, s[8:11], s31 offen offset:0 sc1
    v_mfma_f32_16x16x32_bf16 v[40:43], a[144:147], a[40:43], v[40:43]
    ds_read_b64_tr_b16 a[136:137], v103 offset:49152
    v_mfma_f32_16x16x32_bf16 v[40:43], a[140:143], a[32:35], v[40:43]
    ds_read_b64_tr_b16 a[138:139], v103 offset:53248
    s_waitcnt lgkmcnt(6)
    v_mfma_f32_16x16x32_bf16 v[48:51], a[156:159], a[32:35], v[48:51]
    ds_read_b64_tr_b16 a[140:141], v103 offset:57344
    v_mfma_f32_16x16x32_bf16 v[48:51], a[160:163], a[40:43], v[48:51]
    ds_read_b64_tr_b16 a[142:143], v103 offset:61440
    buffer_load_dwordx4 a[84:87], v30, s[8:11], s31 offen offset:1024 sc1
    v_mfma_f32_16x16x32_bf16 v[48:51], a[164:167], a[48:51], v[48:51]
    ds_read_b64_tr_b16 a[144:145], v104 offset:32768
    v_mfma_f32_16x16x32_bf16 v[48:51], a[168:171], a[56:59], v[48:51]
    ds_read_b64_tr_b16 a[146:147], v104 offset:36864
    buffer_load_dwordx4 a[88:91], v30, s[8:11], s31 offen offset:2048 sc1
    v_mfma_f32_16x16x32_bf16 v[52:55], a[168:171], a[60:63], v[52:55]
    ds_read_b64_tr_b16 a[148:149], v104 offset:40960
    v_mfma_f32_16x16x32_bf16 v[52:55], a[164:167], a[52:55], v[52:55]
    ds_read_b64_tr_b16 a[150:151], v104 offset:45056
    v_mfma_f32_16x16x32_bf16 v[52:55], a[160:163], a[44:47], v[52:55]
    ds_read_b64_tr_b16 a[152:153], v104 offset:49152
    v_mfma_f32_16x16x32_bf16 v[52:55], a[156:159], a[36:39], v[52:55]
    ds_read_b64_tr_b16 a[154:155], v104 offset:53248
    buffer_load_dwordx4 a[92:95], v30, s[8:11], s31 offen offset:3072 sc1
    s_waitcnt lgkmcnt(6)
    v_mfma_f32_16x16x32_bf16 v[60:63], a[128:131], a[36:39], v[60:63]
    ds_read_b64_tr_b16 a[156:157], v104 offset:57344
    s_add_u32 m0, s83, 98304
    v_mfma_f32_16x16x32_bf16 v[60:63], a[132:135], a[44:47], v[60:63]
    ds_read_b64_tr_b16 a[158:159], v104 offset:61440
    s_bfe_u32 s30, s68, 524312
    v_mfma_f32_16x16x32_bf16 v[60:63], a[136:139], a[52:55], v[60:63]
    ds_read_b64_tr_b16 a[160:161], v105 offset:32768
    s_lshl_b32 s30, s30, 16
    v_mfma_f32_16x16x32_bf16 v[60:63], a[140:143], a[60:63], v[60:63]
    ds_read_b64_tr_b16 a[162:163], v105 offset:36864
    buffer_load_dwordx4 v20, s[44:47], s30 offen offset:0  lds
    v_mfma_f32_16x16x32_bf16 v[56:59], a[140:143], a[56:59], v[56:59]
    ds_read_b64_tr_b16 a[164:165], v105 offset:40960
    v_mfma_f32_16x16x32_bf16 v[56:59], a[136:139], a[48:51], v[56:59]
    ds_read_b64_tr_b16 a[166:167], v105 offset:45056
    v_mfma_f32_16x16x32_bf16 v[56:59], a[132:135], a[40:43], v[56:59]
    ds_read_b64_tr_b16 a[168:169], v105 offset:49152
    v_mfma_f32_16x16x32_bf16 v[56:59], a[128:131], a[32:35], v[56:59]
    ds_read_b64_tr_b16 a[170:171], v105 offset:53248
    buffer_load_dwordx4 v21, s[44:47], s30 offen offset:1024  lds
    s_waitcnt lgkmcnt(6)
    v_mfma_f32_16x16x32_bf16 v[64:67], a[144:147], a[32:35], v[64:67]
    ds_read_b64_tr_b16 a[128:129], v105 offset:57344
    v_mfma_f32_16x16x32_bf16 v[64:67], a[148:151], a[40:43], v[64:67]
    ds_read_b64_tr_b16 a[130:131], v105 offset:61440
    v_mfma_f32_16x16x32_bf16 v[64:67], a[152:155], a[48:51], v[64:67]
    ds_read_b64_tr_b16 a[132:133], v106 offset:32768
    v_mfma_f32_16x16x32_bf16 v[64:67], a[156:159], a[56:59], v[64:67]
    ds_read_b64_tr_b16 a[134:135], v106 offset:36864
    buffer_load_dwordx4 v22, s[44:47], s30 offen offset:2048  lds
    v_mfma_f32_16x16x32_bf16 v[68:71], a[156:159], a[60:63], v[68:71]
    ds_read_b64_tr_b16 a[136:137], v106 offset:40960
    v_mfma_f32_16x16x32_bf16 v[68:71], a[152:155], a[52:55], v[68:71]
    ds_read_b64_tr_b16 a[138:139], v106 offset:45056
    v_mfma_f32_16x16x32_bf16 v[68:71], a[148:151], a[44:47], v[68:71]
    ds_read_b64_tr_b16 a[140:141], v106 offset:49152
    v_mfma_f32_16x16x32_bf16 v[68:71], a[144:147], a[36:39], v[68:71]
    ds_read_b64_tr_b16 a[142:143], v106 offset:53248
    buffer_load_dwordx4 v23, s[44:47], s30 offen offset:3072  lds
    s_waitcnt lgkmcnt(6)
    v_mfma_f32_16x16x32_bf16 v[76:79], a[160:163], a[36:39], v[76:79]
    ds_read_b64_tr_b16 a[144:145], v106 offset:57344
    s_add_u32 m0, s83, 102400
    v_mfma_f32_16x16x32_bf16 v[76:79], a[164:167], a[44:47], v[76:79]
    ds_read_b64_tr_b16 a[146:147], v106 offset:61440
    v_mfma_f32_16x16x32_bf16 v[76:79], a[168:171], a[52:55], v[76:79]
    ds_read_b64_tr_b16 a[148:149], v107 offset:32768
    v_mfma_f32_16x16x32_bf16 v[76:79], a[128:131], a[60:63], v[76:79]
    ds_read_b64_tr_b16 a[150:151], v107 offset:36864
    buffer_load_dwordx4 v24, s[44:47], s30 offen offset:0  lds
    v_mfma_f32_16x16x32_bf16 v[72:75], a[128:131], a[56:59], v[72:75]
    ds_read_b64_tr_b16 a[152:153], v107 offset:40960
    v_mfma_f32_16x16x32_bf16 v[72:75], a[168:171], a[48:51], v[72:75]
    ds_read_b64_tr_b16 a[154:155], v107 offset:45056
    buffer_load_dwordx4 v25, s[44:47], s30 offen offset:1024  lds
    v_mfma_f32_16x16x32_bf16 v[72:75], a[164:167], a[40:43], v[72:75]
    ds_read_b64_tr_b16 a[156:157], v107 offset:49152
    v_mfma_f32_16x16x32_bf16 v[72:75], a[160:163], a[32:35], v[72:75]
    ds_read_b64_tr_b16 a[158:159], v107 offset:53248
    s_waitcnt lgkmcnt(6)
    v_mfma_f32_16x16x32_bf16 v[80:83], a[132:135], a[32:35], v[80:83]
    ds_read_b64_tr_b16 a[160:161], v107 offset:57344
    v_mfma_f32_16x16x32_bf16 v[80:83], a[136:139], a[40:43], v[80:83]
    ds_read_b64_tr_b16 a[162:163], v107 offset:61440
    buffer_load_dwordx4 v26, s[44:47], s30 offen offset:2048  lds
    v_mfma_f32_16x16x32_bf16 v[80:83], a[140:143], a[48:51], v[80:83]
    s_waitcnt vmcnt(15)
    s_barrier
    ds_read_b64_tr_b16 a[164:165], v108 offset:0
    v_mfma_f32_16x16x32_bf16 v[80:83], a[144:147], a[56:59], v[80:83]
    ds_read_b64_tr_b16 a[166:167], v108 offset:4096
    v_mfma_f32_16x16x32_bf16 v[84:87], a[144:147], a[60:63], v[84:87]
    ds_read_b64_tr_b16 a[168:169], v108 offset:8192
    v_mfma_f32_16x16x32_bf16 v[84:87], a[140:143], a[52:55], v[84:87]
    ds_read_b64_tr_b16 a[170:171], v108 offset:12288
    buffer_load_dwordx4 v27, s[44:47], s30 offen offset:3072  lds
    v_mfma_f32_16x16x32_bf16 v[84:87], a[136:139], a[44:47], v[84:87]
    ds_read_b64_tr_b16 a[128:129], v108 offset:16384
    s_bfe_u32 s31, s66, 262156
    v_mfma_f32_16x16x32_bf16 v[84:87], a[132:135], a[36:39], v[84:87]
    ds_read_b64_tr_b16 a[130:131], v108 offset:20480
    v_accvgpr_read_b32 v28, a203
    buffer_load_dword v29, v28, s[8:11], s87 offen sc1
    s_lshl_b32 s31, s31, 13
    s_waitcnt lgkmcnt(6)
    v_mfma_f32_16x16x32_bf16 v[92:95], a[148:151], a[36:39], v[92:95]
    ds_read_b64_tr_b16 a[132:133], v108 offset:24576
    s_add_u32 s31, s31, s17
    v_mfma_f32_16x16x32_bf16 v[92:95], a[152:155], a[44:47], v[92:95]
    ds_read_b64_tr_b16 a[134:135], v108 offset:28672
    buffer_load_dwordx4 a[96:99], v1, s[8:11], s31 offen offset:0 sc1
    v_mfma_f32_16x16x32_bf16 v[92:95], a[156:159], a[52:55], v[92:95]
    ds_read_b64_tr_b16 a[136:137], v109 offset:0
    v_mfma_f32_16x16x32_bf16 v[92:95], a[160:163], a[60:63], v[92:95]
    ds_read_b64_tr_b16 a[138:139], v109 offset:4096
    v_mfma_f32_16x16x32_bf16 v[88:91], a[160:163], a[56:59], v[88:91]
    ds_read_b64_tr_b16 a[140:141], v109 offset:8192
    v_mfma_f32_16x16x32_bf16 v[88:91], a[156:159], a[48:51], v[88:91]
    ds_read_b64_tr_b16 a[142:143], v109 offset:12288
    buffer_load_dwordx4 a[100:103], v1, s[8:11], s31 offen offset:1024 sc1
    v_mfma_f32_16x16x32_bf16 v[88:91], a[152:155], a[40:43], v[88:91]
    ds_read_b64_tr_b16 a[144:145], v109 offset:16384
    v_mfma_f32_16x16x32_bf16 v[88:91], a[148:151], a[32:35], v[88:91]
    ds_read_b64_tr_b16 a[146:147], v109 offset:20480
    s_waitcnt vmcnt(11) lgkmcnt(6)
    v_mfma_f32_16x16x32_bf16 v[32:35], a[164:167], a[64:67], v[32:35]
    ds_read_b64_tr_b16 a[148:149], v109 offset:24576
    v_mfma_f32_16x16x32_bf16 v[32:35], a[168:171], a[72:75], v[32:35]
    ds_read_b64_tr_b16 a[150:151], v109 offset:28672
    buffer_load_dwordx4 a[104:107], v1, s[8:11], s31 offen offset:2048 sc1
    v_mfma_f32_16x16x32_bf16 v[32:35], a[128:131], a[80:83], v[32:35]
    ds_read_b64_tr_b16 a[152:153], v110 offset:0
    v_mfma_f32_16x16x32_bf16 v[32:35], a[132:135], a[88:91], v[32:35]
    ds_read_b64_tr_b16 a[154:155], v110 offset:4096
    v_mfma_f32_16x16x32_bf16 v[36:39], a[132:135], a[92:95], v[36:39]
    ds_read_b64_tr_b16 a[156:157], v110 offset:8192
    v_mfma_f32_16x16x32_bf16 v[36:39], a[128:131], a[84:87], v[36:39]
    ds_read_b64_tr_b16 a[158:159], v110 offset:12288
    buffer_load_dwordx4 a[108:111], v1, s[8:11], s31 offen offset:3072 sc1
    v_mfma_f32_16x16x32_bf16 v[36:39], a[168:171], a[76:79], v[36:39]
    ds_read_b64_tr_b16 a[160:161], v110 offset:16384
    v_mfma_f32_16x16x32_bf16 v[36:39], a[164:167], a[68:71], v[36:39]
    ds_read_b64_tr_b16 a[162:163], v110 offset:20480
    s_waitcnt lgkmcnt(6)
    v_mfma_f32_16x16x32_bf16 v[44:47], a[136:139], a[68:71], v[44:47]
    ds_read_b64_tr_b16 a[164:165], v110 offset:24576
    v_mfma_f32_16x16x32_bf16 v[44:47], a[140:143], a[76:79], v[44:47]
    ds_read_b64_tr_b16 a[166:167], v110 offset:28672
    buffer_load_dwordx4 a[112:115], v30, s[8:11], s31 offen offset:0 sc1
    v_mfma_f32_16x16x32_bf16 v[44:47], a[144:147], a[84:87], v[44:47]
    ds_read_b64_tr_b16 a[168:169], v111 offset:0
    v_mfma_f32_16x16x32_bf16 v[44:47], a[148:151], a[92:95], v[44:47]
    ds_read_b64_tr_b16 a[170:171], v111 offset:4096
    v_mfma_f32_16x16x32_bf16 v[40:43], a[148:151], a[88:91], v[40:43]
    ds_read_b64_tr_b16 a[128:129], v111 offset:8192
    v_mfma_f32_16x16x32_bf16 v[40:43], a[144:147], a[80:83], v[40:43]
    ds_read_b64_tr_b16 a[130:131], v111 offset:12288
    buffer_load_dwordx4 a[116:119], v30, s[8:11], s31 offen offset:1024 sc1
    v_mfma_f32_16x16x32_bf16 v[40:43], a[140:143], a[72:75], v[40:43]
    ds_read_b64_tr_b16 a[132:133], v111 offset:16384
    v_mfma_f32_16x16x32_bf16 v[40:43], a[136:139], a[64:67], v[40:43]
    ds_read_b64_tr_b16 a[134:135], v111 offset:20480
    s_waitcnt lgkmcnt(6)
    v_mfma_f32_16x16x32_bf16 v[48:51], a[152:155], a[64:67], v[48:51]
    ds_read_b64_tr_b16 a[136:137], v111 offset:24576
    v_mfma_f32_16x16x32_bf16 v[48:51], a[156:159], a[72:75], v[48:51]
    ds_read_b64_tr_b16 a[138:139], v111 offset:28672
    buffer_load_dwordx4 a[120:123], v30, s[8:11], s31 offen offset:2048 sc1
    v_mfma_f32_16x16x32_bf16 v[48:51], a[160:163], a[80:83], v[48:51]
    ds_read_b64_tr_b16 a[140:141], v112 offset:0
    v_mfma_f32_16x16x32_bf16 v[48:51], a[164:167], a[88:91], v[48:51]
    ds_read_b64_tr_b16 a[142:143], v112 offset:4096
    buffer_load_dwordx4 a[124:127], v30, s[8:11], s31 offen offset:3072 sc1
    v_mfma_f32_16x16x32_bf16 v[52:55], a[164:167], a[92:95], v[52:55]
    ds_read_b64_tr_b16 a[144:145], v112 offset:8192
    v_accvgpr_read_b32 v31, a201
    v_mfma_f32_16x16x32_bf16 v[52:55], a[160:163], a[84:87], v[52:55]
    ds_read_b64_tr_b16 a[146:147], v112 offset:12288
    v_mfma_f32_16x16x32_bf16 v[52:55], a[156:159], a[76:79], v[52:55]
    ds_read_b64_tr_b16 a[148:149], v112 offset:16384
    v_mfma_f32_16x16x32_bf16 v[52:55], a[152:155], a[68:71], v[52:55]
    ds_read_b64_tr_b16 a[150:151], v112 offset:20480
    global_load_dword a200, v31, s[74:75]
    s_waitcnt lgkmcnt(6)
    v_mfma_f32_16x16x32_bf16 v[60:63], a[168:171], a[68:71], v[60:63]
    ds_read_b64_tr_b16 a[152:153], v112 offset:24576
    s_add_u32 m0, s83, 0
    v_mfma_f32_16x16x32_bf16 v[60:63], a[128:131], a[76:79], v[60:63]
    ds_read_b64_tr_b16 a[154:155], v112 offset:28672
    s_bfe_u32 s30, s69, 524288
    v_mfma_f32_16x16x32_bf16 v[60:63], a[132:135], a[84:87], v[60:63]
    ds_read_b64_tr_b16 a[156:157], v113 offset:0
    s_lshl_b32 s30, s30, 16
    v_mfma_f32_16x16x32_bf16 v[60:63], a[136:139], a[92:95], v[60:63]
    ds_read_b64_tr_b16 a[158:159], v113 offset:4096
    buffer_load_dwordx4 v20, s[44:47], s30 offen offset:0  lds
    v_mfma_f32_16x16x32_bf16 v[56:59], a[136:139], a[88:91], v[56:59]
    ds_read_b64_tr_b16 a[160:161], v113 offset:8192
    v_mfma_f32_16x16x32_bf16 v[56:59], a[132:135], a[80:83], v[56:59]
    ds_read_b64_tr_b16 a[162:163], v113 offset:12288
    v_mfma_f32_16x16x32_bf16 v[56:59], a[128:131], a[72:75], v[56:59]
    ds_read_b64_tr_b16 a[164:165], v113 offset:16384
    v_mfma_f32_16x16x32_bf16 v[56:59], a[168:171], a[64:67], v[56:59]
    ds_read_b64_tr_b16 a[166:167], v113 offset:20480
    buffer_load_dwordx4 v21, s[44:47], s30 offen offset:1024  lds
    s_waitcnt lgkmcnt(6)
    v_mfma_f32_16x16x32_bf16 v[64:67], a[140:143], a[64:67], v[64:67]
    ds_read_b64_tr_b16 a[168:169], v113 offset:24576
    v_mfma_f32_16x16x32_bf16 v[64:67], a[144:147], a[72:75], v[64:67]
    ds_read_b64_tr_b16 a[170:171], v113 offset:28672
    v_mfma_f32_16x16x32_bf16 v[64:67], a[148:151], a[80:83], v[64:67]
    ds_read_b64_tr_b16 a[128:129], v114 offset:0
    v_mfma_f32_16x16x32_bf16 v[64:67], a[152:155], a[88:91], v[64:67]
    ds_read_b64_tr_b16 a[130:131], v114 offset:4096
    buffer_load_dwordx4 v22, s[44:47], s30 offen offset:2048  lds
    v_mfma_f32_16x16x32_bf16 v[68:71], a[152:155], a[92:95], v[68:71]
    ds_read_b64_tr_b16 a[132:133], v114 offset:8192
    v_mfma_f32_16x16x32_bf16 v[68:71], a[148:151], a[84:87], v[68:71]
    ds_read_b64_tr_b16 a[134:135], v114 offset:12288
    v_mfma_f32_16x16x32_bf16 v[68:71], a[144:147], a[76:79], v[68:71]
    ds_read_b64_tr_b16 a[136:137], v114 offset:16384
    v_mfma_f32_16x16x32_bf16 v[68:71], a[140:143], a[68:71], v[68:71]
    ds_read_b64_tr_b16 a[138:139], v114 offset:20480
    buffer_load_dwordx4 v23, s[44:47], s30 offen offset:3072  lds
    s_waitcnt lgkmcnt(6)
    v_mfma_f32_16x16x32_bf16 v[76:79], a[156:159], a[68:71], v[76:79]
    ds_read_b64_tr_b16 a[140:141], v114 offset:24576
    s_add_u32 m0, s83, 4096
    v_mfma_f32_16x16x32_bf16 v[76:79], a[160:163], a[76:79], v[76:79]
    ds_read_b64_tr_b16 a[142:143], v114 offset:28672
    v_mfma_f32_16x16x32_bf16 v[76:79], a[164:167], a[84:87], v[76:79]
    ds_read_b64_tr_b16 a[144:145], v115 offset:0
    v_mfma_f32_16x16x32_bf16 v[76:79], a[168:171], a[92:95], v[76:79]
    ds_read_b64_tr_b16 a[146:147], v115 offset:4096
    buffer_load_dwordx4 v24, s[44:47], s30 offen offset:0  lds
    v_mfma_f32_16x16x32_bf16 v[72:75], a[168:171], a[88:91], v[72:75]
    ds_read_b64_tr_b16 a[148:149], v115 offset:8192
    v_mfma_f32_16x16x32_bf16 v[72:75], a[164:167], a[80:83], v[72:75]
    ds_read_b64_tr_b16 a[150:151], v115 offset:12288
    buffer_load_dwordx4 v25, s[44:47], s30 offen offset:1024  lds
    v_mfma_f32_16x16x32_bf16 v[72:75], a[160:163], a[72:75], v[72:75]
    ds_read_b64_tr_b16 a[152:153], v115 offset:16384
    v_mfma_f32_16x16x32_bf16 v[72:75], a[156:159], a[64:67], v[72:75]
    ds_read_b64_tr_b16 a[154:155], v115 offset:20480
    s_waitcnt lgkmcnt(6)
    v_mfma_f32_16x16x32_bf16 v[80:83], a[128:131], a[64:67], v[80:83]
    ds_read_b64_tr_b16 a[156:157], v115 offset:24576
    v_mfma_f32_16x16x32_bf16 v[80:83], a[132:135], a[72:75], v[80:83]
    ds_read_b64_tr_b16 a[158:159], v115 offset:28672
    buffer_load_dwordx4 v26, s[44:47], s30 offen offset:2048  lds
    v_mfma_f32_16x16x32_bf16 v[80:83], a[136:139], a[80:83], v[80:83]
    s_waitcnt vmcnt(17)
    s_waitcnt vmcnt(16)
    s_cmp_eq_u32 s4, 0
    s_cselect_b32 s19, s86, 0
    v_cmp_le_u32 vcc, s19, v29
    s_cmp_eq_u64 vcc, -1
    s_cbranch_scc0 L_slow_30
L_back_31:
    s_barrier
    ds_read_b64_tr_b16 a[160:161], v108 offset:32768
    v_mfma_f32_16x16x32_bf16 v[80:83], a[140:143], a[88:91], v[80:83]
    ds_read_b64_tr_b16 a[162:163], v108 offset:36864
    v_mfma_f32_16x16x32_bf16 v[84:87], a[140:143], a[92:95], v[84:87]
    ds_read_b64_tr_b16 a[164:165], v108 offset:40960
    v_mfma_f32_16x16x32_bf16 v[84:87], a[136:139], a[84:87], v[84:87]
    ds_read_b64_tr_b16 a[166:167], v108 offset:45056
    buffer_load_dwordx4 v27, s[44:47], s30 offen offset:3072  lds
    v_mfma_f32_16x16x32_bf16 v[84:87], a[132:135], a[76:79], v[84:87]
    ds_read_b64_tr_b16 a[168:169], v108 offset:49152
    s_add_u32 m0, s83, 32768
    v_mfma_f32_16x16x32_bf16 v[84:87], a[128:131], a[68:71], v[84:87]
    ds_read_b64_tr_b16 a[170:171], v108 offset:53248
    s_bfe_u32 s30, s69, 524296
    s_waitcnt lgkmcnt(6)
    v_mfma_f32_16x16x32_bf16 v[92:95], a[144:147], a[68:71], v[92:95]
    ds_read_b64_tr_b16 a[128:129], v108 offset:57344
    s_bfe_u32 s31, s66, 262160
    v_mfma_f32_16x16x32_bf16 v[92:95], a[148:151], a[76:79], v[92:95]
    ds_read_b64_tr_b16 a[130:131], v108 offset:61440
    s_lshl_b32 s31, s31, 13
    s_add_u32 s31, s31, s17
    v_mfma_f32_16x16x32_bf16 v[92:95], a[152:155], a[84:87], v[92:95]
    ds_read_b64_tr_b16 a[132:133], v109 offset:32768
    v_mfma_f32_16x16x32_bf16 v[92:95], a[156:159], a[92:95], v[92:95]
    ds_read_b64_tr_b16 a[134:135], v109 offset:36864
    buffer_load_dwordx4 a[0:3], v1, s[8:11], s31 offen offset:0 sc1
    v_mfma_f32_16x16x32_bf16 v[88:91], a[156:159], a[88:91], v[88:91]
    ds_read_b64_tr_b16 a[136:137], v109 offset:40960
    v_mfma_f32_16x16x32_bf16 v[88:91], a[152:155], a[80:83], v[88:91]
    ds_read_b64_tr_b16 a[138:139], v109 offset:45056
    buffer_load_dwordx4 a[4:7], v1, s[8:11], s31 offen offset:1024 sc1
    v_mfma_f32_16x16x32_bf16 v[88:91], a[148:151], a[72:75], v[88:91]
    ds_read_b64_tr_b16 a[140:141], v109 offset:49152
    v_mfma_f32_16x16x32_bf16 v[88:91], a[144:147], a[64:67], v[88:91]
    ds_read_b64_tr_b16 a[142:143], v109 offset:53248
    s_waitcnt vmcnt(11) lgkmcnt(6)
    v_mfma_f32_16x16x32_bf16 v[32:35], a[160:163], a[96:99], v[32:35]
    ds_read_b64_tr_b16 a[144:145], v109 offset:57344
    v_mfma_f32_16x16x32_bf16 v[32:35], a[164:167], a[104:107], v[32:35]
    ds_read_b64_tr_b16 a[146:147], v109 offset:61440
    buffer_load_dwordx4 a[8:11], v1, s[8:11], s31 offen offset:2048 sc1
    v_mfma_f32_16x16x32_bf16 v[32:35], a[168:171], a[112:115], v[32:35]
    ds_read_b64_tr_b16 a[148:149], v110 offset:32768
    v_mfma_f32_16x16x32_bf16 v[32:35], a[128:131], a[120:123], v[32:35]
    ds_read_b64_tr_b16 a[150:151], v110 offset:36864
    v_mfma_f32_16x16x32_bf16 v[36:39], a[128:131], a[124:127], v[36:39]
    ds_read_b64_tr_b16 a[152:153], v110 offset:40960
    v_mfma_f32_16x16x32_bf16 v[36:39], a[168:171], a[116:119], v[36:39]
    ds_read_b64_tr_b16 a[154:155], v110 offset:45056
    buffer_load_dwordx4 a[12:15], v1, s[8:11], s31 offen offset:3072 sc1
    v_mfma_f32_16x16x32_bf16 v[36:39], a[164:167], a[108:111], v[36:39]
    ds_read_b64_tr_b16 a[156:157], v110 offset:49152
    v_mfma_f32_16x16x32_bf16 v[36:39], a[160:163], a[100:103], v[36:39]
    ds_read_b64_tr_b16 a[158:159], v110 offset:53248
    s_waitcnt lgkmcnt(6)
    v_mfma_f32_16x16x32_bf16 v[44:47], a[132:135], a[100:103], v[44:47]
    ds_read_b64_tr_b16 a[160:161], v110 offset:57344
    v_mfma_f32_16x16x32_bf16 v[44:47], a[136:139], a[108:111], v[44:47]
    ds_read_b64_tr_b16 a[162:163], v110 offset:61440
    buffer_load_dwordx4 a[16:19], v30, s[8:11], s31 offen offset:0 sc1
    v_mfma_f32_16x16x32_bf16 v[44:47], a[140:143], a[116:119], v[44:47]
    ds_read_b64_tr_b16 a[164:165], v111 offset:32768
    v_mfma_f32_16x16x32_bf16 v[44:47], a[144:147], a[124:127], v[44:47]
    ds_read_b64_tr_b16 a[166:167], v111 offset:36864
    v_mfma_f32_16x16x32_bf16 v[40:43], a[144:147], a[120:123], v[40:43]
    ds_read_b64_tr_b16 a[168:169], v111 offset:40960
    v_mfma_f32_16x16x32_bf16 v[40:43], a[140:143], a[112:115], v[40:43]
    ds_read_b64_tr_b16 a[170:171], v111 offset:45056
    buffer_load_dwordx4 a[20:23], v30, s[8:11], s31 offen offset:1024 sc1
    v_mfma_f32_16x16x32_bf16 v[40:43], a[136:139], a[104:107], v[40:43]
    ds_read_b64_tr_b16 a[128:129], v111 offset:49152
    v_mfma_f32_16x16x32_bf16 v[40:43], a[132:135], a[96:99], v[40:43]
    ds_read_b64_tr_b16 a[130:131], v111 offset:53248
    s_waitcnt lgkmcnt(6)
    v_mfma_f32_16x16x32_bf16 v[48:51], a[148:151], a[96:99], v[48:51]
    ds_read_b64_tr_b16 a[132:133], v111 offset:57344
    v_mfma_f32_16x16x32_bf16 v[48:51], a[152:155], a[104:107], v[48:51]
    ds_read_b64_tr_b16 a[134:135], v111 offset:61440
    buffer_load_dwordx4 a[24:27], v30, s[8:11], s31 offen offset:2048 sc1
    v_mfma_f32_16x16x32_bf16 v[48:51], a[156:159], a[112:115], v[48:51]
    ds_read_b64_tr_b16 a[136:137], v112 offset:32768
    v_mfma_f32_16x16x32_bf16 v[48:51], a[160:163], a[120:123], v[48:51]
    ds_read_b64_tr_b16 a[138:139], v112 offset:36864
    buffer_load_dwordx4 a[28:31], v30, s[8:11], s31 offen offset:3072 sc1
    v_mfma_f32_16x16x32_bf16 v[52:55], a[160:163], a[124:127], v[52:55]
    ds_read_b64_tr_b16 a[140:141], v112 offset:40960
    s_lshl_b32 s30, s30, 16
    v_mfma_f32_16x16x32_bf16 v[52:55], a[156:159], a[116:119], v[52:55]
    ds_read_b64_tr_b16 a[142:143], v112 offset:45056
    v_mfma_f32_16x16x32_bf16 v[52:55], a[152:155], a[108:111], v[52:55]
    ds_read_b64_tr_b16 a[144:145], v112 offset:49152
    v_mfma_f32_16x16x32_bf16 v[52:55], a[148:151], a[100:103], v[52:55]
    ds_read_b64_tr_b16 a[146:147], v112 offset:53248
    buffer_load_dwordx4 v20, s[44:47], s30 offen offset:0  lds
    s_waitcnt lgkmcnt(6)
    v_mfma_f32_16x16x32_bf16 v[60:63], a[164:167], a[100:103], v[60:63]
    ds_read_b64_tr_b16 a[148:149], v112 offset:57344
    v_mfma_f32_16x16x32_bf16 v[60:63], a[168:171], a[108:111], v[60:63]
    ds_read_b64_tr_b16 a[150:151], v112 offset:61440
    v_mfma_f32_16x16x32_bf16 v[60:63], a[128:131], a[116:119], v[60:63]
    ds_read_b64_tr_b16 a[152:153], v113 offset:32768
    v_mfma_f32_16x16x32_bf16 v[60:63], a[132:135], a[124:127], v[60:63]
    ds_read_b64_tr_b16 a[154:155], v113 offset:36864
    buffer_load_dwordx4 v21, s[44:47], s30 offen offset:1024  lds
    v_mfma_f32_16x16x32_bf16 v[56:59], a[132:135], a[120:123], v[56:59]
    ds_read_b64_tr_b16 a[156:157], v113 offset:40960
    v_mfma_f32_16x16x32_bf16 v[56:59], a[128:131], a[112:115], v[56:59]
    ds_read_b64_tr_b16 a[158:159], v113 offset:45056
    v_mfma_f32_16x16x32_bf16 v[56:59], a[168:171], a[104:107], v[56:59]
    ds_read_b64_tr_b16 a[160:161], v113 offset:49152
    v_mfma_f32_16x16x32_bf16 v[56:59], a[164:167], a[96:99], v[56:59]
    ds_read_b64_tr_b16 a[162:163], v113 offset:53248
    buffer_load_dwordx4 v22, s[44:47], s30 offen offset:2048  lds
    s_waitcnt lgkmcnt(6)
    v_mfma_f32_16x16x32_bf16 v[64:67], a[136:139], a[96:99], v[64:67]
    ds_read_b64_tr_b16 a[164:165], v113 offset:57344
    v_mfma_f32_16x16x32_bf16 v[64:67], a[140:143], a[104:107], v[64:67]
    ds_read_b64_tr_b16 a[166:167], v113 offset:61440
    v_mfma_f32_16x16x32_bf16 v[64:67], a[144:147], a[112:115], v[64:67]
    ds_read_b64_tr_b16 a[168:169], v114 offset:32768
    v_mfma_f32_16x16x32_bf16 v[64:67], a[148:151], a[120:123], v[64:67]
    ds_read_b64_tr_b16 a[170:171], v114 offset:36864
    buffer_load_dwordx4 v23, s[44:47], s30 offen offset:3072  lds
    v_mfma_f32_16x16x32_bf16 v[68:71], a[148:151], a[124:127], v[68:71]
    ds_read_b64_tr_b16 a[128:129], v114 offset:40960
    s_add_u32 m0, s83, 36864
    v_mfma_f32_16x16x32_bf16 v[68:71], a[144:147], a[116:119], v[68:71]
    ds_read_b64_tr_b16 a[130:131], v114 offset:45056
    v_mfma_f32_16x16x32_bf16 v[68:71], a[140:143], a[108:111], v[68:71]
    ds_read_b64_tr_b16 a[132:133], v114 offset:49152
    v_mfma_f32_16x16x32_bf16 v[68:71], a[136:139], a[100:103], v[68:71]
    ds_read_b64_tr_b16 a[134:135], v114 offset:53248
    buffer_load_dwordx4 v24, s[44:47], s30 offen offset:0  lds
    s_waitcnt lgkmcnt(6)
    v_mfma_f32_16x16x32_bf16 v[76:79], a[152:155], a[100:103], v[76:79]
    ds_read_b64_tr_b16 a[136:137], v114 offset:57344
    v_mfma_f32_16x16x32_bf16 v[76:79], a[156:159], a[108:111], v[76:79]
    ds_read_b64_tr_b16 a[138:139], v114 offset:61440
    v_mfma_f32_16x16x32_bf16 v[76:79], a[160:163], a[116:119], v[76:79]
    ds_read_b64_tr_b16 a[140:141], v115 offset:32768
    v_mfma_f32_16x16x32_bf16 v[76:79], a[164:167], a[124:127], v[76:79]
    ds_read_b64_tr_b16 a[142:143], v115 offset:36864
    buffer_load_dwordx4 v25, s[44:47], s30 offen offset:1024  lds
    v_mfma_f32_16x16x32_bf16 v[72:75], a[164:167], a[120:123], v[72:75]
    ds_read_b64_tr_b16 a[144:145], v115 offset:40960
    v_mfma_f32_16x16x32_bf16 v[72:75], a[160:163], a[112:115], v[72:75]
    ds_read_b64_tr_b16 a[146:147], v115 offset:45056
    buffer_load_dwordx4 v26, s[44:47], s30 offen offset:2048  lds
    v_mfma_f32_16x16x32_bf16 v[72:75], a[156:159], a[104:107], v[72:75]
    ds_read_b64_tr_b16 a[148:149], v115 offset:49152
    v_mfma_f32_16x16x32_bf16 v[72:75], a[152:155], a[96:99], v[72:75]
    ds_read_b64_tr_b16 a[150:151], v115 offset:53248
    s_waitcnt lgkmcnt(6)
    v_mfma_f32_16x16x32_bf16 v[80:83], a[168:171], a[96:99], v[80:83]
    ds_read_b64_tr_b16 a[152:153], v115 offset:57344
    v_mfma_f32_16x16x32_bf16 v[80:83], a[128:131], a[104:107], v[80:83]
    ds_read_b64_tr_b16 a[154:155], v115 offset:61440
    buffer_load_dwordx4 v27, s[44:47], s30 offen offset:3072  lds
    v_mfma_f32_16x16x32_bf16 v[80:83], a[132:135], a[112:115], v[80:83]
    s_waitcnt vmcnt(16)
    s_barrier
    ds_read_b64_tr_b16 a[156:157], v100 offset:0
    s_bfe_u32 s31, s66, 262164
    v_mfma_f32_16x16x32_bf16 v[80:83], a[136:139], a[120:123], v[80:83]
    ds_read_b64_tr_b16 a[158:159], v100 offset:4096
    s_lshl_b32 s31, s31, 13
    v_mfma_f32_16x16x32_bf16 v[84:87], a[136:139], a[124:127], v[84:87]
    ds_read_b64_tr_b16 a[160:161], v100 offset:8192
    s_add_u32 s31, s31, s17
    v_mfma_f32_16x16x32_bf16 v[84:87], a[132:135], a[116:119], v[84:87]
    ds_read_b64_tr_b16 a[162:163], v100 offset:12288
    buffer_load_dwordx4 a[32:35], v1, s[8:11], s31 offen offset:0 sc1
    v_mfma_f32_16x16x32_bf16 v[84:87], a[128:131], a[108:111], v[84:87]
    ds_read_b64_tr_b16 a[164:165], v100 offset:16384
    v_mfma_f32_16x16x32_bf16 v[84:87], a[168:171], a[100:103], v[84:87]
    ds_read_b64_tr_b16 a[166:167], v100 offset:20480
    s_waitcnt lgkmcnt(6)
    v_mfma_f32_16x16x32_bf16 v[92:95], a[140:143], a[100:103], v[92:95]
    ds_read_b64_tr_b16 a[168:169], v100 offset:24576
    v_mfma_f32_16x16x32_bf16 v[92:95], a[144:147], a[108:111], v[92:95]
    ds_read_b64_tr_b16 a[170:171], v100 offset:28672
    buffer_load_dwordx4 a[36:39], v1, s[8:11], s31 offen offset:1024 sc1
    v_mfma_f32_16x16x32_bf16 v[92:95], a[148:151], a[116:119], v[92:95]
    ds_read_b64_tr_b16 a[128:129], v101 offset:0
    v_mfma_f32_16x16x32_bf16 v[92:95], a[152:155], a[124:127], v[92:95]
    ds_read_b64_tr_b16 a[130:131], v101 offset:4096
    v_mfma_f32_16x16x32_bf16 v[88:91], a[152:155], a[120:123], v[88:91]
    ds_read_b64_tr_b16 a[132:133], v101 offset:8192
    v_mfma_f32_16x16x32_bf16 v[88:91], a[148:151], a[112:115], v[88:91]
    ds_read_b64_tr_b16 a[134:135], v101 offset:12288
    buffer_load_dwordx4 a[40:43], v1, s[8:11], s31 offen offset:2048 sc1
    v_mfma_f32_16x16x32_bf16 v[88:91], a[144:147], a[104:107], v[88:91]
    ds_read_b64_tr_b16 a[136:137], v101 offset:16384
    v_mfma_f32_16x16x32_bf16 v[88:91], a[140:143], a[96:99], v[88:91]
    ds_read_b64_tr_b16 a[138:139], v101 offset:20480
    s_waitcnt vmcnt(11) lgkmcnt(6)
    v_mfma_f32_16x16x32_bf16 v[32:35], a[156:159], a[0:3], v[32:35]
    ds_read_b64_tr_b16 a[140:141], v101 offset:24576
    v_mfma_f32_16x16x32_bf16 v[32:35], a[160:163], a[8:11], v[32:35]
    ds_read_b64_tr_b16 a[142:143], v101 offset:28672
    buffer_load_dwordx4 a[44:47], v1, s[8:11], s31 offen offset:3072 sc1
    v_mfma_f32_16x16x32_bf16 v[32:35], a[164:167], a[16:19], v[32:35]
    ds_read_b64_tr_b16 a[144:145], v102 offset:0
    v_mfma_f32_16x16x32_bf16 v[32:35], a[168:171], a[24:27], v[32:35]
    ds_read_b64_tr_b16 a[146:147], v102 offset:4096
    v_mfma_f32_16x16x32_bf16 v[36:39], a[168:171], a[28:31], v[36:39]
    ds_read_b64_tr_b16 a[148:149], v102 offset:8192
    v_mfma_f32_16x16x32_bf16 v[36:39], a[164:167], a[20:23], v[36:39]
    ds_read_b64_tr_b16 a[150:151], v102 offset:12288
    buffer_load_dwordx4 a[48:51], v30, s[8:11], s31 offen offset:0 sc1
    v_mfma_f32_16x16x32_bf16 v[36:39], a[160:163], a[12:15], v[36:39]
    ds_read_b64_tr_b16 a[152:153], v102 offset:16384
    v_mfma_f32_16x16x32_bf16 v[36:39], a[156:159], a[4:7], v[36:39]
    ds_read_b64_tr_b16 a[154:155], v102 offset:20480
    buffer_load_dwordx4 a[52:55], v30, s[8:11], s31 offen offset:1024 sc1
    s_waitcnt lgkmcnt(6)
    v_mfma_f32_16x16x32_bf16 v[44:47], a[128:131], a[4:7], v[44:47]
    ds_read_b64_tr_b16 a[156:157], v102 offset:24576
    v_mfma_f32_16x16x32_bf16 v[44:47], a[132:135], a[12:15], v[44:47]
    ds_read_b64_tr_b16 a[158:159], v102 offset:28672
    v_mfma_f32_16x16x32_bf16 v[44:47], a[136:139], a[20:23], v[44:47]
    ds_read_b64_tr_b16 a[160:161], v103 offset:0
    v_mfma_f32_16x16x32_bf16 v[44:47], a[140:143], a[28:31], v[44:47]
    ds_read_b64_tr_b16 a[162:163], v103 offset:4096
    buffer_load_dwordx4 a[56:59], v30, s[8:11], s31 offen offset:2048 sc1
    v_mfma_f32_16x16x32_bf16 v[40:43], a[140:143], a[24:27], v[40:43]
    ds_read_b64_tr_b16 a[164:165], v103 offset:8192
    v_mfma_f32_16x16x32_bf16 v[40:43], a[136:139], a[16:19], v[40:43]
    ds_read_b64_tr_b16 a[166:167], v103 offset:12288
    v_mfma_f32_16x16x32_bf16 v[40:43], a[132:135], a[8:11], v[40:43]
    ds_read_b64_tr_b16 a[168:169], v103 offset:16384
    v_mfma_f32_16x16x32_bf16 v[40:43], a[128:131], a[0:3], v[40:43]
    ds_read_b64_tr_b16 a[170:171], v103 offset:20480
    buffer_load_dwordx4 a[60:63], v30, s[8:11], s31 offen offset:3072 sc1
    s_waitcnt lgkmcnt(6)
    v_mfma_f32_16x16x32_bf16 v[48:51], a[144:147], a[0:3], v[48:51]
    ds_read_b64_tr_b16 a[128:129], v103 offset:24576
    s_add_u32 m0, s83, 65536
    v_mfma_f32_16x16x32_bf16 v[48:51], a[148:151], a[8:11], v[48:51]
    ds_read_b64_tr_b16 a[130:131], v103 offset:28672
    s_bfe_u32 s30, s69, 524304
    v_mfma_f32_16x16x32_bf16 v[48:51], a[152:155], a[16:19], v[48:51]
    ds_read_b64_tr_b16 a[132:133], v104 offset:0
    s_lshl_b32 s30, s30, 16
    v_mfma_f32_16x16x32_bf16 v[48:51], a[156:159], a[24:27], v[48:51]
    ds_read_b64_tr_b16 a[134:135], v104 offset:4096
    buffer_load_dwordx4 v20, s[44:47], s30 offen offset:0  lds
    v_mfma_f32_16x16x32_bf16 v[52:55], a[156:159], a[28:31], v[52:55]
    ds_read_b64_tr_b16 a[136:137], v104 offset:8192
    v_mfma_f32_16x16x32_bf16 v[52:55], a[152:155], a[20:23], v[52:55]
    ds_read_b64_tr_b16 a[138:139], v104 offset:12288
    v_mfma_f32_16x16x32_bf16 v[52:55], a[148:151], a[12:15], v[52:55]
    ds_read_b64_tr_b16 a[140:141], v104 offset:16384
    v_mfma_f32_16x16x32_bf16 v[52:55], a[144:147], a[4:7], v[52:55]
    ds_read_b64_tr_b16 a[142:143], v104 offset:20480
    buffer_load_dwordx4 v21, s[44:47], s30 offen offset:1024  lds
    s_waitcnt lgkmcnt(6)
    v_mfma_f32_16x16x32_bf16 v[60:63], a[160:163], a[4:7], v[60:63]
    ds_read_b64_tr_b16 a[144:145], v104 offset:24576
    v_mfma_f32_16x16x32_bf16 v[60:63], a[164:167], a[12:15], v[60:63]
    ds_read_b64_tr_b16 a[146:147], v104 offset:28672
    v_mfma_f32_16x16x32_bf16 v[60:63], a[168:171], a[20:23], v[60:63]
    ds_read_b64_tr_b16 a[148:149], v105 offset:0
    v_mfma_f32_16x16x32_bf16 v[60:63], a[128:131], a[28:31], v[60:63]
    ds_read_b64_tr_b16 a[150:151], v105 offset:4096
    buffer_load_dwordx4 v22, s[44:47], s30 offen offset:2048  lds
    v_mfma_f32_16x16x32_bf16 v[56:59], a[128:131], a[24:27], v[56:59]
    ds_read_b64_tr_b16 a[152:153], v105 offset:8192
    v_mfma_f32_16x16x32_bf16 v[56:59], a[168:171], a[16:19], v[56:59]
    ds_read_b64_tr_b16 a[154:155], v105 offset:12288
    buffer_load_dwordx4 v23, s[44:47], s30 offen offset:3072  lds
    v_mfma_f32_16x16x32_bf16 v[56:59], a[164:167], a[8:11], v[56:59]
    ds_read_b64_tr_b16 a[156:157], v105 offset:16384
    s_add_u32 m0, s83, 69632
    v_mfma_f32_16x16x32_bf16 v[56:59], a[160:163], a[0:3], v[56:59]
    ds_read_b64_tr_b16 a[158:159], v105 offset:20480
    s_waitcnt lgkmcnt(6)
    v_mfma_f32_16x16x32_bf16 v[64:67], a[132:135], a[0:3], v[64:67]
    ds_read_b64_tr_b16 a[160:161], v105 offset:24576
    v_mfma_f32_16x16x32_bf16 v[64:67], a[136:139], a[8:11], v[64:67]
    ds_read_b64_tr_b16 a[162:163], v105 offset:28672
    buffer_load_dwordx4 v24, s[44:47], s30 offen offset:0  lds
    v_mfma_f32_16x16x32_bf16 v[64:67], a[140:143], a[16:19], v[64:67]
    ds_read_b64_tr_b16 a[164:165], v106 offset:0
    v_mfma_f32_16x16x32_bf16 v[64:67], a[144:147], a[24:27], v[64:67]
    ds_read_b64_tr_b16 a[166:167], v106 offset:4096
    v_mfma_f32_16x16x32_bf16 v[68:71], a[144:147], a[28:31], v[68:71]
    ds_read_b64_tr_b16 a[168:169], v106 offset:8192
    v_mfma_f32_16x16x32_bf16 v[68:71], a[140:143], a[20:23], v[68:71]
    ds_read_b64_tr_b16 a[170:171], v106 offset:12288
    buffer_load_dwordx4 v25, s[44:47], s30 offen offset:1024  lds
    v_mfma_f32_16x16x32_bf16 v[68:71], a[136:139], a[12:15], v[68:71]
    ds_read_b64_tr_b16 a[128:129], v106 offset:16384
    v_mfma_f32_16x16x32_bf16 v[68:71], a[132:135], a[4:7], v[68:71]
    ds_read_b64_tr_b16 a[130:131], v106 offset:20480
    s_waitcnt lgkmcnt(6)
    v_mfma_f32_16x16x32_bf16 v[76:79], a[148:151], a[4:7], v[76:79]
    ds_read_b64_tr_b16 a[132:133], v106 offset:24576
    v_mfma_f32_16x16x32_bf16 v[76:79], a[152:155], a[12:15], v[76:79]
    ds_read_b64_tr_b16 a[134:135], v106 offset:28672
    buffer_load_dwordx4 v26, s[44:47], s30 offen offset:2048  lds
    v_mfma_f32_16x16x32_bf16 v[76:79], a[156:159], a[20:23], v[76:79]
    ds_read_b64_tr_b16 a[136:137], v107 offset:0
    v_mfma_f32_16x16x32_bf16 v[76:79], a[160:163], a[28:31], v[76:79]
    ds_read_b64_tr_b16 a[138:139], v107 offset:4096
    v_mfma_f32_16x16x32_bf16 v[72:75], a[160:163], a[24:27], v[72:75]
    ds_read_b64_tr_b16 a[140:141], v107 offset:8192
    v_mfma_f32_16x16x32_bf16 v[72:75], a[156:159], a[16:19], v[72:75]
    ds_read_b64_tr_b16 a[142:143], v107 offset:12288
    buffer_load_dwordx4 v27, s[44:47], s30 offen offset:3072  lds
    v_mfma_f32_16x16x32_bf16 v[72:75], a[152:155], a[8:11], v[72:75]
    ds_read_b64_tr_b16 a[144:145], v107 offset:16384
    s_bfe_u32 s31, s66, 262168
    v_mfma_f32_16x16x32_bf16 v[72:75], a[148:151], a[0:3], v[72:75]
    ds_read_b64_tr_b16 a[146:147], v107 offset:20480
    s_lshl_b32 s31, s31, 13
    s_waitcnt lgkmcnt(6)
    v_mfma_f32_16x16x32_bf16 v[80:83], a[164:167], a[0:3], v[80:83]
    ds_read_b64_tr_b16 a[148:149], v107 offset:24576
    s_add_u32 s31, s31, s17
    v_mfma_f32_16x16x32_bf16 v[80:83], a[168:171], a[8:11], v[80:83]
    ds_read_b64_tr_b16 a[150:151], v107 offset:28672
    buffer_load_dwordx4 a[64:67], v1, s[8:11], s31 offen offset:0 sc1
    v_mfma_f32_16x16x32_bf16 v[80:83], a[128:131], a[16:19], v[80:83]
    s_waitcnt vmcnt(17)
    s_barrier
    ds_read_b64_tr_b16 a[152:153], v100 offset:32768
    v_mfma_f32_16x16x32_bf16 v[80:83], a[132:135], a[24:27], v[80:83]
    ds_read_b64_tr_b16 a[154:155], v100 offset:36864
    v_mfma_f32_16x16x32_bf16 v[84:87], a[132:135], a[28:31], v[84:87]
    ds_read_b64_tr_b16 a[156:157], v100 offset:40960
    v_mfma_f32_16x16x32_bf16 v[84:87], a[128:131], a[20:23], v[84:87]
    ds_read_b64_tr_b16 a[158:159], v100 offset:45056
    buffer_load_dwordx4 a[68:71], v1, s[8:11], s31 offen offset:1024 sc1
    v_mfma_f32_16x16x32_bf16 v[84:87], a[168:171], a[12:15], v[84:87]
    ds_read_b64_tr_b16 a[160:161], v100 offset:49152
    v_mfma_f32_16x16x32_bf16 v[84:87], a[164:167], a[4:7], v[84:87]
    ds_read_b64_tr_b16 a[162:163], v100 offset:53248
    buffer_load_dwordx4 a[72:75], v1, s[8:11], s31 offen offset:2048 sc1
    s_waitcnt lgkmcnt(6)
    v_mfma_f32_16x16x32_bf16 v[92:95], a[136:139], a[4:7], v[92:95]
    ds_read_b64_tr_b16 a[164:165], v100 offset:57344
    v_mfma_f32_16x16x32_bf16 v[92:95], a[140:143], a[12:15], v[92:95]
    ds_read_b64_tr_b16 a[166:167], v100 offset:61440
    v_mfma_f32_16x16x32_bf16 v[92:95], a[144:147], a[20:23], v[92:95]
    ds_read_b64_tr_b16 a[168:169], v101 offset:32768
    v_mfma_f32_16x16x32_bf16 v[92:95], a[148:151], a[28:31], v[92:95]
    ds_read_b64_tr_b16 a[170:171], v101 offset:36864
    buffer_load_dwordx4 a[76:79], v1, s[8:11], s31 offen offset:3072 sc1
    v_mfma_f32_16x16x32_bf16 v[88:91], a[148:151], a[24:27], v[88:91]
    ds_read_b64_tr_b16 a[128:129], v101 offset:40960
    v_mfma_f32_16x16x32_bf16 v[88:91], a[144:147], a[16:19], v[88:91]
    ds_read_b64_tr_b16 a[130:131], v101 offset:45056
    v_mfma_f32_16x16x32_bf16 v[88:91], a[140:143], a[8:11], v[88:91]
    ds_read_b64_tr_b16 a[132:133], v101 offset:49152
    v_mfma_f32_16x16x32_bf16 v[88:91], a[136:139], a[0:3], v[88:91]
    ds_read_b64_tr_b16 a[134:135], v101 offset:53248
    buffer_load_dwordx4 a[80:83], v30, s[8:11], s31 offen offset:0 sc1
    s_waitcnt vmcnt(13) lgkmcnt(6)
    v_mfma_f32_16x16x32_bf16 v[32:35], a[152:155], a[32:35], v[32:35]
    ds_read_b64_tr_b16 a[136:137], v101 offset:57344
    v_mfma_f32_16x16x32_bf16 v[32:35], a[156:159], a[40:43], v[32:35]
    ds_read_b64_tr_b16 a[138:139], v101 offset:61440
    v_mfma_f32_16x16x32_bf16 v[32:35], a[160:163], a[48:51], v[32:35]
    ds_read_b64_tr_b16 a[140:141], v102 offset:32768
    v_mfma_f32_16x16x32_bf16 v[32:35], a[164:167], a[56:59], v[32:35]
    ds_read_b64_tr_b16 a[142:143], v102 offset:36864
    buffer_load_dwordx4 a[84:87], v30, s[8:11], s31 offen offset:1024 sc1
    v_mfma_f32_16x16x32_bf16 v[36:39], a[164:167], a[60:63], v[36:39]
    ds_read_b64_tr_b16 a[144:145], v102 offset:40960
    v_mfma_f32_16x16x32_bf16 v[36:39], a[160:163], a[52:55], v[36:39]
    ds_read_b64_tr_b16 a[146:147], v102 offset:45056
    v_mfma_f32_16x16x32_bf16 v[36:39], a[156:159], a[44:47], v[36:39]
    ds_read_b64_tr_b16 a[148:149], v102 offset:49152
    v_mfma_f32_16x16x32_bf16 v[36:39], a[152:155], a[36:39], v[36:39]
    ds_read_b64_tr_b16 a[150:151], v102 offset:53248
    buffer_load_dwordx4 a[88:91], v30, s[8:11], s31 offen offset:2048 sc1
    s_waitcnt lgkmcnt(6)
    v_mfma_f32_16x16x32_bf16 v[44:47], a[168:171], a[36:39], v[44:47]
    ds_read_b64_tr_b16 a[152:153], v102 offset:57344
    v_mfma_f32_16x16x32_bf16 v[44:47], a[128:131], a[44:47], v[44:47]
    ds_read_b64_tr_b16 a[154:155], v102 offset:61440
    v_mfma_f32_16x16x32_bf16 v[44:47], a[132:135], a[52:55], v[44:47]
    ds_read_b64_tr_b16 a[156:157], v103 offset:32768
    v_mfma_f32_16x16x32_bf16 v[44:47], a[136:139], a[60:63], v[44:47]
    ds_read_b64_tr_b16 a[158:159], v103 offset:36864
    buffer_load_dwordx4 a[92:95], v30, s[8:11], s31 offen offset:3072 sc1
    v_mfma_f32_16x16x32_bf16 v[40:43], a[136:139], a[56:59], v[40:43]
    ds_read_b64_tr_b16 a[160:161], v103 offset:40960
    s_add_u32 m0, s83, 98304
    v_mfma_f32_16x16x32_bf16 v[40:43], a[132:135], a[48:51], v[40:43]
    ds_read_b64_tr_b16 a[162:163], v103 offset:45056
    s_bfe_u32 s30, s69, 524312
    v_mfma_f32_16x16x32_bf16 v[40:43], a[128:131], a[40:43], v[40:43]
    ds_read_b64_tr_b16 a[164:165], v103 offset:49152
    s_lshl_b32 s30, s30, 16
    v_mfma_f32_16x16x32_bf16 v[40:43], a[168:171], a[32:35], v[40:43]
    ds_read_b64_tr_b16 a[166:167], v103 offset:53248
    buffer_load_dwordx4 v20, s[44:47], s30 offen offset:0  lds
    s_waitcnt lgkmcnt(6)
    v_mfma_f32_16x16x32_bf16 v[48:51], a[140:143], a[32:35], v[48:51]
    ds_read_b64_tr_b16 a[168:169], v103 offset:57344
    v_mfma_f32_16x16x32_bf16 v[48:51], a[144:147], a[40:43], v[48:51]
    ds_read_b64_tr_b16 a[170:171], v103 offset:61440
    buffer_load_dwordx4 v21, s[44:47], s30 offen offset:1024  lds
    v_mfma_f32_16x16x32_bf16 v[48:51], a[148:151], a[48:51], v[48:51]
    ds_read_b64_tr_b16 a[128:129], v104 offset:32768
    v_mfma_f32_16x16x32_bf16 v[48:51], a[152:155], a[56:59], v[48:51]
    ds_read_b64_tr_b16 a[130:131], v104 offset:36864
    v_mfma_f32_16x16x32_bf16 v[52:55], a[152:155], a[60:63], v[52:55]
    ds_read_b64_tr_b16 a[132:133], v104 offset:40960
    v_mfma_f32_16x16x32_bf16 v[52:55], a[148:151], a[52:55], v[52:55]
    ds_read_b64_tr_b16 a[134:135], v104 offset:45056
    buffer_load_dwordx4 v22, s[44:47], s30 offen offset:2048  lds
    v_mfma_f32_16x16x32_bf16 v[52:55], a[144:147], a[44:47], v[52:55]
    ds_read_b64_tr_b16 a[136:137], v104 offset:49152
    v_mfma_f32_16x16x32_bf16 v[52:55], a[140:143], a[36:39], v[52:55]
    ds_read_b64_tr_b16 a[138:139], v104 offset:53248
    s_waitcnt lgkmcnt(6)
    v_mfma_f32_16x16x32_bf16 v[60:63], a[156:159], a[36:39], v[60:63]
    ds_read_b64_tr_b16 a[140:141], v104 offset:57344
    v_mfma_f32_16x16x32_bf16 v[60:63], a[160:163], a[44:47], v[60:63]
    ds_read_b64_tr_b16 a[142:143], v104 offset:61440
    buffer_load_dwordx4 v23, s[44:47], s30 offen offset:3072  lds
    v_mfma_f32_16x16x32_bf16 v[60:63], a[164:167], a[52:55], v[60:63]
    ds_read_b64_tr_b16 a[144:145], v105 offset:32768
    s_add_u32 m0, s83, 102400
    v_mfma_f32_16x16x32_bf16 v[60:63], a[168:171], a[60:63], v[60:63]
    ds_read_b64_tr_b16 a[146:147], v105 offset:36864
    v_mfma_f32_16x16x32_bf16 v[56:59], a[168:171], a[56:59], v[56:59]
    ds_read_b64_tr_b16 a[148:149], v105 offset:40960
    v_mfma_f32_16x16x32_bf16 v[56:59], a[164:167], a[48:51], v[56:59]
    ds_read_b64_tr_b16 a[150:151], v105 offset:45056
    buffer_load_dwordx4 v24, s[44:47], s30 offen offset:0  lds
    v_mfma_f32_16x16x32_bf16 v[56:59], a[160:163], a[40:43], v[56:59]
    ds_read_b64_tr_b16 a[152:153], v105 offset:49152
    v_mfma_f32_16x16x32_bf16 v[56:59], a[156:159], a[32:35], v[56:59]
    ds_read_b64_tr_b16 a[154:155], v105 offset:53248
    s_waitcnt lgkmcnt(6)
    v_mfma_f32_16x16x32_bf16 v[64:67], a[128:131], a[32:35], v[64:67]
    ds_read_b64_tr_b16 a[156:157], v105 offset:57344
    v_mfma_f32_16x16x32_bf16 v[64:67], a[132:135], a[40:43], v[64:67]
    ds_read_b64_tr_b16 a[158:159], v105 offset:61440
    buffer_load_dwordx4 v25, s[44:47], s30 offen offset:1024  lds
    v_mfma_f32_16x16x32_bf16 v[64:67], a[136:139], a[48:51], v[64:67]
    ds_read_b64_tr_b16 a[160:161], v106 offset:32768
    v_mfma_f32_16x16x32_bf16 v[64:67], a[140:143], a[56:59], v[64:67]
    ds_read_b64_tr_b16 a[162:163], v106 offset:36864
    v_mfma_f32_16x16x32_bf16 v[68:71], a[140:143], a[60:63], v[68:71]
    ds_read_b64_tr_b16 a[164:165], v106 offset:40960
    v_mfma_f32_16x16x32_bf16 v[68:71], a[136:139], a[52:55], v[68:71]
    ds_read_b64_tr_b16 a[166:167], v106 offset:45056
    buffer_load_dwordx4 v26, s[44:47], s30 offen offset:2048  lds
    v_mfma_f32_16x16x32_bf16 v[68:71], a[132:135], a[44:47], v[68:71]
    ds_read_b64_tr_b16 a[168:169], v106 offset:49152
    v_mfma_f32_16x16x32_bf16 v[68:71], a[128:131], a[36:39], v[68:71]
    ds_read_b64_tr_b16 a[170:171], v106 offset:53248
    buffer_load_dwordx4 v27, s[44:47], s30 offen offset:3072  lds
    s_waitcnt lgkmcnt(6)
    v_mfma_f32_16x16x32_bf16 v[76:79], a[144:147], a[36:39], v[76:79]
    ds_read_b64_tr_b16 a[128:129], v106 offset:57344
    s_bfe_u32 s31, s66, 262172
    v_mfma_f32_16x16x32_bf16 v[76:79], a[148:151], a[44:47], v[76:79]
    ds_read_b64_tr_b16 a[130:131], v106 offset:61440
    s_lshl_b32 s31, s31, 13
    v_mfma_f32_16x16x32_bf16 v[76:79], a[152:155], a[52:55], v[76:79]
    ds_read_b64_tr_b16 a[132:133], v107 offset:32768
    s_add_u32 s31, s31, s17
    v_mfma_f32_16x16x32_bf16 v[76:79], a[156:159], a[60:63], v[76:79]
    ds_read_b64_tr_b16 a[134:135], v107 offset:36864
    buffer_load_dwordx4 a[96:99], v1, s[8:11], s31 offen offset:0 sc1
    v_mfma_f32_16x16x32_bf16 v[72:75], a[156:159], a[56:59], v[72:75]
    ds_read_b64_tr_b16 a[136:137], v107 offset:40960
    v_mfma_f32_16x16x32_bf16 v[72:75], a[152:155], a[48:51], v[72:75]
    ds_read_b64_tr_b16 a[138:139], v107 offset:45056
    v_mfma_f32_16x16x32_bf16 v[72:75], a[148:151], a[40:43], v[72:75]
    ds_read_b64_tr_b16 a[140:141], v107 offset:49152
    v_mfma_f32_16x16x32_bf16 v[72:75], a[144:147], a[32:35], v[72:75]
    ds_read_b64_tr_b16 a[142:143], v107 offset:53248
    buffer_load_dwordx4 a[100:103], v1, s[8:11], s31 offen offset:1024 sc1
    s_waitcnt lgkmcnt(6)
    v_mfma_f32_16x16x32_bf16 v[80:83], a[160:163], a[32:35], v[80:83]
    ds_read_b64_tr_b16 a[144:145], v107 offset:57344
    v_mfma_f32_16x16x32_bf16 v[80:83], a[164:167], a[40:43], v[80:83]
    ds_read_b64_tr_b16 a[146:147], v107 offset:61440
    v_mfma_f32_16x16x32_bf16 v[80:83], a[168:171], a[48:51], v[80:83]
    s_waitcnt vmcnt(18)
    s_barrier
    ds_read_b64_tr_b16 a[148:149], v108 offset:0
    v_mfma_f32_16x16x32_bf16 v[80:83], a[128:131], a[56:59], v[80:83]
    ds_read_b64_tr_b16 a[150:151], v108 offset:4096
    buffer_load_dwordx4 a[104:107], v1, s[8:11], s31 offen offset:2048 sc1
    v_mfma_f32_16x16x32_bf16 v[84:87], a[128:131], a[60:63], v[84:87]
    ds_read_b64_tr_b16 a[152:153], v108 offset:8192
    v_mfma_f32_16x16x32_bf16 v[84:87], a[168:171], a[52:55], v[84:87]
    ds_read_b64_tr_b16 a[154:155], v108 offset:12288
    v_mfma_f32_16x16x32_bf16 v[84:87], a[164:167], a[44:47], v[84:87]
    ds_read_b64_tr_b16 a[156:157], v108 offset:16384
    v_mfma_f32_16x16x32_bf16 v[84:87], a[160:163], a[36:39], v[84:87]
    ds_read_b64_tr_b16 a[158:159], v108 offset:20480
    buffer_load_dwordx4 a[108:111], v1, s[8:11], s31 offen offset:3072 sc1
    s_waitcnt lgkmcnt(6)
    v_mfma_f32_16x16x32_bf16 v[92:95], a[132:135], a[36:39], v[92:95]
    ds_read_b64_tr_b16 a[160:161], v108 offset:24576
    v_mfma_f32_16x16x32_bf16 v[92:95], a[136:139], a[44:47], v[92:95]
    ds_read_b64_tr_b16 a[162:163], v108 offset:28672
    v_mfma_f32_16x16x32_bf16 v[92:95], a[140:143], a[52:55], v[92:95]
    ds_read_b64_tr_b16 a[164:165], v109 offset:0
    v_mfma_f32_16x16x32_bf16 v[92:95], a[144:147], a[60:63], v[92:95]
    ds_read_b64_tr_b16 a[166:167], v109 offset:4096
    buffer_load_dwordx4 a[112:115], v30, s[8:11], s31 offen offset:0 sc1
    v_mfma_f32_16x16x32_bf16 v[88:91], a[144:147], a[56:59], v[88:91]
    ds_read_b64_tr_b16 a[168:169], v109 offset:8192
    v_mfma_f32_16x16x32_bf16 v[88:91], a[140:143], a[48:51], v[88:91]
    ds_read_b64_tr_b16 a[170:171], v109 offset:12288
    v_mfma_f32_16x16x32_bf16 v[88:91], a[136:139], a[40:43], v[88:91]
    ds_read_b64_tr_b16 a[128:129], v109 offset:16384
    v_mfma_f32_16x16x32_bf16 v[88:91], a[132:135], a[32:35], v[88:91]
    ds_read_b64_tr_b16 a[130:131], v109 offset:20480
    buffer_load_dwordx4 a[116:119], v30, s[8:11], s31 offen offset:1024 sc1
    s_waitcnt vmcnt(14) lgkmcnt(6)
    v_mfma_f32_16x16x32_bf16 v[32:35], a[148:151], a[64:67], v[32:35]
    ds_read_b64_tr_b16 a[132:133], v109 offset:24576
    v_mfma_f32_16x16x32_bf16 v[32:35], a[152:155], a[72:75], v[32:35]
    ds_read_b64_tr_b16 a[134:135], v109 offset:28672
    buffer_load_dwordx4 a[120:123], v30, s[8:11], s31 offen offset:2048 sc1
    v_mfma_f32_16x16x32_bf16 v[32:35], a[156:159], a[80:83], v[32:35]
    ds_read_b64_tr_b16 a[136:137], v110 offset:0
    v_mfma_f32_16x16x32_bf16 v[32:35], a[160:163], a[88:91], v[32:35]
    ds_read_b64_tr_b16 a[138:139], v110 offset:4096
    v_mfma_f32_16x16x32_bf16 v[36:39], a[160:163], a[92:95], v[36:39]
    ds_read_b64_tr_b16 a[140:141], v110 offset:8192
    v_mfma_f32_16x16x32_bf16 v[36:39], a[156:159], a[84:87], v[36:39]
    ds_read_b64_tr_b16 a[142:143], v110 offset:12288
    buffer_load_dwordx4 a[124:127], v30, s[8:11], s31 offen offset:3072 sc1
    v_mfma_f32_16x16x32_bf16 v[36:39], a[152:155], a[76:79], v[36:39]
    ds_read_b64_tr_b16 a[144:145], v110 offset:16384
    s_add_u32 m0, s83, 0
    v_mfma_f32_16x16x32_bf16 v[36:39], a[148:151], a[68:71], v[36:39]
    ds_read_b64_tr_b16 a[146:147], v110 offset:20480
    s_bfe_u32 s30, s70, 524288
    s_waitcnt lgkmcnt(6)
    v_mfma_f32_16x16x32_bf16 v[44:47], a[164:167], a[68:71], v[44:47]
    ds_read_b64_tr_b16 a[148:149], v110 offset:24576
    s_lshl_b32 s30, s30, 16
    v_mfma_f32_16x16x32_bf16 v[44:47], a[168:171], a[76:79], v[44:47]
    ds_read_b64_tr_b16 a[150:151], v110 offset:28672
    buffer_load_dwordx4 v20, s[44:47], s30 offen offset:0  lds
    v_mfma_f32_16x16x32_bf16 v[44:47], a[128:131], a[84:87], v[44:47]
    ds_read_b64_tr_b16 a[152:153], v111 offset:0
    v_mfma_f32_16x16x32_bf16 v[44:47], a[132:135], a[92:95], v[44:47]
    ds_read_b64_tr_b16 a[154:155], v111 offset:4096
    v_mfma_f32_16x16x32_bf16 v[40:43], a[132:135], a[88:91], v[40:43]
    ds_read_b64_tr_b16 a[156:157], v111 offset:8192
    v_mfma_f32_16x16x32_bf16 v[40:43], a[128:131], a[80:83], v[40:43]
    ds_read_b64_tr_b16 a[158:159], v111 offset:12288
    buffer_load_dwordx4 v21, s[44:47], s30 offen offset:1024  lds
    v_mfma_f32_16x16x32_bf16 v[40:43], a[168:171], a[72:75], v[40:43]
    ds_read_b64_tr_b16 a[160:161], v111 offset:16384
    v_mfma_f32_16x16x32_bf16 v[40:43], a[164:167], a[64:67], v[40:43]
    ds_read_b64_tr_b16 a[162:163], v111 offset:20480
    s_waitcnt lgkmcnt(6)
    v_mfma_f32_16x16x32_bf16 v[48:51], a[136:139], a[64:67], v[48:51]
    ds_read_b64_tr_b16 a[164:165], v111 offset:24576
    v_mfma_f32_16x16x32_bf16 v[48:51], a[140:143], a[72:75], v[48:51]
    ds_read_b64_tr_b16 a[166:167], v111 offset:28672
    buffer_load_dwordx4 v22, s[44:47], s30 offen offset:2048  lds
    v_mfma_f32_16x16x32_bf16 v[48:51], a[144:147], a[80:83], v[48:51]
    ds_read_b64_tr_b16 a[168:169], v112 offset:0
    v_mfma_f32_16x16x32_bf16 v[48:51], a[148:151], a[88:91], v[48:51]
    ds_read_b64_tr_b16 a[170:171], v112 offset:4096
    v_mfma_f32_16x16x32_bf16 v[52:55], a[148:151], a[92:95], v[52:55]
    ds_read_b64_tr_b16 a[128:129], v112 offset:8192
    v_mfma_f32_16x16x32_bf16 v[52:55], a[144:147], a[84:87], v[52:55]
    ds_read_b64_tr_b16 a[130:131], v112 offset:12288
    buffer_load_dwordx4 v23, s[44:47], s30 offen offset:3072  lds
    v_mfma_f32_16x16x32_bf16 v[52:55], a[140:143], a[76:79], v[52:55]
    ds_read_b64_tr_b16 a[132:133], v112 offset:16384
    s_add_u32 m0, s83, 4096
    v_mfma_f32_16x16x32_bf16 v[52:55], a[136:139], a[68:71], v[52:55]
    ds_read_b64_tr_b16 a[134:135], v112 offset:20480
    s_waitcnt lgkmcnt(6)
    v_mfma_f32_16x16x32_bf16 v[60:63], a[152:155], a[68:71], v[60:63]
    ds_read_b64_tr_b16 a[136:137], v112 offset:24576
    v_mfma_f32_16x16x32_bf16 v[60:63], a[156:159], a[76:79], v[60:63]
    ds_read_b64_tr_b16 a[138:139], v112 offset:28672
    buffer_load_dwordx4 v24, s[44:47], s30 offen offset:0  lds
    v_mfma_f32_16x16x32_bf16 v[60:63], a[160:163], a[84:87], v[60:63]
    ds_read_b64_tr_b16 a[140:141], v113 offset:0
    v_mfma_f32_16x16x32_bf16 v[60:63], a[164:167], a[92:95], v[60:63]
    ds_read_b64_tr_b16 a[142:143], v113 offset:4096
    buffer_load_dwordx4 v25, s[44:47], s30 offen offset:1024  lds
    v_mfma_f32_16x16x32_bf16 v[56:59], a[164:167], a[88:91], v[56:59]
    ds_read_b64_tr_b16 a[144:145], v113 offset:8192
    v_mfma_f32_16x16x32_bf16 v[56:59], a[160:163], a[80:83], v[56:59]
    ds_read_b64_tr_b16 a[146:147], v113 offset:12288
    v_mfma_f32_16x16x32_bf16 v[56:59], a[156:159], a[72:75], v[56:59]
    ds_read_b64_tr_b16 a[148:149], v113 offset:16384
    v_mfma_f32_16x16x32_bf16 v[56:59], a[152:155], a[64:67], v[56:59]
    ds_read_b64_tr_b16 a[150:151], v113 offset:20480
    buffer_load_dwordx4 v26, s[44:47], s30 offen offset:2048  lds
    s_waitcnt lgkmcnt(6)
    v_mfma_f32_16x16x32_bf16 v[64:67], a[168:171], a[64:67], v[64:67]
    ds_read_b64_tr_b16 a[152:153], v113 offset:24576
    v_mfma_f32_16x16x32_bf16 v[64:67], a[128:131], a[72:75], v[64:67]
    ds_read_b64_tr_b16 a[154:155], v113 offset:28672
    v_mfma_f32_16x16x32_bf16 v[64:67], a[132:135], a[80:83], v[64:67]
    ds_read_b64_tr_b16 a[156:157], v114 offset:0
    v_mfma_f32_16x16x32_bf16 v[64:67], a[136:139], a[88:91], v[64:67]
    ds_read_b64_tr_b16 a[158:159], v114 offset:4096
    buffer_load_dwordx4 v27, s[44:47], s30 offen offset:3072  lds
    v_mfma_f32_16x16x32_bf16 v[68:71], a[136:139], a[92:95], v[68:71]
    ds_read_b64_tr_b16 a[160:161], v114 offset:8192
    s_bfe_u32 s31, s67, 262144
    v_mfma_f32_16x16x32_bf16 v[68:71], a[132:135], a[84:87], v[68:71]
    ds_read_b64_tr_b16 a[162:163], v114 offset:12288
    s_lshl_b32 s31, s31, 13
    v_mfma_f32_16x16x32_bf16 v[68:71], a[128:131], a[76:79], v[68:71]
    ds_read_b64_tr_b16 a[164:165], v114 offset:16384
    s_add_u32 s31, s31, s17
    v_mfma_f32_16x16x32_bf16 v[68:71], a[168:171], a[68:71], v[68:71]
    ds_read_b64_tr_b16 a[166:167], v114 offset:20480
    buffer_load_dwordx4 a[0:3], v1, s[8:11], s31 offen offset:0 sc1
    s_waitcnt lgkmcnt(6)
    v_mfma_f32_16x16x32_bf16 v[76:79], a[140:143], a[68:71], v[76:79]
    ds_read_b64_tr_b16 a[168:169], v114 offset:24576
    v_mfma_f32_16x16x32_bf16 v[76:79], a[144:147], a[76:79], v[76:79]
    ds_read_b64_tr_b16 a[170:171], v114 offset:28672
    v_mfma_f32_16x16x32_bf16 v[76:79], a[148:151], a[84:87], v[76:79]
    ds_read_b64_tr_b16 a[128:129], v115 offset:0
    v_mfma_f32_16x16x32_bf16 v[76:79], a[152:155], a[92:95], v[76:79]
    ds_read_b64_tr_b16 a[130:131], v115 offset:4096
    buffer_load_dwordx4 a[4:7], v1, s[8:11], s31 offen offset:1024 sc1
    v_mfma_f32_16x16x32_bf16 v[72:75], a[152:155], a[88:91], v[72:75]
    ds_read_b64_tr_b16 a[132:133], v115 offset:8192
    v_mfma_f32_16x16x32_bf16 v[72:75], a[148:151], a[80:83], v[72:75]
    ds_read_b64_tr_b16 a[134:135], v115 offset:12288
    v_mfma_f32_16x16x32_bf16 v[72:75], a[144:147], a[72:75], v[72:75]
    ds_read_b64_tr_b16 a[136:137], v115 offset:16384
    v_mfma_f32_16x16x32_bf16 v[72:75], a[140:143], a[64:67], v[72:75]
    ds_read_b64_tr_b16 a[138:139], v115 offset:20480
    buffer_load_dwordx4 a[8:11], v1, s[8:11], s31 offen offset:2048 sc1
    s_waitcnt lgkmcnt(6)
    v_mfma_f32_16x16x32_bf16 v[80:83], a[156:159], a[64:67], v[80:83]
    ds_read_b64_tr_b16 a[140:141], v115 offset:24576
    v_mfma_f32_16x16x32_bf16 v[80:83], a[160:163], a[72:75], v[80:83]
    ds_read_b64_tr_b16 a[142:143], v115 offset:28672
    buffer_load_dwordx4 a[12:15], v1, s[8:11], s31 offen offset:3072 sc1
    v_mfma_f32_16x16x32_bf16 v[80:83], a[164:167], a[80:83], v[80:83]
    s_waitcnt vmcnt(20)
    s_barrier
    ds_read_b64_tr_b16 a[144:145], v108 offset:32768
    v_mfma_f32_16x16x32_bf16 v[80:83], a[168:171], a[88:91], v[80:83]
    ds_read_b64_tr_b16 a[146:147], v108 offset:36864
    v_mfma_f32_16x16x32_bf16 v[84:87], a[168:171], a[92:95], v[84:87]
    ds_read_b64_tr_b16 a[148:149], v108 offset:40960
    v_mfma_f32_16x16x32_bf16 v[84:87], a[164:167], a[84:87], v[84:87]
    ds_read_b64_tr_b16 a[150:151], v108 offset:45056
    buffer_load_dwordx4 a[16:19], v30, s[8:11], s31 offen offset:0 sc1
    v_mfma_f32_16x16x32_bf16 v[84:87], a[160:163], a[76:79], v[84:87]
    ds_read_b64_tr_b16 a[152:153], v108 offset:49152
    v_mfma_f32_16x16x32_bf16 v[84:87], a[156:159], a[68:71], v[84:87]
    ds_read_b64_tr_b16 a[154:155], v108 offset:53248
    s_waitcnt lgkmcnt(6)
    v_mfma_f32_16x16x32_bf16 v[92:95], a[128:131], a[68:71], v[92:95]
    ds_read_b64_tr_b16 a[156:157], v108 offset:57344
    v_mfma_f32_16x16x32_bf16 v[92:95], a[132:135], a[76:79], v[92:95]
    ds_read_b64_tr_b16 a[158:159], v108 offset:61440
    buffer_load_dwordx4 a[20:23], v30, s[8:11], s31 offen offset:1024 sc1
    v_mfma_f32_16x16x32_bf16 v[92:95], a[136:139], a[84:87], v[92:95]
    ds_read_b64_tr_b16 a[160:161], v109 offset:32768
    v_mfma_f32_16x16x32_bf16 v[92:95], a[140:143], a[92:95], v[92:95]
    ds_read_b64_tr_b16 a[162:163], v109 offset:36864
    v_mfma_f32_16x16x32_bf16 v[88:91], a[140:143], a[88:91], v[88:91]
    ds_read_b64_tr_b16 a[164:165], v109 offset:40960
    v_mfma_f32_16x16x32_bf16 v[88:91], a[136:139], a[80:83], v[88:91]
    ds_read_b64_tr_b16 a[166:167], v109 offset:45056
    buffer_load_dwordx4 a[24:27], v30, s[8:11], s31 offen offset:2048 sc1
    v_mfma_f32_16x16x32_bf16 v[88:91], a[132:135], a[72:75], v[88:91]
    ds_read_b64_tr_b16 a[168:169], v109 offset:49152
    v_mfma_f32_16x16x32_bf16 v[88:91], a[128:131], a[64:67], v[88:91]
    ds_read_b64_tr_b16 a[170:171], v109 offset:53248
    s_waitcnt vmcnt(15) lgkmcnt(6)
    v_mfma_f32_16x16x32_bf16 v[32:35], a[144:147], a[96:99], v[32:35]
    ds_read_b64_tr_b16 a[128:129], v109 offset:57344
    v_mfma_f32_16x16x32_bf16 v[32:35], a[148:151], a[104:107], v[32:35]
    ds_read_b64_tr_b16 a[130:131], v109 offset:61440
    buffer_load_dwordx4 a[28:31], v30, s[8:11], s31 offen offset:3072 sc1
    v_mfma_f32_16x16x32_bf16 v[32:35], a[152:155], a[112:115], v[32:35]
    ds_read_b64_tr_b16 a[132:133], v110 offset:32768
    s_add_u32 m0, s83, 32768
    v_mfma_f32_16x16x32_bf16 v[32:35], a[156:159], a[120:123], v[32:35]
    ds_read_b64_tr_b16 a[134:135], v110 offset:36864
    s_bfe_u32 s30, s70, 524296
    v_mfma_f32_16x16x32_bf16 v[36:39], a[156:159], a[124:127], v[36:39]
    ds_read_b64_tr_b16 a[136:137], v110 offset:40960
    s_lshl_b32 s30, s30, 16
    v_mfma_f32_16x16x32_bf16 v[36:39], a[152:155], a[116:119], v[36:39]
    ds_read_b64_tr_b16 a[138:139], v110 offset:45056
    buffer_load_dwordx4 v20, s[44:47], s30 offen offset:0  lds
    v_mfma_f32_16x16x32_bf16 v[36:39], a[148:151], a[108:111], v[36:39]
    ds_read_b64_tr_b16 a[140:141], v110 offset:49152
    v_mfma_f32_16x16x32_bf16 v[36:39], a[144:147], a[100:103], v[36:39]
    ds_read_b64_tr_b16 a[142:143], v110 offset:53248
    s_waitcnt lgkmcnt(6)
    v_mfma_f32_16x16x32_bf16 v[44:47], a[160:163], a[100:103], v[44:47]
    ds_read_b64_tr_b16 a[144:145], v110 offset:57344
    v_mfma_f32_16x16x32_bf16 v[44:47], a[164:167], a[108:111], v[44:47]
    ds_read_b64_tr_b16 a[146:147], v110 offset:61440
    buffer_load_dwordx4 v21, s[44:47], s30 offen offset:1024  lds
    v_mfma_f32_16x16x32_bf16 v[44:47], a[168:171], a[116:119], v[44:47]
    ds_read_b64_tr_b16 a[148:149], v111 offset:32768
    v_mfma_f32_16x16x32_bf16 v[44:47], a[128:131], a[124:127], v[44:47]
    ds_read_b64_tr_b16 a[150:151], v111 offset:36864
    buffer_load_dwordx4 v22, s[44:47], s30 offen offset:2048  lds
    v_mfma_f32_16x16x32_bf16 v[40:43], a[128:131], a[120:123], v[40:43]
    ds_read_b64_tr_b16 a[152:153], v111 offset:40960
    v_mfma_f32_16x16x32_bf16 v[40:43], a[168:171], a[112:115], v[40:43]
    ds_read_b64_tr_b16 a[154:155], v111 offset:45056
    v_mfma_f32_16x16x32_bf16 v[40:43], a[164:167], a[104:107], v[40:43]
    ds_read_b64_tr_b16 a[156:157], v111 offset:49152
    v_mfma_f32_16x16x32_bf16 v[40:43], a[160:163], a[96:99], v[40:43]
    ds_read_b64_tr_b16 a[158:159], v111 offset:53248
    buffer_load_dwordx4 v23, s[44:47], s30 offen offset:3072  lds
    s_waitcnt lgkmcnt(6)
    v_mfma_f32_16x16x32_bf16 v[48:51], a[132:135], a[96:99], v[48:51]
    ds_read_b64_tr_b16 a[160:161], v111 offset:57344
    s_add_u32 m0, s83, 36864
    v_mfma_f32_16x16x32_bf16 v[48:51], a[136:139], a[104:107], v[48:51]
    ds_read_b64_tr_b16 a[162:163], v111 offset:61440
    v_mfma_f32_16x16x32_bf16 v[48:51], a[140:143], a[112:115], v[48:51]
    ds_read_b64_tr_b16 a[164:165], v112 offset:32768
    v_mfma_f32_16x16x32_bf16 v[48:51], a[144:147], a[120:123], v[48:51]
    ds_read_b64_tr_b16 a[166:167], v112 offset:36864
    buffer_load_dwordx4 v24, s[44:47], s30 offen offset:0  lds
    v_mfma_f32_16x16x32_bf16 v[52:55], a[144:147], a[124:127], v[52:55]
    ds_read_b64_tr_b16 a[168:169], v112 offset:40960
    v_mfma_f32_16x16x32_bf16 v[52:55], a[140:143], a[116:119], v[52:55]
    ds_read_b64_tr_b16 a[170:171], v112 offset:45056
    v_mfma_f32_16x16x32_bf16 v[52:55], a[136:139], a[108:111], v[52:55]
    ds_read_b64_tr_b16 a[128:129], v112 offset:49152
    v_mfma_f32_16x16x32_bf16 v[52:55], a[132:135], a[100:103], v[52:55]
    ds_read_b64_tr_b16 a[130:131], v112 offset:53248
    buffer_load_dwordx4 v25, s[44:47], s30 offen offset:1024  lds
    s_waitcnt lgkmcnt(6)
    v_mfma_f32_16x16x32_bf16 v[60:63], a[148:151], a[100:103], v[60:63]
    ds_read_b64_tr_b16 a[132:133], v112 offset:57344
    v_mfma_f32_16x16x32_bf16 v[60:63], a[152:155], a[108:111], v[60:63]
    ds_read_b64_tr_b16 a[134:135], v112 offset:61440
    v_mfma_f32_16x16x32_bf16 v[60:63], a[156:159], a[116:119], v[60:63]
    ds_read_b64_tr_b16 a[136:137], v113 offset:32768
    v_mfma_f32_16x16x32_bf16 v[60:63], a[160:163], a[124:127], v[60:63]
    ds_read_b64_tr_b16 a[138:139], v113 offset:36864
    buffer_load_dwordx4 v26, s[44:47], s30 offen offset:2048  lds
    v_mfma_f32_16x16x32_bf16 v[56:59], a[160:163], a[120:123], v[56:59]
    ds_read_b64_tr_b16 a[140:141], v113 offset:40960
    v_mfma_f32_16x16x32_bf16 v[56:59], a[156:159], a[112:115], v[56:59]
    ds_read_b64_tr_b16 a[142:143], v113 offset:45056
    v_mfma_f32_16x16x32_bf16 v[56:59], a[152:155], a[104:107], v[56:59]
    ds_read_b64_tr_b16 a[144:145], v113 offset:49152
    v_mfma_f32_16x16x32_bf16 v[56:59], a[148:151], a[96:99], v[56:59]
    ds_read_b64_tr_b16 a[146:147], v113 offset:53248
    buffer_load_dwordx4 v27, s[44:47], s30 offen offset:3072  lds
    s_waitcnt lgkmcnt(6)
    v_mfma_f32_16x16x32_bf16 v[64:67], a[164:167], a[96:99], v[64:67]
    ds_read_b64_tr_b16 a[148:149], v113 offset:57344
    s_bfe_u32 s31, s67, 262148
    v_mfma_f32_16x16x32_bf16 v[64:67], a[168:171], a[104:107], v[64:67]
    ds_read_b64_tr_b16 a[150:151], v113 offset:61440
    s_lshl_b32 s31, s31, 13
    v_mfma_f32_16x16x32_bf16 v[64:67], a[128:131], a[112:115], v[64:67]
    ds_read_b64_tr_b16 a[152:153], v114 offset:32768
    s_add_u32 s31, s31, s17
    v_mfma_f32_16x16x32_bf16 v[64:67], a[132:135], a[120:123], v[64:67]
    ds_read_b64_tr_b16 a[154:155], v114 offset:36864
    buffer_load_dwordx4 a[32:35], v1, s[8:11], s31 offen offset:0 sc1
    v_mfma_f32_16x16x32_bf16 v[68:71], a[132:135], a[124:127], v[68:71]
    ds_read_b64_tr_b16 a[156:157], v114 offset:40960
    v_mfma_f32_16x16x32_bf16 v[68:71], a[128:131], a[116:119], v[68:71]
    ds_read_b64_tr_b16 a[158:159], v114 offset:45056
    buffer_load_dwordx4 a[36:39], v1, s[8:11], s31 offen offset:1024 sc1
    v_mfma_f32_16x16x32_bf16 v[68:71], a[168:171], a[108:111], v[68:71]
    ds_read_b64_tr_b16 a[160:161], v114 offset:49152
    v_mfma_f32_16x16x32_bf16 v[68:71], a[164:167], a[100:103], v[68:71]
    ds_read_b64_tr_b16 a[162:163], v114 offset:53248
    s_waitcnt lgkmcnt(6)
    v_mfma_f32_16x16x32_bf16 v[76:79], a[136:139], a[100:103], v[76:79]
    ds_read_b64_tr_b16 a[164:165], v114 offset:57344
    v_mfma_f32_16x16x32_bf16 v[76:79], a[140:143], a[108:111], v[76:79]
    ds_read_b64_tr_b16 a[166:167], v114 offset:61440
    buffer_load_dwordx4 a[40:43], v1, s[8:11], s31 offen offset:2048 sc1
    v_mfma_f32_16x16x32_bf16 v[76:79], a[144:147], a[116:119], v[76:79]
    ds_read_b64_tr_b16 a[168:169], v115 offset:32768
    v_mfma_f32_16x16x32_bf16 v[76:79], a[148:151], a[124:127], v[76:79]
    ds_read_b64_tr_b16 a[170:171], v115 offset:36864
    v_mfma_f32_16x16x32_bf16 v[72:75], a[148:151], a[120:123], v[72:75]
    ds_read_b64_tr_b16 a[128:129], v115 offset:40960
    v_mfma_f32_16x16x32_bf16 v[72:75], a[144:147], a[112:115], v[72:75]
    ds_read_b64_tr_b16 a[130:131], v115 offset:45056
    buffer_load_dwordx4 a[44:47], v1, s[8:11], s31 offen offset:3072 sc1
    v_mfma_f32_16x16x32_bf16 v[72:75], a[140:143], a[104:107], v[72:75]
    ds_read_b64_tr_b16 a[132:133], v115 offset:49152
    v_mfma_f32_16x16x32_bf16 v[72:75], a[136:139], a[96:99], v[72:75]
    ds_read_b64_tr_b16 a[134:135], v115 offset:53248
    s_waitcnt lgkmcnt(6)
    v_mfma_f32_16x16x32_bf16 v[80:83], a[152:155], a[96:99], v[80:83]
    ds_read_b64_tr_b16 a[136:137], v115 offset:57344
    v_mfma_f32_16x16x32_bf16 v[80:83], a[156:159], a[104:107], v[80:83]
    ds_read_b64_tr_b16 a[138:139], v115 offset:61440
    buffer_load_dwordx4 a[48:51], v30, s[8:11], s31 offen offset:0 sc1
    v_mfma_f32_16x16x32_bf16 v[80:83], a[160:163], a[112:115], v[80:83]
    s_waitcnt vmcnt(21)
    s_barrier
    ds_read_b64_tr_b16 a[140:141], v100 offset:0
    v_mfma_f32_16x16x32_bf16 v[80:83], a[164:167], a[120:123], v[80:83]
    ds_read_b64_tr_b16 a[142:143], v100 offset:4096
    v_mfma_f32_16x16x32_bf16 v[84:87], a[164:167], a[124:127], v[84:87]
    ds_read_b64_tr_b16 a[144:145], v100 offset:8192
    v_mfma_f32_16x16x32_bf16 v[84:87], a[160:163], a[116:119], v[84:87]
    ds_read_b64_tr_b16 a[146:147], v100 offset:12288
    buffer_load_dwordx4 a[52:55], v30, s[8:11], s31 offen offset:1024 sc1
    v_mfma_f32_16x16x32_bf16 v[84:87], a[156:159], a[108:111], v[84:87]
    ds_read_b64_tr_b16 a[148:149], v100 offset:16384
    v_mfma_f32_16x16x32_bf16 v[84:87], a[152:155], a[100:103], v[84:87]
    ds_read_b64_tr_b16 a[150:151], v100 offset:20480
    s_waitcnt lgkmcnt(6)
    v_mfma_f32_16x16x32_bf16 v[92:95], a[168:171], a[100:103], v[92:95]
    ds_read_b64_tr_b16 a[152:153], v100 offset:24576
    v_mfma_f32_16x16x32_bf16 v[92:95], a[128:131], a[108:111], v[92:95]
    ds_read_b64_tr_b16 a[154:155], v100 offset:28672
    buffer_load_dwordx4 a[56:59], v30, s[8:11], s31 offen offset:2048 sc1
    v_mfma_f32_16x16x32_bf16 v[92:95], a[132:135], a[116:119], v[92:95]
    ds_read_b64_tr_b16 a[156:157], v101 offset:0
    v_mfma_f32_16x16x32_bf16 v[92:95], a[136:139], a[124:127], v[92:95]
    ds_read_b64_tr_b16 a[158:159], v101 offset:4096
    buffer_load_dwordx4 a[60:63], v30, s[8:11], s31 offen offset:3072 sc1
    v_mfma_f32_16x16x32_bf16 v[88:91], a[136:139], a[120:123], v[88:91]
    ds_read_b64_tr_b16 a[160:161], v101 offset:8192
    v_accvgpr_read_b32 v31, a201
    v_mfma_f32_16x16x32_bf16 v[88:91], a[132:135], a[112:115], v[88:91]
    ds_read_b64_tr_b16 a[162:163], v101 offset:12288
    v_mfma_f32_16x16x32_bf16 v[88:91], a[128:131], a[104:107], v[88:91]
    ds_read_b64_tr_b16 a[164:165], v101 offset:16384
    v_mfma_f32_16x16x32_bf16 v[88:91], a[168:171], a[96:99], v[88:91]
    ds_read_b64_tr_b16 a[166:167], v101 offset:20480
    global_load_dword a200, v31, s[74:75]
    s_waitcnt vmcnt(17) lgkmcnt(6)
    v_mfma_f32_16x16x32_bf16 v[32:35], a[140:143], a[0:3], v[32:35]
    ds_read_b64_tr_b16 a[168:169], v101 offset:24576
    s_add_u32 m0, s83, 65536
    v_mfma_f32_16x16x32_bf16 v[32:35], a[144:147], a[8:11], v[32:35]
    ds_read_b64_tr_b16 a[170:171], v101 offset:28672
    s_bfe_u32 s30, s70, 524304
    v_mfma_f32_16x16x32_bf16 v[32:35], a[148:151], a[16:19], v[32:35]
    ds_read_b64_tr_b16 a[128:129], v102 offset:0
    s_lshl_b32 s30, s30, 16
    v_mfma_f32_16x16x32_bf16 v[32:35], a[152:155], a[24:27], v[32:35]
    ds_read_b64_tr_b16 a[130:131], v102 offset:4096
    buffer_load_dwordx4 v20, s[44:47], s30 offen offset:0  lds
    v_mfma_f32_16x16x32_bf16 v[36:39], a[152:155], a[28:31], v[36:39]
    ds_read_b64_tr_b16 a[132:133], v102 offset:8192
    v_mfma_f32_16x16x32_bf16 v[36:39], a[148:151], a[20:23], v[36:39]
    ds_read_b64_tr_b16 a[134:135], v102 offset:12288
    v_mfma_f32_16x16x32_bf16 v[36:39], a[144:147], a[12:15], v[36:39]
    ds_read_b64_tr_b16 a[136:137], v102 offset:16384
    v_mfma_f32_16x16x32_bf16 v[36:39], a[140:143], a[4:7], v[36:39]
    ds_read_b64_tr_b16 a[138:139], v102 offset:20480
    buffer_load_dwordx4 v21, s[44:47], s30 offen offset:1024  lds
    s_waitcnt lgkmcnt(6)
    v_mfma_f32_16x16x32_bf16 v[44:47], a[156:159], a[4:7], v[44:47]
    ds_read_b64_tr_b16 a[140:141], v102 offset:24576
    v_mfma_f32_16x16x32_bf16 v[44:47], a[160:163], a[12:15], v[44:47]
    ds_read_b64_tr_b16 a[142:143], v102 offset:28672
    v_mfma_f32_16x16x32_bf16 v[44:47], a[164:167], a[20:23], v[44:47]
    ds_read_b64_tr_b16 a[144:145], v103 offset:0
    v_mfma_f32_16x16x32_bf16 v[44:47], a[168:171], a[28:31], v[44:47]
    ds_read_b64_tr_b16 a[146:147], v103 offset:4096
    buffer_load_dwordx4 v22, s[44:47], s30 offen offset:2048  lds
    v_mfma_f32_16x16x32_bf16 v[40:43], a[168:171], a[24:27], v[40:43]
    ds_read_b64_tr_b16 a[148:149], v103 offset:8192
    v_mfma_f32_16x16x32_bf16 v[40:43], a[164:167], a[16:19], v[40:43]
    ds_read_b64_tr_b16 a[150:151], v103 offset:12288
    v_mfma_f32_16x16x32_bf16 v[40:43], a[160:163], a[8:11], v[40:43]
    ds_read_b64_tr_b16 a[152:153], v103 offset:16384
    v_mfma_f32_16x16x32_bf16 v[40:43], a[156:159], a[0:3], v[40:43]
    ds_read_b64_tr_b16 a[154:155], v103 offset:20480
    buffer_load_dwordx4 v23, s[44:47], s30 offen offset:3072  lds
    s_waitcnt lgkmcnt(6)
    v_mfma_f32_16x16x32_bf16 v[48:51], a[128:131], a[0:3], v[48:51]
    ds_read_b64_tr_b16 a[156:157], v103 offset:24576
    s_add_u32 m0, s83, 69632
    v_mfma_f32_16x16x32_bf16 v[48:51], a[132:135], a[8:11], v[48:51]
    ds_read_b64_tr_b16 a[158:159], v103 offset:28672
    v_mfma_f32_16x16x32_bf16 v[48:51], a[136:139], a[16:19], v[48:51]
    ds_read_b64_tr_b16 a[160:161], v104 offset:0
    v_mfma_f32_16x16x32_bf16 v[48:51], a[140:143], a[24:27], v[48:51]
    ds_read_b64_tr_b16 a[162:163], v104 offset:4096
    buffer_load_dwordx4 v24, s[44:47], s30 offen offset:0  lds
    v_mfma_f32_16x16x32_bf16 v[52:55], a[140:143], a[28:31], v[52:55]
    ds_read_b64_tr_b16 a[164:165], v104 offset:8192
    v_mfma_f32_16x16x32_bf16 v[52:55], a[136:139], a[20:23], v[52:55]
    ds_read_b64_tr_b16 a[166:167], v104 offset:12288
    buffer_load_dwordx4 v25, s[44:47], s30 offen offset:1024  lds
    v_mfma_f32_16x16x32_bf16 v[52:55], a[132:135], a[12:15], v[52:55]
    ds_read_b64_tr_b16 a[168:169], v104 offset:16384
    v_mfma_f32_16x16x32_bf16 v[52:55], a[128:131], a[4:7], v[52:55]
    ds_read_b64_tr_b16 a[170:171], v104 offset:20480
    s_waitcnt lgkmcnt(6)
    v_mfma_f32_16x16x32_bf16 v[60:63], a[144:147], a[4:7], v[60:63]
    ds_read_b64_tr_b16 a[128:129], v104 offset:24576
    v_mfma_f32_16x16x32_bf16 v[60:63], a[148:151], a[12:15], v[60:63]
    ds_read_b64_tr_b16 a[130:131], v104 offset:28672
    buffer_load_dwordx4 v26, s[44:47], s30 offen offset:2048  lds
    v_mfma_f32_16x16x32_bf16 v[60:63], a[152:155], a[20:23], v[60:63]
    ds_read_b64_tr_b16 a[132:133], v105 offset:0
    v_mfma_f32_16x16x32_bf16 v[60:63], a[156:159], a[28:31], v[60:63]
    ds_read_b64_tr_b16 a[134:135], v105 offset:4096
    v_mfma_f32_16x16x32_bf16 v[56:59], a[156:159], a[24:27], v[56:59]
    ds_read_b64_tr_b16 a[136:137], v105 offset:8192
    v_mfma_f32_16x16x32_bf16 v[56:59], a[152:155], a[16:19], v[56:59]
    ds_read_b64_tr_b16 a[138:139], v105 offset:12288
    buffer_load_dwordx4 v27, s[44:47], s30 offen offset:3072  lds
    v_mfma_f32_16x16x32_bf16 v[56:59], a[148:151], a[8:11], v[56:59]
    ds_read_b64_tr_b16 a[140:141], v105 offset:16384
    s_bfe_u32 s31, s67, 262152
    v_mfma_f32_16x16x32_bf16 v[56:59], a[144:147], a[0:3], v[56:59]
    ds_read_b64_tr_b16 a[142:143], v105 offset:20480
    s_lshl_b32 s31, s31, 13
    s_waitcnt lgkmcnt(6)
    v_mfma_f32_16x16x32_bf16 v[64:67], a[160:163], a[0:3], v[64:67]
    ds_read_b64_tr_b16 a[144:145], v105 offset:24576
    s_add_u32 s31, s31, s17
    v_mfma_f32_16x16x32_bf16 v[64:67], a[164:167], a[8:11], v[64:67]
    ds_read_b64_tr_b16 a[146:147], v105 offset:28672
    buffer_load_dwordx4 a[64:67], v1, s[8:11], s31 offen offset:0 sc1
    v_mfma_f32_16x16x32_bf16 v[64:67], a[168:171], a[16:19], v[64:67]
    ds_read_b64_tr_b16 a[148:149], v106 offset:0
    v_mfma_f32_16x16x32_bf16 v[64:67], a[128:131], a[24:27], v[64:67]
    ds_read_b64_tr_b16 a[150:151], v106 offset:4096
    v_mfma_f32_16x16x32_bf16 v[68:71], a[128:131], a[28:31], v[68:71]
    ds_read_b64_tr_b16 a[152:153], v106 offset:8192
    v_mfma_f32_16x16x32_bf16 v[68:71], a[168:171], a[20:23], v[68:71]
    ds_read_b64_tr_b16 a[154:155], v106 offset:12288
    buffer_load_dwordx4 a[68:71], v1, s[8:11], s31 offen offset:1024 sc1
    v_mfma_f32_16x16x32_bf16 v[68:71], a[164:167], a[12:15], v[68:71]
    ds_read_b64_tr_b16 a[156:157], v106 offset:16384
    v_mfma_f32_16x16x32_bf16 v[68:71], a[160:163], a[4:7], v[68:71]
    ds_read_b64_tr_b16 a[158:159], v106 offset:20480
    s_waitcnt lgkmcnt(6)
    v_mfma_f32_16x16x32_bf16 v[76:79], a[132:135], a[4:7], v[76:79]
    ds_read_b64_tr_b16 a[160:161], v106 offset:24576
    v_mfma_f32_16x16x32_bf16 v[76:79], a[136:139], a[12:15], v[76:79]
    ds_read_b64_tr_b16 a[162:163], v106 offset:28672
    buffer_load_dwordx4 a[72:75], v1, s[8:11], s31 offen offset:2048 sc1
    v_mfma_f32_16x16x32_bf16 v[76:79], a[140:143], a[20:23], v[76:79]
    ds_read_b64_tr_b16 a[164:165], v107 offset:0
    v_mfma_f32_16x16x32_bf16 v[76:79], a[144:147], a[28:31], v[76:79]
    ds_read_b64_tr_b16 a[166:167], v107 offset:4096
    v_mfma_f32_16x16x32_bf16 v[72:75], a[144:147], a[24:27], v[72:75]
    ds_read_b64_tr_b16 a[168:169], v107 offset:8192
    v_mfma_f32_16x16x32_bf16 v[72:75], a[140:143], a[16:19], v[72:75]
    ds_read_b64_tr_b16 a[170:171], v107 offset:12288
    buffer_load_dwordx4 a[76:79], v1, s[8:11], s31 offen offset:3072 sc1
    v_mfma_f32_16x16x32_bf16 v[72:75], a[136:139], a[8:11], v[72:75]
    ds_read_b64_tr_b16 a[128:129], v107 offset:16384
    v_mfma_f32_16x16x32_bf16 v[72:75], a[132:135], a[0:3], v[72:75]
    ds_read_b64_tr_b16 a[130:131], v107 offset:20480
    buffer_load_dwordx4 a[80:83], v30, s[8:11], s31 offen offset:0 sc1
    s_waitcnt lgkmcnt(6)
    v_mfma_f32_16x16x32_bf16 v[80:83], a[148:151], a[0:3], v[80:83]
    ds_read_b64_tr_b16 a[132:133], v107 offset:24576
    v_mfma_f32_16x16x32_bf16 v[80:83], a[152:155], a[8:11], v[80:83]
    ds_read_b64_tr_b16 a[134:135], v107 offset:28672
    v_mfma_f32_16x16x32_bf16 v[80:83], a[156:159], a[16:19], v[80:83]
    s_waitcnt vmcnt(22)
    s_barrier
    ds_read_b64_tr_b16 a[136:137], v100 offset:32768
    v_mfma_f32_16x16x32_bf16 v[80:83], a[160:163], a[24:27], v[80:83]
    ds_read_b64_tr_b16 a[138:139], v100 offset:36864
    buffer_load_dwordx4 a[84:87], v30, s[8:11], s31 offen offset:1024 sc1
    v_mfma_f32_16x16x32_bf16 v[84:87], a[160:163], a[28:31], v[84:87]
    ds_read_b64_tr_b16 a[140:141], v100 offset:40960
    v_mfma_f32_16x16x32_bf16 v[84:87], a[156:159], a[20:23], v[84:87]
    ds_read_b64_tr_b16 a[142:143], v100 offset:45056
    v_mfma_f32_16x16x32_bf16 v[84:87], a[152:155], a[12:15], v[84:87]
    ds_read_b64_tr_b16 a[144:145], v100 offset:49152
    v_mfma_f32_16x16x32_bf16 v[84:87], a[148:151], a[4:7], v[84:87]
    ds_read_b64_tr_b16 a[146:147], v100 offset:53248
    buffer_load_dwordx4 a[88:91], v30, s[8:11], s31 offen offset:2048 sc1
    s_waitcnt lgkmcnt(6)
    v_mfma_f32_16x16x32_bf16 v[92:95], a[164:167], a[4:7], v[92:95]
    ds_read_b64_tr_b16 a[148:149], v100 offset:57344
    v_mfma_f32_16x16x32_bf16 v[92:95], a[168:171], a[12:15], v[92:95]
    ds_read_b64_tr_b16 a[150:151], v100 offset:61440
    v_mfma_f32_16x16x32_bf16 v[92:95], a[128:131], a[20:23], v[92:95]
    ds_read_b64_tr_b16 a[152:153], v101 offset:32768
    v_mfma_f32_16x16x32_bf16 v[92:95], a[132:135], a[28:31], v[92:95]
    ds_read_b64_tr_b16 a[154:155], v101 offset:36864
    buffer_load_dwordx4 a[92:95], v30, s[8:11], s31 offen offset:3072 sc1
    v_mfma_f32_16x16x32_bf16 v[88:91], a[132:135], a[24:27], v[88:91]
    ds_read_b64_tr_b16 a[156:157], v101 offset:40960
    s_add_u32 m0, s83, 98304
    v_mfma_f32_16x16x32_bf16 v[88:91], a[128:131], a[16:19], v[88:91]
    ds_read_b64_tr_b16 a[158:159], v101 offset:45056
    s_bfe_u32 s30, s70, 524312
    v_mfma_f32_16x16x32_bf16 v[88:91], a[168:171], a[8:11], v[88:91]
    ds_read_b64_tr_b16 a[160:161], v101 offset:49152
    s_lshl_b32 s30, s30, 16
    v_mfma_f32_16x16x32_bf16 v[88:91], a[164:167], a[0:3], v[88:91]
    ds_read_b64_tr_b16 a[162:163], v101 offset:53248
    buffer_load_dwordx4 v20, s[44:47], s30 offen offset:0  lds
    s_waitcnt vmcnt(18) lgkmcnt(6)
    v_mfma_f32_16x16x32_bf16 v[32:35], a[136:139], a[32:35], v[32:35]
    ds_read_b64_tr_b16 a[164:165], v101 offset:57344
    v_mfma_f32_16x16x32_bf16 v[32:35], a[140:143], a[40:43], v[32:35]
    ds_read_b64_tr_b16 a[166:167], v101 offset:61440
    v_mfma_f32_16x16x32_bf16 v[32:35], a[144:147], a[48:51], v[32:35]
    ds_read_b64_tr_b16 a[168:169], v102 offset:32768
    v_mfma_f32_16x16x32_bf16 v[32:35], a[148:151], a[56:59], v[32:35]
    ds_read_b64_tr_b16 a[170:171], v102 offset:36864
    buffer_load_dwordx4 v21, s[44:47], s30 offen offset:1024  lds
    v_mfma_f32_16x16x32_bf16 v[36:39], a[148:151], a[60:63], v[36:39]
    ds_read_b64_tr_b16 a[128:129], v102 offset:40960
    v_mfma_f32_16x16x32_bf16 v[36:39], a[144:147], a[52:55], v[36:39]
    ds_read_b64_tr_b16 a[130:131], v102 offset:45056
    buffer_load_dwordx4 v22, s[44:47], s30 offen offset:2048  lds
    v_mfma_f32_16x16x32_bf16 v[36:39], a[140:143], a[44:47], v[36:39]
    ds_read_b64_tr_b16 a[132:133], v102 offset:49152
    v_mfma_f32_16x16x32_bf16 v[36:39], a[136:139], a[36:39], v[36:39]
    ds_read_b64_tr_b16 a[134:135], v102 offset:53248
    s_waitcnt lgkmcnt(6)
    v_mfma_f32_16x16x32_bf16 v[44:47], a[152:155], a[36:39], v[44:47]
    ds_read_b64_tr_b16 a[136:137], v102 offset:57344
    v_mfma_f32_16x16x32_bf16 v[44:47], a[156:159], a[44:47], v[44:47]
    ds_read_b64_tr_b16 a[138:139], v102 offset:61440
    buffer_load_dwordx4 v23, s[44:47], s30 offen offset:3072  lds
    v_mfma_f32_16x16x32_bf16 v[44:47], a[160:163], a[52:55], v[44:47]
    ds_read_b64_tr_b16 a[140:141], v103 offset:32768
    s_add_u32 m0, s83, 102400
    v_mfma_f32_16x16x32_bf16 v[44:47], a[164:167], a[60:63], v[44:47]
    ds_read_b64_tr_b16 a[142:143], v103 offset:36864
    v_mfma_f32_16x16x32_bf16 v[40:43], a[164:167], a[56:59], v[40:43]
    ds_read_b64_tr_b16 a[144:145], v103 offset:40960
    v_mfma_f32_16x16x32_bf16 v[40:43], a[160:163], a[48:51], v[40:43]
    ds_read_b64_tr_b16 a[146:147], v103 offset:45056
    buffer_load_dwordx4 v24, s[44:47], s30 offen offset:0  lds
    v_mfma_f32_16x16x32_bf16 v[40:43], a[156:159], a[40:43], v[40:43]
    ds_read_b64_tr_b16 a[148:149], v103 offset:49152
    v_mfma_f32_16x16x32_bf16 v[40:43], a[152:155], a[32:35], v[40:43]
    ds_read_b64_tr_b16 a[150:151], v103 offset:53248
    s_waitcnt lgkmcnt(6)
    v_mfma_f32_16x16x32_bf16 v[48:51], a[168:171], a[32:35], v[48:51]
    ds_read_b64_tr_b16 a[152:153], v103 offset:57344
    v_mfma_f32_16x16x32_bf16 v[48:51], a[128:131], a[40:43], v[48:51]
    ds_read_b64_tr_b16 a[154:155], v103 offset:61440
    buffer_load_dwordx4 v25, s[44:47], s30 offen offset:1024  lds
    v_mfma_f32_16x16x32_bf16 v[48:51], a[132:135], a[48:51], v[48:51]
    ds_read_b64_tr_b16 a[156:157], v104 offset:32768
    v_mfma_f32_16x16x32_bf16 v[48:51], a[136:139], a[56:59], v[48:51]
    ds_read_b64_tr_b16 a[158:159], v104 offset:36864
    v_mfma_f32_16x16x32_bf16 v[52:55], a[136:139], a[60:63], v[52:55]
    ds_read_b64_tr_b16 a[160:161], v104 offset:40960
    v_mfma_f32_16x16x32_bf16 v[52:55], a[132:135], a[52:55], v[52:55]
    ds_read_b64_tr_b16 a[162:163], v104 offset:45056
    buffer_load_dwordx4 v26, s[44:47], s30 offen offset:2048  lds
    v_mfma_f32_16x16x32_bf16 v[52:55], a[128:131], a[44:47], v[52:55]
    ds_read_b64_tr_b16 a[164:165], v104 offset:49152
    v_mfma_f32_16x16x32_bf16 v[52:55], a[168:171], a[36:39], v[52:55]
    ds_read_b64_tr_b16 a[166:167], v104 offset:53248
    s_waitcnt lgkmcnt(6)
    v_mfma_f32_16x16x32_bf16 v[60:63], a[140:143], a[36:39], v[60:63]
    ds_read_b64_tr_b16 a[168:169], v104 offset:57344
    v_mfma_f32_16x16x32_bf16 v[60:63], a[144:147], a[44:47], v[60:63]
    ds_read_b64_tr_b16 a[170:171], v104 offset:61440
    buffer_load_dwordx4 v27, s[44:47], s30 offen offset:3072  lds
    v_mfma_f32_16x16x32_bf16 v[60:63], a[148:151], a[52:55], v[60:63]
    ds_read_b64_tr_b16 a[128:129], v105 offset:32768
    s_bfe_u32 s31, s67, 262156
    v_mfma_f32_16x16x32_bf16 v[60:63], a[152:155], a[60:63], v[60:63]
    ds_read_b64_tr_b16 a[130:131], v105 offset:36864
    s_lshl_b32 s31, s31, 13
    v_mfma_f32_16x16x32_bf16 v[56:59], a[152:155], a[56:59], v[56:59]
    ds_read_b64_tr_b16 a[132:133], v105 offset:40960
    s_add_u32 s31, s31, s17
    v_mfma_f32_16x16x32_bf16 v[56:59], a[148:151], a[48:51], v[56:59]
    ds_read_b64_tr_b16 a[134:135], v105 offset:45056
    buffer_load_dwordx4 a[96:99], v1, s[8:11], s31 offen offset:0 sc1
    v_mfma_f32_16x16x32_bf16 v[56:59], a[144:147], a[40:43], v[56:59]
    ds_read_b64_tr_b16 a[136:137], v105 offset:49152
    v_mfma_f32_16x16x32_bf16 v[56:59], a[140:143], a[32:35], v[56:59]
    ds_read_b64_tr_b16 a[138:139], v105 offset:53248
    buffer_load_dwordx4 a[100:103], v1, s[8:11], s31 offen offset:1024 sc1
    s_waitcnt lgkmcnt(6)
    v_mfma_f32_16x16x32_bf16 v[64:67], a[156:159], a[32:35], v[64:67]
    ds_read_b64_tr_b16 a[140:141], v105 offset:57344
    v_mfma_f32_16x16x32_bf16 v[64:67], a[160:163], a[40:43], v[64:67]
    ds_read_b64_tr_b16 a[142:143], v105 offset:61440
    v_mfma_f32_16x16x32_bf16 v[64:67], a[164:167], a[48:51], v[64:67]
    ds_read_b64_tr_b16 a[144:145], v106 offset:32768
    v_mfma_f32_16x16x32_bf16 v[64:67], a[168:171], a[56:59], v[64:67]
    ds_read_b64_tr_b16 a[146:147], v106 offset:36864
    buffer_load_dwordx4 a[104:107], v1, s[8:11], s31 offen offset:2048 sc1
    v_mfma_f32_16x16x32_bf16 v[68:71], a[168:171], a[60:63], v[68:71]
    ds_read_b64_tr_b16 a[148:149], v106 offset:40960
    v_mfma_f32_16x16x32_bf16 v[68:71], a[164:167], a[52:55], v[68:71]
    ds_read_b64_tr_b16 a[150:151], v106 offset:45056
    v_mfma_f32_16x16x32_bf16 v[68:71], a[160:163], a[44:47], v[68:71]
    ds_read_b64_tr_b16 a[152:153], v106 offset:49152
    v_mfma_f32_16x16x32_bf16 v[68:71], a[156:159], a[36:39], v[68:71]
    ds_read_b64_tr_b16 a[154:155], v106 offset:53248
    buffer_load_dwordx4 a[108:111], v1, s[8:11], s31 offen offset:3072 sc1
    s_waitcnt lgkmcnt(6)
    v_mfma_f32_16x16x32_bf16 v[76:79], a[128:131], a[36:39], v[76:79]
    ds_read_b64_tr_b16 a[156:157], v106 offset:57344
    v_mfma_f32_16x16x32_bf16 v[76:79], a[132:135], a[44:47], v[76:79]
    ds_read_b64_tr_b16 a[158:159], v106 offset:61440
    v_mfma_f32_16x16x32_bf16 v[76:79], a[136:139], a[52:55], v[76:79]
    ds_read_b64_tr_b16 a[160:161], v107 offset:32768
    v_mfma_f32_16x16x32_bf16 v[76:79], a[140:143], a[60:63], v[76:79]
    ds_read_b64_tr_b16 a[162:163], v107 offset:36864
    buffer_load_dwordx4 a[112:115], v30, s[8:11], s31 offen offset:0 sc1
    v_mfma_f32_16x16x32_bf16 v[72:75], a[140:143], a[56:59], v[72:75]
    ds_read_b64_tr_b16 a[164:165], v107 offset:40960
    v_mfma_f32_16x16x32_bf16 v[72:75], a[136:139], a[48:51], v[72:75]
    ds_read_b64_tr_b16 a[166:167], v107 offset:45056
    v_mfma_f32_16x16x32_bf16 v[72:75], a[132:135], a[40:43], v[72:75]
    ds_read_b64_tr_b16 a[168:169], v107 offset:49152
    v_mfma_f32_16x16x32_bf16 v[72:75], a[128:131], a[32:35], v[72:75]
    ds_read_b64_tr_b16 a[170:171], v107 offset:53248
    buffer_load_dwordx4 a[116:119], v30, s[8:11], s31 offen offset:1024 sc1
    s_waitcnt lgkmcnt(6)
    v_mfma_f32_16x16x32_bf16 v[80:83], a[144:147], a[32:35], v[80:83]
    ds_read_b64_tr_b16 a[128:129], v107 offset:57344
    v_mfma_f32_16x16x32_bf16 v[80:83], a[148:151], a[40:43], v[80:83]
    ds_read_b64_tr_b16 a[130:131], v107 offset:61440
    v_mfma_f32_16x16x32_bf16 v[80:83], a[152:155], a[48:51], v[80:83]
    s_waitcnt vmcnt(22)
    s_barrier
    ds_read_b64_tr_b16 a[132:133], v108 offset:0
    v_mfma_f32_16x16x32_bf16 v[80:83], a[156:159], a[56:59], v[80:83]
    ds_read_b64_tr_b16 a[134:135], v108 offset:4096
    buffer_load_dwordx4 a[120:123], v30, s[8:11], s31 offen offset:2048 sc1
    v_mfma_f32_16x16x32_bf16 v[84:87], a[156:159], a[60:63], v[84:87]
    ds_read_b64_tr_b16 a[136:137], v108 offset:8192
    v_mfma_f32_16x16x32_bf16 v[84:87], a[152:155], a[52:55], v[84:87]
    ds_read_b64_tr_b16 a[138:139], v108 offset:12288
    v_mfma_f32_16x16x32_bf16 v[84:87], a[148:151], a[44:47], v[84:87]
    ds_read_b64_tr_b16 a[140:141], v108 offset:16384
    v_mfma_f32_16x16x32_bf16 v[84:87], a[144:147], a[36:39], v[84:87]
    ds_read_b64_tr_b16 a[142:143], v108 offset:20480
    buffer_load_dwordx4 a[124:127], v30, s[8:11], s31 offen offset:3072 sc1
    s_waitcnt lgkmcnt(6)
    v_mfma_f32_16x16x32_bf16 v[92:95], a[160:163], a[36:39], v[92:95]
    ds_read_b64_tr_b16 a[144:145], v108 offset:24576
    s_add_u32 m0, s83, 0
    v_mfma_f32_16x16x32_bf16 v[92:95], a[164:167], a[44:47], v[92:95]
    ds_read_b64_tr_b16 a[146:147], v108 offset:28672
    s_bfe_u32 s30, s71, 524288
    s_lshl_b32 s30, s30, 16
    v_mfma_f32_16x16x32_bf16 v[92:95], a[168:171], a[52:55], v[92:95]
    ds_read_b64_tr_b16 a[148:149], v109 offset:0
    s_add_u32 s30, s30, s73
    v_mfma_f32_16x16x32_bf16 v[92:95], a[128:131], a[60:63], v[92:95]
    ds_read_b64_tr_b16 a[150:151], v109 offset:4096
    buffer_load_dwordx4 v20, s[44:47], s30 offen offset:0  lds
    v_mfma_f32_16x16x32_bf16 v[88:91], a[128:131], a[56:59], v[88:91]
    ds_read_b64_tr_b16 a[152:153], v109 offset:8192
    v_mfma_f32_16x16x32_bf16 v[88:91], a[168:171], a[48:51], v[88:91]
    ds_read_b64_tr_b16 a[154:155], v109 offset:12288
    buffer_load_dwordx4 v21, s[44:47], s30 offen offset:1024  lds
    v_mfma_f32_16x16x32_bf16 v[88:91], a[164:167], a[40:43], v[88:91]
    ds_read_b64_tr_b16 a[156:157], v109 offset:16384
    v_mfma_f32_16x16x32_bf16 v[88:91], a[160:163], a[32:35], v[88:91]
    ds_read_b64_tr_b16 a[158:159], v109 offset:20480
    s_waitcnt vmcnt(18) lgkmcnt(6)
    v_mfma_f32_16x16x32_bf16 v[32:35], a[132:135], a[64:67], v[32:35]
    ds_read_b64_tr_b16 a[160:161], v109 offset:24576
    v_mfma_f32_16x16x32_bf16 v[32:35], a[136:139], a[72:75], v[32:35]
    ds_read_b64_tr_b16 a[162:163], v109 offset:28672
    buffer_load_dwordx4 v22, s[44:47], s30 offen offset:2048  lds
    v_mfma_f32_16x16x32_bf16 v[32:35], a[140:143], a[80:83], v[32:35]
    ds_read_b64_tr_b16 a[164:165], v110 offset:0
    v_mfma_f32_16x16x32_bf16 v[32:35], a[144:147], a[88:91], v[32:35]
    ds_read_b64_tr_b16 a[166:167], v110 offset:4096
    v_mfma_f32_16x16x32_bf16 v[36:39], a[144:147], a[92:95], v[36:39]
    ds_read_b64_tr_b16 a[168:169], v110 offset:8192
    v_mfma_f32_16x16x32_bf16 v[36:39], a[140:143], a[84:87], v[36:39]
    ds_read_b64_tr_b16 a[170:171], v110 offset:12288
    buffer_load_dwordx4 v23, s[44:47], s30 offen offset:3072  lds
    v_mfma_f32_16x16x32_bf16 v[36:39], a[136:139], a[76:79], v[36:39]
    ds_read_b64_tr_b16 a[128:129], v110 offset:16384
    s_add_u32 m0, s83, 4096
    v_mfma_f32_16x16x32_bf16 v[36:39], a[132:135], a[68:71], v[36:39]
    ds_read_b64_tr_b16 a[130:131], v110 offset:20480
    s_waitcnt lgkmcnt(6)
    v_mfma_f32_16x16x32_bf16 v[44:47], a[148:151], a[68:71], v[44:47]
    ds_read_b64_tr_b16 a[132:133], v110 offset:24576
    v_mfma_f32_16x16x32_bf16 v[44:47], a[152:155], a[76:79], v[44:47]
    ds_read_b64_tr_b16 a[134:135], v110 offset:28672
    buffer_load_dwordx4 v24, s[44:47], s30 offen offset:0  lds
    v_mfma_f32_16x16x32_bf16 v[44:47], a[156:159], a[84:87], v[44:47]
    ds_read_b64_tr_b16 a[136:137], v111 offset:0
    v_mfma_f32_16x16x32_bf16 v[44:47], a[160:163], a[92:95], v[44:47]
    ds_read_b64_tr_b16 a[138:139], v111 offset:4096
    v_mfma_f32_16x16x32_bf16 v[40:43], a[160:163], a[88:91], v[40:43]
    ds_read_b64_tr_b16 a[140:141], v111 offset:8192
    v_mfma_f32_16x16x32_bf16 v[40:43], a[156:159], a[80:83], v[40:43]
    ds_read_b64_tr_b16 a[142:143], v111 offset:12288
    buffer_load_dwordx4 v25, s[44:47], s30 offen offset:1024  lds
    v_mfma_f32_16x16x32_bf16 v[40:43], a[152:155], a[72:75], v[40:43]
    ds_read_b64_tr_b16 a[144:145], v111 offset:16384
    v_mfma_f32_16x16x32_bf16 v[40:43], a[148:151], a[64:67], v[40:43]
    ds_read_b64_tr_b16 a[146:147], v111 offset:20480
    s_waitcnt lgkmcnt(6)
    v_mfma_f32_16x16x32_bf16 v[48:51], a[164:167], a[64:67], v[48:51]
    ds_read_b64_tr_b16 a[148:149], v111 offset:24576
    v_mfma_f32_16x16x32_bf16 v[48:51], a[168:171], a[72:75], v[48:51]
    ds_read_b64_tr_b16 a[150:151], v111 offset:28672
    buffer_load_dwordx4 v26, s[44:47], s30 offen offset:2048  lds
    v_mfma_f32_16x16x32_bf16 v[48:51], a[128:131], a[80:83], v[48:51]
    ds_read_b64_tr_b16 a[152:153], v112 offset:0
    v_mfma_f32_16x16x32_bf16 v[48:51], a[132:135], a[88:91], v[48:51]
    ds_read_b64_tr_b16 a[154:155], v112 offset:4096
    buffer_load_dwordx4 v27, s[44:47], s30 offen offset:3072  lds
    v_mfma_f32_16x16x32_bf16 v[52:55], a[132:135], a[92:95], v[52:55]
    ds_read_b64_tr_b16 a[156:157], v112 offset:8192
    s_bfe_u32 s31, s67, 262160
    v_mfma_f32_16x16x32_bf16 v[52:55], a[128:131], a[84:87], v[52:55]
    ds_read_b64_tr_b16 a[158:159], v112 offset:12288
    s_lshl_b32 s31, s31, 13
    v_mfma_f32_16x16x32_bf16 v[52:55], a[168:171], a[76:79], v[52:55]
    ds_read_b64_tr_b16 a[160:161], v112 offset:16384
    s_add_u32 s31, s31, s17
    v_mfma_f32_16x16x32_bf16 v[52:55], a[164:167], a[68:71], v[52:55]
    ds_read_b64_tr_b16 a[162:163], v112 offset:20480
    buffer_load_dwordx4 a[0:3], v1, s[8:11], s31 offen offset:0 sc1
    s_waitcnt lgkmcnt(6)
    v_mfma_f32_16x16x32_bf16 v[60:63], a[136:139], a[68:71], v[60:63]
    ds_read_b64_tr_b16 a[164:165], v112 offset:24576
    v_mfma_f32_16x16x32_bf16 v[60:63], a[140:143], a[76:79], v[60:63]
    ds_read_b64_tr_b16 a[166:167], v112 offset:28672
    v_mfma_f32_16x16x32_bf16 v[60:63], a[144:147], a[84:87], v[60:63]
    ds_read_b64_tr_b16 a[168:169], v113 offset:0
    v_mfma_f32_16x16x32_bf16 v[60:63], a[148:151], a[92:95], v[60:63]
    ds_read_b64_tr_b16 a[170:171], v113 offset:4096
    buffer_load_dwordx4 a[4:7], v1, s[8:11], s31 offen offset:1024 sc1
    v_mfma_f32_16x16x32_bf16 v[56:59], a[148:151], a[88:91], v[56:59]
    ds_read_b64_tr_b16 a[128:129], v113 offset:8192
    v_mfma_f32_16x16x32_bf16 v[56:59], a[144:147], a[80:83], v[56:59]
    ds_read_b64_tr_b16 a[130:131], v113 offset:12288
    v_mfma_f32_16x16x32_bf16 v[56:59], a[140:143], a[72:75], v[56:59]
    ds_read_b64_tr_b16 a[132:133], v113 offset:16384
    v_mfma_f32_16x16x32_bf16 v[56:59], a[136:139], a[64:67], v[56:59]
    ds_read_b64_tr_b16 a[134:135], v113 offset:20480
    buffer_load_dwordx4 a[8:11], v1, s[8:11], s31 offen offset:2048 sc1
    s_waitcnt lgkmcnt(6)
    v_mfma_f32_16x16x32_bf16 v[64:67], a[152:155], a[64:67], v[64:67]
    ds_read_b64_tr_b16 a[136:137], v113 offset:24576
    v_mfma_f32_16x16x32_bf16 v[64:67], a[156:159], a[72:75], v[64:67]
    ds_read_b64_tr_b16 a[138:139], v113 offset:28672
    v_mfma_f32_16x16x32_bf16 v[64:67], a[160:163], a[80:83], v[64:67]
    ds_read_b64_tr_b16 a[140:141], v114 offset:0
    v_mfma_f32_16x16x32_bf16 v[64:67], a[164:167], a[88:91], v[64:67]
    ds_read_b64_tr_b16 a[142:143], v114 offset:4096
    buffer_load_dwordx4 a[12:15], v1, s[8:11], s31 offen offset:3072 sc1
    v_mfma_f32_16x16x32_bf16 v[68:71], a[164:167], a[92:95], v[68:71]
    ds_read_b64_tr_b16 a[144:145], v114 offset:8192
    v_mfma_f32_16x16x32_bf16 v[68:71], a[160:163], a[84:87], v[68:71]
    ds_read_b64_tr_b16 a[146:147], v114 offset:12288
    v_mfma_f32_16x16x32_bf16 v[68:71], a[156:159], a[76:79], v[68:71]
    ds_read_b64_tr_b16 a[148:149], v114 offset:16384
    v_mfma_f32_16x16x32_bf16 v[68:71], a[152:155], a[68:71], v[68:71]
    ds_read_b64_tr_b16 a[150:151], v114 offset:20480
    buffer_load_dwordx4 a[16:19], v30, s[8:11], s31 offen offset:0 sc1
    s_waitcnt lgkmcnt(6)
    v_mfma_f32_16x16x32_bf16 v[76:79], a[168:171], a[68:71], v[76:79]
    ds_read_b64_tr_b16 a[152:153], v114 offset:24576
    v_mfma_f32_16x16x32_bf16 v[76:79], a[128:131], a[76:79], v[76:79]
    ds_read_b64_tr_b16 a[154:155], v114 offset:28672
    v_mfma_f32_16x16x32_bf16 v[76:79], a[132:135], a[84:87], v[76:79]
    ds_read_b64_tr_b16 a[156:157], v115 offset:0
    v_mfma_f32_16x16x32_bf16 v[76:79], a[136:139], a[92:95], v[76:79]
    ds_read_b64_tr_b16 a[158:159], v115 offset:4096
    buffer_load_dwordx4 a[20:23], v30, s[8:11], s31 offen offset:1024 sc1
    v_mfma_f32_16x16x32_bf16 v[72:75], a[136:139], a[88:91], v[72:75]
    ds_read_b64_tr_b16 a[160:161], v115 offset:8192
    v_mfma_f32_16x16x32_bf16 v[72:75], a[132:135], a[80:83], v[72:75]
    ds_read_b64_tr_b16 a[162:163], v115 offset:12288
    buffer_load_dwordx4 a[24:27], v30, s[8:11], s31 offen offset:2048 sc1
    v_mfma_f32_16x16x32_bf16 v[72:75], a[128:131], a[72:75], v[72:75]
    ds_read_b64_tr_b16 a[164:165], v115 offset:16384
    v_mfma_f32_16x16x32_bf16 v[72:75], a[168:171], a[64:67], v[72:75]
    ds_read_b64_tr_b16 a[166:167], v115 offset:20480
    s_waitcnt lgkmcnt(6)
    v_mfma_f32_16x16x32_bf16 v[80:83], a[140:143], a[64:67], v[80:83]
    ds_read_b64_tr_b16 a[168:169], v115 offset:24576
    v_mfma_f32_16x16x32_bf16 v[80:83], a[144:147], a[72:75], v[80:83]
    ds_read_b64_tr_b16 a[170:171], v115 offset:28672
    buffer_load_dwordx4 a[28:31], v30, s[8:11], s31 offen offset:3072 sc1
    v_mfma_f32_16x16x32_bf16 v[80:83], a[148:151], a[80:83], v[80:83]
    s_waitcnt vmcnt(24)
    s_barrier
    ds_read_b64_tr_b16 a[128:129], v108 offset:32768
    s_add_u32 m0, s83, 32768
    v_mfma_f32_16x16x32_bf16 v[80:83], a[152:155], a[88:91], v[80:83]
    ds_read_b64_tr_b16 a[130:131], v108 offset:36864
    s_bfe_u32 s30, s71, 524296
    v_mfma_f32_16x16x32_bf16 v[84:87], a[152:155], a[92:95], v[84:87]
    ds_read_b64_tr_b16 a[132:133], v108 offset:40960
    s_lshl_b32 s30, s30, 16
    v_mfma_f32_16x16x32_bf16 v[84:87], a[148:151], a[84:87], v[84:87]
    ds_read_b64_tr_b16 a[134:135], v108 offset:45056
    s_add_u32 s30, s30, s73
    buffer_load_dwordx4 v20, s[44:47], s30 offen offset:0  lds
    v_mfma_f32_16x16x32_bf16 v[84:87], a[144:147], a[76:79], v[84:87]
    ds_read_b64_tr_b16 a[136:137], v108 offset:49152
    v_mfma_f32_16x16x32_bf16 v[84:87], a[140:143], a[68:71], v[84:87]
    ds_read_b64_tr_b16 a[138:139], v108 offset:53248
    s_waitcnt lgkmcnt(6)
    v_mfma_f32_16x16x32_bf16 v[92:95], a[156:159], a[68:71], v[92:95]
    ds_read_b64_tr_b16 a[140:141], v108 offset:57344
    v_mfma_f32_16x16x32_bf16 v[92:95], a[160:163], a[76:79], v[92:95]
    ds_read_b64_tr_b16 a[142:143], v108 offset:61440
    buffer_load_dwordx4 v21, s[44:47], s30 offen offset:1024  lds
    v_mfma_f32_16x16x32_bf16 v[92:95], a[164:167], a[84:87], v[92:95]
    ds_read_b64_tr_b16 a[144:145], v109 offset:32768
    v_mfma_f32_16x16x32_bf16 v[92:95], a[168:171], a[92:95], v[92:95]
    ds_read_b64_tr_b16 a[146:147], v109 offset:36864
    v_mfma_f32_16x16x32_bf16 v[88:91], a[168:171], a[88:91], v[88:91]
    ds_read_b64_tr_b16 a[148:149], v109 offset:40960
    v_mfma_f32_16x16x32_bf16 v[88:91], a[164:167], a[80:83], v[88:91]
    ds_read_b64_tr_b16 a[150:151], v109 offset:45056
    buffer_load_dwordx4 v22, s[44:47], s30 offen offset:2048  lds
    v_mfma_f32_16x16x32_bf16 v[88:91], a[160:163], a[72:75], v[88:91]
    ds_read_b64_tr_b16 a[152:153], v109 offset:49152
    v_mfma_f32_16x16x32_bf16 v[88:91], a[156:159], a[64:67], v[88:91]
    ds_read_b64_tr_b16 a[154:155], v109 offset:53248
    s_waitcnt vmcnt(19) lgkmcnt(6)
    v_mfma_f32_16x16x32_bf16 v[32:35], a[128:131], a[96:99], v[32:35]
    ds_read_b64_tr_b16 a[156:157], v109 offset:57344
    v_mfma_f32_16x16x32_bf16 v[32:35], a[132:135], a[104:107], v[32:35]
    ds_read_b64_tr_b16 a[158:159], v109 offset:61440
    buffer_load_dwordx4 v23, s[44:47], s30 offen offset:3072  lds
    v_mfma_f32_16x16x32_bf16 v[32:35], a[136:139], a[112:115], v[32:35]
    ds_read_b64_tr_b16 a[160:161], v110 offset:32768
    s_add_u32 m0, s83, 36864
    v_mfma_f32_16x16x32_bf16 v[32:35], a[140:143], a[120:123], v[32:35]
    ds_read_b64_tr_b16 a[162:163], v110 offset:36864
    v_mfma_f32_16x16x32_bf16 v[36:39], a[140:143], a[124:127], v[36:39]
    ds_read_b64_tr_b16 a[164:165], v110 offset:40960
    v_mfma_f32_16x16x32_bf16 v[36:39], a[136:139], a[116:119], v[36:39]
    ds_read_b64_tr_b16 a[166:167], v110 offset:45056
    buffer_load_dwordx4 v24, s[44:47], s30 offen offset:0  lds
    v_mfma_f32_16x16x32_bf16 v[36:39], a[132:135], a[108:111], v[36:39]
    ds_read_b64_tr_b16 a[168:169], v110 offset:49152
    v_mfma_f32_16x16x32_bf16 v[36:39], a[128:131], a[100:103], v[36:39]
    ds_read_b64_tr_b16 a[170:171], v110 offset:53248
    buffer_load_dwordx4 v25, s[44:47], s30 offen offset:1024  lds
    s_waitcnt lgkmcnt(6)
    v_mfma_f32_16x16x32_bf16 v[44:47], a[144:147], a[100:103], v[44:47]
    ds_read_b64_tr_b16 a[128:129], v110 offset:57344
    v_mfma_f32_16x16x32_bf16 v[44:47], a[148:151], a[108:111], v[44:47]
    ds_read_b64_tr_b16 a[130:131], v110 offset:61440
    v_mfma_f32_16x16x32_bf16 v[44:47], a[152:155], a[116:119], v[44:47]
    ds_read_b64_tr_b16 a[132:133], v111 offset:32768
    v_mfma_f32_16x16x32_bf16 v[44:47], a[156:159], a[124:127], v[44:47]
    ds_read_b64_tr_b16 a[134:135], v111 offset:36864
    buffer_load_dwordx4 v26, s[44:47], s30 offen offset:2048  lds
    v_mfma_f32_16x16x32_bf16 v[40:43], a[156:159], a[120:123], v[40:43]
    ds_read_b64_tr_b16 a[136:137], v111 offset:40960
    v_mfma_f32_16x16x32_bf16 v[40:43], a[152:155], a[112:115], v[40:43]
    ds_read_b64_tr_b16 a[138:139], v111 offset:45056
    v_mfma_f32_16x16x32_bf16 v[40:43], a[148:151], a[104:107], v[40:43]
    ds_read_b64_tr_b16 a[140:141], v111 offset:49152
    v_mfma_f32_16x16x32_bf16 v[40:43], a[144:147], a[96:99], v[40:43]
    ds_read_b64_tr_b16 a[142:143], v111 offset:53248
    buffer_load_dwordx4 v27, s[44:47], s30 offen offset:3072  lds
    s_waitcnt lgkmcnt(6)
    v_mfma_f32_16x16x32_bf16 v[48:51], a[160:163], a[96:99], v[48:51]
    ds_read_b64_tr_b16 a[144:145], v111 offset:57344
    s_bfe_u32 s31, s67, 262164
    v_mfma_f32_16x16x32_bf16 v[48:51], a[164:167], a[104:107], v[48:51]
    ds_read_b64_tr_b16 a[146:147], v111 offset:61440
    s_lshl_b32 s31, s31, 13
    v_mfma_f32_16x16x32_bf16 v[48:51], a[168:171], a[112:115], v[48:51]
    ds_read_b64_tr_b16 a[148:149], v112 offset:32768
    s_add_u32 s31, s31, s17
    v_mfma_f32_16x16x32_bf16 v[48:51], a[128:131], a[120:123], v[48:51]
    ds_read_b64_tr_b16 a[150:151], v112 offset:36864
    buffer_load_dwordx4 a[32:35], v1, s[8:11], s31 offen offset:0 sc1
    v_mfma_f32_16x16x32_bf16 v[52:55], a[128:131], a[124:127], v[52:55]
    ds_read_b64_tr_b16 a[152:153], v112 offset:40960
    v_mfma_f32_16x16x32_bf16 v[52:55], a[168:171], a[116:119], v[52:55]
    ds_read_b64_tr_b16 a[154:155], v112 offset:45056
    v_mfma_f32_16x16x32_bf16 v[52:55], a[164:167], a[108:111], v[52:55]
    ds_read_b64_tr_b16 a[156:157], v112 offset:49152
    v_mfma_f32_16x16x32_bf16 v[52:55], a[160:163], a[100:103], v[52:55]
    ds_read_b64_tr_b16 a[158:159], v112 offset:53248
    buffer_load_dwordx4 a[36:39], v1, s[8:11], s31 offen offset:1024 sc1
    s_waitcnt lgkmcnt(6)
    v_mfma_f32_16x16x32_bf16 v[60:63], a[132:135], a[100:103], v[60:63]
    ds_read_b64_tr_b16 a[160:161], v112 offset:57344
    v_mfma_f32_16x16x32_bf16 v[60:63], a[136:139], a[108:111], v[60:63]
    ds_read_b64_tr_b16 a[162:163], v112 offset:61440
    v_mfma_f32_16x16x32_bf16 v[60:63], a[140:143], a[116:119], v[60:63]
    ds_read_b64_tr_b16 a[164:165], v113 offset:32768
    v_mfma_f32_16x16x32_bf16 v[60:63], a[144:147], a[124:127], v[60:63]
    ds_read_b64_tr_b16 a[166:167], v113 offset:36864
    buffer_load_dwordx4 a[40:43], v1, s[8:11], s31 offen offset:2048 sc1
    v_mfma_f32_16x16x32_bf16 v[56:59], a[144:147], a[120:123], v[56:59]
    ds_read_b64_tr_b16 a[168:169], v113 offset:40960
    v_mfma_f32_16x16x32_bf16 v[56:59], a[140:143], a[112:115], v[56:59]
    ds_read_b64_tr_b16 a[170:171], v113 offset:45056
    buffer_load_dwordx4 a[44:47], v1, s[8:11], s31 offen offset:3072 sc1
    v_mfma_f32_16x16x32_bf16 v[56:59], a[136:139], a[104:107], v[56:59]
    ds_read_b64_tr_b16 a[128:129], v113 offset:49152
    v_mfma_f32_16x16x32_bf16 v[56:59], a[132:135], a[96:99], v[56:59]
    ds_read_b64_tr_b16 a[130:131], v113 offset:53248
    s_waitcnt lgkmcnt(6)
    v_mfma_f32_16x16x32_bf16 v[64:67], a[148:151], a[96:99], v[64:67]
    ds_read_b64_tr_b16 a[132:133], v113 offset:57344
    v_mfma_f32_16x16x32_bf16 v[64:67], a[152:155], a[104:107], v[64:67]
    ds_read_b64_tr_b16 a[134:135], v113 offset:61440
    buffer_load_dwordx4 a[48:51], v30, s[8:11], s31 offen offset:0 sc1
    v_mfma_f32_16x16x32_bf16 v[64:67], a[156:159], a[112:115], v[64:67]
    ds_read_b64_tr_b16 a[136:137], v114 offset:32768
    v_mfma_f32_16x16x32_bf16 v[64:67], a[160:163], a[120:123], v[64:67]
    ds_read_b64_tr_b16 a[138:139], v114 offset:36864
    v_mfma_f32_16x16x32_bf16 v[68:71], a[160:163], a[124:127], v[68:71]
    ds_read_b64_tr_b16 a[140:141], v114 offset:40960
    v_mfma_f32_16x16x32_bf16 v[68:71], a[156:159], a[116:119], v[68:71]
    ds_read_b64_tr_b16 a[142:143], v114 offset:45056
    buffer_load_dwordx4 a[52:55], v30, s[8:11], s31 offen offset:1024 sc1
    v_mfma_f32_16x16x32_bf16 v[68:71], a[152:155], a[108:111], v[68:71]
    ds_read_b64_tr_b16 a[144:145], v114 offset:49152
    v_mfma_f32_16x16x32_bf16 v[68:71], a[148:151], a[100:103], v[68:71]
    ds_read_b64_tr_b16 a[146:147], v114 offset:53248
    s_waitcnt lgkmcnt(6)
    v_mfma_f32_16x16x32_bf16 v[76:79], a[164:167], a[100:103], v[76:79]
    ds_read_b64_tr_b16 a[148:149], v114 offset:57344
    v_mfma_f32_16x16x32_bf16 v[76:79], a[168:171], a[108:111], v[76:79]
    ds_read_b64_tr_b16 a[150:151], v114 offset:61440
    buffer_load_dwordx4 a[56:59], v30, s[8:11], s31 offen offset:2048 sc1
    v_mfma_f32_16x16x32_bf16 v[76:79], a[128:131], a[116:119], v[76:79]
    ds_read_b64_tr_b16 a[152:153], v115 offset:32768
    v_mfma_f32_16x16x32_bf16 v[76:79], a[132:135], a[124:127], v[76:79]
    ds_read_b64_tr_b16 a[154:155], v115 offset:36864
    v_mfma_f32_16x16x32_bf16 v[72:75], a[132:135], a[120:123], v[72:75]
    ds_read_b64_tr_b16 a[156:157], v115 offset:40960
    v_mfma_f32_16x16x32_bf16 v[72:75], a[128:131], a[112:115], v[72:75]
    ds_read_b64_tr_b16 a[158:159], v115 offset:45056
    buffer_load_dwordx4 a[60:63], v30, s[8:11], s31 offen offset:3072 sc1
    v_mfma_f32_16x16x32_bf16 v[72:75], a[168:171], a[104:107], v[72:75]
    ds_read_b64_tr_b16 a[160:161], v115 offset:49152
    v_accvgpr_read_b32 v31, a201
    v_mfma_f32_16x16x32_bf16 v[72:75], a[164:167], a[96:99], v[72:75]
    ds_read_b64_tr_b16 a[162:163], v115 offset:53248
    s_waitcnt lgkmcnt(6)
    v_mfma_f32_16x16x32_bf16 v[80:83], a[136:139], a[96:99], v[80:83]
    ds_read_b64_tr_b16 a[164:165], v115 offset:57344
    v_mfma_f32_16x16x32_bf16 v[80:83], a[140:143], a[104:107], v[80:83]
    ds_read_b64_tr_b16 a[166:167], v115 offset:61440
    global_load_dword a200, v31, s[74:75]
    v_mfma_f32_16x16x32_bf16 v[80:83], a[144:147], a[112:115], v[80:83]
    s_waitcnt vmcnt(9)
    s_barrier
    ds_read_b64_tr_b16 a[168:169], v100 offset:0
    v_mfma_f32_16x16x32_bf16 v[80:83], a[148:151], a[120:123], v[80:83]
    ds_read_b64_tr_b16 a[170:171], v100 offset:4096
    v_mfma_f32_16x16x32_bf16 v[84:87], a[148:151], a[124:127], v[84:87]
    ds_read_b64_tr_b16 a[128:129], v100 offset:8192
    v_mfma_f32_16x16x32_bf16 v[84:87], a[144:147], a[116:119], v[84:87]
    ds_read_b64_tr_b16 a[130:131], v100 offset:12288
    v_mfma_f32_16x16x32_bf16 v[84:87], a[140:143], a[108:111], v[84:87]
    ds_read_b64_tr_b16 a[132:133], v100 offset:16384
    v_mfma_f32_16x16x32_bf16 v[84:87], a[136:139], a[100:103], v[84:87]
    ds_read_b64_tr_b16 a[134:135], v100 offset:20480
    s_waitcnt lgkmcnt(6)
    v_mfma_f32_16x16x32_bf16 v[92:95], a[152:155], a[100:103], v[92:95]
    ds_read_b64_tr_b16 a[136:137], v100 offset:24576
    v_mfma_f32_16x16x32_bf16 v[92:95], a[156:159], a[108:111], v[92:95]
    ds_read_b64_tr_b16 a[138:139], v100 offset:28672
    v_mfma_f32_16x16x32_bf16 v[92:95], a[160:163], a[116:119], v[92:95]
    ds_read_b64_tr_b16 a[140:141], v101 offset:0
    v_mfma_f32_16x16x32_bf16 v[92:95], a[164:167], a[124:127], v[92:95]
    ds_read_b64_tr_b16 a[142:143], v101 offset:4096
    v_mfma_f32_16x16x32_bf16 v[88:91], a[164:167], a[120:123], v[88:91]
    ds_read_b64_tr_b16 a[144:145], v101 offset:8192
    v_mfma_f32_16x16x32_bf16 v[88:91], a[160:163], a[112:115], v[88:91]
    ds_read_b64_tr_b16 a[146:147], v101 offset:12288
    v_mfma_f32_16x16x32_bf16 v[88:91], a[156:159], a[104:107], v[88:91]
    ds_read_b64_tr_b16 a[148:149], v101 offset:16384
    v_mfma_f32_16x16x32_bf16 v[88:91], a[152:155], a[96:99], v[88:91]
    ds_read_b64_tr_b16 a[150:151], v101 offset:20480
    s_cmp_eq_u32 s86, 10
    s_cbranch_scc1 L_pfin
    s_waitcnt lgkmcnt(6)
    v_mfma_f32_16x16x32_bf16 v[32:35], a[168:171], a[0:3], v[32:35]
    ds_read_b64_tr_b16 a[152:153], v101 offset:24576
    v_mfma_f32_16x16x32_bf16 v[32:35], a[128:131], a[8:11], v[32:35]
    ds_read_b64_tr_b16 a[154:155], v101 offset:28672
    v_mfma_f32_16x16x32_bf16 v[32:35], a[132:135], a[16:19], v[32:35]
    ds_read_b64_tr_b16 a[156:157], v100 offset:32768
    v_mfma_f32_16x16x32_bf16 v[32:35], a[136:139], a[24:27], v[32:35]
    ds_read_b64_tr_b16 a[158:159], v100 offset:36864
    v_mfma_f32_16x16x32_bf16 v[36:39], a[136:139], a[28:31], v[36:39]
    ds_read_b64_tr_b16 a[160:161], v100 offset:40960
    v_mfma_f32_16x16x32_bf16 v[36:39], a[132:135], a[20:23], v[36:39]
    ds_read_b64_tr_b16 a[162:163], v100 offset:45056
    v_mfma_f32_16x16x32_bf16 v[36:39], a[128:131], a[12:15], v[36:39]
    ds_read_b64_tr_b16 a[164:165], v100 offset:49152
    v_mfma_f32_16x16x32_bf16 v[36:39], a[168:171], a[4:7], v[36:39]
    ds_read_b64_tr_b16 a[166:167], v100 offset:53248
    s_waitcnt lgkmcnt(6)
    v_mfma_f32_16x16x32_bf16 v[44:47], a[140:143], a[4:7], v[44:47]
    ds_read_b64_tr_b16 a[168:169], v100 offset:57344
    v_mfma_f32_16x16x32_bf16 v[44:47], a[144:147], a[12:15], v[44:47]
    ds_read_b64_tr_b16 a[170:171], v100 offset:61440
    v_mfma_f32_16x16x32_bf16 v[44:47], a[148:151], a[20:23], v[44:47]
    ds_read_b64_tr_b16 a[128:129], v101 offset:32768
    v_mfma_f32_16x16x32_bf16 v[44:47], a[152:155], a[28:31], v[44:47]
    ds_read_b64_tr_b16 a[130:131], v101 offset:36864
    v_mfma_f32_16x16x32_bf16 v[40:43], a[152:155], a[24:27], v[40:43]
    ds_read_b64_tr_b16 a[132:133], v101 offset:40960
    v_mfma_f32_16x16x32_bf16 v[40:43], a[148:151], a[16:19], v[40:43]
    ds_read_b64_tr_b16 a[134:135], v101 offset:45056
    v_mfma_f32_16x16x32_bf16 v[40:43], a[144:147], a[8:11], v[40:43]
    ds_read_b64_tr_b16 a[136:137], v101 offset:49152
    v_mfma_f32_16x16x32_bf16 v[40:43], a[140:143], a[0:3], v[40:43]
    ds_read_b64_tr_b16 a[138:139], v101 offset:53248
    s_waitcnt vmcnt(1) lgkmcnt(6)
    v_mfma_f32_16x16x32_bf16 v[32:35], a[156:159], a[32:35], v[32:35]
    ds_read_b64_tr_b16 a[140:141], v101 offset:57344
    v_mfma_f32_16x16x32_bf16 v[32:35], a[160:163], a[40:43], v[32:35]
    ds_read_b64_tr_b16 a[142:143], v101 offset:61440
    v_mfma_f32_16x16x32_bf16 v[32:35], a[164:167], a[48:51], v[32:35]
    ds_read_b64_tr_b16 a[144:145], v102 offset:0
    v_mfma_f32_16x16x32_bf16 v[32:35], a[168:171], a[56:59], v[32:35]
    ds_read_b64_tr_b16 a[146:147], v102 offset:4096
    v_mfma_f32_16x16x32_bf16 v[36:39], a[168:171], a[60:63], v[36:39]
    ds_read_b64_tr_b16 a[148:149], v102 offset:8192
    v_mfma_f32_16x16x32_bf16 v[36:39], a[164:167], a[52:55], v[36:39]
    ds_read_b64_tr_b16 a[150:151], v102 offset:12288
    v_mfma_f32_16x16x32_bf16 v[36:39], a[160:163], a[44:47], v[36:39]
    ds_read_b64_tr_b16 a[152:153], v102 offset:16384
    v_mfma_f32_16x16x32_bf16 v[36:39], a[156:159], a[36:39], v[36:39]
    ds_read_b64_tr_b16 a[154:155], v102 offset:20480
    s_waitcnt lgkmcnt(6)
    v_mfma_f32_16x16x32_bf16 v[44:47], a[128:131], a[36:39], v[44:47]
    ds_read_b64_tr_b16 a[156:157], v102 offset:24576
    v_mfma_f32_16x16x32_bf16 v[44:47], a[132:135], a[44:47], v[44:47]
    ds_read_b64_tr_b16 a[158:159], v102 offset:28672
    v_mfma_f32_16x16x32_bf16 v[44:47], a[136:139], a[52:55], v[44:47]
    ds_read_b64_tr_b16 a[160:161], v103 offset:0
    v_cvt_pk_bf16_f32 v8, v36, v37
    v_mfma_f32_16x16x32_bf16 v[44:47], a[140:143], a[60:63], v[44:47]
    ds_read_b64_tr_b16 a[162:163], v103 offset:4096
    v_mfma_f32_16x16x32_bf16 v[40:43], a[140:143], a[56:59], v[40:43]
    ds_read_b64_tr_b16 a[164:165], v103 offset:8192
    v_mfma_f32_16x16x32_bf16 v[40:43], a[136:139], a[48:51], v[40:43]
    ds_read_b64_tr_b16 a[166:167], v103 offset:12288
    v_mfma_f32_16x16x32_bf16 v[40:43], a[132:135], a[40:43], v[40:43]
    ds_read_b64_tr_b16 a[168:169], v103 offset:16384
    v_mfma_f32_16x16x32_bf16 v[40:43], a[128:131], a[32:35], v[40:43]
    ds_read_b64_tr_b16 a[170:171], v103 offset:20480
    v_cvt_pk_bf16_f32 v10, v44, v45
    s_waitcnt lgkmcnt(6)
    v_mfma_f32_16x16x32_bf16 v[48:51], a[144:147], a[0:3], v[48:51]
    ds_read_b64_tr_b16 a[128:129], v103 offset:24576
    v_cvt_pk_bf16_f32 v9, v38, v39
    v_mfma_f32_16x16x32_bf16 v[48:51], a[148:151], a[8:11], v[48:51]
    ds_read_b64_tr_b16 a[130:131], v103 offset:28672
    v_cvt_pk_bf16_f32 v11, v46, v47
    v_mfma_f32_16x16x32_bf16 v[48:51], a[152:155], a[16:19], v[48:51]
    ds_read_b64_tr_b16 a[132:133], v102 offset:32768
    v_permlane16_swap_b32 v8, v10
    v_mfma_f32_16x16x32_bf16 v[48:51], a[156:159], a[24:27], v[48:51]
    ds_read_b64_tr_b16 a[134:135], v102 offset:36864
    v_cvt_pk_bf16_f32 v12, v32, v33
    v_mfma_f32_16x16x32_bf16 v[52:55], a[156:159], a[28:31], v[52:55]
    ds_read_b64_tr_b16 a[136:137], v102 offset:40960
    v_permlane16_swap_b32 v9, v11
    v_mfma_f32_16x16x32_bf16 v[52:55], a[152:155], a[20:23], v[52:55]
    ds_read_b64_tr_b16 a[138:139], v102 offset:45056
    buffer_store_dwordx4 v[8:11], v4, s[8:11], s20 offen offset:1024 sc1
    v_mfma_f32_16x16x32_bf16 v[52:55], a[148:151], a[12:15], v[52:55]
    ds_read_b64_tr_b16 a[140:141], v102 offset:49152
    v_cvt_pk_bf16_f32 v14, v40, v41
    v_mfma_f32_16x16x32_bf16 v[52:55], a[144:147], a[4:7], v[52:55]
    ds_read_b64_tr_b16 a[142:143], v102 offset:53248
    v_cvt_pk_bf16_f32 v13, v34, v35
    s_waitcnt lgkmcnt(6)
    v_mfma_f32_16x16x32_bf16 v[60:63], a[160:163], a[4:7], v[60:63]
    ds_read_b64_tr_b16 a[144:145], v102 offset:57344
    v_cvt_pk_bf16_f32 v15, v42, v43
    v_mfma_f32_16x16x32_bf16 v[60:63], a[164:167], a[12:15], v[60:63]
    ds_read_b64_tr_b16 a[146:147], v102 offset:61440
    v_permlane16_swap_b32 v12, v14
    v_mfma_f32_16x16x32_bf16 v[60:63], a[168:171], a[20:23], v[60:63]
    ds_read_b64_tr_b16 a[148:149], v103 offset:32768
    v_permlane16_swap_b32 v13, v15
    v_mfma_f32_16x16x32_bf16 v[60:63], a[128:131], a[28:31], v[60:63]
    ds_read_b64_tr_b16 a[150:151], v103 offset:36864
    buffer_store_dwordx4 v[12:15], v4, s[8:11], s20 offen offset:0 sc1
    v_mfma_f32_16x16x32_bf16 v[56:59], a[128:131], a[24:27], v[56:59]
    ds_read_b64_tr_b16 a[152:153], v103 offset:40960
    v_mfma_f32_16x16x32_bf16 v[56:59], a[168:171], a[16:19], v[56:59]
    ds_read_b64_tr_b16 a[154:155], v103 offset:45056
    v_mfma_f32_16x16x32_bf16 v[56:59], a[164:167], a[8:11], v[56:59]
    ds_read_b64_tr_b16 a[156:157], v103 offset:49152
    v_mfma_f32_16x16x32_bf16 v[56:59], a[160:163], a[0:3], v[56:59]
    ds_read_b64_tr_b16 a[158:159], v103 offset:53248
    s_waitcnt lgkmcnt(6)
    v_mfma_f32_16x16x32_bf16 v[48:51], a[132:135], a[32:35], v[48:51]
    ds_read_b64_tr_b16 a[160:161], v103 offset:57344
    v_mfma_f32_16x16x32_bf16 v[48:51], a[136:139], a[40:43], v[48:51]
    ds_read_b64_tr_b16 a[162:163], v103 offset:61440
    v_mfma_f32_16x16x32_bf16 v[48:51], a[140:143], a[48:51], v[48:51]
    ds_read_b64_tr_b16 a[164:165], v104 offset:0
    v_mfma_f32_16x16x32_bf16 v[48:51], a[144:147], a[56:59], v[48:51]
    ds_read_b64_tr_b16 a[166:167], v104 offset:4096
    v_mfma_f32_16x16x32_bf16 v[52:55], a[144:147], a[60:63], v[52:55]
    ds_read_b64_tr_b16 a[168:169], v104 offset:8192
    v_mfma_f32_16x16x32_bf16 v[52:55], a[140:143], a[52:55], v[52:55]
    ds_read_b64_tr_b16 a[170:171], v104 offset:12288
    v_mfma_f32_16x16x32_bf16 v[52:55], a[136:139], a[44:47], v[52:55]
    ds_read_b64_tr_b16 a[128:129], v104 offset:16384
    v_mfma_f32_16x16x32_bf16 v[52:55], a[132:135], a[36:39], v[52:55]
    ds_read_b64_tr_b16 a[130:131], v104 offset:20480
    s_waitcnt lgkmcnt(6)
    v_mfma_f32_16x16x32_bf16 v[60:63], a[148:151], a[36:39], v[60:63]
    ds_read_b64_tr_b16 a[132:133], v104 offset:24576
    v_mfma_f32_16x16x32_bf16 v[60:63], a[152:155], a[44:47], v[60:63]
    ds_read_b64_tr_b16 a[134:135], v104 offset:28672
    v_mfma_f32_16x16x32_bf16 v[60:63], a[156:159], a[52:55], v[60:63]
    ds_read_b64_tr_b16 a[136:137], v105 offset:0
    v_cvt_pk_bf16_f32 v16, v52, v53
    v_mfma_f32_16x16x32_bf16 v[60:63], a[160:163], a[60:63], v[60:63]
    ds_read_b64_tr_b16 a[138:139], v105 offset:4096
    v_mfma_f32_16x16x32_bf16 v[56:59], a[160:163], a[56:59], v[56:59]
    ds_read_b64_tr_b16 a[140:141], v105 offset:8192
    v_mfma_f32_16x16x32_bf16 v[56:59], a[156:159], a[48:51], v[56:59]
    ds_read_b64_tr_b16 a[142:143], v105 offset:12288
    v_mfma_f32_16x16x32_bf16 v[56:59], a[152:155], a[40:43], v[56:59]
    ds_read_b64_tr_b16 a[144:145], v105 offset:16384
    v_mfma_f32_16x16x32_bf16 v[56:59], a[148:151], a[32:35], v[56:59]
    ds_read_b64_tr_b16 a[146:147], v105 offset:20480
    v_cvt_pk_bf16_f32 v18, v60, v61
    s_waitcnt lgkmcnt(6)
    v_mfma_f32_16x16x32_bf16 v[64:67], a[164:167], a[0:3], v[64:67]
    ds_read_b64_tr_b16 a[148:149], v105 offset:24576
    v_cvt_pk_bf16_f32 v17, v54, v55
    v_mfma_f32_16x16x32_bf16 v[64:67], a[168:171], a[8:11], v[64:67]
    ds_read_b64_tr_b16 a[150:151], v105 offset:28672
    v_cvt_pk_bf16_f32 v19, v62, v63
    v_mfma_f32_16x16x32_bf16 v[64:67], a[128:131], a[16:19], v[64:67]
    ds_read_b64_tr_b16 a[152:153], v104 offset:32768
    v_permlane16_swap_b32 v16, v18
    v_mfma_f32_16x16x32_bf16 v[64:67], a[132:135], a[24:27], v[64:67]
    ds_read_b64_tr_b16 a[154:155], v104 offset:36864
    v_cvt_pk_bf16_f32 v8, v48, v49
    v_mfma_f32_16x16x32_bf16 v[68:71], a[132:135], a[28:31], v[68:71]
    ds_read_b64_tr_b16 a[156:157], v104 offset:40960
    v_permlane16_swap_b32 v17, v19
    v_mfma_f32_16x16x32_bf16 v[68:71], a[128:131], a[20:23], v[68:71]
    ds_read_b64_tr_b16 a[158:159], v104 offset:45056
    buffer_store_dwordx4 v[16:19], v4, s[8:11], s21 offen offset:1024 sc1
    v_mfma_f32_16x16x32_bf16 v[68:71], a[168:171], a[12:15], v[68:71]
    ds_read_b64_tr_b16 a[160:161], v104 offset:49152
    v_cvt_pk_bf16_f32 v10, v56, v57
    v_mfma_f32_16x16x32_bf16 v[68:71], a[164:167], a[4:7], v[68:71]
    ds_read_b64_tr_b16 a[162:163], v104 offset:53248
    v_cvt_pk_bf16_f32 v9, v50, v51
    s_waitcnt lgkmcnt(6)
    v_mfma_f32_16x16x32_bf16 v[76:79], a[136:139], a[4:7], v[76:79]
    ds_read_b64_tr_b16 a[164:165], v104 offset:57344
    v_cvt_pk_bf16_f32 v11, v58, v59
    v_mfma_f32_16x16x32_bf16 v[76:79], a[140:143], a[12:15], v[76:79]
    ds_read_b64_tr_b16 a[166:167], v104 offset:61440
    v_permlane16_swap_b32 v8, v10
    v_mfma_f32_16x16x32_bf16 v[76:79], a[144:147], a[20:23], v[76:79]
    ds_read_b64_tr_b16 a[168:169], v105 offset:32768
    v_permlane16_swap_b32 v9, v11
    v_mfma_f32_16x16x32_bf16 v[76:79], a[148:151], a[28:31], v[76:79]
    ds_read_b64_tr_b16 a[170:171], v105 offset:36864
    buffer_store_dwordx4 v[8:11], v4, s[8:11], s21 offen offset:0 sc1
    v_mfma_f32_16x16x32_bf16 v[72:75], a[148:151], a[24:27], v[72:75]
    ds_read_b64_tr_b16 a[128:129], v105 offset:40960
    v_mfma_f32_16x16x32_bf16 v[72:75], a[144:147], a[16:19], v[72:75]
    ds_read_b64_tr_b16 a[130:131], v105 offset:45056
    v_mfma_f32_16x16x32_bf16 v[72:75], a[140:143], a[8:11], v[72:75]
    ds_read_b64_tr_b16 a[132:133], v105 offset:49152
    v_mfma_f32_16x16x32_bf16 v[72:75], a[136:139], a[0:3], v[72:75]
    ds_read_b64_tr_b16 a[134:135], v105 offset:53248
    s_waitcnt lgkmcnt(6)
    v_mfma_f32_16x16x32_bf16 v[64:67], a[152:155], a[32:35], v[64:67]
    ds_read_b64_tr_b16 a[136:137], v105 offset:57344
    v_mfma_f32_16x16x32_bf16 v[64:67], a[156:159], a[40:43], v[64:67]
    ds_read_b64_tr_b16 a[138:139], v105 offset:61440
    v_mfma_f32_16x16x32_bf16 v[64:67], a[160:163], a[48:51], v[64:67]
    ds_read_b64_tr_b16 a[140:141], v106 offset:0
    v_mfma_f32_16x16x32_bf16 v[64:67], a[164:167], a[56:59], v[64:67]
    ds_read_b64_tr_b16 a[142:143], v106 offset:4096
    v_mfma_f32_16x16x32_bf16 v[68:71], a[164:167], a[60:63], v[68:71]
    ds_read_b64_tr_b16 a[144:145], v106 offset:8192
    v_mfma_f32_16x16x32_bf16 v[68:71], a[160:163], a[52:55], v[68:71]
    ds_read_b64_tr_b16 a[146:147], v106 offset:12288
    v_mfma_f32_16x16x32_bf16 v[68:71], a[156:159], a[44:47], v[68:71]
    ds_read_b64_tr_b16 a[148:149], v106 offset:16384
    v_mfma_f32_16x16x32_bf16 v[68:71], a[152:155], a[36:39], v[68:71]
    ds_read_b64_tr_b16 a[150:151], v106 offset:20480
    s_waitcnt lgkmcnt(6)
    v_mfma_f32_16x16x32_bf16 v[76:79], a[168:171], a[36:39], v[76:79]
    ds_read_b64_tr_b16 a[152:153], v106 offset:24576
    v_mfma_f32_16x16x32_bf16 v[76:79], a[128:131], a[44:47], v[76:79]
    ds_read_b64_tr_b16 a[154:155], v106 offset:28672
    v_mfma_f32_16x16x32_bf16 v[76:79], a[132:135], a[52:55], v[76:79]
    ds_read_b64_tr_b16 a[156:157], v107 offset:0
    v_cvt_pk_bf16_f32 v12, v68, v69
    v_mfma_f32_16x16x32_bf16 v[76:79], a[136:139], a[60:63], v[76:79]
    ds_read_b64_tr_b16 a[158:159], v107 offset:4096
    v_mfma_f32_16x16x32_bf16 v[72:75], a[136:139], a[56:59], v[72:75]
    ds_read_b64_tr_b16 a[160:161], v107 offset:8192
    v_mfma_f32_16x16x32_bf16 v[72:75], a[132:135], a[48:51], v[72:75]
    ds_read_b64_tr_b16 a[162:163], v107 offset:12288
    v_mfma_f32_16x16x32_bf16 v[72:75], a[128:131], a[40:43], v[72:75]
    ds_read_b64_tr_b16 a[164:165], v107 offset:16384
    v_mfma_f32_16x16x32_bf16 v[72:75], a[168:171], a[32:35], v[72:75]
    ds_read_b64_tr_b16 a[166:167], v107 offset:20480
    v_cvt_pk_bf16_f32 v14, v76, v77
    s_waitcnt lgkmcnt(6)
    v_mfma_f32_16x16x32_bf16 v[80:83], a[140:143], a[0:3], v[80:83]
    ds_read_b64_tr_b16 a[168:169], v107 offset:24576
    v_cvt_pk_bf16_f32 v13, v70, v71
    v_mfma_f32_16x16x32_bf16 v[80:83], a[144:147], a[8:11], v[80:83]
    ds_read_b64_tr_b16 a[170:171], v107 offset:28672
    v_cvt_pk_bf16_f32 v15, v78, v79
    v_mfma_f32_16x16x32_bf16 v[80:83], a[148:151], a[16:19], v[80:83]
    ds_read_b64_tr_b16 a[128:129], v106 offset:32768
    v_permlane16_swap_b32 v12, v14
    v_mfma_f32_16x16x32_bf16 v[80:83], a[152:155], a[24:27], v[80:83]
    ds_read_b64_tr_b16 a[130:131], v106 offset:36864
    v_cvt_pk_bf16_f32 v16, v64, v65
    v_mfma_f32_16x16x32_bf16 v[84:87], a[152:155], a[28:31], v[84:87]
    ds_read_b64_tr_b16 a[132:133], v106 offset:40960
    v_permlane16_swap_b32 v13, v15
    v_mfma_f32_16x16x32_bf16 v[84:87], a[148:151], a[20:23], v[84:87]
    ds_read_b64_tr_b16 a[134:135], v106 offset:45056
    buffer_store_dwordx4 v[12:15], v4, s[8:11], s22 offen offset:1024 sc1
    v_mfma_f32_16x16x32_bf16 v[84:87], a[144:147], a[12:15], v[84:87]
    ds_read_b64_tr_b16 a[136:137], v106 offset:49152
    v_cvt_pk_bf16_f32 v18, v72, v73
    v_mfma_f32_16x16x32_bf16 v[84:87], a[140:143], a[4:7], v[84:87]
    ds_read_b64_tr_b16 a[138:139], v106 offset:53248
    v_cvt_pk_bf16_f32 v17, v66, v67
    s_waitcnt lgkmcnt(6)
    v_mfma_f32_16x16x32_bf16 v[92:95], a[156:159], a[4:7], v[92:95]
    ds_read_b64_tr_b16 a[140:141], v106 offset:57344
    v_cvt_pk_bf16_f32 v19, v74, v75
    v_mfma_f32_16x16x32_bf16 v[92:95], a[160:163], a[12:15], v[92:95]
    ds_read_b64_tr_b16 a[142:143], v106 offset:61440
    v_permlane16_swap_b32 v16, v18
    v_mfma_f32_16x16x32_bf16 v[92:95], a[164:167], a[20:23], v[92:95]
    ds_read_b64_tr_b16 a[144:145], v107 offset:32768
    v_permlane16_swap_b32 v17, v19
    v_mfma_f32_16x16x32_bf16 v[92:95], a[168:171], a[28:31], v[92:95]
    ds_read_b64_tr_b16 a[146:147], v107 offset:36864
    buffer_store_dwordx4 v[16:19], v4, s[8:11], s22 offen offset:0 sc1
    v_mfma_f32_16x16x32_bf16 v[88:91], a[168:171], a[24:27], v[88:91]
    ds_read_b64_tr_b16 a[148:149], v107 offset:40960
    v_mfma_f32_16x16x32_bf16 v[88:91], a[164:167], a[16:19], v[88:91]
    ds_read_b64_tr_b16 a[150:151], v107 offset:45056
    v_mfma_f32_16x16x32_bf16 v[88:91], a[160:163], a[8:11], v[88:91]
    ds_read_b64_tr_b16 a[152:153], v107 offset:49152
    v_mfma_f32_16x16x32_bf16 v[88:91], a[156:159], a[0:3], v[88:91]
    ds_read_b64_tr_b16 a[154:155], v107 offset:53248
    s_waitcnt lgkmcnt(6)
    v_mfma_f32_16x16x32_bf16 v[80:83], a[128:131], a[32:35], v[80:83]
    ds_read_b64_tr_b16 a[156:157], v107 offset:57344
    v_mfma_f32_16x16x32_bf16 v[80:83], a[132:135], a[40:43], v[80:83]
    ds_read_b64_tr_b16 a[158:159], v107 offset:61440
    v_mfma_f32_16x16x32_bf16 v[80:83], a[136:139], a[48:51], v[80:83]
    v_mfma_f32_16x16x32_bf16 v[80:83], a[140:143], a[56:59], v[80:83]
    v_mfma_f32_16x16x32_bf16 v[84:87], a[140:143], a[60:63], v[84:87]
    v_mfma_f32_16x16x32_bf16 v[84:87], a[136:139], a[52:55], v[84:87]
    v_mfma_f32_16x16x32_bf16 v[84:87], a[132:135], a[44:47], v[84:87]
    v_mfma_f32_16x16x32_bf16 v[84:87], a[128:131], a[36:39], v[84:87]
    s_waitcnt vmcnt(2)
    s_barrier
    s_add_u32 s86, s86, 1
    v_mov_b32 v29, s86
    buffer_store_dword v29, v2, s[8:11], s101 offen sc1
    s_waitcnt lgkmcnt(0)
    v_mfma_f32_16x16x32_bf16 v[92:95], a[144:147], a[36:39], v[92:95]
    v_mfma_f32_16x16x32_bf16 v[92:95], a[148:151], a[44:47], v[92:95]
    v_cvt_pk_bf16_f32 v8, v84, v85
    v_mfma_f32_16x16x32_bf16 v[92:95], a[152:155], a[52:55], v[92:95]
    v_mfma_f32_16x16x32_bf16 v[92:95], a[156:159], a[60:63], v[92:95]
    v_mfma_f32_16x16x32_bf16 v[88:91], a[156:159], a[56:59], v[88:91]
    v_mfma_f32_16x16x32_bf16 v[88:91], a[152:155], a[48:51], v[88:91]
    v_mfma_f32_16x16x32_bf16 v[88:91], a[148:151], a[40:43], v[88:91]
    v_mfma_f32_16x16x32_bf16 v[88:91], a[144:147], a[32:35], v[88:91]
    s_nop 3
    v_cvt_pk_bf16_f32 v10, v92, v93
    v_cvt_pk_bf16_f32 v9, v86, v87
    v_cvt_pk_bf16_f32 v11, v94, v95
    v_permlane16_swap_b32 v8, v10
    v_cvt_pk_bf16_f32 v12, v80, v81
    v_permlane16_swap_b32 v9, v11
    buffer_store_dwordx4 v[8:11], v4, s[8:11], s23 offen offset:1024 sc1
    v_cvt_pk_bf16_f32 v14, v88, v89
    v_cvt_pk_bf16_f32 v13, v82, v83
    v_cvt_pk_bf16_f32 v15, v90, v91
    v_permlane16_swap_b32 v12, v14
    s_nop 0
    v_permlane16_swap_b32 v13, v15
    buffer_store_dwordx4 v[12:15], v4, s[8:11], s23 offen offset:0 sc1
    v_and_b32 v4, 7, v0
    v_lshrrev_b32 v5, 3, v0
    v_lshrrev_b32 v6, 2, v5
    v_and_b32 v7, 3, v5
    v_lshlrev_b32 v6, 12, v6
    v_lshl_add_u32 v6, v7, 8, v6
    v_lshl_add_u32 v6, v4, 4, v6
    v_lshlrev_b32 v7, 11, v4
    v_lshl_add_u32 v7, v5, 4, v7
    v_lshlrev_b32 v15, 5, v4
    v_add_u32 v15, 159744, v15
    s_lshl_b32 s7, s4, 3
    v_add_u32 v14, s7, v15
    v_bfe_u32 v13, v3, 4, 1
    v_lshl_add_u32 v14, v13, 2, v14
    s_lshr_b32 s5, s84, 3
    s_lshl_b32 s12, s5, 17
    s_bfe_u32 s5, s84, 0x20001
    s_lshl_b32 s5, s5, 10
    s_add_u32 s12, s12, s5
    s_and_b32 s5, s84, 1
    s_lshl_b32 s5, s5, 7
    s_add_u32 s12, s12, s5
    s_add_u32 s12, s12, s85
    s_lshl_b32 s13, s84, 14
    v_accvgpr_read_b32 v32, a224
    v_accvgpr_read_b32 v33, a225
    v_accvgpr_read_b32 v34, a226
    v_accvgpr_read_b32 v35, a227
    v_accvgpr_read_b32 v36, a228
    v_accvgpr_read_b32 v37, a229
    v_accvgpr_read_b32 v38, a230
    v_accvgpr_read_b32 v39, a231
    v_accvgpr_read_b32 v40, a232
    v_accvgpr_read_b32 v41, a233
    v_accvgpr_read_b32 v42, a234
    v_accvgpr_read_b32 v43, a235
    v_accvgpr_read_b32 v44, a236
    v_accvgpr_read_b32 v45, a237
    v_accvgpr_read_b32 v46, a238
    v_accvgpr_read_b32 v47, a239
    v_lshlrev_b32 v96, 16, v32
    v_and_b32 v97, 0xffff0000, v32
    v_lshlrev_b32 v98, 16, v33
    v_and_b32 v99, 0xffff0000, v33
    v_lshlrev_b32 v100, 16, v34
    v_and_b32 v101, 0xffff0000, v34
    v_lshlrev_b32 v102, 16, v35
    v_and_b32 v103, 0xffff0000, v35
    v_lshlrev_b32 v104, 16, v36
    v_and_b32 v105, 0xffff0000, v36
    v_lshlrev_b32 v106, 16, v37
    v_and_b32 v107, 0xffff0000, v37
    v_lshlrev_b32 v108, 16, v38
    v_and_b32 v109, 0xffff0000, v38
    v_lshlrev_b32 v110, 16, v39
    v_and_b32 v111, 0xffff0000, v39
    v_lshlrev_b32 v112, 16, v40
    v_and_b32 v113, 0xffff0000, v40
    v_lshlrev_b32 v114, 16, v41
    v_and_b32 v115, 0xffff0000, v41
    v_lshlrev_b32 v116, 16, v42
    v_and_b32 v117, 0xffff0000, v42
    v_lshlrev_b32 v118, 16, v43
    v_and_b32 v119, 0xffff0000, v43
    v_lshlrev_b32 v120, 16, v44
    v_and_b32 v121, 0xffff0000, v44
    v_lshlrev_b32 v122, 16, v45
    v_and_b32 v123, 0xffff0000, v45
    v_lshlrev_b32 v124, 16, v46
    v_and_b32 v125, 0xffff0000, v46
    v_lshlrev_b32 v126, 16, v47
    v_and_b32 v127, 0xffff0000, v47
    v_accvgpr_read_b32 v28, a206
    s_and_b32 s17, s4, 1
    s_lshl_b32 s17, s17, 22
    s_xor_b32 s18, s17, 4194304
    s_add_u32 s17, s17, s12
    s_add_u32 s18, s18, s12
    s_mov_b32 s19, s86
    s_waitcnt vmcnt(0)
    buffer_load_dword v31, v28, s[8:11], s87 offen sc1
    s_barrier
    s_add_u32 s86, s86, 1
    v_mov_b32 v29, s86
    buffer_store_dword v29, v2, s[8:11], s101 offen sc1
    v_accvgpr_read_b32 v32, a240
    v_accvgpr_read_b32 v33, a241
    v_accvgpr_read_b32 v34, a242
    v_accvgpr_read_b32 v35, a243
    v_accvgpr_read_b32 v36, a244
    v_accvgpr_read_b32 v37, a245
    v_accvgpr_read_b32 v38, a246
    v_accvgpr_read_b32 v39, a247
    v_accvgpr_read_b32 v40, a248
    v_accvgpr_read_b32 v41, a249
    v_accvgpr_read_b32 v42, a250
    v_accvgpr_read_b32 v43, a251
    v_accvgpr_read_b32 v44, a252
    v_accvgpr_read_b32 v45, a253
    v_accvgpr_read_b32 v46, a254
    v_accvgpr_read_b32 v47, a255
    v_lshlrev_b32 v128, 16, v32
    v_and_b32 v129, 0xffff0000, v32
    v_lshlrev_b32 v130, 16, v33
    v_and_b32 v131, 0xffff0000, v33
    v_lshlrev_b32 v132, 16, v34
    v_and_b32 v133, 0xffff0000, v34
    v_lshlrev_b32 v134, 16, v35
    v_and_b32 v135, 0xffff0000, v35
    v_lshlrev_b32 v136, 16, v36
    v_and_b32 v137, 0xffff0000, v36
    v_lshlrev_b32 v138, 16, v37
    v_and_b32 v139, 0xffff0000, v37
    v_lshlrev_b32 v140, 16, v38
    v_and_b32 v141, 0xffff0000, v38
    v_lshlrev_b32 v142, 16, v39
    v_and_b32 v143, 0xffff0000, v39
    v_lshlrev_b32 v144, 16, v40
    v_and_b32 v145, 0xffff0000, v40
    v_lshlrev_b32 v146, 16, v41
    v_and_b32 v147, 0xffff0000, v41
    v_lshlrev_b32 v148, 16, v42
    v_and_b32 v149, 0xffff0000, v42
    v_lshlrev_b32 v150, 16, v43
    v_and_b32 v151, 0xffff0000, v43
    v_lshlrev_b32 v152, 16, v44
    v_and_b32 v153, 0xffff0000, v44
    v_lshlrev_b32 v154, 16, v45
    v_and_b32 v155, 0xffff0000, v45
    v_lshlrev_b32 v156, 16, v46
    v_and_b32 v157, 0xffff0000, v46
    v_lshlrev_b32 v158, 16, v47
    v_and_b32 v159, 0xffff0000, v47
    s_waitcnt vmcnt(1)
    v_cmp_le_u32 vcc, s19, v31
    s_cmp_eq_u64 vcc, -1
    s_cbranch_scc1 L_pe
    s_mov_b32 s3, 0
L_poll_35:
    buffer_load_dword v29, v28, s[8:11], s87 offen sc1
    s_add_u32 s3, s3, 1
    s_waitcnt vmcnt(0)
    v_cmp_gt_u32 vcc, s19, v29
    s_and_b64 exec, exec, vcc
    s_cbranch_scc0 L_pexit_37
    s_cmp_lt_u32 s3, 400000
    s_cbranch_scc1 L_poll_35
L_pexit_37:
    s_mov_b64 exec, -1
L_pdone_36:
L_pe:
    s_add_u32 s16, s17, 58720256
    buffer_load_dwordx4 v[192:195], v6, s[8:11], s16 offen sc1
    s_add_u32 s16, s17, 58753024
    buffer_load_dwordx4 v[196:199], v6, s[8:11], s16 offen sc1
    s_add_u32 s16, s17, 58785792
    buffer_load_dwordx4 v[200:203], v6, s[8:11], s16 offen sc1
    s_add_u32 s16, s17, 58818560
    buffer_load_dwordx4 v[204:207], v6, s[8:11], s16 offen sc1
    v_xor_b32 v28, 0x200, v28
    buffer_load_dword v29, v28, s[8:11], s87 offen sc1
    s_waitcnt vmcnt(0)
    v_cmp_le_u32 vcc, s86, v29
    s_cmp_eq_u64 vcc, -1
    s_cbranch_scc1 L_pf
    s_mov_b32 s3, 0
L_poll_38:
    buffer_load_dword v29, v28, s[8:11], s87 offen sc1
    s_add_u32 s3, s3, 1
    s_waitcnt vmcnt(0)
    v_cmp_gt_u32 vcc, s86, v29
    s_and_b64 exec, exec, vcc
    s_cbranch_scc0 L_pexit_40
    s_cmp_lt_u32 s3, 400000
    s_cbranch_scc1 L_poll_38
L_pexit_40:
    s_mov_b64 exec, -1
L_pdone_39:
L_pf:
    s_add_u32 s16, s18, 58720256
    buffer_load_dwordx4 v[208:211], v6, s[8:11], s16 offen sc1
    s_add_u32 s16, s18, 58753024
    buffer_load_dwordx4 v[212:215], v6, s[8:11], s16 offen sc1
    s_add_u32 s16, s18, 58785792
    buffer_load_dwordx4 v[216:219], v6, s[8:11], s16 offen sc1
    s_add_u32 s16, s18, 58818560
    buffer_load_dwordx4 v[220:223], v6, s[8:11], s16 offen sc1
    v_lshlrev_b32 v20, 16, v192
    v_and_b32 v21, 0xffff0000, v192
    v_pk_add_f32 v[96:97], v[96:97], v[20:21]
    v_lshlrev_b32 v22, 16, v193
    v_and_b32 v23, 0xffff0000, v193
    v_pk_add_f32 v[98:99], v[98:99], v[22:23]
    v_lshlrev_b32 v20, 16, v194
    v_and_b32 v21, 0xffff0000, v194
    v_pk_add_f32 v[100:101], v[100:101], v[20:21]
    v_lshlrev_b32 v22, 16, v195
    v_and_b32 v23, 0xffff0000, v195
    v_pk_add_f32 v[102:103], v[102:103], v[22:23]
    v_lshlrev_b32 v20, 16, v196
    v_and_b32 v21, 0xffff0000, v196
    v_pk_add_f32 v[104:105], v[104:105], v[20:21]
    v_lshlrev_b32 v22, 16, v197
    v_and_b32 v23, 0xffff0000, v197
    v_pk_add_f32 v[106:107], v[106:107], v[22:23]
    v_lshlrev_b32 v20, 16, v198
    v_and_b32 v21, 0xffff0000, v198
    v_pk_add_f32 v[108:109], v[108:109], v[20:21]
    v_lshlrev_b32 v22, 16, v199
    v_and_b32 v23, 0xffff0000, v199
    v_pk_add_f32 v[110:111], v[110:111], v[22:23]
    v_lshlrev_b32 v20, 16, v200
    v_and_b32 v21, 0xffff0000, v200
    v_pk_add_f32 v[112:113], v[112:113], v[20:21]
    v_lshlrev_b32 v22, 16, v201
    v_and_b32 v23, 0xffff0000, v201
    v_pk_add_f32 v[114:115], v[114:115], v[22:23]
    v_lshlrev_b32 v20, 16, v202
    v_and_b32 v21, 0xffff0000, v202
    v_pk_add_f32 v[116:117], v[116:117], v[20:21]
    v_lshlrev_b32 v22, 16, v203
    v_and_b32 v23, 0xffff0000, v203
    v_pk_add_f32 v[118:119], v[118:119], v[22:23]
    v_lshlrev_b32 v20, 16, v204
    v_and_b32 v21, 0xffff0000, v204
    v_pk_add_f32 v[120:121], v[120:121], v[20:21]
    v_lshlrev_b32 v22, 16, v205
    v_and_b32 v23, 0xffff0000, v205
    v_pk_add_f32 v[122:123], v[122:123], v[22:23]
    v_lshlrev_b32 v20, 16, v206
    v_and_b32 v21, 0xffff0000, v206
    v_pk_add_f32 v[124:125], v[124:125], v[20:21]
    v_lshlrev_b32 v22, 16, v207
    v_and_b32 v23, 0xffff0000, v207
    v_pk_add_f32 v[126:127], v[126:127], v[22:23]
    s_add_u32 s85, s85, 33554432
    s_add_u32 s12, s12, 33554432
    s_load_dwordx2 s[36:37], s[0:1], 80
    v_lshlrev_b32 v41, 6, v4
    v_add_u32 v41, 160256, v41
    v_lshrrev_b32 v40, 4, v0
    v_lshl_add_u32 v40, v40, 2, v41
    v_pk_add_f32 v[42:43], v[128:129], v[130:131]
    v_pk_add_f32 v[42:43], v[42:43], v[132:133]
    v_pk_add_f32 v[42:43], v[42:43], v[134:135]
    v_pk_add_f32 v[42:43], v[42:43], v[136:137]
    v_pk_add_f32 v[42:43], v[42:43], v[138:139]
    v_pk_add_f32 v[42:43], v[42:43], v[140:141]
    v_pk_add_f32 v[42:43], v[42:43], v[142:143]
    v_pk_add_f32 v[42:43], v[42:43], v[144:145]
    v_pk_add_f32 v[42:43], v[42:43], v[146:147]
    v_pk_add_f32 v[42:43], v[42:43], v[148:149]
    v_pk_add_f32 v[42:43], v[42:43], v[150:151]
    v_pk_add_f32 v[42:43], v[42:43], v[152:153]
    v_pk_add_f32 v[42:43], v[42:43], v[154:155]
    v_pk_add_f32 v[42:43], v[42:43], v[156:157]
    v_pk_add_f32 v[42:43], v[42:43], v[158:159]
    v_add_f32 v42, v42, v43
    s_waitcnt vmcnt(3)
    v_lshlrev_b32 v20, 16, v208
    v_and_b32 v21, 0xffff0000, v208
    v_pk_add_f32 v[96:97], v[96:97], v[20:21]
    v_pk_mul_f32 v[12:13], v[96:97], v[96:97]
    v_pk_mul_f32 v[44:45], v[96:97], v[128:129]
    v_lshlrev_b32 v20, 16, v209
    v_and_b32 v21, 0xffff0000, v209
    v_pk_add_f32 v[98:99], v[98:99], v[20:21]
    v_pk_add_f32 v[10:11], v[96:97], v[98:99]
    v_pk_fma_f32 v[12:13], v[98:99], v[98:99], v[12:13]
    v_pk_fma_f32 v[44:45], v[98:99], v[130:131], v[44:45]
    v_lshlrev_b32 v20, 16, v210
    v_and_b32 v21, 0xffff0000, v210
    v_pk_add_f32 v[100:101], v[100:101], v[20:21]
    v_pk_add_f32 v[10:11], v[10:11], v[100:101]
    v_pk_fma_f32 v[12:13], v[100:101], v[100:101], v[12:13]
    v_pk_fma_f32 v[44:45], v[100:101], v[132:133], v[44:45]
    v_lshlrev_b32 v20, 16, v211
    v_and_b32 v21, 0xffff0000, v211
    v_pk_add_f32 v[102:103], v[102:103], v[20:21]
    v_pk_add_f32 v[10:11], v[10:11], v[102:103]
    v_pk_fma_f32 v[12:13], v[102:103], v[102:103], v[12:13]
    v_pk_fma_f32 v[44:45], v[102:103], v[134:135], v[44:45]
    s_waitcnt vmcnt(2)
    v_lshlrev_b32 v20, 16, v212
    v_and_b32 v21, 0xffff0000, v212
    v_pk_add_f32 v[104:105], v[104:105], v[20:21]
    v_pk_add_f32 v[10:11], v[10:11], v[104:105]
    v_pk_fma_f32 v[12:13], v[104:105], v[104:105], v[12:13]
    v_pk_fma_f32 v[44:45], v[104:105], v[136:137], v[44:45]
    v_lshlrev_b32 v20, 16, v213
    v_and_b32 v21, 0xffff0000, v213
    v_pk_add_f32 v[106:107], v[106:107], v[20:21]
    v_pk_add_f32 v[10:11], v[10:11], v[106:107]
    v_pk_fma_f32 v[12:13], v[106:107], v[106:107], v[12:13]
    v_pk_fma_f32 v[44:45], v[106:107], v[138:139], v[44:45]
    v_lshlrev_b32 v20, 16, v214
    v_and_b32 v21, 0xffff0000, v214
    v_pk_add_f32 v[108:109], v[108:109], v[20:21]
    v_pk_add_f32 v[10:11], v[10:11], v[108:109]
    v_pk_fma_f32 v[12:13], v[108:109], v[108:109], v[12:13]
    v_pk_fma_f32 v[44:45], v[108:109], v[140:141], v[44:45]
    v_lshlrev_b32 v20, 16, v215
    v_and_b32 v21, 0xffff0000, v215
    v_pk_add_f32 v[110:111], v[110:111], v[20:21]
    v_pk_add_f32 v[10:11], v[10:11], v[110:111]
    v_pk_fma_f32 v[12:13], v[110:111], v[110:111], v[12:13]
    v_pk_fma_f32 v[44:45], v[110:111], v[142:143], v[44:45]
    s_waitcnt vmcnt(1)
    v_lshlrev_b32 v20, 16, v216
    v_and_b32 v21, 0xffff0000, v216
    v_pk_add_f32 v[112:113], v[112:113], v[20:21]
    v_pk_add_f32 v[10:11], v[10:11], v[112:113]
    v_pk_fma_f32 v[12:13], v[112:113], v[112:113], v[12:13]
    v_pk_fma_f32 v[44:45], v[112:113], v[144:145], v[44:45]
    v_lshlrev_b32 v20, 16, v217
    v_and_b32 v21, 0xffff0000, v217
    v_pk_add_f32 v[114:115], v[114:115], v[20:21]
    v_pk_add_f32 v[10:11], v[10:11], v[114:115]
    v_pk_fma_f32 v[12:13], v[114:115], v[114:115], v[12:13]
    v_pk_fma_f32 v[44:45], v[114:115], v[146:147], v[44:45]
    v_lshlrev_b32 v20, 16, v218
    v_and_b32 v21, 0xffff0000, v218
    v_pk_add_f32 v[116:117], v[116:117], v[20:21]
    v_pk_add_f32 v[10:11], v[10:11], v[116:117]
    v_pk_fma_f32 v[12:13], v[116:117], v[116:117], v[12:13]
    v_pk_fma_f32 v[44:45], v[116:117], v[148:149], v[44:45]
    v_lshlrev_b32 v20, 16, v219
    v_and_b32 v21, 0xffff0000, v219
    v_pk_add_f32 v[118:119], v[118:119], v[20:21]
    v_pk_add_f32 v[10:11], v[10:11], v[118:119]
    v_pk_fma_f32 v[12:13], v[118:119], v[118:119], v[12:13]
    v_pk_fma_f32 v[44:45], v[118:119], v[150:151], v[44:45]
    s_waitcnt vmcnt(0)
    v_lshlrev_b32 v20, 16, v220
    v_and_b32 v21, 0xffff0000, v220
    v_pk_add_f32 v[120:121], v[120:121], v[20:21]
    v_pk_add_f32 v[10:11], v[10:11], v[120:121]
    v_pk_fma_f32 v[12:13], v[120:121], v[120:121], v[12:13]
    v_pk_fma_f32 v[44:45], v[120:121], v[152:153], v[44:45]
    v_lshlrev_b32 v20, 16, v221
    v_and_b32 v21, 0xffff0000, v221
    v_pk_add_f32 v[122:123], v[122:123], v[20:21]
    v_pk_add_f32 v[10:11], v[10:11], v[122:123]
    v_pk_fma_f32 v[12:13], v[122:123], v[122:123], v[12:13]
    v_pk_fma_f32 v[44:45], v[122:123], v[154:155], v[44:45]
    v_lshlrev_b32 v20, 16, v222
    v_and_b32 v21, 0xffff0000, v222
    v_pk_add_f32 v[124:125], v[124:125], v[20:21]
    v_pk_add_f32 v[10:11], v[10:11], v[124:125]
    v_pk_fma_f32 v[12:13], v[124:125], v[124:125], v[12:13]
    v_pk_fma_f32 v[44:45], v[124:125], v[156:157], v[44:45]
    v_lshlrev_b32 v20, 16, v223
    v_and_b32 v21, 0xffff0000, v223
    v_pk_add_f32 v[126:127], v[126:127], v[20:21]
    v_pk_add_f32 v[10:11], v[10:11], v[126:127]
    v_pk_fma_f32 v[12:13], v[126:127], v[126:127], v[12:13]
    v_pk_fma_f32 v[44:45], v[126:127], v[158:159], v[44:45]
    v_add_f32 v20, v10, v11
    v_add_f32 v21, v12, v13
    v_add_f32 v22, v44, v45
    s_nop 0
    v_permlane16_swap_b32 v20, v21
    v_permlane16_swap_b32 v22, v42
    v_add_f32 v20, v20, v21
    v_add_f32 v22, v22, v42
    s_nop 1
    v_permlane32_swap_b32 v20, v22
    v_add_f32 v20, v20, v22
    s_nop 1
    v_add_f32_dpp v20, v20, v20 row_ror:8 row_mask:0xf bank_mask:0xf
    ds_write_b32 v40, v20
    s_waitcnt lgkmcnt(0)
    s_barrier
    ds_read_b128 v[20:23], v41
    ds_read_b128 v[24:27], v41 offset:16
    ds_read_b128 v[32:35], v41 offset:32
    ds_read_b128 v[36:39], v41 offset:48
    s_waitcnt lgkmcnt(2)
    v_pk_add_f32 v[20:21], v[20:21], v[24:25]
    v_pk_add_f32 v[22:23], v[22:23], v[26:27]
    s_waitcnt lgkmcnt(0)
    v_pk_add_f32 v[32:33], v[32:33], v[36:37]
    v_pk_add_f32 v[34:35], v[34:35], v[38:39]
    v_pk_add_f32 v[20:21], v[20:21], v[32:33]
    v_pk_add_f32 v[22:23], v[22:23], v[34:35]
    v_mul_f32 v46, 0x3a800000, v20
    v_mul_f32 v47, 0x3a800000, v21
    v_fma_f32 v47, -v46, v46, v47
    v_max_f32 v47, 0, v47
    v_cvt_pk_bf16_f32 v47, v47, v47
    v_lshlrev_b32 v47, 16, v47
    v_add_f32 v47, 0x3727c5ac, v47
    v_cvt_pk_bf16_f32 v47, v47, v47
    v_lshlrev_b32 v47, 16, v47
    v_sqrt_f32 v47, v47
    v_cvt_pk_bf16_f32 v20, v46, v46
    v_lshlrev_b32 v20, 16, v20
    v_cvt_pk_bf16_f32 v47, v47, v47
    v_lshlrev_b32 v47, 16, v47
    v_rcp_f32 v16, v47
    v_fma_f32 v22, -v20, v23, v22
    v_mul_f32 v18, -v20, v16
    v_mul_f32 v22, v22, v16
    v_mov_b32 v17, v16
    v_fmamk_f32 v22, v22, 0x3a800000, v46
    v_mov_b32 v19, v18
    v_cvt_pk_bf16_f32 v22, v22, v22
    v_lshlrev_b32 v22, 16, v22
    v_mul_f32 v24, -v22, v16
    v_mul_f32 v25, -v22, v16
    v_pk_fma_f32 v[20:21], v[96:97], v[16:17], v[18:19]
    v_pk_fma_f32 v[96:97], v[20:21], v[128:129], v[96:97]
    v_pk_fma_f32 v[20:21], v[96:97], v[16:17], v[24:25]
    v_cvt_pk_bf16_f32 v176, v20, v21
    v_pk_fma_f32 v[22:23], v[98:99], v[16:17], v[18:19]
    v_pk_fma_f32 v[98:99], v[22:23], v[130:131], v[98:99]
    v_pk_fma_f32 v[22:23], v[98:99], v[16:17], v[24:25]
    v_cvt_pk_bf16_f32 v177, v22, v23
    v_pk_fma_f32 v[20:21], v[100:101], v[16:17], v[18:19]
    v_pk_fma_f32 v[100:101], v[20:21], v[132:133], v[100:101]
    v_pk_fma_f32 v[20:21], v[100:101], v[16:17], v[24:25]
    v_cvt_pk_bf16_f32 v178, v20, v21
    v_pk_fma_f32 v[22:23], v[102:103], v[16:17], v[18:19]
    v_pk_fma_f32 v[102:103], v[22:23], v[134:135], v[102:103]
    v_pk_fma_f32 v[22:23], v[102:103], v[16:17], v[24:25]
    v_cvt_pk_bf16_f32 v179, v22, v23
    s_add_u32 s16, s12, 37748736
    buffer_store_dwordx4 v[176:179], v6, s[8:11], s16 offen sc1
    v_pk_fma_f32 v[20:21], v[104:105], v[16:17], v[18:19]
    v_pk_fma_f32 v[104:105], v[20:21], v[136:137], v[104:105]
    v_pk_fma_f32 v[20:21], v[104:105], v[16:17], v[24:25]
    v_cvt_pk_bf16_f32 v180, v20, v21
    v_pk_fma_f32 v[22:23], v[106:107], v[16:17], v[18:19]
    v_pk_fma_f32 v[106:107], v[22:23], v[138:139], v[106:107]
    v_pk_fma_f32 v[22:23], v[106:107], v[16:17], v[24:25]
    v_cvt_pk_bf16_f32 v181, v22, v23
    v_pk_fma_f32 v[20:21], v[108:109], v[16:17], v[18:19]
    v_pk_fma_f32 v[108:109], v[20:21], v[140:141], v[108:109]
    v_pk_fma_f32 v[20:21], v[108:109], v[16:17], v[24:25]
    v_cvt_pk_bf16_f32 v182, v20, v21
    v_pk_fma_f32 v[22:23], v[110:111], v[16:17], v[18:19]
    v_pk_fma_f32 v[110:111], v[22:23], v[142:143], v[110:111]
    v_pk_fma_f32 v[22:23], v[110:111], v[16:17], v[24:25]
    v_cvt_pk_bf16_f32 v183, v22, v23
    s_add_u32 s16, s12, 37781504
    buffer_store_dwordx4 v[180:183], v6, s[8:11], s16 offen sc1
    v_pk_fma_f32 v[20:21], v[112:113], v[16:17], v[18:19]
    v_pk_fma_f32 v[112:113], v[20:21], v[144:145], v[112:113]
    v_pk_fma_f32 v[20:21], v[112:113], v[16:17], v[24:25]
    v_cvt_pk_bf16_f32 v184, v20, v21
    v_pk_fma_f32 v[22:23], v[114:115], v[16:17], v[18:19]
    v_pk_fma_f32 v[114:115], v[22:23], v[146:147], v[114:115]
    v_pk_fma_f32 v[22:23], v[114:115], v[16:17], v[24:25]
    v_cvt_pk_bf16_f32 v185, v22, v23
    v_pk_fma_f32 v[20:21], v[116:117], v[16:17], v[18:19]
    v_pk_fma_f32 v[116:117], v[20:21], v[148:149], v[116:117]
    v_pk_fma_f32 v[20:21], v[116:117], v[16:17], v[24:25]
    v_cvt_pk_bf16_f32 v186, v20, v21
    v_pk_fma_f32 v[22:23], v[118:119], v[16:17], v[18:19]
    v_pk_fma_f32 v[118:119], v[22:23], v[150:151], v[118:119]
    v_pk_fma_f32 v[22:23], v[118:119], v[16:17], v[24:25]
    v_cvt_pk_bf16_f32 v187, v22, v23
    s_add_u32 s16, s12, 37814272
    buffer_store_dwordx4 v[184:187], v6, s[8:11], s16 offen sc1
    v_pk_fma_f32 v[20:21], v[120:121], v[16:17], v[18:19]
    v_pk_fma_f32 v[120:121], v[20:21], v[152:153], v[120:121]
    v_pk_fma_f32 v[20:21], v[120:121], v[16:17], v[24:25]
    v_cvt_pk_bf16_f32 v188, v20, v21
    v_pk_fma_f32 v[22:23], v[122:123], v[16:17], v[18:19]
    v_pk_fma_f32 v[122:123], v[22:23], v[154:155], v[122:123]
    v_pk_fma_f32 v[22:23], v[122:123], v[16:17], v[24:25]
    v_cvt_pk_bf16_f32 v189, v22, v23
    v_pk_fma_f32 v[20:21], v[124:125], v[16:17], v[18:19]
    v_pk_fma_f32 v[124:125], v[20:21], v[156:157], v[124:125]
    v_pk_fma_f32 v[20:21], v[124:125], v[16:17], v[24:25]
    v_cvt_pk_bf16_f32 v190, v20, v21
    v_pk_fma_f32 v[22:23], v[126:127], v[16:17], v[18:19]
    v_pk_fma_f32 v[126:127], v[22:23], v[158:159], v[126:127]
    v_pk_fma_f32 v[22:23], v[126:127], v[16:17], v[24:25]
    v_cvt_pk_bf16_f32 v191, v22, v23
    s_add_u32 s16, s12, 37847040
    buffer_store_dwordx4 v[188:191], v6, s[8:11], s16 offen sc1
    v_pk_mul_f32 v[12:13], v[96:97], v[96:97]
    v_pk_add_f32 v[10:11], v[96:97], v[98:99]
    v_pk_fma_f32 v[12:13], v[98:99], v[98:99], v[12:13]
    v_pk_add_f32 v[10:11], v[10:11], v[100:101]
    v_pk_fma_f32 v[12:13], v[100:101], v[100:101], v[12:13]
    v_pk_add_f32 v[10:11], v[10:11], v[102:103]
    v_pk_fma_f32 v[12:13], v[102:103], v[102:103], v[12:13]
    v_pk_add_f32 v[10:11], v[10:11], v[104:105]
    v_pk_fma_f32 v[12:13], v[104:105], v[104:105], v[12:13]
    v_pk_add_f32 v[10:11], v[10:11], v[106:107]
    v_pk_fma_f32 v[12:13], v[106:107], v[106:107], v[12:13]
    v_pk_add_f32 v[10:11], v[10:11], v[108:109]
    v_pk_fma_f32 v[12:13], v[108:109], v[108:109], v[12:13]
    v_pk_add_f32 v[10:11], v[10:11], v[110:111]
    v_pk_fma_f32 v[12:13], v[110:111], v[110:111], v[12:13]
    v_pk_add_f32 v[10:11], v[10:11], v[112:113]
    v_pk_fma_f32 v[12:13], v[112:113], v[112:113], v[12:13]
    v_pk_add_f32 v[10:11], v[10:11], v[114:115]
    v_pk_fma_f32 v[12:13], v[114:115], v[114:115], v[12:13]
    v_pk_add_f32 v[10:11], v[10:11], v[116:117]
    v_pk_fma_f32 v[12:13], v[116:117], v[116:117], v[12:13]
    v_pk_add_f32 v[10:11], v[10:11], v[118:119]
    v_pk_fma_f32 v[12:13], v[118:119], v[118:119], v[12:13]
    v_pk_add_f32 v[10:11], v[10:11], v[120:121]
    v_pk_fma_f32 v[12:13], v[120:121], v[120:121], v[12:13]
    v_pk_add_f32 v[10:11], v[10:11], v[122:123]
    v_pk_fma_f32 v[12:13], v[122:123], v[122:123], v[12:13]
    v_pk_add_f32 v[10:11], v[10:11], v[124:125]
    v_pk_fma_f32 v[12:13], v[124:125], v[124:125], v[12:13]
    v_pk_add_f32 v[10:11], v[10:11], v[126:127]
    v_pk_fma_f32 v[12:13], v[126:127], v[126:127], v[12:13]
    v_add_f32 v20, v10, v11
    v_add_f32 v21, v12, v13
    s_nop 1
    v_permlane16_swap_b32 v20, v21
    v_add_f32 v20, v20, v21
    s_nop 1
    v_add_f32_dpp v20, v20, v20 row_ror:8 row_mask:0xf bank_mask:0xf
    v_mov_b32 v22, v20
    s_nop 1
    v_permlane32_swap_b32 v20, v22
    v_add_f32 v20, v20, v22
    ds_write_b32 v14, v20 offset:256
    s_waitcnt lgkmcnt(0)
    s_barrier
    ds_read_b128 v[20:23], v15 offset:256
    ds_read_b128 v[24:27], v15 offset:272
    s_waitcnt lgkmcnt(0)
    v_pk_add_f32 v[20:21], v[20:21], v[22:23]
    v_pk_add_f32 v[24:25], v[24:25], v[26:27]
    v_pk_add_f32 v[20:21], v[20:21], v[24:25]
    v_mul_f32 v20, 0x3a800000, v20
    v_mul_f32 v21, 0x3a800000, v21
    v_fma_f32 v21, -v20, v20, v21
    v_max_f32 v21, 0, v21
    v_cvt_pk_bf16_f32 v21, v21, v21
    v_lshlrev_b32 v21, 16, v21
    v_add_f32 v21, 0x3727c5ac, v21
    v_cvt_pk_bf16_f32 v21, v21, v21
    v_lshlrev_b32 v21, 16, v21
    v_sqrt_f32 v21, v21
    v_cvt_pk_bf16_f32 v20, v20, v20
    v_lshlrev_b32 v20, 16, v20
    v_cvt_pk_bf16_f32 v21, v21, v21
    v_lshlrev_b32 v21, 16, v21
    v_rcp_f32 v16, v21
    s_nop 0
    v_mul_f32 v18, -v20, v16
    v_mov_b32 v17, v16
    v_mov_b32 v19, v18
    v_mul_f32 v16, v16, v47
    v_cmp_gt_u32 vcc, 8, v0
    v_mul_f32 v16, v16, v16
    v_lshlrev_b32 v18, 2, v0
    v_bfrev_b32 v17, 1
    v_accvgpr_write_b32 a196, v16
    v_cndmask_b32 v17, v17, v18, vcc
    v_cvt_pk_bf16_f32 v160, v96, v97
    v_cvt_pk_bf16_f32 v161, v98, v99
    v_cvt_pk_bf16_f32 v162, v100, v101
    v_cvt_pk_bf16_f32 v163, v102, v103
    v_cvt_pk_bf16_f32 v164, v104, v105
    v_cvt_pk_bf16_f32 v165, v106, v107
    v_cvt_pk_bf16_f32 v166, v108, v109
    v_cvt_pk_bf16_f32 v167, v110, v111
    v_cvt_pk_bf16_f32 v168, v112, v113
    v_cvt_pk_bf16_f32 v169, v114, v115
    v_cvt_pk_bf16_f32 v170, v116, v117
    v_cvt_pk_bf16_f32 v171, v118, v119
    v_cvt_pk_bf16_f32 v172, v120, v121
    v_cvt_pk_bf16_f32 v173, v122, v123
    v_cvt_pk_bf16_f32 v174, v124, v125
    v_cvt_pk_bf16_f32 v175, v126, v127
    v_accvgpr_write_b32 a180, v160
    v_accvgpr_write_b32 a181, v161
    v_accvgpr_write_b32 a182, v162
    v_accvgpr_write_b32 a183, v163
    v_accvgpr_write_b32 a184, v164
    v_accvgpr_write_b32 a185, v165
    v_accvgpr_write_b32 a186, v166
    v_accvgpr_write_b32 a187, v167
    v_accvgpr_write_b32 a188, v168
    v_accvgpr_write_b32 a189, v169
    v_accvgpr_write_b32 a190, v170
    v_accvgpr_write_b32 a191, v171
    v_accvgpr_write_b32 a192, v172
    v_accvgpr_write_b32 a193, v173
    v_accvgpr_write_b32 a194, v174
    v_accvgpr_write_b32 a195, v175
    v_mov_b32 v27, v6
    s_add_u32 s56, s12, 33554432
    s_add_u32 s57, s12, 33587200
    s_add_u32 s58, s12, 33619968
    s_add_u32 s59, s12, 33652736
    s_branch L_layer
L_fin:
L_pfin:
    s_waitcnt lgkmcnt(6)
    v_mfma_f32_16x16x32_bf16 v[32:35], a[168:171], a[0:3], v[32:35]
    ds_read_b64_tr_b16 a[152:153], v101 offset:24576
    s_lshl_b32 s24, s100, 22
    v_mfma_f32_16x16x32_bf16 v[32:35], a[128:131], a[8:11], v[32:35]
    ds_read_b64_tr_b16 a[154:155], v101 offset:28672
    s_sub_u32 s24, s22, s24
    v_mfma_f32_16x16x32_bf16 v[32:35], a[132:135], a[16:19], v[32:35]
    ds_read_b64_tr_b16 a[156:157], v100 offset:32768
    s_add_u32 s24, s24, 4269801472
    v_mfma_f32_16x16x32_bf16 v[32:35], a[136:139], a[24:27], v[32:35]
    ds_read_b64_tr_b16 a[158:159], v100 offset:36864
    s_add_u32 s25, s24, 4096
    v_mfma_f32_16x16x32_bf16 v[36:39], a[136:139], a[28:31], v[36:39]
    ds_read_b64_tr_b16 a[160:161], v100 offset:40960
    v_and_b32 v7, 15, v3
    v_mfma_f32_16x16x32_bf16 v[36:39], a[132:135], a[20:23], v[36:39]
    ds_read_b64_tr_b16 a[162:163], v100 offset:45056
    v_lshlrev_b32 v7, 2, v7
    v_mfma_f32_16x16x32_bf16 v[36:39], a[128:131], a[12:15], v[36:39]
    ds_read_b64_tr_b16 a[164:165], v100 offset:49152
    s_lshl_b32 s5, s14, 7
    v_mfma_f32_16x16x32_bf16 v[36:39], a[168:171], a[4:7], v[36:39]
    ds_read_b64_tr_b16 a[166:167], v100 offset:53248
    s_add_u32 s5, s5, 22020096
    s_waitcnt lgkmcnt(6)
    v_mfma_f32_16x16x32_bf16 v[44:47], a[140:143], a[4:7], v[44:47]
    ds_read_b64_tr_b16 a[168:169], v100 offset:57344
    buffer_load_dword v200, v7, s[8:11], s5 offen offset:0 sc1
    v_mfma_f32_16x16x32_bf16 v[44:47], a[144:147], a[12:15], v[44:47]
    ds_read_b64_tr_b16 a[170:171], v100 offset:61440
    buffer_load_dword v202, v7, s[8:11], s5 offen offset:64 sc1
    v_mfma_f32_16x16x32_bf16 v[44:47], a[148:151], a[20:23], v[44:47]
    ds_read_b64_tr_b16 a[128:129], v101 offset:32768
    buffer_load_dwordx4 v[120:123], v4, s[8:11], s24 offen offset:0 sc1
    v_mfma_f32_16x16x32_bf16 v[44:47], a[152:155], a[28:31], v[44:47]
    ds_read_b64_tr_b16 a[130:131], v101 offset:36864
    buffer_load_dwordx4 v[124:127], v4, s[8:11], s24 offen offset:1024 sc1
    v_mfma_f32_16x16x32_bf16 v[40:43], a[152:155], a[24:27], v[40:43]
    ds_read_b64_tr_b16 a[132:133], v101 offset:40960
    buffer_load_dwordx4 v[128:131], v4, s[8:11], s25 offen offset:0 sc1
    v_mfma_f32_16x16x32_bf16 v[40:43], a[148:151], a[16:19], v[40:43]
    ds_read_b64_tr_b16 a[134:135], v101 offset:45056
    buffer_load_dwordx4 v[132:135], v4, s[8:11], s25 offen offset:1024 sc1
    v_mfma_f32_16x16x32_bf16 v[40:43], a[144:147], a[8:11], v[40:43]
    ds_read_b64_tr_b16 a[136:137], v101 offset:49152
    s_lshl_b32 s26, s2, 2
    v_mfma_f32_16x16x32_bf16 v[40:43], a[140:143], a[0:3], v[40:43]
    ds_read_b64_tr_b16 a[138:139], v101 offset:53248
    s_add_u32 s26, s26, s4
    s_waitcnt vmcnt(7) lgkmcnt(6)
    v_mfma_f32_16x16x32_bf16 v[32:35], a[156:159], a[32:35], v[32:35]
    ds_read_b64_tr_b16 a[140:141], v101 offset:57344
    s_lshl_b32 s26, s26, 12
    v_mfma_f32_16x16x32_bf16 v[32:35], a[160:163], a[40:43], v[32:35]
    ds_read_b64_tr_b16 a[142:143], v101 offset:61440
    s_add_u32 s26, s26, 92274688
    v_mfma_f32_16x16x32_bf16 v[32:35], a[164:167], a[48:51], v[32:35]
    ds_read_b64_tr_b16 a[144:145], v102 offset:0
    v_mfma_f32_16x16x32_bf16 v[32:35], a[168:171], a[56:59], v[32:35]
    ds_read_b64_tr_b16 a[146:147], v102 offset:4096
    v_mfma_f32_16x16x32_bf16 v[36:39], a[168:171], a[60:63], v[36:39]
    ds_read_b64_tr_b16 a[148:149], v102 offset:8192
    v_mfma_f32_16x16x32_bf16 v[36:39], a[164:167], a[52:55], v[36:39]
    ds_read_b64_tr_b16 a[150:151], v102 offset:12288
    v_mfma_f32_16x16x32_bf16 v[36:39], a[160:163], a[44:47], v[36:39]
    ds_read_b64_tr_b16 a[152:153], v102 offset:16384
    v_mfma_f32_16x16x32_bf16 v[36:39], a[156:159], a[36:39], v[36:39]
    ds_read_b64_tr_b16 a[154:155], v102 offset:20480
    s_waitcnt lgkmcnt(6)
    v_mfma_f32_16x16x32_bf16 v[44:47], a[128:131], a[36:39], v[44:47]
    ds_read_b64_tr_b16 a[156:157], v102 offset:24576
    v_mfma_f32_16x16x32_bf16 v[44:47], a[132:135], a[44:47], v[44:47]
    ds_read_b64_tr_b16 a[158:159], v102 offset:28672
    v_mfma_f32_16x16x32_bf16 v[44:47], a[136:139], a[52:55], v[44:47]
    ds_read_b64_tr_b16 a[160:161], v103 offset:0
    v_cvt_pk_bf16_f32 v188, v36, v37
    v_mfma_f32_16x16x32_bf16 v[44:47], a[140:143], a[60:63], v[44:47]
    ds_read_b64_tr_b16 a[162:163], v103 offset:4096
    v_cvt_pk_bf16_f32 v189, v38, v39
    v_mfma_f32_16x16x32_bf16 v[40:43], a[140:143], a[56:59], v[40:43]
    ds_read_b64_tr_b16 a[164:165], v103 offset:8192
    v_mfma_f32_16x16x32_bf16 v[40:43], a[136:139], a[48:51], v[40:43]
    ds_read_b64_tr_b16 a[166:167], v103 offset:12288
    v_mfma_f32_16x16x32_bf16 v[40:43], a[132:135], a[40:43], v[40:43]
    ds_read_b64_tr_b16 a[168:169], v103 offset:16384
    v_cvt_pk_bf16_f32 v190, v44, v45
    v_mfma_f32_16x16x32_bf16 v[40:43], a[128:131], a[32:35], v[40:43]
    ds_read_b64_tr_b16 a[170:171], v103 offset:20480
    v_cvt_pk_bf16_f32 v191, v46, v47
    s_waitcnt lgkmcnt(6)
    v_mfma_f32_16x16x32_bf16 v[48:51], a[144:147], a[0:3], v[48:51]
    ds_read_b64_tr_b16 a[128:129], v103 offset:24576
    v_min_u32 v188, -2, v188
    v_mfma_f32_16x16x32_bf16 v[48:51], a[148:151], a[8:11], v[48:51]
    ds_read_b64_tr_b16 a[130:131], v103 offset:28672
    v_min_u32 v189, -2, v189
    v_mfma_f32_16x16x32_bf16 v[48:51], a[152:155], a[16:19], v[48:51]
    ds_read_b64_tr_b16 a[132:133], v102 offset:32768
    v_min_u32 v190, -2, v190
    v_mfma_f32_16x16x32_bf16 v[48:51], a[156:159], a[24:27], v[48:51]
    ds_read_b64_tr_b16 a[134:135], v102 offset:36864
    v_min_u32 v191, -2, v191
    v_mfma_f32_16x16x32_bf16 v[52:55], a[156:159], a[28:31], v[52:55]
    ds_read_b64_tr_b16 a[136:137], v102 offset:40960
    buffer_store_dwordx4 v[188:191], v1, s[8:11], s26 offen offset:1024 sc1
    v_mfma_f32_16x16x32_bf16 v[52:55], a[152:155], a[20:23], v[52:55]
    ds_read_b64_tr_b16 a[138:139], v102 offset:45056
    v_cvt_pk_bf16_f32 v184, v32, v33
    v_mfma_f32_16x16x32_bf16 v[52:55], a[148:151], a[12:15], v[52:55]
    ds_read_b64_tr_b16 a[140:141], v102 offset:49152
    v_cvt_pk_bf16_f32 v185, v34, v35
    v_mfma_f32_16x16x32_bf16 v[52:55], a[144:147], a[4:7], v[52:55]
    ds_read_b64_tr_b16 a[142:143], v102 offset:53248
    v_cvt_pk_bf16_f32 v186, v40, v41
    s_waitcnt lgkmcnt(6)
    v_mfma_f32_16x16x32_bf16 v[60:63], a[160:163], a[4:7], v[60:63]
    ds_read_b64_tr_b16 a[144:145], v102 offset:57344
    v_cvt_pk_bf16_f32 v187, v42, v43
    v_mfma_f32_16x16x32_bf16 v[60:63], a[164:167], a[12:15], v[60:63]
    ds_read_b64_tr_b16 a[146:147], v102 offset:61440
    v_min_u32 v184, -2, v184
    v_mfma_f32_16x16x32_bf16 v[60:63], a[168:171], a[20:23], v[60:63]
    ds_read_b64_tr_b16 a[148:149], v103 offset:32768
    v_min_u32 v185, -2, v185
    v_mfma_f32_16x16x32_bf16 v[60:63], a[128:131], a[28:31], v[60:63]
    ds_read_b64_tr_b16 a[150:151], v103 offset:36864
    v_min_u32 v186, -2, v186
    v_mfma_f32_16x16x32_bf16 v[56:59], a[128:131], a[24:27], v[56:59]
    ds_read_b64_tr_b16 a[152:153], v103 offset:40960
    v_min_u32 v187, -2, v187
    v_mfma_f32_16x16x32_bf16 v[56:59], a[168:171], a[16:19], v[56:59]
    ds_read_b64_tr_b16 a[154:155], v103 offset:45056
    buffer_store_dwordx4 v[184:187], v1, s[8:11], s26 offen offset:0 sc1
    v_mfma_f32_16x16x32_bf16 v[56:59], a[164:167], a[8:11], v[56:59]
    ds_read_b64_tr_b16 a[156:157], v103 offset:49152
    s_xor_b32 s27, s26, 0x10000
    v_mfma_f32_16x16x32_bf16 v[56:59], a[160:163], a[0:3], v[56:59]
    ds_read_b64_tr_b16 a[158:159], v103 offset:53248
    v_and_b32 v5, 15, v3
    s_waitcnt lgkmcnt(6)
    v_mfma_f32_16x16x32_bf16 v[48:51], a[132:135], a[32:35], v[48:51]
    ds_read_b64_tr_b16 a[160:161], v103 offset:57344
    v_bfe_u32 v6, v4, 8, 2
    v_mfma_f32_16x16x32_bf16 v[48:51], a[136:139], a[40:43], v[48:51]
    ds_read_b64_tr_b16 a[162:163], v103 offset:61440
    v_lshlrev_b32 v5, 11, v5
    v_mfma_f32_16x16x32_bf16 v[48:51], a[140:143], a[48:51], v[48:51]
    ds_read_b64_tr_b16 a[164:165], v104 offset:0
    v_lshl_add_u32 v5, v6, 4, v5
    v_mfma_f32_16x16x32_bf16 v[48:51], a[144:147], a[56:59], v[48:51]
    ds_read_b64_tr_b16 a[166:167], v104 offset:4096
    s_lshl_b32 s12, s14, 16
    v_mfma_f32_16x16x32_bf16 v[52:55], a[144:147], a[60:63], v[52:55]
    ds_read_b64_tr_b16 a[168:169], v104 offset:8192
    s_lshl_b32 s13, s99, 8
    v_mfma_f32_16x16x32_bf16 v[52:55], a[140:143], a[52:55], v[52:55]
    ds_read_b64_tr_b16 a[170:171], v104 offset:12288
    s_add_u32 s12, s12, s13
    v_mfma_f32_16x16x32_bf16 v[52:55], a[136:139], a[44:47], v[52:55]
    ds_read_b64_tr_b16 a[128:129], v104 offset:16384
    s_lshl_b32 s13, s100, 7
    v_mfma_f32_16x16x32_bf16 v[52:55], a[132:135], a[36:39], v[52:55]
    ds_read_b64_tr_b16 a[130:131], v104 offset:20480
    s_xor_b32 s13, s13, 128
    s_waitcnt lgkmcnt(6)
    v_mfma_f32_16x16x32_bf16 v[60:63], a[148:151], a[36:39], v[60:63]
    ds_read_b64_tr_b16 a[132:133], v104 offset:24576
    s_add_u32 s12, s12, s13
    v_mfma_f32_16x16x32_bf16 v[60:63], a[152:155], a[44:47], v[60:63]
    ds_read_b64_tr_b16 a[134:135], v104 offset:28672
    s_add_u32 s13, s12, 32768
    v_mfma_f32_16x16x32_bf16 v[60:63], a[156:159], a[52:55], v[60:63]
    ds_read_b64_tr_b16 a[136:137], v105 offset:0
    v_cvt_pk_bf16_f32 v196, v52, v53
    v_mfma_f32_16x16x32_bf16 v[60:63], a[160:163], a[60:63], v[60:63]
    ds_read_b64_tr_b16 a[138:139], v105 offset:4096
    v_cvt_pk_bf16_f32 v197, v54, v55
    v_mfma_f32_16x16x32_bf16 v[56:59], a[160:163], a[56:59], v[56:59]
    ds_read_b64_tr_b16 a[140:141], v105 offset:8192
    v_mfma_f32_16x16x32_bf16 v[56:59], a[156:159], a[48:51], v[56:59]
    ds_read_b64_tr_b16 a[142:143], v105 offset:12288
    v_mfma_f32_16x16x32_bf16 v[56:59], a[152:155], a[40:43], v[56:59]
    ds_read_b64_tr_b16 a[144:145], v105 offset:16384
    v_cvt_pk_bf16_f32 v198, v60, v61
    v_mfma_f32_16x16x32_bf16 v[56:59], a[148:151], a[32:35], v[56:59]
    ds_read_b64_tr_b16 a[146:147], v105 offset:20480
    v_cvt_pk_bf16_f32 v199, v62, v63
    s_waitcnt lgkmcnt(6)
    v_mfma_f32_16x16x32_bf16 v[64:67], a[164:167], a[0:3], v[64:67]
    ds_read_b64_tr_b16 a[148:149], v105 offset:24576
    v_min_u32 v196, -2, v196
    v_mfma_f32_16x16x32_bf16 v[64:67], a[168:171], a[8:11], v[64:67]
    ds_read_b64_tr_b16 a[150:151], v105 offset:28672
    v_min_u32 v197, -2, v197
    v_mfma_f32_16x16x32_bf16 v[64:67], a[128:131], a[16:19], v[64:67]
    ds_read_b64_tr_b16 a[152:153], v104 offset:32768
    v_min_u32 v198, -2, v198
    v_mfma_f32_16x16x32_bf16 v[64:67], a[132:135], a[24:27], v[64:67]
    ds_read_b64_tr_b16 a[154:155], v104 offset:36864
    v_min_u32 v199, -2, v199
    v_mfma_f32_16x16x32_bf16 v[68:71], a[132:135], a[28:31], v[68:71]
    ds_read_b64_tr_b16 a[156:157], v104 offset:40960
    buffer_store_dwordx4 v[196:199], v1, s[8:11], s26 offen offset:3072 sc1
    v_mfma_f32_16x16x32_bf16 v[68:71], a[128:131], a[20:23], v[68:71]
    ds_read_b64_tr_b16 a[158:159], v104 offset:45056
    v_cvt_pk_bf16_f32 v192, v48, v49
    v_mfma_f32_16x16x32_bf16 v[68:71], a[168:171], a[12:15], v[68:71]
    ds_read_b64_tr_b16 a[160:161], v104 offset:49152
    v_cvt_pk_bf16_f32 v193, v50, v51
    v_mfma_f32_16x16x32_bf16 v[68:71], a[164:167], a[4:7], v[68:71]
    ds_read_b64_tr_b16 a[162:163], v104 offset:53248
    v_cvt_pk_bf16_f32 v194, v56, v57
    s_waitcnt lgkmcnt(6)
    v_mfma_f32_16x16x32_bf16 v[76:79], a[136:139], a[4:7], v[76:79]
    ds_read_b64_tr_b16 a[164:165], v104 offset:57344
    v_cvt_pk_bf16_f32 v195, v58, v59
    v_mfma_f32_16x16x32_bf16 v[76:79], a[140:143], a[12:15], v[76:79]
    ds_read_b64_tr_b16 a[166:167], v104 offset:61440
    v_min_u32 v192, -2, v192
    v_mfma_f32_16x16x32_bf16 v[76:79], a[144:147], a[20:23], v[76:79]
    ds_read_b64_tr_b16 a[168:169], v105 offset:32768
    v_min_u32 v193, -2, v193
    v_mfma_f32_16x16x32_bf16 v[76:79], a[148:151], a[28:31], v[76:79]
    ds_read_b64_tr_b16 a[170:171], v105 offset:36864
    v_min_u32 v194, -2, v194
    v_mfma_f32_16x16x32_bf16 v[72:75], a[148:151], a[24:27], v[72:75]
    ds_read_b64_tr_b16 a[128:129], v105 offset:40960
    v_min_u32 v195, -2, v195
    v_mfma_f32_16x16x32_bf16 v[72:75], a[144:147], a[16:19], v[72:75]
    ds_read_b64_tr_b16 a[130:131], v105 offset:45056
    buffer_store_dwordx4 v[192:195], v1, s[8:11], s26 offen offset:2048 sc1
    v_mfma_f32_16x16x32_bf16 v[72:75], a[140:143], a[8:11], v[72:75]
    ds_read_b64_tr_b16 a[132:133], v105 offset:49152
    s_waitcnt vmcnt(4)
    v_mfma_f32_16x16x32_bf16 v[72:75], a[136:139], a[0:3], v[72:75]
    ds_read_b64_tr_b16 a[134:135], v105 offset:53248
    v_mov_b32 v201, v200
    s_waitcnt lgkmcnt(6)
    v_mfma_f32_16x16x32_bf16 v[64:67], a[152:155], a[32:35], v[64:67]
    ds_read_b64_tr_b16 a[136:137], v105 offset:57344
    v_mov_b32 v203, v202
    v_mfma_f32_16x16x32_bf16 v[64:67], a[156:159], a[40:43], v[64:67]
    ds_read_b64_tr_b16 a[138:139], v105 offset:61440
    v_permlane16_swap_b32 v120, v122
    v_mfma_f32_16x16x32_bf16 v[64:67], a[160:163], a[48:51], v[64:67]
    ds_read_b64_tr_b16 a[140:141], v106 offset:0
    v_permlane16_swap_b32 v121, v123
    v_mfma_f32_16x16x32_bf16 v[64:67], a[164:167], a[56:59], v[64:67]
    ds_read_b64_tr_b16 a[142:143], v106 offset:4096
    v_permlane16_swap_b32 v124, v126
    v_mfma_f32_16x16x32_bf16 v[68:71], a[164:167], a[60:63], v[68:71]
    ds_read_b64_tr_b16 a[144:145], v106 offset:8192
    v_permlane16_swap_b32 v125, v127
    v_mfma_f32_16x16x32_bf16 v[68:71], a[160:163], a[52:55], v[68:71]
    ds_read_b64_tr_b16 a[146:147], v106 offset:12288
    v_permlane16_swap_b32 v128, v130
    v_mfma_f32_16x16x32_bf16 v[68:71], a[156:159], a[44:47], v[68:71]
    ds_read_b64_tr_b16 a[148:149], v106 offset:16384
    v_permlane16_swap_b32 v129, v131
    v_mfma_f32_16x16x32_bf16 v[68:71], a[152:155], a[36:39], v[68:71]
    ds_read_b64_tr_b16 a[150:151], v106 offset:20480
    v_permlane16_swap_b32 v132, v134
    s_waitcnt lgkmcnt(6)
    v_mfma_f32_16x16x32_bf16 v[76:79], a[168:171], a[36:39], v[76:79]
    ds_read_b64_tr_b16 a[152:153], v106 offset:24576
    v_permlane16_swap_b32 v133, v135
    v_mfma_f32_16x16x32_bf16 v[76:79], a[128:131], a[44:47], v[76:79]
    ds_read_b64_tr_b16 a[154:155], v106 offset:28672
    v_lshlrev_b32 v136, 16, v120
    v_mfma_f32_16x16x32_bf16 v[76:79], a[132:135], a[52:55], v[76:79]
    ds_read_b64_tr_b16 a[156:157], v107 offset:0
    v_and_b32 v137, 0xffff0000, v120
    v_mfma_f32_16x16x32_bf16 v[76:79], a[136:139], a[60:63], v[76:79]
    ds_read_b64_tr_b16 a[158:159], v107 offset:4096
    v_lshlrev_b32 v138, 16, v121
    v_mfma_f32_16x16x32_bf16 v[72:75], a[136:139], a[56:59], v[72:75]
    ds_read_b64_tr_b16 a[160:161], v107 offset:8192
    v_and_b32 v139, 0xffff0000, v121
    v_mfma_f32_16x16x32_bf16 v[72:75], a[132:135], a[48:51], v[72:75]
    ds_read_b64_tr_b16 a[162:163], v107 offset:12288
    v_lshlrev_b32 v140, 16, v122
    v_mfma_f32_16x16x32_bf16 v[72:75], a[128:131], a[40:43], v[72:75]
    ds_read_b64_tr_b16 a[164:165], v107 offset:16384
    v_and_b32 v141, 0xffff0000, v122
    v_mfma_f32_16x16x32_bf16 v[72:75], a[168:171], a[32:35], v[72:75]
    ds_read_b64_tr_b16 a[166:167], v107 offset:20480
    v_lshlrev_b32 v142, 16, v123
    s_waitcnt lgkmcnt(6)
    v_mfma_f32_16x16x32_bf16 v[80:83], a[140:143], a[0:3], v[80:83]
    ds_read_b64_tr_b16 a[168:169], v107 offset:24576
    v_and_b32 v143, 0xffff0000, v123
    v_mfma_f32_16x16x32_bf16 v[80:83], a[144:147], a[8:11], v[80:83]
    ds_read_b64_tr_b16 a[170:171], v107 offset:28672
    v_lshlrev_b32 v144, 16, v124
    v_mfma_f32_16x16x32_bf16 v[80:83], a[148:151], a[16:19], v[80:83]
    ds_read_b64_tr_b16 a[128:129], v106 offset:32768
    v_and_b32 v145, 0xffff0000, v124
    v_mfma_f32_16x16x32_bf16 v[80:83], a[152:155], a[24:27], v[80:83]
    ds_read_b64_tr_b16 a[130:131], v106 offset:36864
    v_lshlrev_b32 v146, 16, v125
    v_mfma_f32_16x16x32_bf16 v[84:87], a[152:155], a[28:31], v[84:87]
    ds_read_b64_tr_b16 a[132:133], v106 offset:40960
    v_and_b32 v147, 0xffff0000, v125
    v_mfma_f32_16x16x32_bf16 v[84:87], a[148:151], a[20:23], v[84:87]
    ds_read_b64_tr_b16 a[134:135], v106 offset:45056
    v_lshlrev_b32 v148, 16, v126
    v_mfma_f32_16x16x32_bf16 v[84:87], a[144:147], a[12:15], v[84:87]
    ds_read_b64_tr_b16 a[136:137], v106 offset:49152
    v_and_b32 v149, 0xffff0000, v126
    v_mfma_f32_16x16x32_bf16 v[84:87], a[140:143], a[4:7], v[84:87]
    ds_read_b64_tr_b16 a[138:139], v106 offset:53248
    v_lshlrev_b32 v150, 16, v127
    s_waitcnt lgkmcnt(6)
    v_mfma_f32_16x16x32_bf16 v[92:95], a[156:159], a[4:7], v[92:95]
    ds_read_b64_tr_b16 a[140:141], v106 offset:57344
    v_and_b32 v151, 0xffff0000, v127
    v_mfma_f32_16x16x32_bf16 v[92:95], a[160:163], a[12:15], v[92:95]
    ds_read_b64_tr_b16 a[142:143], v106 offset:61440
    v_lshlrev_b32 v152, 16, v128
    v_mfma_f32_16x16x32_bf16 v[92:95], a[164:167], a[20:23], v[92:95]
    ds_read_b64_tr_b16 a[144:145], v107 offset:32768
    v_and_b32 v153, 0xffff0000, v128
    v_mfma_f32_16x16x32_bf16 v[92:95], a[168:171], a[28:31], v[92:95]
    ds_read_b64_tr_b16 a[146:147], v107 offset:36864
    v_lshlrev_b32 v154, 16, v129
    v_mfma_f32_16x16x32_bf16 v[88:91], a[168:171], a[24:27], v[88:91]
    ds_read_b64_tr_b16 a[148:149], v107 offset:40960
    v_and_b32 v155, 0xffff0000, v129
    v_mfma_f32_16x16x32_bf16 v[88:91], a[164:167], a[16:19], v[88:91]
    ds_read_b64_tr_b16 a[150:151], v107 offset:45056
    v_lshlrev_b32 v156, 16, v130
    v_mfma_f32_16x16x32_bf16 v[88:91], a[160:163], a[8:11], v[88:91]
    ds_read_b64_tr_b16 a[152:153], v107 offset:49152
    v_and_b32 v157, 0xffff0000, v130
    v_mfma_f32_16x16x32_bf16 v[88:91], a[156:159], a[0:3], v[88:91]
    ds_read_b64_tr_b16 a[154:155], v107 offset:53248
    buffer_load_dwordx4 v[168:171], v1, s[8:11], s27 offen offset:0 sc1
    s_waitcnt lgkmcnt(6)
    v_mfma_f32_16x16x32_bf16 v[80:83], a[128:131], a[32:35], v[80:83]
    ds_read_b64_tr_b16 a[156:157], v107 offset:57344
    v_lshlrev_b32 v158, 16, v131
    v_mfma_f32_16x16x32_bf16 v[80:83], a[132:135], a[40:43], v[80:83]
    ds_read_b64_tr_b16 a[158:159], v107 offset:61440
    v_and_b32 v159, 0xffff0000, v131
    v_mfma_f32_16x16x32_bf16 v[80:83], a[136:139], a[48:51], v[80:83]
    v_lshlrev_b32 v160, 16, v132
    v_and_b32 v161, 0xffff0000, v132
    v_mfma_f32_16x16x32_bf16 v[80:83], a[140:143], a[56:59], v[80:83]
    buffer_load_dwordx4 v[172:175], v1, s[8:11], s27 offen offset:1024 sc1
    v_mfma_f32_16x16x32_bf16 v[84:87], a[140:143], a[60:63], v[84:87]
    v_lshlrev_b32 v162, 16, v133
    v_and_b32 v163, 0xffff0000, v133
    v_mfma_f32_16x16x32_bf16 v[84:87], a[136:139], a[52:55], v[84:87]
    v_lshlrev_b32 v164, 16, v134
    v_and_b32 v165, 0xffff0000, v134
    v_mfma_f32_16x16x32_bf16 v[84:87], a[132:135], a[44:47], v[84:87]
    v_lshlrev_b32 v166, 16, v135
    v_and_b32 v167, 0xffff0000, v135
    v_mfma_f32_16x16x32_bf16 v[84:87], a[128:131], a[36:39], v[84:87]
    buffer_load_dwordx4 v[176:179], v1, s[8:11], s27 offen offset:2048 sc1
    s_waitcnt lgkmcnt(0)
    v_mfma_f32_16x16x32_bf16 v[92:95], a[144:147], a[36:39], v[92:95]
    v_pk_fma_f32 v[68:69], v[68:69], v[202:203], v[144:145]
    v_pk_fma_f32 v[70:71], v[70:71], v[202:203], v[146:147]
    v_mfma_f32_16x16x32_bf16 v[92:95], a[148:151], a[44:47], v[92:95]
    v_pk_fma_f32 v[76:77], v[76:77], v[202:203], v[148:149]
    v_pk_fma_f32 v[78:79], v[78:79], v[202:203], v[150:151]
    v_mfma_f32_16x16x32_bf16 v[92:95], a[152:155], a[52:55], v[92:95]
    v_pk_fma_f32 v[64:65], v[64:65], v[200:201], v[136:137]
    v_pk_fma_f32 v[66:67], v[66:67], v[200:201], v[138:139]
    v_mfma_f32_16x16x32_bf16 v[92:95], a[156:159], a[60:63], v[92:95]
    buffer_load_dwordx4 v[180:183], v1, s[8:11], s27 offen offset:3072 sc1
    v_mfma_f32_16x16x32_bf16 v[88:91], a[156:159], a[56:59], v[88:91]
    v_pk_fma_f32 v[72:73], v[72:73], v[200:201], v[140:141]
    v_pk_fma_f32 v[74:75], v[74:75], v[200:201], v[142:143]
    v_mfma_f32_16x16x32_bf16 v[88:91], a[152:155], a[48:51], v[88:91]
    v_pk_fma_f32 v[84:85], v[84:85], v[202:203], v[160:161]
    v_pk_fma_f32 v[86:87], v[86:87], v[202:203], v[162:163]
    v_mfma_f32_16x16x32_bf16 v[88:91], a[148:151], a[40:43], v[88:91]
    v_pk_fma_f32 v[92:93], v[92:93], v[202:203], v[164:165]
    v_pk_fma_f32 v[94:95], v[94:95], v[202:203], v[166:167]
    v_mfma_f32_16x16x32_bf16 v[88:91], a[144:147], a[32:35], v[88:91]
    v_pk_fma_f32 v[80:81], v[80:81], v[200:201], v[152:153]
    v_pk_fma_f32 v[82:83], v[82:83], v[200:201], v[154:155]
    s_nop 5
    v_pk_fma_f32 v[88:89], v[88:89], v[200:201], v[156:157]
    v_pk_fma_f32 v[90:91], v[90:91], v[200:201], v[158:159]
    s_waitcnt vmcnt(3)
    v_max3_u32 v22, v168, v169, v170
    v_max_u32 v22, v22, v171
    v_cmp_eq_u32 vcc, -1, v22
    s_cmp_lg_u64 vcc, 0
    s_cbranch_scc1 L_fre0
L_fok0:
    v_lshlrev_b32 v20, 16, v168
    v_and_b32 v21, 0xffff0000, v168
    v_pk_fma_f32 v[64:65], v[20:21], v[200:201], v[64:65]
    v_cvt_pk_bf16_f32 v184, v64, v65
    v_lshlrev_b32 v20, 16, v170
    v_and_b32 v21, 0xffff0000, v170
    v_pk_fma_f32 v[72:73], v[20:21], v[200:201], v[72:73]
    v_cvt_pk_bf16_f32 v186, v72, v73
    v_lshlrev_b32 v20, 16, v169
    v_and_b32 v21, 0xffff0000, v169
    v_pk_fma_f32 v[66:67], v[20:21], v[200:201], v[66:67]
    v_cvt_pk_bf16_f32 v185, v66, v67
    v_lshlrev_b32 v20, 16, v171
    v_and_b32 v21, 0xffff0000, v171
    v_pk_fma_f32 v[74:75], v[20:21], v[200:201], v[74:75]
    v_cvt_pk_bf16_f32 v187, v74, v75
    v_permlane16_swap_b32 v184, v186
    s_nop 0
    v_permlane16_swap_b32 v185, v187
    buffer_store_dwordx4 v[184:187], v5, s[36:39], s12 offen offset:0 sc1
    s_waitcnt vmcnt(3)
    v_max3_u32 v22, v172, v173, v174
    v_max_u32 v22, v22, v175
    v_cmp_eq_u32 vcc, -1, v22
    s_cmp_lg_u64 vcc, 0
    s_cbranch_scc1 L_fre1
L_fok1:
    v_lshlrev_b32 v20, 16, v172
    v_and_b32 v21, 0xffff0000, v172
    v_pk_fma_f32 v[68:69], v[20:21], v[202:203], v[68:69]
    v_cvt_pk_bf16_f32 v188, v68, v69
    v_lshlrev_b32 v20, 16, v174
    v_and_b32 v21, 0xffff0000, v174
    v_pk_fma_f32 v[76:77], v[20:21], v[202:203], v[76:77]
    v_cvt_pk_bf16_f32 v190, v76, v77
    v_lshlrev_b32 v20, 16, v173
    v_and_b32 v21, 0xffff0000, v173
    v_pk_fma_f32 v[70:71], v[20:21], v[202:203], v[70:71]
    v_cvt_pk_bf16_f32 v189, v70, v71
    v_lshlrev_b32 v20, 16, v175
    v_and_b32 v21, 0xffff0000, v175
    v_pk_fma_f32 v[78:79], v[20:21], v[202:203], v[78:79]
    v_cvt_pk_bf16_f32 v191, v78, v79
    v_permlane16_swap_b32 v188, v190
    s_nop 0
    v_permlane16_swap_b32 v189, v191
    buffer_store_dwordx4 v[188:191], v5, s[36:39], s13 offen offset:0 sc1
    s_waitcnt vmcnt(3)
    v_max3_u32 v22, v176, v177, v178
    v_max_u32 v22, v22, v179
    v_cmp_eq_u32 vcc, -1, v22
    s_cmp_lg_u64 vcc, 0
    s_cbranch_scc1 L_fre2
L_fok2:
    v_lshlrev_b32 v20, 16, v176
    v_and_b32 v21, 0xffff0000, v176
    v_pk_fma_f32 v[80:81], v[20:21], v[200:201], v[80:81]
    v_cvt_pk_bf16_f32 v192, v80, v81
    v_lshlrev_b32 v20, 16, v178
    v_and_b32 v21, 0xffff0000, v178
    v_pk_fma_f32 v[88:89], v[20:21], v[200:201], v[88:89]
    v_cvt_pk_bf16_f32 v194, v88, v89
    v_lshlrev_b32 v20, 16, v177
    v_and_b32 v21, 0xffff0000, v177
    v_pk_fma_f32 v[82:83], v[20:21], v[200:201], v[82:83]
    v_cvt_pk_bf16_f32 v193, v82, v83
    v_lshlrev_b32 v20, 16, v179
    v_and_b32 v21, 0xffff0000, v179
    v_pk_fma_f32 v[90:91], v[20:21], v[200:201], v[90:91]
    v_cvt_pk_bf16_f32 v195, v90, v91
    v_permlane16_swap_b32 v192, v194
    s_nop 0
    v_permlane16_swap_b32 v193, v195
    buffer_store_dwordx4 v[192:195], v5, s[36:39], s12 offen offset:64 sc1
    s_waitcnt vmcnt(3)
    v_max3_u32 v22, v180, v181, v182
    v_max_u32 v22, v22, v183
    v_cmp_eq_u32 vcc, -1, v22
    s_cmp_lg_u64 vcc, 0
    s_cbranch_scc1 L_fre3
L_fok3:
    v_lshlrev_b32 v20, 16, v180
    v_and_b32 v21, 0xffff0000, v180
    v_pk_fma_f32 v[84:85], v[20:21], v[202:203], v[84:85]
    v_cvt_pk_bf16_f32 v196, v84, v85
    v_lshlrev_b32 v20, 16, v182
    v_and_b32 v21, 0xffff0000, v182
    v_pk_fma_f32 v[92:93], v[20:21], v[202:203], v[92:93]
    v_cvt_pk_bf16_f32 v198, v92, v93
    v_lshlrev_b32 v20, 16, v181
    v_and_b32 v21, 0xffff0000, v181
    v_pk_fma_f32 v[86:87], v[20:21], v[202:203], v[86:87]
    v_cvt_pk_bf16_f32 v197, v86, v87
    v_lshlrev_b32 v20, 16, v183
    v_and_b32 v21, 0xffff0000, v183
    v_pk_fma_f32 v[94:95], v[20:21], v[202:203], v[94:95]
    v_cvt_pk_bf16_f32 v199, v94, v95
    v_permlane16_swap_b32 v196, v198
    s_nop 0
    v_permlane16_swap_b32 v197, v199
    buffer_store_dwordx4 v[196:199], v5, s[36:39], s13 offen offset:64 sc1
L_end:
    s_endpgm
L_probe:
    s_mov_b32 s3, 0
    s_mov_b64 exec, vcc
L_probe2:
    buffer_load_dword v19, v28, s[8:11], s26 offen sc1
    s_add_u32 s3, s3, 1
    s_waitcnt vmcnt(0)
    v_cmp_eq_u32 vcc, -1, v19
    s_and_b64 exec, exec, vcc
    s_cbranch_scc0 L_probe3
    s_cmp_lt_u32 s3, 200
    s_cbranch_scc1 L_probe2
    s_mov_b64 exec, -1
L_strict:
    s_waitcnt vmcnt(0) lgkmcnt(0)
    s_mov_b64 s[12:13], 0
    v_accvgpr_read_b32 v28, a204
    s_mov_b32 s3, 0
L_poll_12:
    buffer_load_dword v29, v28, s[8:11], s87 offen sc1
    s_add_u32 s3, s3, 1
    s_waitcnt vmcnt(0)
    v_cmp_gt_u32 vcc, s86, v29
    s_and_b64 exec, exec, vcc
    s_cbranch_scc0 L_pexit_14
    s_cmp_lt_u32 s3, 400000
    s_cbranch_scc1 L_poll_12
L_pexit_14:
    s_mov_b64 exec, -1
L_pdone_13:
L_probe3:
    s_mov_b64 exec, -1
    s_branch L_g1go
L_slow_15:
    s_mov_b32 s3, 0
L_poll_17:
    buffer_load_dword v29, v28, s[8:11], s87 offen sc1
    s_add_u32 s3, s3, 1
    s_waitcnt vmcnt(0)
    v_cmp_gt_u32 vcc, s86, v29
    s_and_b64 exec, exec, vcc
    s_cbranch_scc0 L_pexit_19
    s_cmp_lt_u32 s3, 400000
    s_cbranch_scc1 L_poll_17
L_pexit_19:
    s_mov_b64 exec, -1
L_pdone_18:
    s_branch L_back_16
L_slow_20:
    s_cmp_lg_u32 s4, 0
    s_cbranch_scc1 L_pdone_23
    s_mov_b32 s3, 0
L_poll_22:
    buffer_load_dword v29, v28, s[8:11], s87 offen sc1
    s_add_u32 s3, s3, 1
    s_waitcnt vmcnt(0)
    v_cmp_gt_u32 vcc, s86, v29
    s_and_b64 exec, exec, vcc
    s_cbranch_scc0 L_pexit_24
    s_cmp_lt_u32 s3, 400000
    s_cbranch_scc1 L_poll_22
L_pexit_24:
    s_mov_b64 exec, -1
L_pdone_23:
    s_branch L_back_21
L_slow_30:
    s_cmp_lg_u32 s4, 0
    s_cbranch_scc1 L_pdone_33
    s_mov_b32 s3, 0
L_poll_32:
    buffer_load_dword v29, v28, s[8:11], s87 offen sc1
    s_add_u32 s3, s3, 1
    s_waitcnt vmcnt(0)
    v_cmp_gt_u32 vcc, s86, v29
    s_and_b64 exec, exec, vcc
    s_cbranch_scc0 L_pexit_34
    s_cmp_lt_u32 s3, 400000
    s_cbranch_scc1 L_poll_32
L_pexit_34:
    s_mov_b64 exec, -1
L_pdone_33:
    s_branch L_back_31
L_fre0:
    s_mov_b32 s3, 0
L_frl0:
    buffer_load_dwordx4 v[168:171], v1, s[8:11], s27 offen offset:0 sc1
    buffer_load_dwordx4 v[172:175], v1, s[8:11], s27 offen offset:1024 sc1
    buffer_load_dwordx4 v[176:179], v1, s[8:11], s27 offen offset:2048 sc1
    buffer_load_dwordx4 v[180:183], v1, s[8:11], s27 offen offset:3072 sc1
    s_add_u32 s3, s3, 1
    s_waitcnt vmcnt(0)
    v_max3_u32 v22, v168, v169, v170
    v_max_u32 v22, v22, v171
    v_cmp_eq_u32 vcc, -1, v22
    s_cmp_lg_u64 vcc, 0
    s_cbranch_scc0 L_fok0
    s_cmp_lt_u32 s3, 400000
    s_cbranch_scc1 L_frl0
    s_branch L_fok0
L_fre1:
    s_mov_b32 s3, 0
L_frl1:
    buffer_load_dwordx4 v[172:175], v1, s[8:11], s27 offen offset:1024 sc1
    buffer_load_dwordx4 v[176:179], v1, s[8:11], s27 offen offset:2048 sc1
    buffer_load_dwordx4 v[180:183], v1, s[8:11], s27 offen offset:3072 sc1
    s_add_u32 s3, s3, 1
    s_waitcnt vmcnt(0)
    v_max3_u32 v22, v172, v173, v174
    v_max_u32 v22, v22, v175
    v_cmp_eq_u32 vcc, -1, v22
    s_cmp_lg_u64 vcc, 0
    s_cbranch_scc0 L_fok1
    s_cmp_lt_u32 s3, 400000
    s_cbranch_scc1 L_frl1
    s_branch L_fok1
L_fre2:
    s_mov_b32 s3, 0
L_frl2:
    buffer_load_dwordx4 v[176:179], v1, s[8:11], s27 offen offset:2048 sc1
    buffer_load_dwordx4 v[180:183], v1, s[8:11], s27 offen offset:3072 sc1
    s_add_u32 s3, s3, 1
    s_waitcnt vmcnt(0)
    v_max3_u32 v22, v176, v177, v178
    v_max_u32 v22, v22, v179
    v_cmp_eq_u32 vcc, -1, v22
    s_cmp_lg_u64 vcc, 0
    s_cbranch_scc0 L_fok2
    s_cmp_lt_u32 s3, 400000
    s_cbranch_scc1 L_frl2
    s_branch L_fok2
L_fre3:
    s_mov_b32 s3, 0
L_frl3:
    buffer_load_dwordx4 v[180:183], v1, s[8:11], s27 offen offset:3072 sc1
    s_add_u32 s3, s3, 1
    s_waitcnt vmcnt(0)
    v_max3_u32 v22, v180, v181, v182
    v_max_u32 v22, v22, v183
    v_cmp_eq_u32 vcc, -1, v22
    s_cmp_lg_u64 vcc, 0
    s_cbranch_scc0 L_fok3
    s_cmp_lt_u32 s3, 400000
    s_cbranch_scc1 L_frl3
    s_branch L_fok3

.section .rodata,"a"
.p2align 6
.amdhsa_kernel interleave_layers__ssm_conv_h3__glu_gated_bilinear__prompt_kernel
  .amdhsa_next_free_vgpr 512
  .amdhsa_next_free_sgpr 102
  .amdhsa_accum_offset 256
  .amdhsa_group_segment_fixed_size 0
  .amdhsa_kernarg_size 104
  .amdhsa_user_sgpr_count 2
  .amdhsa_user_sgpr_kernarg_segment_ptr 1
  .amdhsa_system_sgpr_workgroup_id_x 1
.end_amdhsa_kernel
```
